```python
import torch

def _softmax(x, axis=-1):
    return torch.softmax(x, dim=axis)
def _gelu(x):
    return torch.nn.functional.gelu(x, approximate="tanh")
def _silu(x):
    return torch.nn.functional.silu(x)
def _sigmoid(x):
    return torch.sigmoid(x)
def _layernorm(x, axis=-1, eps=1e-5):
    m = x.mean(dim=axis, keepdim=True)
    v = x.var(dim=axis, keepdim=True, unbiased=False)
    return (x - m) / torch.sqrt(v + eps)
def _scatter_add(tgt, idx, src, axis=0):
    return tgt.clone().index_add_(axis, idx, src)
def _segment_sum(src, seg, n):
    out = torch.zeros((n,) + src.shape[1:], dtype=src.dtype)
    return out.index_add_(0, seg, src)
def _pad(x, pw):
    flat = tuple(v for pair in reversed(pw) for v in pair)
    return torch.nn.functional.pad(x, flat)

kernel_name = 'concat_heads__mha_block_cached__gqa_block_cached__near_ridge'

def setup_inputs():

    _w = (lambda a: (lambda t: t.to(torch.bfloat16) if t.is_floating_point() else t)(torch.as_tensor(a)))
    def _A_setup():
        B, Sq, D = 16, 144, 640
        H, Sk, Dh = 32, 512, 192
        return {
            "x": _w((lambda *s: torch.randn(*s, dtype=torch.bfloat16) * 0.8)(B, Sq, D)),
            "k_cache": _w((lambda *s: torch.randn(*s, dtype=torch.bfloat16) * 0.8)(B, H, Sk, Dh)),
            "v_cache": _w((lambda *s: torch.randn(*s, dtype=torch.bfloat16) * 0.05)(B, H, Sk, Dh)),
            "wq": _w((lambda *s: torch.randn(*s, dtype=torch.bfloat16) * 0.8)(D, H * Dh) * (D ** -0.5)),
            "wo": _w((lambda *s: torch.randn(*s, dtype=torch.bfloat16) * 0.05)(H * Dh, D) * ((H * Dh) ** -0.5)),
        }
    _A_in = _A_setup()

    def _B_setup():
        B, Sq, D = 16, 144, 640
        Hq, Hkv, Sk, Dh = 32, 32, 512, 192
        assert Hq % Hkv == 0, (Hq, Hkv)
        return {
            "x": _w((lambda *s: torch.randn(*s, dtype=torch.bfloat16) * 0.8)(B, Sq, D)),
            "k_cache": _w((lambda *s: torch.randn(*s, dtype=torch.bfloat16) * 0.8)(B, Hkv, Sk, Dh)),
            "v_cache": _w((lambda *s: torch.randn(*s, dtype=torch.bfloat16) * 0.05)(B, Hkv, Sk, Dh)),
            "wq": _w((lambda *s: torch.randn(*s, dtype=torch.bfloat16) * 0.8)(D, Hq * Dh) * (D ** -0.5)),
            "wo": _w((lambda *s: torch.randn(*s, dtype=torch.bfloat16) * 0.05)(Hq * Dh, D) * ((Hq * Dh) ** -0.5)),
        }
    _B_in = _B_setup()

    return {
        "A_x": _A_in["x"],
        "A_k_cache": _A_in["k_cache"],
        "A_v_cache": _A_in["v_cache"],
        "A_wq": _A_in["wq"],
        "A_wo": _A_in["wo"],
        "B_x": _B_in["x"],
        "B_k_cache": _B_in["k_cache"],
        "B_v_cache": _B_in["v_cache"],
        "B_wq": _B_in["wq"],
        "B_wo": _B_in["wo"],
    }

def reference(A_x, A_k_cache, A_v_cache, A_wq, A_wo, B_x, B_k_cache, B_v_cache, B_wq, B_wo):
    def _A_ref(x, k_cache, v_cache, wq, wo):
        B, Sq, D = x.shape
        H, Dh = 32, 192
        q = (lambda x, *d: x.permute(*d))((x @ wq).reshape(B, Sq, H, Dh), 0, 2, 1, 3)
        scores = torch.einsum("bhqd,bhkd->bhqk", q, k_cache) * (Dh ** -0.5)
        p = _softmax(scores, axis=-1)
        o = torch.einsum("bhqk,bhkd->bhqd", p, v_cache)
        return (lambda x, *d: x.permute(*d))(o, 0, 2, 1, 3).reshape(B, Sq, H * Dh) @ wo

    def _B_ref(x, k_cache, v_cache, wq, wo):
        B, Sq, D = x.shape
        Hq, Dh = 32, 192
        Hkv = k_cache.shape[1]
        rep = Hq // Hkv
        q = (lambda x, *d: x.permute(*d))((x @ wq).reshape(B, Sq, Hq, Dh), 0, 2, 1, 3)
        k = (lambda x, n, axis: torch.repeat_interleave(x, n, dim=axis))(k_cache, rep, axis=1)
        v = (lambda x, n, axis: torch.repeat_interleave(x, n, dim=axis))(v_cache, rep, axis=1)
        scores = torch.einsum("bhqd,bhkd->bhqk", q, k) * (Dh ** -0.5)
        p = _softmax(scores, axis=-1)
        o = torch.einsum("bhqk,bhkd->bhqd", p, v)
        return (lambda x, *d: x.permute(*d))(o, 0, 2, 1, 3).reshape(B, Sq, Hq * Dh) @ wo

    a = _A_ref(A_x, A_k_cache, A_v_cache, A_wq, A_wo)
    b = _B_ref(B_x, B_k_cache, B_v_cache, B_wq, B_wo)
    return torch.concatenate([a, b], axis=-1)
```

```asm
; @launch grid=(256,1,1) block=(256,1,1) lds=163840
.amdgcn_target "amdgcn-amd-amdhsa--gfx950"
.text
.globl concat_heads__mha_block_cached__gqa_block_cached__near_ridge_kernel
.p2align 8
.type concat_heads__mha_block_cached__gqa_block_cached__near_ridge_kernel,@function
concat_heads__mha_block_cached__gqa_block_cached__near_ridge_kernel:
    s_cmp_ge_u32 s2, 256
    s_cbranch_scc1 K_end
    s_load_dwordx8 s[52:59], s[0:1], 0
    s_load_dwordx2 s[60:61], s[0:1], 32
    s_load_dwordx8 s[4:11], s[0:1], 40
    s_load_dwordx2 s[12:13], s[0:1], 72
    s_load_dwordx2 s[62:63], s[0:1], 80
    s_load_dwordx4 s[64:67], s[0:1], 88
    v_lshrrev_b32 v1, 6, v0
    s_nop 0
    v_readfirstlane_b32 s24, v1
    s_getpc_b64 s[14:15]
K_pc:
    s_lshr_b32 s36, s2, 3
    s_lshl_b32 s36, s36, 2
    s_add_u32 s36, s36, s24
    s_and_b32 s36, s36, 15
    s_lshl_b32 s36, s36, 13
    v_and_b32 v12, 63, v0
    v_lshlrev_b32 v12, 7, v12
    v_add_u32 v12, s36, v12
    v_min_u32 v12, K_end-K_pc, v12
    global_load_dword v255, v12, s[14:15]
    s_lshr_b32 s36, s2, 7
    s_bfe_u32 s70, s2, 0x40003
    s_and_b32 s71, s2, 7
    s_lshl_b32 s71, s71, 1
    s_add_u32 s71, s71, s36
    s_bfe_u32 s100, s2, 0x20001
    s_lshl_b32 s100, s100, 2
    s_lshr_b32 s36, s2, 6
    s_add_u32 s100, s100, s36
    s_and_b32 s69, s2, 1
    s_lshl_b32 s69, s69, 3
    s_bfe_u32 s37, s2, 0x30003
    s_add_u32 s69, s69, s37
    s_and_b32 s38, s71, 7
    s_lshl_b32 s38, s38, 4
    s_add_u32 s38, s38, s70
    s_lshl_b32 s38, s38, 2
    s_add_u32 s38, s38, s24
    s_mul_i32 s3, s38, 1280
    s_lshr_b32 s2, s2, 3
    s_lshr_b32 s25, s24, 1
    s_and_b32 s26, s24, 1
    s_mov_b32 s68, 0
    s_lshl_b32 s73, s100, 3
    s_waitcnt lgkmcnt(0)
    s_mul_i32 s36, s2, 52
    s_lshr_b32 s36, s36, 8
    s_lshl_b32 s36, s36, 1
    s_add_u32 s36, s36, s26
    s_min_u32 s36, s36, 11
    s_mul_i32 s37, s36, 43
    s_lshr_b32 s37, s37, 7
    s_and_b32 s0, s71, 12
    s_add_u32 s0, s0, s37
    s_mul_i32 s37, s37, 3
    s_sub_u32 s1, s36, s37
    s_cmp_lt_u32 s71, 8
    s_cselect_b64 s[52:53], s[52:53], s[4:5]
    s_cselect_b64 s[54:55], s[54:55], s[6:7]
    s_cselect_b64 s[56:57], s[56:57], s[8:9]
    s_cselect_b64 s[58:59], s[58:59], s[10:11]
    s_cselect_b64 s[60:61], s[60:61], s[12:13]
    s_and_b32 s36, s100, 7
    s_mul_i32 s36, s36, 368640
    s_add_u32 s76, s52, s36
    s_addc_u32 s77, s53, 0
    s_mov_b32 s78, 0
    s_mov_b32 s79, 0x00020000
    s_mul_i32 s36, s25, 184320
    s_add_u32 s4, s76, s36
    s_addc_u32 s5, s77, 0
    s_mov_b32 s6, 184320
    s_mov_b32 s7, 0x00020000
    s_lshl_b32 s36, s68, 4
    s_add_u32 s36, s36, s69
    s_mul_i32 s36, s36, 384
    s_add_u32 s8, s58, s36
    s_addc_u32 s9, s59, 0
    s_sub_u32 s10, 7864320, s36
    s_mov_b32 s11, 0x00020000
    s_mul_i32 s49, s24, 98304
    s_and_b32 s36, s100, 3
    s_mul_i32 s36, s36, 4
    s_and_b32 s37, s69, 7
    s_mul_i32 s37, s37, 2
    s_add_u32 s36, s36, s37
    s_lshr_b32 s36, s36, 2
    s_cmp_ge_u32 s36, 10
    s_cselect_b32 s37, 10, 0
    s_sub_u32 s36, s36, s37
    s_lshl_b32 s28, s36, 7
    s_mul_i32 s29, s36, 786432
    s_add_u32 s29, s29, s49
    s_cmp_eq_u32 s25, 0
    s_mul_i32 s40, s24, 10240
    s_add_u32 s40, s40, 86016
    s_mul_i32 s41, s24, 3072
    s_add_u32 s41, s41, 36864
    s_mov_b32 s50, s41
    v_and_b32 v0, 63, v0
    v_lshrrev_b32 v1, 3, v0
    v_and_b32 v2, 7, v0
    v_and_b32 v3, 6, v1
    v_xor_b32 v3, v2, v3
    v_lshlrev_b32 v3, 4, v3
    v_mul_u32_u24 v223, 1280, v1
    v_add_u32 v223, v223, v3
    s_lshl_b32 s36, s26, 2
    v_xor_b32 v3, s36, v2
    v_lshlrev_b32 v3, 4, v3
    v_mul_u32_u24 v224, 12288, v1
    v_add_u32 v224, v224, v3
    s_mul_i32 s36, s100, 192
    s_mul_i32 s37, s69, 6
    s_add_u32 s36, s36, s37
    s_mul_i32 s36, s36, 18432
    s_add_u32 s20, s66, s36
    s_addc_u32 s21, s67, 0
    s_mov_b32 s22, 0
    s_mov_b32 s23, 0x00020000
    s_cmp_eq_u32 s26, 1
    s_cbranch_scc1 K_fresh1
    s_add_u32 m0, s50, 0
    s_nop 0
    buffer_load_dwordx4 v224, s[8:11], s29 offen lds
    s_add_u32 m0, s50, 896
    s_nop 0
    buffer_load_dwordx4 v224, s[8:11], s29 offen offset:128 lds
    s_add_u32 m0, s50, 1792
    s_nop 0
    buffer_load_dwordx4 v224, s[8:11], s29 offen offset:256 lds
    s_add_u32 s29, s29, 393216
    s_add_u32 s50, s50, 12288
    s_cmp_ge_u32 s50, 86016
    s_cselect_b32 s50, s41, s50
    s_add_u32 s38, s28, 0
    s_add_u32 m0, s40, 0
    s_nop 0
    buffer_load_dwordx4 v223, s[4:7], s38 offen lds
    s_add_u32 s38, s28, 10240
    s_add_u32 m0, s40, 1024
    s_nop 0
    buffer_load_dwordx4 v223, s[4:7], s38 offen lds
    s_add_u32 s38, s28, 20480
    s_add_u32 m0, s40, 2048
    s_nop 0
    buffer_load_dwordx4 v223, s[4:7], s38 offen lds
    s_add_u32 s38, s28, 30720
    s_add_u32 m0, s40, 3072
    s_nop 0
    buffer_load_dwordx4 v223, s[4:7], s38 offen lds
    s_add_u32 s38, s28, 40960
    s_add_u32 m0, s40, 4096
    s_nop 0
    buffer_load_dwordx4 v223, s[4:7], s38 offen lds
    s_add_u32 s38, s28, 51200
    s_add_u32 m0, s40, 5120
    s_nop 0
    buffer_load_dwordx4 v223, s[4:7], s38 offen lds
    s_add_u32 s38, s28, 61440
    s_add_u32 m0, s40, 6144
    s_nop 0
    buffer_load_dwordx4 v223, s[4:7], s38 offen lds
    s_add_u32 s38, s28, 71680
    s_add_u32 m0, s40, 7168
    s_nop 0
    buffer_load_dwordx4 v223, s[4:7], s38 offen lds
    s_add_u32 s38, s28, 163840
    s_add_u32 m0, s40, 8192
    s_nop 0
    buffer_load_dwordx4 v223, s[4:7], s38 offen lds
    s_add_u32 s38, s28, 174080
    s_add_u32 m0, s40, 9216
    s_nop 0
    buffer_load_dwordx4 v223, s[4:7], s38 offen lds
    s_add_u32 s28, s28, 128
    s_cmp_ge_u32 s28, 1280
    s_cselect_b32 s28, 0, s28
    s_add_u32 s76, s66, 75497472
    s_addc_u32 s77, s67, 0
    s_mov_b32 s78, 131072
    s_lshr_b32 s36, s71, 1
    s_lshl_b32 s36, s36, 5
    s_add_u32 s36, s36, s2
    s_lshl_b32 s36, s36, 2
    s_add_u32 s36, s36, s24
    s_lshl_b32 s36, s36, 7
    v_mov_b32 v254, 0
    buffer_store_dword v254, v254, s[76:79], s36 offen sc1
    buffer_store_dword v0, v0, s[20:23], 0 offen
    buffer_store_dword v0, v0, s[20:23], 0 offen
    buffer_store_dword v0, v0, s[20:23], 0 offen
    buffer_store_dword v0, v0, s[20:23], 0 offen
    buffer_store_dword v0, v0, s[20:23], 0 offen
    buffer_store_dword v0, v0, s[20:23], 0 offen
    buffer_store_dword v0, v0, s[20:23], 0 offen
    buffer_store_dword v0, v0, s[20:23], 0 offen
    buffer_store_dword v0, v0, s[20:23], 0 offen
    buffer_store_dword v0, v0, s[20:23], 0 offen
    buffer_store_dword v0, v0, s[20:23], 0 offen
    buffer_store_dword v0, v0, s[20:23], 0 offen
    buffer_store_dword v0, v0, s[20:23], 0 offen
    buffer_store_dword v0, v0, s[20:23], 0 offen
    buffer_store_dword v0, v0, s[20:23], 0 offen
    buffer_store_dword v0, v0, s[20:23], 0 offen
    buffer_store_dword v0, v0, s[20:23], 0 offen
    buffer_store_dword v0, v0, s[20:23], 0 offen
    buffer_store_dword v0, v0, s[20:23], 0 offen
    buffer_store_dword v0, v0, s[20:23], 0 offen
    buffer_store_dword v0, v0, s[20:23], 0 offen
    buffer_store_dword v0, v0, s[20:23], 0 offen
    buffer_store_dword v0, v0, s[20:23], 0 offen
    buffer_store_dword v0, v0, s[20:23], 0 offen
K_q0:
    s_lshl_b32 s37, s68, 4
    s_add_u32 s37, s37, s69
    s_and_b32 s36, s100, 7
    s_lshl_b32 s36, s36, 1
    s_add_u32 s36, s36, s25
    s_lshl_b32 s36, s36, 5
    s_add_u32 s36, s36, s37
    s_mul_i32 s36, s36, 196608
    s_add_u32 s12, s54, s36
    s_addc_u32 s13, s55, 0
    s_mov_b32 s15, 0x00020000
    s_add_u32 s16, s56, s36
    s_addc_u32 s17, s57, 0
    s_mov_b32 s19, 0x00020000
    s_mov_b32 s14, 196608
    s_mov_b32 s18, s14
    s_mul_i32 s45, s25, 9216
    s_lshl_b32 s36, s26, 12
    s_add_u32 s44, s45, s36
    s_add_u32 s45, s45, 8192
    s_xor_b32 s75, s68, 1
    s_mul_i32 s30, s26, 6144
    s_mov_b32 s31, s30
    s_cmp_eq_u32 s25, 0
    s_cselect_b32 s38, 0, 151552
    s_mov_b32 s35, -12288
    s_cselect_b32 s35, 12288, s35
    s_lshl_b32 s37, s35, 1
    s_add_u32 s34, s38, s30
    s_add_u32 s32, s34, s37
    s_add_u32 s33, s32, s37
    s_lshl_b32 s47, s24, 13
    s_xor_b32 s48, s47, 0x2000
    s_mul_i32 s36, s25, 6144
    s_add_u32 s36, s36, 73728
    v_mbcnt_lo_u32_b32 v120, -1, 0
    v_mbcnt_hi_u32_b32 v120, -1, v120
    v_lshlrev_b32 v248, 4, v120
    v_add_u32 v229, s36, v248
    v_add_u32 v251, 49152, v248
    v_add_u32 v249, s47, v251
    v_add_u32 v250, s48, v251
    v_lshrrev_b32 v121, 3, v120
    v_and_b32 v122, 7, v120
    v_and_b32 v123, 6, v121
    v_xor_b32 v123, v122, v123
    v_lshlrev_b32 v123, 4, v123
    v_mul_u32_u24 v216, 384, v121
    v_add_u32 v216, v216, v123
    v_and_b32 v121, 15, v120
    v_lshrrev_b32 v122, 4, v120
    v_and_b32 v123, 7, v121
    v_and_b32 v124, 6, v121
    v_xor_b32 v124, v122, v124
    v_lshl_add_u32 v124, v123, 3, v124
    v_lshlrev_b32 v124, 4, v124
    v_xor_b32 v125, 64, v124
    v_lshrrev_b32 v126, 3, v121
    v_mul_u32_u24 v127, 3072, v126
    v_add_u32 v127, s38, v127
    v_add_u32 v217, v127, v124
    v_add_u32 v218, v127, v125
    v_lshlrev_b32 v127, 10, v126
    v_add_u32 v128, s40, v127
    v_add_u32 v225, v128, v124
    v_add_u32 v226, v128, v125
    v_bfe_u32 v123, v120, 2, 2
    v_and_b32 v124, 3, v120
    v_and_b32 v125, 1, v122
    v_lshl_add_u32 v126, v125, 2, v123
    v_and_b32 v127, 6, v126
    v_lshrrev_b32 v128, 1, v124
    v_xor_b32 v127, v127, v128
    v_lshl_add_u32 v127, v126, 3, v127
    v_lshlrev_b32 v127, 4, v127
    v_and_b32 v128, 1, v124
    v_lshl_add_u32 v127, v128, 3, v127
    v_lshrrev_b32 v128, 1, v122
    v_mul_u32_u24 v128, 3072, v128
    s_add_u32 s36, s38, s35
    v_add_u32 v128, s36, v128
    v_xor_b32 v129, 0, v127
    v_add_u32 v219, v128, v129
    v_xor_b32 v129, 32, v127
    v_add_u32 v220, v128, v129
    v_xor_b32 v129, 64, v127
    v_add_u32 v221, v128, v129
    v_xor_b32 v129, 96, v127
    v_add_u32 v222, v128, v129
    v_lshlrev_b32 v127, 2, v125
    v_xor_b32 v127, v127, v124
    v_lshl_add_u32 v127, v123, 3, v127
    v_lshlrev_b32 v127, 4, v127
    v_mul_u32_u24 v128, 3072, v122
    v_add_u32 v128, 36864, v128
    v_add_u32 v227, v128, v127
    v_xor_b32 v127, 64, v127
    v_add_u32 v228, v128, v127
    s_mov_b32 s51, 0
    s_mov_b32 s46, -36864
    s_mov_b32 s42, 0x3dd53b95
    s_mul_i32 s36, s100, 0
    s_mul_i32 s37, s69, 0
    s_add_u32 s36, s36, s37
    s_mul_i32 s37, s25, 0
    s_add_u32 s36, s36, s37
    s_and_b32 s37, s36, 15
    s_mul_i32 s37, s37, 12288
    s_add_u32 s48, s30, s37
    s_add_u32 s36, s36, s68
    s_and_b32 s37, s36, 15
    s_mul_i32 s37, s37, 12288
    s_add_u32 s31, s31, s37
    s_add_u32 s36, s36, s68
    s_and_b32 s37, s36, 15
    s_mul_i32 s37, s37, 12288
    s_add_u32 s30, s30, s37
    s_mov_b32 s76, s60
    s_mov_b32 s77, s61
    s_mul_i32 s78, s68, 7864320
    v_min_u32 v253, 9, v120
    v_lshlrev_b32 v253, 7, v253
    v_mov_b32 v235, 0xff7fffff
    v_mov_b32 v236, 0xff7fffff
    v_mov_b32 v237, 0xff7fffff
    v_mov_b32 v238, 0xff7fffff
    v_mov_b32 v239, 0xff7fffff
    s_mov_b32 s72, 0x4e800000
    s_add_u32 m0, s50, 0
    s_barrier
    buffer_load_dwordx4 v224, s[8:11], s29 offen lds
    s_waitcnt vmcnt(26)
    ds_read_b128 a[0:3], v225 offset:0
    s_barrier
    ds_read_b128 a[20:23], v226 offset:0
    ds_read_b64_tr_b16 a[240:241], v227 offset:0
    s_add_u32 m0, s50, 896
    ds_read_b64_tr_b16 a[242:243], v227 offset:512
    buffer_load_dwordx4 v224, s[8:11], s29 offen offset:128 lds
    ds_read_b128 a[4:7], v225 offset:2048
    ds_read_b128 a[8:11], v225 offset:4096
    ds_read_b128 a[24:27], v226 offset:2048
    s_add_u32 m0, s50, 1792
    s_add_u32 s50, s50, 12288
    buffer_load_dwordx4 v224, s[8:11], s29 offen offset:256 lds
    ds_read_b128 a[12:15], v225 offset:6144
    s_cmp_ge_u32 s50, 86016
    s_cselect_b32 s50, s41, s50
    ds_read_b128 a[16:19], v225 offset:8192
    s_add_u32 s29, s29, 393216
    s_add_u32 m0, s50, 0
    s_cmp_ge_u32 s29, 7864320
    s_cselect_b32 s29, s49, s29
    buffer_load_dwordx4 v224, s[8:11], s29 offen lds
    ds_read_b64_tr_b16 a[244:245], v227 offset:8
    ds_read_b64_tr_b16 a[246:247], v227 offset:520
    s_add_u32 m0, s50, 896
    ds_read_b128 a[28:31], v226 offset:4096
    buffer_load_dwordx4 v224, s[8:11], s29 offen offset:128 lds
    s_add_u32 m0, s50, 1792
    ds_read_b128 a[32:35], v226 offset:6144
    buffer_load_dwordx4 v224, s[8:11], s29 offen offset:256 lds
    s_add_u32 m0, s40, 0
    s_add_u32 s38, s28, 0
    ds_read_b64_tr_b16 a[248:249], v228 offset:0
    s_waitcnt lgkmcnt(12)
    buffer_load_dwordx4 v223, s[4:7], s38 offen lds
    ds_read_b64_tr_b16 a[250:251], v228 offset:512
    s_waitcnt lgkmcnt(11)
    v_mfma_f32_16x16x32_bf16 v[0:3], a[240:243], a[0:3], 0
    s_waitcnt lgkmcnt(10)
    s_add_u32 m0, s40, 1024
    s_add_u32 s38, s28, 10240
    v_mfma_f32_16x16x32_bf16 v[48:51], a[240:243], a[4:7], 0
    s_waitcnt lgkmcnt(9)
    buffer_load_dwordx4 v223, s[4:7], s38 offen lds
    v_mfma_f32_16x16x32_bf16 v[96:99], a[240:243], a[8:11], 0
    s_waitcnt lgkmcnt(7)
    s_add_u32 m0, s40, 2048
    s_add_u32 s38, s28, 20480
    v_mfma_f32_16x16x32_bf16 v[144:147], a[240:243], a[12:15], 0
    s_waitcnt lgkmcnt(6)
    buffer_load_dwordx4 v223, s[4:7], s38 offen lds
    v_mfma_f32_16x16x32_bf16 v[192:195], a[240:243], a[16:19], 0
    s_waitcnt lgkmcnt(4)
    ds_read_b128 a[36:39], v226 offset:8192
    s_add_u32 m0, s40, 3072
    s_add_u32 s38, s28, 30720
    v_mfma_f32_16x16x32_bf16 v[4:7], a[244:247], a[0:3], 0
    s_add_u32 s50, s50, 12288
    buffer_load_dwordx4 v223, s[4:7], s38 offen lds
    v_mfma_f32_16x16x32_bf16 v[52:55], a[244:247], a[4:7], 0
    s_add_u32 m0, s40, 4096
    ds_read_b64_tr_b16 a[252:253], v228 offset:8
    ds_read_b64_tr_b16 a[254:255], v228 offset:520
    v_mfma_f32_16x16x32_bf16 v[100:103], a[244:247], a[8:11], 0
    s_add_u32 s38, s28, 40960
    s_waitcnt lgkmcnt(6)
    buffer_load_dwordx4 v223, s[4:7], s38 offen lds
    v_mfma_f32_16x16x32_bf16 v[148:151], a[244:247], a[12:15], 0
    s_add_u32 m0, s40, 5120
    s_add_u32 s38, s28, 51200
    buffer_load_dwordx4 v223, s[4:7], s38 offen lds
    v_mfma_f32_16x16x32_bf16 v[196:199], a[244:247], a[16:19], 0
    s_waitcnt lgkmcnt(3)
    s_add_u32 m0, s40, 6144
    s_add_u32 s38, s28, 61440
    v_mfma_f32_16x16x32_bf16 v[8:11], a[248:251], a[0:3], 0
    s_add_u32 s29, s29, 393216
    buffer_load_dwordx4 v223, s[4:7], s38 offen lds
    v_mfma_f32_16x16x32_bf16 v[56:59], a[248:251], a[4:7], 0
    s_add_u32 m0, s40, 7168
    ds_read_b64_tr_b16 v[240:241], v227 offset:1024
    ds_read_b64_tr_b16 v[242:243], v227 offset:1536
    v_mfma_f32_16x16x32_bf16 v[104:107], a[248:251], a[8:11], 0
    s_add_u32 s38, s28, 71680
    buffer_load_dwordx4 v223, s[4:7], s38 offen lds
    v_mfma_f32_16x16x32_bf16 v[152:155], a[248:251], a[12:15], 0
    s_add_u32 m0, s40, 8192
    s_add_u32 s38, s28, 163840
    ds_read_b64_tr_b16 v[244:245], v227 offset:1032
    v_mfma_f32_16x16x32_bf16 v[200:203], a[248:251], a[16:19], 0
    s_waitcnt lgkmcnt(3)
    buffer_load_dwordx4 v223, s[4:7], s38 offen lds
    s_add_u32 m0, s40, 9216
    s_add_u32 s38, s28, 174080
    buffer_load_dwordx4 v223, s[4:7], s38 offen lds
    v_mfma_f32_16x16x32_bf16 v[12:15], a[252:255], a[0:3], 0
    s_add_u32 s51, s51, 1
    ds_read_b64_tr_b16 v[246:247], v227 offset:1544
    ds_read_b64_tr_b16 a[240:241], v228 offset:1024
    v_mfma_f32_16x16x32_bf16 v[60:63], a[252:255], a[4:7], 0
    s_add_u32 s28, s28, 128
    ds_read_b64_tr_b16 a[242:243], v228 offset:1536
    ds_read_b64_tr_b16 a[244:245], v228 offset:1032
    v_mfma_f32_16x16x32_bf16 v[108:111], a[252:255], a[8:11], 0
    s_add_u32 s74, s3, 0
    ds_read_b64_tr_b16 a[246:247], v228 offset:1544
    ds_read_b64_tr_b16 a[248:249], v227 offset:2048
    v_mfma_f32_16x16x32_bf16 v[156:159], a[252:255], a[12:15], 0
    ds_read_b64_tr_b16 a[250:251], v227 offset:2560
    v_mfma_f32_16x16x32_bf16 v[204:207], a[252:255], a[16:19], 0
    s_waitcnt lgkmcnt(8)
    s_cmp_ge_u32 s50, 86016
    s_cselect_b32 s50, s41, s50
    v_mfma_f32_16x16x32_bf16 v[16:19], v[240:243], a[0:3], 0
    s_add_u32 m0, s50, 0
    ds_read_b64_tr_b16 a[252:253], v227 offset:2056
    ds_read_b64_tr_b16 a[254:255], v227 offset:2568
    v_mfma_f32_16x16x32_bf16 v[64:67], v[240:243], a[4:7], 0
    s_cmp_eq_u32 s51, 4
    s_cselect_b32 s27, s46, 12288
    v_mfma_f32_16x16x32_bf16 v[112:115], v[240:243], a[8:11], 0
    v_add_u32 v227, s27, v227
    v_mfma_f32_16x16x32_bf16 v[160:163], v[240:243], a[12:15], 0
    s_cmp_ge_u32 s28, 1280
    s_cselect_b32 s28, 0, s28
    v_mfma_f32_16x16x32_bf16 v[208:211], v[240:243], a[16:19], 0
    s_waitcnt lgkmcnt(8)
    s_waitcnt vmcnt(13)
    s_barrier
    v_mfma_f32_16x16x32_bf16 v[20:23], v[244:247], a[0:3], 0
    s_add_u32 s38, s28, 0
    buffer_load_dwordx4 v224, s[8:11], s29 offen lds
    v_mfma_f32_16x16x32_bf16 v[68:71], v[244:247], a[4:7], 0
    s_add_u32 m0, s50, 896
    ds_read_b64_tr_b16 v[240:241], v228 offset:2048
    ds_read_b64_tr_b16 v[242:243], v228 offset:2560
    v_mfma_f32_16x16x32_bf16 v[116:119], v[244:247], a[8:11], 0
    buffer_load_dwordx4 v224, s[8:11], s29 offen offset:128 lds
    v_mfma_f32_16x16x32_bf16 v[164:167], v[244:247], a[12:15], 0
    s_add_u32 m0, s50, 1792
    s_add_u32 s50, s50, 12288
    v_mfma_f32_16x16x32_bf16 v[212:215], v[244:247], a[16:19], 0
    s_waitcnt lgkmcnt(8)
    buffer_load_dwordx4 v224, s[8:11], s29 offen offset:256 lds
    v_mfma_f32_16x16x32_bf16 v[24:27], a[240:243], a[0:3], 0
    s_add_u32 s29, s29, 393216
    ds_read_b64_tr_b16 v[244:245], v228 offset:2056
    ds_read_b64_tr_b16 v[246:247], v228 offset:2568
    v_mfma_f32_16x16x32_bf16 v[72:75], a[240:243], a[4:7], 0
    v_add_u32 v228, s27, v228
    v_mfma_f32_16x16x32_bf16 v[120:123], a[240:243], a[8:11], 0
    s_cmp_ge_u32 s50, 86016
    s_cselect_b32 s50, s41, s50
    v_mfma_f32_16x16x32_bf16 v[168:171], a[240:243], a[12:15], 0
    s_waitcnt lgkmcnt(8)
    ds_read_b64_tr_b16 a[240:241], v227 offset:0
    ds_read_b64_tr_b16 a[242:243], v227 offset:512
    v_mfma_f32_16x16x32_bf16 v[28:31], a[244:247], a[0:3], 0
    s_add_u32 m0, s50, 0
    s_cmp_ge_u32 s29, 7864320
    s_cselect_b32 s29, s49, s29
    v_mfma_f32_16x16x32_bf16 v[76:79], a[244:247], a[4:7], 0
    s_cmp_eq_u32 s51, 4
    s_cselect_b32 s51, 0, s51
    v_mfma_f32_16x16x32_bf16 v[124:127], a[244:247], a[8:11], 0
    s_add_u32 s51, s51, 1
    s_cmp_eq_u32 s51, 4
    s_cselect_b32 s27, s46, 12288
    v_mfma_f32_16x16x32_bf16 v[172:175], a[244:247], a[12:15], 0
    s_waitcnt lgkmcnt(8)
    ds_read_b64_tr_b16 a[244:245], v227 offset:8
    ds_read_b64_tr_b16 a[246:247], v227 offset:520
    v_mfma_f32_16x16x32_bf16 v[32:35], a[248:251], a[0:3], 0
    s_cmp_eq_u32 s51, 4
    s_cselect_b32 s51, 0, s51
    v_mfma_f32_16x16x32_bf16 v[80:83], a[248:251], a[4:7], 0
    s_add_u32 s51, s51, 1
    v_mfma_f32_16x16x32_bf16 v[128:131], a[248:251], a[8:11], 0
    v_mfma_f32_16x16x32_bf16 v[176:179], a[248:251], a[12:15], 0
    s_waitcnt lgkmcnt(8)
    ds_read_b64_tr_b16 a[248:249], v228 offset:0
    ds_read_b64_tr_b16 a[250:251], v228 offset:512
    v_mfma_f32_16x16x32_bf16 v[36:39], a[252:255], a[0:3], 0
    v_mfma_f32_16x16x32_bf16 v[84:87], a[252:255], a[4:7], 0
    v_mfma_f32_16x16x32_bf16 v[132:135], a[252:255], a[8:11], 0
    v_mfma_f32_16x16x32_bf16 v[180:183], a[252:255], a[12:15], 0
    s_waitcnt lgkmcnt(8)
    ds_read_b64_tr_b16 a[252:253], v228 offset:8
    ds_read_b64_tr_b16 a[254:255], v228 offset:520
    v_mfma_f32_16x16x32_bf16 v[40:43], v[240:243], a[0:3], 0
    v_mfma_f32_16x16x32_bf16 v[88:91], v[240:243], a[4:7], 0
    v_mfma_f32_16x16x32_bf16 v[136:139], v[240:243], a[8:11], 0
    v_mfma_f32_16x16x32_bf16 v[184:187], v[240:243], a[12:15], 0
    s_waitcnt lgkmcnt(8)
    ds_read_b64_tr_b16 v[240:241], v227 offset:1024
    ds_read_b64_tr_b16 v[242:243], v227 offset:1536
    v_mfma_f32_16x16x32_bf16 v[44:47], v[244:247], a[0:3], 0
    v_mfma_f32_16x16x32_bf16 v[92:95], v[244:247], a[4:7], 0
    v_mfma_f32_16x16x32_bf16 v[140:143], v[244:247], a[8:11], 0
    v_mfma_f32_16x16x32_bf16 v[188:191], v[244:247], a[12:15], 0
    s_waitcnt lgkmcnt(8)
    ds_read_b64_tr_b16 v[244:245], v227 offset:1032
    ds_read_b64_tr_b16 v[246:247], v227 offset:1544
    v_mfma_f32_16x16x32_bf16 v[0:3], a[240:243], a[20:23], v[0:3]
    v_mfma_f32_16x16x32_bf16 v[48:51], a[240:243], a[24:27], v[48:51]
    v_mfma_f32_16x16x32_bf16 v[96:99], a[240:243], a[28:31], v[96:99]
    s_waitcnt vmcnt(11)
    ds_read_b128 a[40:43], v225 offset:0
    ds_read_b128 a[60:63], v226 offset:0
    v_mfma_f32_16x16x32_bf16 v[144:147], a[240:243], a[32:35], v[144:147]
    v_mfma_f32_16x16x32_bf16 v[192:195], a[240:243], a[36:39], v[192:195]
    s_waitcnt lgkmcnt(10)
    ds_read_b64_tr_b16 a[240:241], v228 offset:1024
    ds_read_b64_tr_b16 a[242:243], v228 offset:1536
    v_mfma_f32_16x16x32_bf16 v[4:7], a[244:247], a[20:23], v[4:7]
    s_waitcnt vmcnt(11)
    s_barrier
    v_mfma_f32_16x16x32_bf16 v[52:55], a[244:247], a[24:27], v[52:55]
    buffer_load_dwordx4 v224, s[8:11], s29 offen lds
    v_mfma_f32_16x16x32_bf16 v[100:103], a[244:247], a[28:31], v[100:103]
    s_add_u32 m0, s50, 896
    v_mfma_f32_16x16x32_bf16 v[148:151], a[244:247], a[32:35], v[148:151]
    buffer_load_dwordx4 v224, s[8:11], s29 offen offset:128 lds
    v_mfma_f32_16x16x32_bf16 v[196:199], a[244:247], a[36:39], v[196:199]
    s_waitcnt lgkmcnt(10)
    s_add_u32 m0, s50, 1792
    ds_read_b64_tr_b16 a[244:245], v228 offset:1032
    v_mfma_f32_16x16x32_bf16 v[8:11], a[248:251], a[20:23], v[8:11]
    s_waitcnt vmcnt(11)
    buffer_load_dwordx4 v224, s[8:11], s29 offen offset:256 lds
    v_mfma_f32_16x16x32_bf16 v[56:59], a[248:251], a[24:27], v[56:59]
    s_add_u32 m0, s40, 0
    ds_read_b128 a[44:47], v225 offset:2048
    ds_read_b128 a[64:67], v226 offset:2048
    v_mfma_f32_16x16x32_bf16 v[104:107], a[248:251], a[28:31], v[104:107]
    s_add_u32 s50, s50, 12288
    s_waitcnt lgkmcnt(5)
    buffer_load_dwordx4 v223, s[4:7], s38 offen lds
    v_mfma_f32_16x16x32_bf16 v[152:155], a[248:251], a[32:35], v[152:155]
    s_add_u32 m0, s40, 1024
    s_add_u32 s38, s28, 10240
    ds_read_b64_tr_b16 a[246:247], v228 offset:1544
    v_mfma_f32_16x16x32_bf16 v[200:203], a[248:251], a[36:39], v[200:203]
    buffer_load_dwordx4 v223, s[4:7], s38 offen lds
    v_mfma_f32_16x16x32_bf16 v[12:15], a[252:255], a[20:23], v[12:15]
    s_add_u32 m0, s40, 2048
    s_add_u32 s38, s28, 20480
    ds_read_b64_tr_b16 a[248:249], v227 offset:2048
    v_mfma_f32_16x16x32_bf16 v[60:63], a[252:255], a[24:27], v[60:63]
    s_add_u32 s29, s29, 393216
    ds_read_b64_tr_b16 a[250:251], v227 offset:2560
    v_mfma_f32_16x16x32_bf16 v[108:111], a[252:255], a[28:31], v[108:111]
    s_cmp_ge_u32 s50, 86016
    s_cselect_b32 s50, s41, s50
    v_mfma_f32_16x16x32_bf16 v[156:159], a[252:255], a[32:35], v[156:159]
    s_waitcnt vmcnt(12)
    ds_read_b128 a[48:51], v225 offset:4096
    ds_read_b128 a[68:71], v226 offset:4096
    v_mfma_f32_16x16x32_bf16 v[204:207], a[252:255], a[36:39], v[204:207]
    ds_read_b64_tr_b16 a[252:253], v227 offset:2056
    ds_read_b64_tr_b16 a[254:255], v227 offset:2568
    v_mfma_f32_16x16x32_bf16 v[16:19], v[240:243], a[20:23], v[16:19]
    v_add_u32 v227, s27, v227
    v_mfma_f32_16x16x32_bf16 v[64:67], v[240:243], a[24:27], v[64:67]
    s_waitcnt lgkmcnt(7)
    buffer_load_dwordx4 v223, s[4:7], s38 offen lds
    v_mfma_f32_16x16x32_bf16 v[112:115], v[240:243], a[28:31], v[112:115]
    s_add_u32 m0, s40, 3072
    s_add_u32 s38, s28, 30720
    v_mfma_f32_16x16x32_bf16 v[160:163], v[240:243], a[32:35], v[160:163]
    buffer_load_dwordx4 v223, s[4:7], s38 offen lds
    v_mfma_f32_16x16x32_bf16 v[208:211], v[240:243], a[36:39], v[208:211]
    s_add_u32 m0, s40, 4096
    s_add_u32 s38, s28, 40960
    v_mfma_f32_16x16x32_bf16 v[20:23], v[244:247], a[20:23], v[20:23]
    ds_read_b64_tr_b16 v[240:241], v228 offset:2048
    ds_read_b64_tr_b16 v[242:243], v228 offset:2560
    v_mfma_f32_16x16x32_bf16 v[68:71], v[244:247], a[24:27], v[68:71]
    s_waitcnt vmcnt(12)
    ds_read_b128 a[52:55], v225 offset:6144
    ds_read_b128 a[72:75], v226 offset:6144
    v_mfma_f32_16x16x32_bf16 v[116:119], v[244:247], a[28:31], v[116:119]
    v_mfma_f32_16x16x32_bf16 v[164:167], v[244:247], a[32:35], v[164:167]
    s_waitcnt lgkmcnt(6)
    buffer_load_dwordx4 v223, s[4:7], s38 offen lds
    v_mfma_f32_16x16x32_bf16 v[212:215], v[244:247], a[36:39], v[212:215]
    s_add_u32 m0, s40, 5120
    s_add_u32 s38, s28, 51200
    v_mfma_f32_16x16x32_bf16 v[24:27], a[240:243], a[20:23], v[24:27]
    buffer_load_dwordx4 v223, s[4:7], s38 offen lds
    v_mfma_f32_16x16x32_bf16 v[72:75], a[240:243], a[24:27], v[72:75]
    s_add_u32 m0, s40, 6144
    s_add_u32 s38, s28, 61440
    ds_read_b64_tr_b16 v[244:245], v228 offset:2056
    v_mfma_f32_16x16x32_bf16 v[120:123], a[240:243], a[28:31], v[120:123]
    ds_read_b64_tr_b16 v[246:247], v228 offset:2568
    v_add_u32 v228, s27, v228
    v_mfma_f32_16x16x32_bf16 v[168:171], a[240:243], a[32:35], v[168:171]
    ds_read_b64_tr_b16 a[240:241], v227 offset:0
    ds_read_b64_tr_b16 a[242:243], v227 offset:512
    v_mfma_f32_16x16x32_bf16 v[28:31], a[244:247], a[20:23], v[28:31]
    s_waitcnt vmcnt(12)
    ds_read_b128 a[56:59], v225 offset:8192
    ds_read_b128 a[76:79], v226 offset:8192
    v_mfma_f32_16x16x32_bf16 v[76:79], a[244:247], a[24:27], v[76:79]
    s_cmp_eq_u32 s51, 4
    s_cselect_b32 s27, s46, 12288
    v_mfma_f32_16x16x32_bf16 v[124:127], a[244:247], a[28:31], v[124:127]
    s_waitcnt lgkmcnt(6)
    buffer_load_dwordx4 v223, s[4:7], s38 offen lds
    v_mfma_f32_16x16x32_bf16 v[172:175], a[244:247], a[32:35], v[172:175]
    s_add_u32 m0, s40, 7168
    s_add_u32 s38, s28, 71680
    v_mfma_f32_16x16x32_bf16 v[32:35], a[248:251], a[20:23], v[32:35]
    buffer_load_dwordx4 v223, s[4:7], s38 offen lds
    v_mfma_f32_16x16x32_bf16 v[80:83], a[248:251], a[24:27], v[80:83]
    s_add_u32 m0, s40, 8192
    s_add_u32 s38, s28, 163840
    ds_read_b64_tr_b16 a[244:245], v227 offset:8
    v_mfma_f32_16x16x32_bf16 v[128:131], a[248:251], a[28:31], v[128:131]
    ds_read_b64_tr_b16 a[246:247], v227 offset:520
    v_mfma_f32_16x16x32_bf16 v[176:179], a[248:251], a[32:35], v[176:179]
    ds_read_b64_tr_b16 a[248:249], v228 offset:0
    ds_read_b64_tr_b16 a[250:251], v228 offset:512
    v_mfma_f32_16x16x32_bf16 v[36:39], a[252:255], a[20:23], v[36:39]
    s_cmp_eq_u32 s51, 4
    s_cselect_b32 s51, 0, s51
    v_mfma_f32_16x16x32_bf16 v[84:87], a[252:255], a[24:27], v[84:87]
    s_add_u32 s51, s51, 1
    v_mfma_f32_16x16x32_bf16 v[132:135], a[252:255], a[28:31], v[132:135]
    s_waitcnt lgkmcnt(4)
    buffer_load_dwordx4 v223, s[4:7], s38 offen lds
    v_mfma_f32_16x16x32_bf16 v[180:183], a[252:255], a[32:35], v[180:183]
    s_add_u32 m0, s40, 9216
    s_add_u32 s38, s28, 174080
    v_mfma_f32_16x16x32_bf16 v[40:43], v[240:243], a[20:23], v[40:43]
    s_add_u32 s28, s28, 128
    buffer_load_dwordx4 v223, s[4:7], s38 offen lds
    v_mfma_f32_16x16x32_bf16 v[88:91], v[240:243], a[24:27], v[88:91]
    s_add_u32 m0, s50, 0
    ds_read_b64_tr_b16 a[252:253], v228 offset:8
    ds_read_b64_tr_b16 a[254:255], v228 offset:520
    v_mfma_f32_16x16x32_bf16 v[136:139], v[240:243], a[28:31], v[136:139]
    s_cmp_ge_u32 s28, 1280
    s_cselect_b32 s28, 0, s28
    v_mfma_f32_16x16x32_bf16 v[184:187], v[240:243], a[32:35], v[184:187]
    ds_read_b64_tr_b16 v[240:241], v227 offset:1024
    ds_read_b64_tr_b16 v[242:243], v227 offset:1536
    v_mfma_f32_16x16x32_bf16 v[44:47], v[244:247], a[20:23], v[44:47]
    s_add_u32 s38, s28, 0
    v_mfma_f32_16x16x32_bf16 v[92:95], v[244:247], a[24:27], v[92:95]
    v_mfma_f32_16x16x32_bf16 v[140:143], v[244:247], a[28:31], v[140:143]
    v_mfma_f32_16x16x32_bf16 v[188:191], v[244:247], a[32:35], v[188:191]
    ds_read_b64_tr_b16 v[244:245], v227 offset:1032
    ds_read_b64_tr_b16 v[246:247], v227 offset:1544
    v_mfma_f32_16x16x32_bf16 v[0:3], a[240:243], a[40:43], v[0:3]
    v_mfma_f32_16x16x32_bf16 v[48:51], a[240:243], a[44:47], v[48:51]
    v_mfma_f32_16x16x32_bf16 v[96:99], a[240:243], a[48:51], v[96:99]
    v_mfma_f32_16x16x32_bf16 v[144:147], a[240:243], a[52:55], v[144:147]
    v_mfma_f32_16x16x32_bf16 v[192:195], a[240:243], a[56:59], v[192:195]
    s_waitcnt lgkmcnt(8)
    ds_read_b64_tr_b16 a[240:241], v228 offset:1024
    ds_read_b64_tr_b16 a[242:243], v228 offset:1536
    v_mfma_f32_16x16x32_bf16 v[4:7], a[244:247], a[40:43], v[4:7]
    s_waitcnt vmcnt(13)
    s_barrier
    v_mfma_f32_16x16x32_bf16 v[52:55], a[244:247], a[44:47], v[52:55]
    buffer_load_dwordx4 v224, s[8:11], s29 offen lds
    v_mfma_f32_16x16x32_bf16 v[100:103], a[244:247], a[48:51], v[100:103]
    s_add_u32 m0, s50, 896
    v_mfma_f32_16x16x32_bf16 v[148:151], a[244:247], a[52:55], v[148:151]
    buffer_load_dwordx4 v224, s[8:11], s29 offen offset:128 lds
    v_mfma_f32_16x16x32_bf16 v[196:199], a[244:247], a[56:59], v[196:199]
    s_waitcnt lgkmcnt(8)
    s_add_u32 m0, s50, 1792
    ds_read_b64_tr_b16 a[244:245], v228 offset:1032
    v_mfma_f32_16x16x32_bf16 v[8:11], a[248:251], a[40:43], v[8:11]
    s_add_u32 s50, s50, 12288
    buffer_load_dwordx4 v224, s[8:11], s29 offen offset:256 lds
    v_mfma_f32_16x16x32_bf16 v[56:59], a[248:251], a[44:47], v[56:59]
    s_add_u32 m0, s40, 0
    ds_read_b64_tr_b16 a[246:247], v228 offset:1544
    s_add_u32 s29, s29, 393216
    v_mfma_f32_16x16x32_bf16 v[104:107], a[248:251], a[48:51], v[104:107]
    s_waitcnt vmcnt(11)
    ds_read_b128 a[0:3], v225 offset:0
    ds_read_b128 a[20:23], v226 offset:0
    v_mfma_f32_16x16x32_bf16 v[152:155], a[248:251], a[52:55], v[152:155]
    s_cmp_ge_u32 s50, 86016
    s_cselect_b32 s50, s41, s50
    v_mfma_f32_16x16x32_bf16 v[200:203], a[248:251], a[56:59], v[200:203]
    s_waitcnt lgkmcnt(10)
    ds_read_b64_tr_b16 a[248:249], v227 offset:2048
    ds_read_b64_tr_b16 a[250:251], v227 offset:2560
    v_mfma_f32_16x16x32_bf16 v[12:15], a[252:255], a[40:43], v[12:15]
    s_cmp_ge_u32 s29, 7864320
    s_cselect_b32 s29, s49, s29
    v_mfma_f32_16x16x32_bf16 v[60:63], a[252:255], a[44:47], v[60:63]
    v_mfma_f32_16x16x32_bf16 v[108:111], a[252:255], a[48:51], v[108:111]
    v_mfma_f32_16x16x32_bf16 v[156:159], a[252:255], a[52:55], v[156:159]
    v_mfma_f32_16x16x32_bf16 v[204:207], a[252:255], a[56:59], v[204:207]
    s_waitcnt lgkmcnt(10)
    ds_read_b64_tr_b16 a[252:253], v227 offset:2056
    ds_read_b64_tr_b16 a[254:255], v227 offset:2568
    v_mfma_f32_16x16x32_bf16 v[16:19], v[240:243], a[40:43], v[16:19]
    v_add_u32 v227, s27, v227
    v_mfma_f32_16x16x32_bf16 v[64:67], v[240:243], a[44:47], v[64:67]
    v_mfma_f32_16x16x32_bf16 v[112:115], v[240:243], a[48:51], v[112:115]
    s_waitcnt lgkmcnt(4)
    buffer_load_dwordx4 v223, s[4:7], s38 offen lds
    v_mfma_f32_16x16x32_bf16 v[160:163], v[240:243], a[52:55], v[160:163]
    s_add_u32 m0, s40, 1024
    s_add_u32 s38, s28, 10240
    v_mfma_f32_16x16x32_bf16 v[208:211], v[240:243], a[56:59], v[208:211]
    buffer_load_dwordx4 v223, s[4:7], s38 offen lds
    v_mfma_f32_16x16x32_bf16 v[20:23], v[244:247], a[40:43], v[20:23]
    s_add_u32 m0, s40, 2048
    buffer_load_dword v255, v253, s[76:79], s74 offen
    v_mfma_f32_16x16x32_bf16 v[68:71], v[244:247], a[44:47], v[68:71]
    s_add_u32 s38, s28, 20480
    ds_read_b64_tr_b16 v[240:241], v228 offset:2048
    ds_read_b64_tr_b16 v[242:243], v228 offset:2560
    v_mfma_f32_16x16x32_bf16 v[116:119], v[244:247], a[48:51], v[116:119]
    s_mov_b32 s76, s64
    s_mov_b32 s77, s65
    s_mov_b32 s78, 256
    v_mfma_f32_16x16x32_bf16 v[164:167], v[244:247], a[52:55], v[164:167]
    v_mfma_f32_16x16x32_bf16 v[212:215], v[244:247], a[56:59], v[212:215]
    ds_read_b64_tr_b16 v[244:245], v228 offset:2056
    ds_read_b64_tr_b16 v[246:247], v228 offset:2568
    v_mfma_f32_16x16x32_bf16 v[24:27], a[240:243], a[40:43], v[24:27]
    s_waitcnt vmcnt(12)
    ds_read_b128 a[4:7], v225 offset:2048
    ds_read_b128 a[24:27], v226 offset:2048
    v_mfma_f32_16x16x32_bf16 v[72:75], a[240:243], a[44:47], v[72:75]
    v_add_u32 v228, s27, v228
    v_mfma_f32_16x16x32_bf16 v[120:123], a[240:243], a[48:51], v[120:123]
    s_cmp_eq_u32 s51, 4
    s_cselect_b32 s27, s46, 12288
    v_mfma_f32_16x16x32_bf16 v[168:171], a[240:243], a[52:55], v[168:171]
    ds_read_b64_tr_b16 a[240:241], v227 offset:0
    ds_read_b64_tr_b16 a[242:243], v227 offset:512
    v_mfma_f32_16x16x32_bf16 v[28:31], a[244:247], a[40:43], v[28:31]
    s_cmp_eq_u32 s51, 4
    s_cselect_b32 s51, 0, s51
    v_mfma_f32_16x16x32_bf16 v[76:79], a[244:247], a[44:47], v[76:79]
    v_mfma_f32_16x16x32_bf16 v[124:127], a[244:247], a[48:51], v[124:127]
    v_mfma_f32_16x16x32_bf16 v[172:175], a[244:247], a[52:55], v[172:175]
    s_waitcnt lgkmcnt(10)
    ds_read_b64_tr_b16 a[244:245], v227 offset:8
    ds_read_b64_tr_b16 a[246:247], v227 offset:520
    v_mfma_f32_16x16x32_bf16 v[32:35], a[248:251], a[40:43], v[32:35]
    v_mfma_f32_16x16x32_bf16 v[80:83], a[248:251], a[44:47], v[80:83]
    v_mfma_f32_16x16x32_bf16 v[128:131], a[248:251], a[48:51], v[128:131]
    s_waitcnt lgkmcnt(4)
    buffer_load_dwordx4 v223, s[4:7], s38 offen lds
    v_mfma_f32_16x16x32_bf16 v[176:179], a[248:251], a[52:55], v[176:179]
    s_add_u32 m0, s40, 3072
    s_add_u32 s38, s28, 30720
    v_mfma_f32_16x16x32_bf16 v[36:39], a[252:255], a[40:43], v[36:39]
    buffer_load_dwordx4 v223, s[4:7], s38 offen lds
    v_mfma_f32_16x16x32_bf16 v[84:87], a[252:255], a[44:47], v[84:87]
    s_add_u32 m0, s40, 4096
    ds_read_b64_tr_b16 a[248:249], v228 offset:0
    ds_read_b64_tr_b16 a[250:251], v228 offset:512
    v_mfma_f32_16x16x32_bf16 v[132:135], a[252:255], a[48:51], v[132:135]
    s_add_u32 s38, s28, 40960
    v_mfma_f32_16x16x32_bf16 v[180:183], a[252:255], a[52:55], v[180:183]
    ds_read_b64_tr_b16 a[252:253], v228 offset:8
    ds_read_b64_tr_b16 a[254:255], v228 offset:520
    v_mfma_f32_16x16x32_bf16 v[40:43], v[240:243], a[40:43], v[40:43]
    v_mfma_f32_16x16x32_bf16 v[88:91], v[240:243], a[44:47], v[88:91]
    v_mfma_f32_16x16x32_bf16 v[136:139], v[240:243], a[48:51], v[136:139]
    s_waitcnt vmcnt(12)
    ds_read_b128 a[8:11], v225 offset:4096
    ds_read_b128 a[28:31], v226 offset:4096
    v_mfma_f32_16x16x32_bf16 v[184:187], v[240:243], a[52:55], v[184:187]
    ds_read_b64_tr_b16 v[240:241], v227 offset:1024
    ds_read_b64_tr_b16 v[242:243], v227 offset:1536
    v_mfma_f32_16x16x32_bf16 v[44:47], v[244:247], a[40:43], v[44:47]
    v_mfma_f32_16x16x32_bf16 v[92:95], v[244:247], a[44:47], v[92:95]
    v_mfma_f32_16x16x32_bf16 v[140:143], v[244:247], a[48:51], v[140:143]
    v_mfma_f32_16x16x32_bf16 v[188:191], v[244:247], a[52:55], v[188:191]
    s_waitcnt lgkmcnt(10)
    ds_read_b64_tr_b16 v[244:245], v227 offset:1032
    ds_read_b64_tr_b16 v[246:247], v227 offset:1544
    v_mfma_f32_16x16x32_bf16 v[0:3], a[240:243], a[60:63], v[0:3]
    v_mfma_f32_16x16x32_bf16 v[48:51], a[240:243], a[64:67], v[48:51]
    v_mfma_f32_16x16x32_bf16 v[96:99], a[240:243], a[68:71], v[96:99]
    v_mfma_f32_16x16x32_bf16 v[144:147], a[240:243], a[72:75], v[144:147]
    v_mfma_f32_16x16x32_bf16 v[192:195], a[240:243], a[76:79], v[192:195]
    s_waitcnt lgkmcnt(10)
    s_waitcnt lgkmcnt(4)
    buffer_load_dwordx4 v223, s[4:7], s38 offen lds
    v_mfma_f32_16x16x32_bf16 v[4:7], a[244:247], a[60:63], v[4:7]
    s_waitcnt vmcnt(13)
    s_barrier
    s_add_u32 m0, s40, 5120
    v_mfma_f32_16x16x32_bf16 v[52:55], a[244:247], a[64:67], v[52:55]
    s_add_u32 s38, s28, 51200
    buffer_load_dwordx4 v223, s[4:7], s38 offen lds
    v_mfma_f32_16x16x32_bf16 v[100:103], a[244:247], a[68:71], v[100:103]
    s_add_u32 m0, s50, 0
    ds_read_b64_tr_b16 a[240:241], v228 offset:1024
    ds_read_b64_tr_b16 a[242:243], v228 offset:1536
    v_mfma_f32_16x16x32_bf16 v[148:151], a[244:247], a[72:75], v[148:151]
    s_add_u32 s38, s28, 61440
    buffer_load_dwordx4 v224, s[8:11], s29 offen lds
    v_mfma_f32_16x16x32_bf16 v[196:199], a[244:247], a[76:79], v[196:199]
    s_add_u32 m0, s50, 896
    ds_read_b64_tr_b16 a[244:245], v228 offset:1032
    v_mfma_f32_16x16x32_bf16 v[8:11], a[248:251], a[60:63], v[8:11]
    buffer_load_dwordx4 v224, s[8:11], s29 offen offset:128 lds
    v_mfma_f32_16x16x32_bf16 v[56:59], a[248:251], a[64:67], v[56:59]
    s_add_u32 m0, s50, 1792
    ds_read_b64_tr_b16 a[246:247], v228 offset:1544
    s_add_u32 s50, s50, 12288
    v_mfma_f32_16x16x32_bf16 v[104:107], a[248:251], a[68:71], v[104:107]
    s_waitcnt vmcnt(14)
    ds_read_b128 a[12:15], v225 offset:6144
    ds_read_b128 a[32:35], v226 offset:6144
    v_mfma_f32_16x16x32_bf16 v[152:155], a[248:251], a[72:75], v[152:155]
    buffer_load_dwordx4 v224, s[8:11], s29 offen offset:256 lds
    v_mfma_f32_16x16x32_bf16 v[200:203], a[248:251], a[76:79], v[200:203]
    s_add_u32 m0, s40, 6144
    ds_read_b64_tr_b16 a[248:249], v227 offset:2048
    v_mfma_f32_16x16x32_bf16 v[12:15], a[252:255], a[60:63], v[12:15]
    s_add_u32 s29, s29, 393216
    ds_read_b64_tr_b16 a[250:251], v227 offset:2560
    v_mfma_f32_16x16x32_bf16 v[60:63], a[252:255], a[64:67], v[60:63]
    s_cmp_ge_u32 s50, 86016
    s_cselect_b32 s50, s41, s50
    v_mfma_f32_16x16x32_bf16 v[108:111], a[252:255], a[68:71], v[108:111]
    v_mfma_f32_16x16x32_bf16 v[156:159], a[252:255], a[72:75], v[156:159]
    v_mfma_f32_16x16x32_bf16 v[204:207], a[252:255], a[76:79], v[204:207]
    s_waitcnt lgkmcnt(10)
    ds_read_b64_tr_b16 a[252:253], v227 offset:2056
    ds_read_b64_tr_b16 a[254:255], v227 offset:2568
    v_mfma_f32_16x16x32_bf16 v[16:19], v[240:243], a[60:63], v[16:19]
    v_add_u32 v227, s27, v227
    v_mfma_f32_16x16x32_bf16 v[64:67], v[240:243], a[64:67], v[64:67]
    v_mfma_f32_16x16x32_bf16 v[112:115], v[240:243], a[68:71], v[112:115]
    s_waitcnt lgkmcnt(4)
    buffer_load_dwordx4 v223, s[4:7], s38 offen lds
    v_mfma_f32_16x16x32_bf16 v[160:163], v[240:243], a[72:75], v[160:163]
    s_add_u32 m0, s40, 7168
    s_add_u32 s38, s28, 71680
    v_mfma_f32_16x16x32_bf16 v[208:211], v[240:243], a[76:79], v[208:211]
    buffer_load_dwordx4 v223, s[4:7], s38 offen lds
    v_mfma_f32_16x16x32_bf16 v[20:23], v[244:247], a[60:63], v[20:23]
    s_add_u32 m0, s40, 8192
    ds_read_b64_tr_b16 v[240:241], v228 offset:2048
    ds_read_b64_tr_b16 v[242:243], v228 offset:2560
    v_mfma_f32_16x16x32_bf16 v[68:71], v[244:247], a[64:67], v[68:71]
    s_add_u32 s38, s28, 163840
    v_mfma_f32_16x16x32_bf16 v[116:119], v[244:247], a[68:71], v[116:119]
    v_mfma_f32_16x16x32_bf16 v[164:167], v[244:247], a[72:75], v[164:167]
    v_mfma_f32_16x16x32_bf16 v[212:215], v[244:247], a[76:79], v[212:215]
    ds_read_b64_tr_b16 v[244:245], v228 offset:2056
    ds_read_b64_tr_b16 v[246:247], v228 offset:2568
    v_mfma_f32_16x16x32_bf16 v[24:27], a[240:243], a[60:63], v[24:27]
    s_waitcnt vmcnt(15)
    ds_read_b128 a[16:19], v225 offset:8192
    ds_read_b128 a[36:39], v226 offset:8192
    v_mfma_f32_16x16x32_bf16 v[72:75], a[240:243], a[64:67], v[72:75]
    v_add_u32 v228, s27, v228
    v_mfma_f32_16x16x32_bf16 v[120:123], a[240:243], a[68:71], v[120:123]
    v_mfma_f32_16x16x32_bf16 v[168:171], a[240:243], a[72:75], v[168:171]
    ds_read_b64_tr_b16 a[240:241], v227 offset:0
    ds_read_b64_tr_b16 a[242:243], v227 offset:512
    v_mfma_f32_16x16x32_bf16 v[28:31], a[244:247], a[60:63], v[28:31]
    v_mfma_f32_16x16x32_bf16 v[76:79], a[244:247], a[64:67], v[76:79]
    v_mfma_f32_16x16x32_bf16 v[124:127], a[244:247], a[68:71], v[124:127]
    v_mfma_f32_16x16x32_bf16 v[172:175], a[244:247], a[72:75], v[172:175]
    s_waitcnt lgkmcnt(10)
    ds_read_b64_tr_b16 a[244:245], v227 offset:8
    ds_read_b64_tr_b16 a[246:247], v227 offset:520
    v_mfma_f32_16x16x32_bf16 v[32:35], a[248:251], a[60:63], v[32:35]
    v_mfma_f32_16x16x32_bf16 v[80:83], a[248:251], a[64:67], v[80:83]
    v_mfma_f32_16x16x32_bf16 v[128:131], a[248:251], a[68:71], v[128:131]
    s_waitcnt lgkmcnt(4)
    buffer_load_dwordx4 v223, s[4:7], s38 offen lds
    v_mfma_f32_16x16x32_bf16 v[176:179], a[248:251], a[72:75], v[176:179]
    s_add_u32 m0, s40, 9216
    s_add_u32 s38, s28, 174080
    v_mfma_f32_16x16x32_bf16 v[36:39], a[252:255], a[60:63], v[36:39]
    s_add_u32 s28, s28, 128
    buffer_load_dwordx4 v223, s[4:7], s38 offen lds
    v_mfma_f32_16x16x32_bf16 v[84:87], a[252:255], a[64:67], v[84:87]
    ds_read_b64_tr_b16 a[248:249], v228 offset:0
    ds_read_b64_tr_b16 a[250:251], v228 offset:512
    v_mfma_f32_16x16x32_bf16 v[132:135], a[252:255], a[68:71], v[132:135]
    s_cmp_ge_u32 s28, 1280
    s_cselect_b32 s28, 0, s28
    v_mfma_f32_16x16x32_bf16 v[180:183], a[252:255], a[72:75], v[180:183]
    ds_read_b64_tr_b16 a[252:253], v228 offset:8
    ds_read_b64_tr_b16 a[254:255], v228 offset:520
    v_mfma_f32_16x16x32_bf16 v[40:43], v[240:243], a[60:63], v[40:43]
    v_mfma_f32_16x16x32_bf16 v[88:91], v[240:243], a[64:67], v[88:91]
    v_mfma_f32_16x16x32_bf16 v[136:139], v[240:243], a[68:71], v[136:139]
    v_mfma_f32_16x16x32_bf16 v[184:187], v[240:243], a[72:75], v[184:187]
    ds_read_b64_tr_b16 v[240:241], v227 offset:1024
    ds_read_b64_tr_b16 v[242:243], v227 offset:1536
    v_mfma_f32_16x16x32_bf16 v[44:47], v[244:247], a[60:63], v[44:47]
    v_mfma_f32_16x16x32_bf16 v[92:95], v[244:247], a[64:67], v[92:95]
    v_mfma_f32_16x16x32_bf16 v[140:143], v[244:247], a[68:71], v[140:143]
    v_mfma_f32_16x16x32_bf16 v[188:191], v[244:247], a[72:75], v[188:191]
    s_waitcnt lgkmcnt(8)
    ds_read_b64_tr_b16 v[244:245], v227 offset:1032
    ds_read_b64_tr_b16 v[246:247], v227 offset:1544
    s_mov_b32 s43, 2
K_ql0:
    s_cmp_lg_u32 s43, 2
    s_cbranch_scc1 K_kvs0_0
    s_cmp_lg_u32 s68, 0
    s_cbranch_scc1 K_kvs0_0
    s_mov_b32 s36, m0
    s_mov_b32 s37, s39
    s_add_u32 m0, s34, 0
    s_nop 0
    buffer_load_dwordx4 v216, s[12:15], s30 offen nt lds
    buffer_load_dwordx4 v216, s[12:15], s30 offen offset:3072 nt lds
    s_add_u32 m0, s34, 896
    s_nop 0
    buffer_load_dwordx4 v216, s[12:15], s30 offen offset:128 nt lds
    buffer_load_dwordx4 v216, s[12:15], s30 offen offset:3200 nt lds
    s_add_u32 m0, s34, 1792
    s_nop 0
    buffer_load_dwordx4 v216, s[12:15], s30 offen offset:256 nt lds
    buffer_load_dwordx4 v216, s[12:15], s30 offen offset:3328 nt lds
    s_add_u32 s30, s30, 12288
    s_cmp_ge_u32 s30, 196608
    s_cselect_b32 s30, 0, s30
    s_mov_b32 m0, s36
    s_mov_b32 s39, s37
K_kvs0_0:
    s_cmp_lg_u32 s43, 1
    s_cbranch_scc1 K_kvs0_1
    s_cmp_lg_u32 s68, 0
    s_cbranch_scc1 K_kvs0_1
    s_mov_b32 s36, m0
    s_mov_b32 s37, s39
    s_add_u32 m0, s32, 0
    s_nop 0
    buffer_load_dwordx4 v216, s[12:15], s30 offen nt lds
    buffer_load_dwordx4 v216, s[12:15], s30 offen offset:3072 nt lds
    s_add_u32 m0, s32, 896
    s_nop 0
    buffer_load_dwordx4 v216, s[12:15], s30 offen offset:128 nt lds
    buffer_load_dwordx4 v216, s[12:15], s30 offen offset:3200 nt lds
    s_add_u32 m0, s32, 1792
    s_nop 0
    buffer_load_dwordx4 v216, s[12:15], s30 offen offset:256 nt lds
    buffer_load_dwordx4 v216, s[12:15], s30 offen offset:3328 nt lds
    s_add_u32 s30, s30, 12288
    s_cmp_ge_u32 s30, 196608
    s_cselect_b32 s30, 0, s30
    s_mov_b32 m0, s36
    s_mov_b32 s39, s37
K_kvs0_1:
    s_cmp_lg_u32 s43, 0
    s_cbranch_scc1 K_kvs0_2
    s_cmp_lg_u32 s68, 0
    s_cbranch_scc1 K_kvs0_2
    s_mov_b32 s36, m0
    s_mov_b32 s37, s39
    s_add_u32 s39, s34, s35
    s_add_u32 m0, s39, 0
    s_nop 0
    buffer_load_dwordx4 v216, s[16:19], s31 offen nt lds
    buffer_load_dwordx4 v216, s[16:19], s31 offen offset:3072 nt lds
    s_add_u32 m0, s39, 896
    s_nop 0
    buffer_load_dwordx4 v216, s[16:19], s31 offen offset:128 nt lds
    buffer_load_dwordx4 v216, s[16:19], s31 offen offset:3200 nt lds
    s_add_u32 m0, s39, 1792
    s_nop 0
    buffer_load_dwordx4 v216, s[16:19], s31 offen offset:256 nt lds
    buffer_load_dwordx4 v216, s[16:19], s31 offen offset:3328 nt lds
    s_add_u32 s31, s31, 12288
    s_cmp_ge_u32 s31, 196608
    s_cselect_b32 s31, 0, s31
    s_mov_b32 m0, s36
    s_mov_b32 s39, s37
K_kvs0_2:
    v_mfma_f32_16x16x32_bf16 v[0:3], a[240:243], a[0:3], v[0:3]
    s_add_u32 m0, s50, 0
    s_add_u32 s38, s28, 0
    s_add_u32 s51, s51, 1
    v_mfma_f32_16x16x32_bf16 v[48:51], a[240:243], a[4:7], v[48:51]
    s_cmp_eq_u32 s51, 4
    s_cselect_b32 s27, s46, 12288
    v_mfma_f32_16x16x32_bf16 v[96:99], a[240:243], a[8:11], v[96:99]
    s_cmp_eq_u32 s51, 4
    s_cselect_b32 s51, 0, s51
    v_mfma_f32_16x16x32_bf16 v[144:147], a[240:243], a[12:15], v[144:147]
    s_add_u32 s51, s51, 1
    v_mfma_f32_16x16x32_bf16 v[192:195], a[240:243], a[16:19], v[192:195]
    s_waitcnt lgkmcnt(8)
    ds_read_b64_tr_b16 a[240:241], v228 offset:1024
    ds_read_b64_tr_b16 a[242:243], v228 offset:1536
    v_mfma_f32_16x16x32_bf16 v[4:7], a[244:247], a[0:3], v[4:7]
    s_waitcnt vmcnt(13)
    s_barrier
    v_mfma_f32_16x16x32_bf16 v[52:55], a[244:247], a[4:7], v[52:55]
    buffer_load_dwordx4 v224, s[8:11], s29 offen lds
    v_mfma_f32_16x16x32_bf16 v[100:103], a[244:247], a[8:11], v[100:103]
    s_add_u32 m0, s50, 896
    v_mfma_f32_16x16x32_bf16 v[148:151], a[244:247], a[12:15], v[148:151]
    buffer_load_dwordx4 v224, s[8:11], s29 offen offset:128 lds
    v_mfma_f32_16x16x32_bf16 v[196:199], a[244:247], a[16:19], v[196:199]
    s_waitcnt lgkmcnt(8)
    s_add_u32 m0, s50, 1792
    ds_read_b64_tr_b16 a[244:245], v228 offset:1032
    v_mfma_f32_16x16x32_bf16 v[8:11], a[248:251], a[0:3], v[8:11]
    s_add_u32 s50, s50, 12288
    buffer_load_dwordx4 v224, s[8:11], s29 offen offset:256 lds
    v_mfma_f32_16x16x32_bf16 v[56:59], a[248:251], a[4:7], v[56:59]
    s_add_u32 m0, s40, 0
    ds_read_b64_tr_b16 a[246:247], v228 offset:1544
    s_add_u32 s29, s29, 393216
    v_mfma_f32_16x16x32_bf16 v[104:107], a[248:251], a[8:11], v[104:107]
    s_waitcnt vmcnt(14)
    ds_read_b128 a[40:43], v225 offset:0
    ds_read_b128 a[60:63], v226 offset:0
    v_mfma_f32_16x16x32_bf16 v[152:155], a[248:251], a[12:15], v[152:155]
    s_cmp_ge_u32 s50, 86016
    s_cselect_b32 s50, s41, s50
    v_mfma_f32_16x16x32_bf16 v[200:203], a[248:251], a[16:19], v[200:203]
    s_waitcnt lgkmcnt(10)
    ds_read_b64_tr_b16 a[248:249], v227 offset:2048
    ds_read_b64_tr_b16 a[250:251], v227 offset:2560
    v_mfma_f32_16x16x32_bf16 v[12:15], a[252:255], a[0:3], v[12:15]
    s_cmp_ge_u32 s29, 7864320
    s_cselect_b32 s29, s49, s29
    v_mfma_f32_16x16x32_bf16 v[60:63], a[252:255], a[4:7], v[60:63]
    v_mfma_f32_16x16x32_bf16 v[108:111], a[252:255], a[8:11], v[108:111]
    v_mfma_f32_16x16x32_bf16 v[156:159], a[252:255], a[12:15], v[156:159]
    v_mfma_f32_16x16x32_bf16 v[204:207], a[252:255], a[16:19], v[204:207]
    s_waitcnt lgkmcnt(10)
    ds_read_b64_tr_b16 a[252:253], v227 offset:2056
    ds_read_b64_tr_b16 a[254:255], v227 offset:2568
    v_mfma_f32_16x16x32_bf16 v[16:19], v[240:243], a[0:3], v[16:19]
    v_add_u32 v227, s27, v227
    v_mfma_f32_16x16x32_bf16 v[64:67], v[240:243], a[4:7], v[64:67]
    v_mfma_f32_16x16x32_bf16 v[112:115], v[240:243], a[8:11], v[112:115]
    s_waitcnt lgkmcnt(4)
    buffer_load_dwordx4 v223, s[4:7], s38 offen lds
    v_mfma_f32_16x16x32_bf16 v[160:163], v[240:243], a[12:15], v[160:163]
    s_add_u32 m0, s40, 1024
    s_add_u32 s38, s28, 10240
    v_mfma_f32_16x16x32_bf16 v[208:211], v[240:243], a[16:19], v[208:211]
    buffer_load_dwordx4 v223, s[4:7], s38 offen lds
    v_mfma_f32_16x16x32_bf16 v[20:23], v[244:247], a[0:3], v[20:23]
    s_add_u32 m0, s40, 2048
    ds_read_b64_tr_b16 v[240:241], v228 offset:2048
    ds_read_b64_tr_b16 v[242:243], v228 offset:2560
    v_mfma_f32_16x16x32_bf16 v[68:71], v[244:247], a[4:7], v[68:71]
    s_add_u32 s38, s28, 20480
    v_mfma_f32_16x16x32_bf16 v[116:119], v[244:247], a[8:11], v[116:119]
    v_mfma_f32_16x16x32_bf16 v[164:167], v[244:247], a[12:15], v[164:167]
    v_mfma_f32_16x16x32_bf16 v[212:215], v[244:247], a[16:19], v[212:215]
    ds_read_b64_tr_b16 v[244:245], v228 offset:2056
    ds_read_b64_tr_b16 v[246:247], v228 offset:2568
    v_mfma_f32_16x16x32_bf16 v[24:27], a[240:243], a[0:3], v[24:27]
    s_waitcnt vmcnt(14)
    ds_read_b128 a[44:47], v225 offset:2048
    ds_read_b128 a[64:67], v226 offset:2048
    v_mfma_f32_16x16x32_bf16 v[72:75], a[240:243], a[4:7], v[72:75]
    v_add_u32 v228, s27, v228
    v_mfma_f32_16x16x32_bf16 v[120:123], a[240:243], a[8:11], v[120:123]
    s_cmp_eq_u32 s51, 4
    s_cselect_b32 s27, s46, 12288
    v_mfma_f32_16x16x32_bf16 v[168:171], a[240:243], a[12:15], v[168:171]
    ds_read_b64_tr_b16 a[240:241], v227 offset:0
    ds_read_b64_tr_b16 a[242:243], v227 offset:512
    v_mfma_f32_16x16x32_bf16 v[28:31], a[244:247], a[0:3], v[28:31]
    s_cmp_eq_u32 s51, 4
    s_cselect_b32 s51, 0, s51
    v_mfma_f32_16x16x32_bf16 v[76:79], a[244:247], a[4:7], v[76:79]
    s_add_u32 s51, s51, 1
    v_mfma_f32_16x16x32_bf16 v[124:127], a[244:247], a[8:11], v[124:127]
    v_mfma_f32_16x16x32_bf16 v[172:175], a[244:247], a[12:15], v[172:175]
    s_waitcnt lgkmcnt(10)
    ds_read_b64_tr_b16 a[244:245], v227 offset:8
    ds_read_b64_tr_b16 a[246:247], v227 offset:520
    v_mfma_f32_16x16x32_bf16 v[32:35], a[248:251], a[0:3], v[32:35]
    v_mfma_f32_16x16x32_bf16 v[80:83], a[248:251], a[4:7], v[80:83]
    v_mfma_f32_16x16x32_bf16 v[128:131], a[248:251], a[8:11], v[128:131]
    s_waitcnt lgkmcnt(4)
    buffer_load_dwordx4 v223, s[4:7], s38 offen lds
    v_mfma_f32_16x16x32_bf16 v[176:179], a[248:251], a[12:15], v[176:179]
    s_add_u32 m0, s40, 3072
    s_add_u32 s38, s28, 30720
    v_mfma_f32_16x16x32_bf16 v[36:39], a[252:255], a[0:3], v[36:39]
    buffer_load_dwordx4 v223, s[4:7], s38 offen lds
    v_mfma_f32_16x16x32_bf16 v[84:87], a[252:255], a[4:7], v[84:87]
    s_add_u32 m0, s40, 4096
    ds_read_b64_tr_b16 a[248:249], v228 offset:0
    ds_read_b64_tr_b16 a[250:251], v228 offset:512
    v_mfma_f32_16x16x32_bf16 v[132:135], a[252:255], a[8:11], v[132:135]
    s_add_u32 s38, s28, 40960
    v_mfma_f32_16x16x32_bf16 v[180:183], a[252:255], a[12:15], v[180:183]
    ds_read_b64_tr_b16 a[252:253], v228 offset:8
    ds_read_b64_tr_b16 a[254:255], v228 offset:520
    v_mfma_f32_16x16x32_bf16 v[40:43], v[240:243], a[0:3], v[40:43]
    v_mfma_f32_16x16x32_bf16 v[88:91], v[240:243], a[4:7], v[88:91]
    v_mfma_f32_16x16x32_bf16 v[136:139], v[240:243], a[8:11], v[136:139]
    s_waitcnt vmcnt(14)
    ds_read_b128 a[48:51], v225 offset:4096
    ds_read_b128 a[68:71], v226 offset:4096
    v_mfma_f32_16x16x32_bf16 v[184:187], v[240:243], a[12:15], v[184:187]
    ds_read_b64_tr_b16 v[240:241], v227 offset:1024
    ds_read_b64_tr_b16 v[242:243], v227 offset:1536
    v_mfma_f32_16x16x32_bf16 v[44:47], v[244:247], a[0:3], v[44:47]
    v_mfma_f32_16x16x32_bf16 v[92:95], v[244:247], a[4:7], v[92:95]
    v_mfma_f32_16x16x32_bf16 v[140:143], v[244:247], a[8:11], v[140:143]
    v_mfma_f32_16x16x32_bf16 v[188:191], v[244:247], a[12:15], v[188:191]
    s_waitcnt lgkmcnt(10)
    ds_read_b64_tr_b16 v[244:245], v227 offset:1032
    ds_read_b64_tr_b16 v[246:247], v227 offset:1544
    v_mfma_f32_16x16x32_bf16 v[0:3], a[240:243], a[20:23], v[0:3]
    v_mfma_f32_16x16x32_bf16 v[48:51], a[240:243], a[24:27], v[48:51]
    v_mfma_f32_16x16x32_bf16 v[96:99], a[240:243], a[28:31], v[96:99]
    v_mfma_f32_16x16x32_bf16 v[144:147], a[240:243], a[32:35], v[144:147]
    v_mfma_f32_16x16x32_bf16 v[192:195], a[240:243], a[36:39], v[192:195]
    s_waitcnt lgkmcnt(10)
    s_waitcnt lgkmcnt(4)
    buffer_load_dwordx4 v223, s[4:7], s38 offen lds
    v_mfma_f32_16x16x32_bf16 v[4:7], a[244:247], a[20:23], v[4:7]
    s_waitcnt vmcnt(12)
    s_barrier
    s_add_u32 m0, s40, 5120
    v_mfma_f32_16x16x32_bf16 v[52:55], a[244:247], a[24:27], v[52:55]
    s_add_u32 s38, s28, 51200
    buffer_load_dwordx4 v223, s[4:7], s38 offen lds
    v_mfma_f32_16x16x32_bf16 v[100:103], a[244:247], a[28:31], v[100:103]
    s_add_u32 m0, s50, 0
    ds_read_b64_tr_b16 a[240:241], v228 offset:1024
    ds_read_b64_tr_b16 a[242:243], v228 offset:1536
    v_mfma_f32_16x16x32_bf16 v[148:151], a[244:247], a[32:35], v[148:151]
    s_add_u32 s38, s28, 61440
    buffer_load_dwordx4 v224, s[8:11], s29 offen lds
    v_mfma_f32_16x16x32_bf16 v[196:199], a[244:247], a[36:39], v[196:199]
    s_add_u32 m0, s50, 896
    ds_read_b64_tr_b16 a[244:245], v228 offset:1032
    v_mfma_f32_16x16x32_bf16 v[8:11], a[248:251], a[20:23], v[8:11]
    buffer_load_dwordx4 v224, s[8:11], s29 offen offset:128 lds
    v_mfma_f32_16x16x32_bf16 v[56:59], a[248:251], a[24:27], v[56:59]
    s_add_u32 m0, s50, 1792
    ds_read_b64_tr_b16 a[246:247], v228 offset:1544
    s_add_u32 s50, s50, 12288
    v_mfma_f32_16x16x32_bf16 v[104:107], a[248:251], a[28:31], v[104:107]
    s_waitcnt vmcnt(13)
    ds_read_b128 a[52:55], v225 offset:6144
    ds_read_b128 a[72:75], v226 offset:6144
    v_mfma_f32_16x16x32_bf16 v[152:155], a[248:251], a[32:35], v[152:155]
    buffer_load_dwordx4 v224, s[8:11], s29 offen offset:256 lds
    v_mfma_f32_16x16x32_bf16 v[200:203], a[248:251], a[36:39], v[200:203]
    s_add_u32 m0, s40, 6144
    ds_read_b64_tr_b16 a[248:249], v227 offset:2048
    v_mfma_f32_16x16x32_bf16 v[12:15], a[252:255], a[20:23], v[12:15]
    s_add_u32 s29, s29, 393216
    ds_read_b64_tr_b16 a[250:251], v227 offset:2560
    v_mfma_f32_16x16x32_bf16 v[60:63], a[252:255], a[24:27], v[60:63]
    s_cmp_ge_u32 s50, 86016
    s_cselect_b32 s50, s41, s50
    v_mfma_f32_16x16x32_bf16 v[108:111], a[252:255], a[28:31], v[108:111]
    v_mfma_f32_16x16x32_bf16 v[156:159], a[252:255], a[32:35], v[156:159]
    v_mfma_f32_16x16x32_bf16 v[204:207], a[252:255], a[36:39], v[204:207]
    s_waitcnt lgkmcnt(10)
    ds_read_b64_tr_b16 a[252:253], v227 offset:2056
    ds_read_b64_tr_b16 a[254:255], v227 offset:2568
    v_mfma_f32_16x16x32_bf16 v[16:19], v[240:243], a[20:23], v[16:19]
    v_add_u32 v227, s27, v227
    v_mfma_f32_16x16x32_bf16 v[64:67], v[240:243], a[24:27], v[64:67]
    v_mfma_f32_16x16x32_bf16 v[112:115], v[240:243], a[28:31], v[112:115]
    s_waitcnt lgkmcnt(4)
    buffer_load_dwordx4 v223, s[4:7], s38 offen lds
    v_mfma_f32_16x16x32_bf16 v[160:163], v[240:243], a[32:35], v[160:163]
    s_add_u32 m0, s40, 7168
    s_add_u32 s38, s28, 71680
    v_mfma_f32_16x16x32_bf16 v[208:211], v[240:243], a[36:39], v[208:211]
    buffer_load_dwordx4 v223, s[4:7], s38 offen lds
    v_mfma_f32_16x16x32_bf16 v[20:23], v[244:247], a[20:23], v[20:23]
    s_add_u32 m0, s40, 8192
    ds_read_b64_tr_b16 v[240:241], v228 offset:2048
    ds_read_b64_tr_b16 v[242:243], v228 offset:2560
    v_mfma_f32_16x16x32_bf16 v[68:71], v[244:247], a[24:27], v[68:71]
    s_add_u32 s38, s28, 163840
    v_mfma_f32_16x16x32_bf16 v[116:119], v[244:247], a[28:31], v[116:119]
    v_mfma_f32_16x16x32_bf16 v[164:167], v[244:247], a[32:35], v[164:167]
    v_mfma_f32_16x16x32_bf16 v[212:215], v[244:247], a[36:39], v[212:215]
    ds_read_b64_tr_b16 v[244:245], v228 offset:2056
    ds_read_b64_tr_b16 v[246:247], v228 offset:2568
    v_mfma_f32_16x16x32_bf16 v[24:27], a[240:243], a[20:23], v[24:27]
    s_waitcnt vmcnt(14)
    ds_read_b128 a[56:59], v225 offset:8192
    ds_read_b128 a[76:79], v226 offset:8192
    v_mfma_f32_16x16x32_bf16 v[72:75], a[240:243], a[24:27], v[72:75]
    v_add_u32 v228, s27, v228
    v_mfma_f32_16x16x32_bf16 v[120:123], a[240:243], a[28:31], v[120:123]
    s_cmp_eq_u32 s51, 4
    s_cselect_b32 s27, s46, 12288
    v_mfma_f32_16x16x32_bf16 v[168:171], a[240:243], a[32:35], v[168:171]
    ds_read_b64_tr_b16 a[240:241], v227 offset:0
    ds_read_b64_tr_b16 a[242:243], v227 offset:512
    v_mfma_f32_16x16x32_bf16 v[28:31], a[244:247], a[20:23], v[28:31]
    s_cmp_eq_u32 s51, 4
    s_cselect_b32 s51, 0, s51
    v_mfma_f32_16x16x32_bf16 v[76:79], a[244:247], a[24:27], v[76:79]
    s_add_u32 s51, s51, 1
    v_mfma_f32_16x16x32_bf16 v[124:127], a[244:247], a[28:31], v[124:127]
    v_mfma_f32_16x16x32_bf16 v[172:175], a[244:247], a[32:35], v[172:175]
    s_waitcnt lgkmcnt(10)
    ds_read_b64_tr_b16 a[244:245], v227 offset:8
    ds_read_b64_tr_b16 a[246:247], v227 offset:520
    v_mfma_f32_16x16x32_bf16 v[32:35], a[248:251], a[20:23], v[32:35]
    v_mfma_f32_16x16x32_bf16 v[80:83], a[248:251], a[24:27], v[80:83]
    v_mfma_f32_16x16x32_bf16 v[128:131], a[248:251], a[28:31], v[128:131]
    s_waitcnt lgkmcnt(4)
    buffer_load_dwordx4 v223, s[4:7], s38 offen lds
    v_mfma_f32_16x16x32_bf16 v[176:179], a[248:251], a[32:35], v[176:179]
    s_add_u32 m0, s40, 9216
    s_add_u32 s38, s28, 174080
    v_mfma_f32_16x16x32_bf16 v[36:39], a[252:255], a[20:23], v[36:39]
    s_add_u32 s28, s28, 128
    buffer_load_dwordx4 v223, s[4:7], s38 offen lds
    v_mfma_f32_16x16x32_bf16 v[84:87], a[252:255], a[24:27], v[84:87]
    s_add_u32 m0, s50, 0
    ds_read_b64_tr_b16 a[248:249], v228 offset:0
    ds_read_b64_tr_b16 a[250:251], v228 offset:512
    v_mfma_f32_16x16x32_bf16 v[132:135], a[252:255], a[28:31], v[132:135]
    s_cmp_ge_u32 s28, 1280
    s_cselect_b32 s28, 0, s28
    v_mfma_f32_16x16x32_bf16 v[180:183], a[252:255], a[32:35], v[180:183]
    ds_read_b64_tr_b16 a[252:253], v228 offset:8
    ds_read_b64_tr_b16 a[254:255], v228 offset:520
    v_mfma_f32_16x16x32_bf16 v[40:43], v[240:243], a[20:23], v[40:43]
    s_add_u32 s38, s28, 0
    v_mfma_f32_16x16x32_bf16 v[88:91], v[240:243], a[24:27], v[88:91]
    v_mfma_f32_16x16x32_bf16 v[136:139], v[240:243], a[28:31], v[136:139]
    v_mfma_f32_16x16x32_bf16 v[184:187], v[240:243], a[32:35], v[184:187]
    ds_read_b64_tr_b16 v[240:241], v227 offset:1024
    ds_read_b64_tr_b16 v[242:243], v227 offset:1536
    v_mfma_f32_16x16x32_bf16 v[44:47], v[244:247], a[20:23], v[44:47]
    v_mfma_f32_16x16x32_bf16 v[92:95], v[244:247], a[24:27], v[92:95]
    v_mfma_f32_16x16x32_bf16 v[140:143], v[244:247], a[28:31], v[140:143]
    v_mfma_f32_16x16x32_bf16 v[188:191], v[244:247], a[32:35], v[188:191]
    s_waitcnt lgkmcnt(8)
    ds_read_b64_tr_b16 v[244:245], v227 offset:1032
    ds_read_b64_tr_b16 v[246:247], v227 offset:1544
    v_mfma_f32_16x16x32_bf16 v[0:3], a[240:243], a[40:43], v[0:3]
    v_mfma_f32_16x16x32_bf16 v[48:51], a[240:243], a[44:47], v[48:51]
    v_mfma_f32_16x16x32_bf16 v[96:99], a[240:243], a[48:51], v[96:99]
    v_mfma_f32_16x16x32_bf16 v[144:147], a[240:243], a[52:55], v[144:147]
    v_mfma_f32_16x16x32_bf16 v[192:195], a[240:243], a[56:59], v[192:195]
    s_waitcnt lgkmcnt(8)
    ds_read_b64_tr_b16 a[240:241], v228 offset:1024
    ds_read_b64_tr_b16 a[242:243], v228 offset:1536
    v_mfma_f32_16x16x32_bf16 v[4:7], a[244:247], a[40:43], v[4:7]
    s_waitcnt vmcnt(13)
    s_barrier
    v_mfma_f32_16x16x32_bf16 v[52:55], a[244:247], a[44:47], v[52:55]
    buffer_load_dwordx4 v224, s[8:11], s29 offen lds
    v_mfma_f32_16x16x32_bf16 v[100:103], a[244:247], a[48:51], v[100:103]
    s_add_u32 m0, s50, 896
    v_mfma_f32_16x16x32_bf16 v[148:151], a[244:247], a[52:55], v[148:151]
    buffer_load_dwordx4 v224, s[8:11], s29 offen offset:128 lds
    v_mfma_f32_16x16x32_bf16 v[196:199], a[244:247], a[56:59], v[196:199]
    s_waitcnt lgkmcnt(8)
    s_add_u32 m0, s50, 1792
    ds_read_b64_tr_b16 a[244:245], v228 offset:1032
    v_mfma_f32_16x16x32_bf16 v[8:11], a[248:251], a[40:43], v[8:11]
    s_add_u32 s50, s50, 12288
    buffer_load_dwordx4 v224, s[8:11], s29 offen offset:256 lds
    v_mfma_f32_16x16x32_bf16 v[56:59], a[248:251], a[44:47], v[56:59]
    s_add_u32 m0, s40, 0
    ds_read_b64_tr_b16 a[246:247], v228 offset:1544
    s_add_u32 s29, s29, 393216
    v_mfma_f32_16x16x32_bf16 v[104:107], a[248:251], a[48:51], v[104:107]
    s_waitcnt vmcnt(14)
    ds_read_b128 a[0:3], v225 offset:0
    ds_read_b128 a[20:23], v226 offset:0
    v_mfma_f32_16x16x32_bf16 v[152:155], a[248:251], a[52:55], v[152:155]
    s_cmp_ge_u32 s50, 86016
    s_cselect_b32 s50, s41, s50
    v_mfma_f32_16x16x32_bf16 v[200:203], a[248:251], a[56:59], v[200:203]
    s_waitcnt lgkmcnt(10)
    ds_read_b64_tr_b16 a[248:249], v227 offset:2048
    ds_read_b64_tr_b16 a[250:251], v227 offset:2560
    v_mfma_f32_16x16x32_bf16 v[12:15], a[252:255], a[40:43], v[12:15]
    s_cmp_ge_u32 s29, 7864320
    s_cselect_b32 s29, s49, s29
    v_mfma_f32_16x16x32_bf16 v[60:63], a[252:255], a[44:47], v[60:63]
    v_mfma_f32_16x16x32_bf16 v[108:111], a[252:255], a[48:51], v[108:111]
    v_mfma_f32_16x16x32_bf16 v[156:159], a[252:255], a[52:55], v[156:159]
    v_mfma_f32_16x16x32_bf16 v[204:207], a[252:255], a[56:59], v[204:207]
    s_waitcnt lgkmcnt(10)
    ds_read_b64_tr_b16 a[252:253], v227 offset:2056
    ds_read_b64_tr_b16 a[254:255], v227 offset:2568
    v_mfma_f32_16x16x32_bf16 v[16:19], v[240:243], a[40:43], v[16:19]
    v_add_u32 v227, s27, v227
    v_mfma_f32_16x16x32_bf16 v[64:67], v[240:243], a[44:47], v[64:67]
    v_mfma_f32_16x16x32_bf16 v[112:115], v[240:243], a[48:51], v[112:115]
    s_waitcnt lgkmcnt(4)
    buffer_load_dwordx4 v223, s[4:7], s38 offen lds
    v_mfma_f32_16x16x32_bf16 v[160:163], v[240:243], a[52:55], v[160:163]
    s_add_u32 m0, s40, 1024
    s_add_u32 s38, s28, 10240
    v_mfma_f32_16x16x32_bf16 v[208:211], v[240:243], a[56:59], v[208:211]
    buffer_load_dwordx4 v223, s[4:7], s38 offen lds
    v_mfma_f32_16x16x32_bf16 v[20:23], v[244:247], a[40:43], v[20:23]
    s_add_u32 m0, s40, 2048
    ds_read_b64_tr_b16 v[240:241], v228 offset:2048
    ds_read_b64_tr_b16 v[242:243], v228 offset:2560
    v_mfma_f32_16x16x32_bf16 v[68:71], v[244:247], a[44:47], v[68:71]
    s_add_u32 s38, s28, 20480
    v_mfma_f32_16x16x32_bf16 v[116:119], v[244:247], a[48:51], v[116:119]
    v_mfma_f32_16x16x32_bf16 v[164:167], v[244:247], a[52:55], v[164:167]
    v_mfma_f32_16x16x32_bf16 v[212:215], v[244:247], a[56:59], v[212:215]
    ds_read_b64_tr_b16 v[244:245], v228 offset:2056
    ds_read_b64_tr_b16 v[246:247], v228 offset:2568
    v_mfma_f32_16x16x32_bf16 v[24:27], a[240:243], a[40:43], v[24:27]
    s_waitcnt vmcnt(14)
    ds_read_b128 a[4:7], v225 offset:2048
    ds_read_b128 a[24:27], v226 offset:2048
    v_mfma_f32_16x16x32_bf16 v[72:75], a[240:243], a[44:47], v[72:75]
    v_add_u32 v228, s27, v228
    v_mfma_f32_16x16x32_bf16 v[120:123], a[240:243], a[48:51], v[120:123]
    s_cmp_eq_u32 s51, 4
    s_cselect_b32 s27, s46, 12288
    v_mfma_f32_16x16x32_bf16 v[168:171], a[240:243], a[52:55], v[168:171]
    ds_read_b64_tr_b16 a[240:241], v227 offset:0
    ds_read_b64_tr_b16 a[242:243], v227 offset:512
    v_mfma_f32_16x16x32_bf16 v[28:31], a[244:247], a[40:43], v[28:31]
    s_cmp_eq_u32 s51, 4
    s_cselect_b32 s51, 0, s51
    v_mfma_f32_16x16x32_bf16 v[76:79], a[244:247], a[44:47], v[76:79]
    v_mfma_f32_16x16x32_bf16 v[124:127], a[244:247], a[48:51], v[124:127]
    v_mfma_f32_16x16x32_bf16 v[172:175], a[244:247], a[52:55], v[172:175]
    s_waitcnt lgkmcnt(10)
    ds_read_b64_tr_b16 a[244:245], v227 offset:8
    ds_read_b64_tr_b16 a[246:247], v227 offset:520
    v_mfma_f32_16x16x32_bf16 v[32:35], a[248:251], a[40:43], v[32:35]
    v_mfma_f32_16x16x32_bf16 v[80:83], a[248:251], a[44:47], v[80:83]
    v_mfma_f32_16x16x32_bf16 v[128:131], a[248:251], a[48:51], v[128:131]
    s_waitcnt lgkmcnt(4)
    buffer_load_dwordx4 v223, s[4:7], s38 offen lds
    v_mfma_f32_16x16x32_bf16 v[176:179], a[248:251], a[52:55], v[176:179]
    s_add_u32 m0, s40, 3072
    s_add_u32 s38, s28, 30720
    v_mfma_f32_16x16x32_bf16 v[36:39], a[252:255], a[40:43], v[36:39]
    buffer_load_dwordx4 v223, s[4:7], s38 offen lds
    v_mfma_f32_16x16x32_bf16 v[84:87], a[252:255], a[44:47], v[84:87]
    s_add_u32 m0, s40, 4096
    ds_read_b64_tr_b16 a[248:249], v228 offset:0
    ds_read_b64_tr_b16 a[250:251], v228 offset:512
    v_mfma_f32_16x16x32_bf16 v[132:135], a[252:255], a[48:51], v[132:135]
    s_add_u32 s38, s28, 40960
    v_mfma_f32_16x16x32_bf16 v[180:183], a[252:255], a[52:55], v[180:183]
    ds_read_b64_tr_b16 a[252:253], v228 offset:8
    ds_read_b64_tr_b16 a[254:255], v228 offset:520
    v_mfma_f32_16x16x32_bf16 v[40:43], v[240:243], a[40:43], v[40:43]
    v_mfma_f32_16x16x32_bf16 v[88:91], v[240:243], a[44:47], v[88:91]
    v_mfma_f32_16x16x32_bf16 v[136:139], v[240:243], a[48:51], v[136:139]
    s_waitcnt vmcnt(14)
    ds_read_b128 a[8:11], v225 offset:4096
    ds_read_b128 a[28:31], v226 offset:4096
    v_mfma_f32_16x16x32_bf16 v[184:187], v[240:243], a[52:55], v[184:187]
    ds_read_b64_tr_b16 v[240:241], v227 offset:1024
    ds_read_b64_tr_b16 v[242:243], v227 offset:1536
    v_mfma_f32_16x16x32_bf16 v[44:47], v[244:247], a[40:43], v[44:47]
    v_mfma_f32_16x16x32_bf16 v[92:95], v[244:247], a[44:47], v[92:95]
    v_mfma_f32_16x16x32_bf16 v[140:143], v[244:247], a[48:51], v[140:143]
    v_mfma_f32_16x16x32_bf16 v[188:191], v[244:247], a[52:55], v[188:191]
    s_waitcnt lgkmcnt(10)
    ds_read_b64_tr_b16 v[244:245], v227 offset:1032
    ds_read_b64_tr_b16 v[246:247], v227 offset:1544
    v_mfma_f32_16x16x32_bf16 v[0:3], a[240:243], a[60:63], v[0:3]
    v_mfma_f32_16x16x32_bf16 v[48:51], a[240:243], a[64:67], v[48:51]
    v_mfma_f32_16x16x32_bf16 v[96:99], a[240:243], a[68:71], v[96:99]
    v_mfma_f32_16x16x32_bf16 v[144:147], a[240:243], a[72:75], v[144:147]
    v_mfma_f32_16x16x32_bf16 v[192:195], a[240:243], a[76:79], v[192:195]
    s_waitcnt lgkmcnt(10)
    s_waitcnt lgkmcnt(4)
    buffer_load_dwordx4 v223, s[4:7], s38 offen lds
    v_mfma_f32_16x16x32_bf16 v[4:7], a[244:247], a[60:63], v[4:7]
    s_waitcnt vmcnt(12)
    s_barrier
    s_add_u32 m0, s40, 5120
    v_mfma_f32_16x16x32_bf16 v[52:55], a[244:247], a[64:67], v[52:55]
    s_add_u32 s38, s28, 51200
    buffer_load_dwordx4 v223, s[4:7], s38 offen lds
    v_mfma_f32_16x16x32_bf16 v[100:103], a[244:247], a[68:71], v[100:103]
    s_add_u32 m0, s50, 0
    ds_read_b64_tr_b16 a[240:241], v228 offset:1024
    ds_read_b64_tr_b16 a[242:243], v228 offset:1536
    v_mfma_f32_16x16x32_bf16 v[148:151], a[244:247], a[72:75], v[148:151]
    s_add_u32 s38, s28, 61440
    buffer_load_dwordx4 v224, s[8:11], s29 offen lds
    v_mfma_f32_16x16x32_bf16 v[196:199], a[244:247], a[76:79], v[196:199]
    s_add_u32 m0, s50, 896
    ds_read_b64_tr_b16 a[244:245], v228 offset:1032
    v_mfma_f32_16x16x32_bf16 v[8:11], a[248:251], a[60:63], v[8:11]
    buffer_load_dwordx4 v224, s[8:11], s29 offen offset:128 lds
    v_mfma_f32_16x16x32_bf16 v[56:59], a[248:251], a[64:67], v[56:59]
    s_add_u32 m0, s50, 1792
    ds_read_b64_tr_b16 a[246:247], v228 offset:1544
    s_add_u32 s50, s50, 12288
    v_mfma_f32_16x16x32_bf16 v[104:107], a[248:251], a[68:71], v[104:107]
    s_waitcnt vmcnt(13)
    ds_read_b128 a[12:15], v225 offset:6144
    ds_read_b128 a[32:35], v226 offset:6144
    v_mfma_f32_16x16x32_bf16 v[152:155], a[248:251], a[72:75], v[152:155]
    buffer_load_dwordx4 v224, s[8:11], s29 offen offset:256 lds
    v_mfma_f32_16x16x32_bf16 v[200:203], a[248:251], a[76:79], v[200:203]
    s_add_u32 m0, s40, 6144
    ds_read_b64_tr_b16 a[248:249], v227 offset:2048
    v_mfma_f32_16x16x32_bf16 v[12:15], a[252:255], a[60:63], v[12:15]
    s_add_u32 s29, s29, 393216
    ds_read_b64_tr_b16 a[250:251], v227 offset:2560
    v_mfma_f32_16x16x32_bf16 v[60:63], a[252:255], a[64:67], v[60:63]
    s_cmp_ge_u32 s50, 86016
    s_cselect_b32 s50, s41, s50
    v_mfma_f32_16x16x32_bf16 v[108:111], a[252:255], a[68:71], v[108:111]
    v_mfma_f32_16x16x32_bf16 v[156:159], a[252:255], a[72:75], v[156:159]
    v_mfma_f32_16x16x32_bf16 v[204:207], a[252:255], a[76:79], v[204:207]
    s_waitcnt lgkmcnt(10)
    ds_read_b64_tr_b16 a[252:253], v227 offset:2056
    ds_read_b64_tr_b16 a[254:255], v227 offset:2568
    v_mfma_f32_16x16x32_bf16 v[16:19], v[240:243], a[60:63], v[16:19]
    v_add_u32 v227, s27, v227
    v_mfma_f32_16x16x32_bf16 v[64:67], v[240:243], a[64:67], v[64:67]
    v_mfma_f32_16x16x32_bf16 v[112:115], v[240:243], a[68:71], v[112:115]
    s_waitcnt lgkmcnt(4)
    buffer_load_dwordx4 v223, s[4:7], s38 offen lds
    v_mfma_f32_16x16x32_bf16 v[160:163], v[240:243], a[72:75], v[160:163]
    s_add_u32 m0, s40, 7168
    s_add_u32 s38, s28, 71680
    v_mfma_f32_16x16x32_bf16 v[208:211], v[240:243], a[76:79], v[208:211]
    buffer_load_dwordx4 v223, s[4:7], s38 offen lds
    v_mfma_f32_16x16x32_bf16 v[20:23], v[244:247], a[60:63], v[20:23]
    s_add_u32 m0, s40, 8192
    ds_read_b64_tr_b16 v[240:241], v228 offset:2048
    ds_read_b64_tr_b16 v[242:243], v228 offset:2560
    v_mfma_f32_16x16x32_bf16 v[68:71], v[244:247], a[64:67], v[68:71]
    s_add_u32 s38, s28, 163840
    v_mfma_f32_16x16x32_bf16 v[116:119], v[244:247], a[68:71], v[116:119]
    v_mfma_f32_16x16x32_bf16 v[164:167], v[244:247], a[72:75], v[164:167]
    v_mfma_f32_16x16x32_bf16 v[212:215], v[244:247], a[76:79], v[212:215]
    ds_read_b64_tr_b16 v[244:245], v228 offset:2056
    ds_read_b64_tr_b16 v[246:247], v228 offset:2568
    v_mfma_f32_16x16x32_bf16 v[24:27], a[240:243], a[60:63], v[24:27]
    s_waitcnt vmcnt(14)
    ds_read_b128 a[16:19], v225 offset:8192
    ds_read_b128 a[36:39], v226 offset:8192
    v_mfma_f32_16x16x32_bf16 v[72:75], a[240:243], a[64:67], v[72:75]
    v_add_u32 v228, s27, v228
    v_mfma_f32_16x16x32_bf16 v[120:123], a[240:243], a[68:71], v[120:123]
    v_mfma_f32_16x16x32_bf16 v[168:171], a[240:243], a[72:75], v[168:171]
    ds_read_b64_tr_b16 a[240:241], v227 offset:0
    ds_read_b64_tr_b16 a[242:243], v227 offset:512
    v_mfma_f32_16x16x32_bf16 v[28:31], a[244:247], a[60:63], v[28:31]
    v_mfma_f32_16x16x32_bf16 v[76:79], a[244:247], a[64:67], v[76:79]
    v_mfma_f32_16x16x32_bf16 v[124:127], a[244:247], a[68:71], v[124:127]
    v_mfma_f32_16x16x32_bf16 v[172:175], a[244:247], a[72:75], v[172:175]
    s_waitcnt lgkmcnt(10)
    ds_read_b64_tr_b16 a[244:245], v227 offset:8
    ds_read_b64_tr_b16 a[246:247], v227 offset:520
    v_mfma_f32_16x16x32_bf16 v[32:35], a[248:251], a[60:63], v[32:35]
    v_mfma_f32_16x16x32_bf16 v[80:83], a[248:251], a[64:67], v[80:83]
    v_mfma_f32_16x16x32_bf16 v[128:131], a[248:251], a[68:71], v[128:131]
    s_waitcnt lgkmcnt(4)
    buffer_load_dwordx4 v223, s[4:7], s38 offen lds
    v_mfma_f32_16x16x32_bf16 v[176:179], a[248:251], a[72:75], v[176:179]
    s_add_u32 m0, s40, 9216
    s_add_u32 s38, s28, 174080
    v_mfma_f32_16x16x32_bf16 v[36:39], a[252:255], a[60:63], v[36:39]
    s_add_u32 s28, s28, 128
    buffer_load_dwordx4 v223, s[4:7], s38 offen lds
    v_mfma_f32_16x16x32_bf16 v[84:87], a[252:255], a[64:67], v[84:87]
    ds_read_b64_tr_b16 a[248:249], v228 offset:0
    ds_read_b64_tr_b16 a[250:251], v228 offset:512
    v_mfma_f32_16x16x32_bf16 v[132:135], a[252:255], a[68:71], v[132:135]
    s_cmp_ge_u32 s28, 1280
    s_cselect_b32 s28, 0, s28
    v_mfma_f32_16x16x32_bf16 v[180:183], a[252:255], a[72:75], v[180:183]
    ds_read_b64_tr_b16 a[252:253], v228 offset:8
    ds_read_b64_tr_b16 a[254:255], v228 offset:520
    v_mfma_f32_16x16x32_bf16 v[40:43], v[240:243], a[60:63], v[40:43]
    v_mfma_f32_16x16x32_bf16 v[88:91], v[240:243], a[64:67], v[88:91]
    v_mfma_f32_16x16x32_bf16 v[136:139], v[240:243], a[68:71], v[136:139]
    v_mfma_f32_16x16x32_bf16 v[184:187], v[240:243], a[72:75], v[184:187]
    ds_read_b64_tr_b16 v[240:241], v227 offset:1024
    ds_read_b64_tr_b16 v[242:243], v227 offset:1536
    v_mfma_f32_16x16x32_bf16 v[44:47], v[244:247], a[60:63], v[44:47]
    v_mfma_f32_16x16x32_bf16 v[92:95], v[244:247], a[64:67], v[92:95]
    v_mfma_f32_16x16x32_bf16 v[140:143], v[244:247], a[68:71], v[140:143]
    v_mfma_f32_16x16x32_bf16 v[188:191], v[244:247], a[72:75], v[188:191]
    s_waitcnt lgkmcnt(8)
    ds_read_b64_tr_b16 v[244:245], v227 offset:1032
    ds_read_b64_tr_b16 v[246:247], v227 offset:1544
    s_sub_u32 s43, s43, 1
    s_cbranch_scc0 K_ql0
    v_mfma_f32_16x16x32_bf16 v[0:3], a[240:243], a[0:3], v[0:3]
    s_add_u32 m0, s50, 0
    s_add_u32 s39, s32, s35
    s_add_u32 s51, s51, 1
    v_mfma_f32_16x16x32_bf16 v[48:51], a[240:243], a[4:7], v[48:51]
    s_cmp_eq_u32 s51, 4
    s_cselect_b32 s27, s46, 12288
    v_mfma_f32_16x16x32_bf16 v[96:99], a[240:243], a[8:11], v[96:99]
    s_cmp_eq_u32 s51, 4
    s_cselect_b32 s51, 0, s51
    v_mfma_f32_16x16x32_bf16 v[144:147], a[240:243], a[12:15], v[144:147]
    s_add_u32 s51, s51, 1
    v_mfma_f32_16x16x32_bf16 v[192:195], a[240:243], a[16:19], v[192:195]
    s_waitcnt lgkmcnt(8)
    ds_read_b64_tr_b16 a[240:241], v228 offset:1024
    ds_read_b64_tr_b16 a[242:243], v228 offset:1536
    v_mfma_f32_16x16x32_bf16 v[4:7], a[244:247], a[0:3], v[4:7]
    s_waitcnt vmcnt(13)
    s_barrier
    v_mfma_f32_16x16x32_bf16 v[52:55], a[244:247], a[4:7], v[52:55]
    buffer_load_dwordx4 v224, s[8:11], s29 offen lds
    v_mfma_f32_16x16x32_bf16 v[100:103], a[244:247], a[8:11], v[100:103]
    s_add_u32 m0, s50, 896
    v_mfma_f32_16x16x32_bf16 v[148:151], a[244:247], a[12:15], v[148:151]
    buffer_load_dwordx4 v224, s[8:11], s29 offen offset:128 lds
    v_mfma_f32_16x16x32_bf16 v[196:199], a[244:247], a[16:19], v[196:199]
    s_waitcnt lgkmcnt(8)
    s_add_u32 m0, s50, 1792
    ds_read_b64_tr_b16 a[244:245], v228 offset:1032
    v_mfma_f32_16x16x32_bf16 v[8:11], a[248:251], a[0:3], v[8:11]
    s_add_u32 s50, s50, 12288
    buffer_load_dwordx4 v224, s[8:11], s29 offen offset:256 lds
    v_mfma_f32_16x16x32_bf16 v[56:59], a[248:251], a[4:7], v[56:59]
    s_cmp_eq_u32 s68, 0
    s_cbranch_scc1 K_s0_0
    s_cmp_lg_u32 s24, 0
    s_cbranch_scc1 K_s0_0
    v_mov_b32 v252, 1
    v_mov_b32 v254, 0
    s_mov_b64 exec, 1
    buffer_atomic_add v252, v254, s[76:79], s73 offen sc1
    s_lshl_b32 s74, 1, s2
    v_mov_b32 v231, s74
    s_lshr_b32 s74, s71, 1
    s_lshl_b32 s74, s74, 2
    buffer_atomic_or v231, v254, s[76:79], s74 offen offset:128 sc1
    s_mov_b64 exec, -1
K_s0_0:
    s_add_u32 m0, s33, 0
    s_mul_i32 s74, s68, 1769472
    ds_read_b64_tr_b16 a[246:247], v228 offset:1544
    v_mfma_f32_16x16x32_bf16 v[104:107], a[248:251], a[8:11], v[104:107]
    s_waitcnt vmcnt(14)
    s_add_u32 s20, s20, s74
    s_addc_u32 s21, s21, 0
    v_mfma_f32_16x16x32_bf16 v[152:155], a[248:251], a[12:15], v[152:155]
    s_mov_b32 s74, 36864
    ds_read_b128 a[40:43], v225 offset:0
    ds_read_b128 a[60:63], v226 offset:0
    v_mfma_f32_16x16x32_bf16 v[200:203], a[248:251], a[16:19], v[200:203]
    s_waitcnt lgkmcnt(10)
    ds_read_b64_tr_b16 a[248:249], v227 offset:2048
    ds_read_b64_tr_b16 a[250:251], v227 offset:2560
    v_mfma_f32_16x16x32_bf16 v[12:15], a[252:255], a[0:3], v[12:15]
    s_mov_b32 s22, 110592
    s_add_u32 s29, s29, 393216
    v_mfma_f32_16x16x32_bf16 v[60:63], a[252:255], a[4:7], v[60:63]
    s_cmp_ge_u32 s29, 7864320
    s_cselect_b32 s29, s49, s29
    v_mfma_f32_16x16x32_bf16 v[108:111], a[252:255], a[8:11], v[108:111]
    s_cmp_ge_u32 s50, 86016
    s_cselect_b32 s50, s41, s50
    v_mfma_f32_16x16x32_bf16 v[156:159], a[252:255], a[12:15], v[156:159]
    v_mfma_f32_16x16x32_bf16 v[204:207], a[252:255], a[16:19], v[204:207]
    s_waitcnt lgkmcnt(10)
    ds_read_b64_tr_b16 a[252:253], v227 offset:2056
    ds_read_b64_tr_b16 a[254:255], v227 offset:2568
    v_mfma_f32_16x16x32_bf16 v[16:19], v[240:243], a[0:3], v[16:19]
    v_add_u32 v227, s27, v227
    v_mfma_f32_16x16x32_bf16 v[64:67], v[240:243], a[4:7], v[64:67]
    v_mfma_f32_16x16x32_bf16 v[112:115], v[240:243], a[8:11], v[112:115]
    v_mfma_f32_16x16x32_bf16 v[160:163], v[240:243], a[12:15], v[160:163]
    v_mfma_f32_16x16x32_bf16 v[208:211], v[240:243], a[16:19], v[208:211]
    s_waitcnt lgkmcnt(10)
    ds_read_b64_tr_b16 v[240:241], v228 offset:2048
    ds_read_b64_tr_b16 v[242:243], v228 offset:2560
    v_mfma_f32_16x16x32_bf16 v[20:23], v[244:247], a[0:3], v[20:23]
    v_mfma_f32_16x16x32_bf16 v[68:71], v[244:247], a[4:7], v[68:71]
    v_mfma_f32_16x16x32_bf16 v[116:119], v[244:247], a[8:11], v[116:119]
    v_mfma_f32_16x16x32_bf16 v[164:167], v[244:247], a[12:15], v[164:167]
    v_mfma_f32_16x16x32_bf16 v[212:215], v[244:247], a[16:19], v[212:215]
    s_waitcnt lgkmcnt(10)
    ds_read_b64_tr_b16 v[244:245], v228 offset:2056
    ds_read_b64_tr_b16 v[246:247], v228 offset:2568
    v_mfma_f32_16x16x32_bf16 v[24:27], a[240:243], a[0:3], v[24:27]
    s_waitcnt vmcnt(12)
    ds_read_b128 a[44:47], v225 offset:2048
    ds_read_b128 a[64:67], v226 offset:2048
    v_mfma_f32_16x16x32_bf16 v[72:75], a[240:243], a[4:7], v[72:75]
    v_add_u32 v228, s27, v228
    v_mfma_f32_16x16x32_bf16 v[120:123], a[240:243], a[8:11], v[120:123]
    s_cmp_eq_u32 s51, 4
    s_cselect_b32 s27, s46, 12288
    v_mfma_f32_16x16x32_bf16 v[168:171], a[240:243], a[12:15], v[168:171]
    s_waitcnt lgkmcnt(12)
    ds_read_b64_tr_b16 a[240:241], v227 offset:0
    ds_read_b64_tr_b16 a[242:243], v227 offset:512
    v_mfma_f32_16x16x32_bf16 v[28:31], a[244:247], a[0:3], v[28:31]
    s_cmp_eq_u32 s51, 4
    s_cselect_b32 s51, 0, s51
    v_mfma_f32_16x16x32_bf16 v[76:79], a[244:247], a[4:7], v[76:79]
    s_add_u32 s51, s51, 1
    v_mfma_f32_16x16x32_bf16 v[124:127], a[244:247], a[8:11], v[124:127]
    buffer_load_dwordx4 a[100:103], v248, s[12:15], s74 offen
    v_mfma_f32_16x16x32_bf16 v[172:175], a[244:247], a[12:15], v[172:175]
    s_waitcnt lgkmcnt(10)
    ds_read_b64_tr_b16 a[244:245], v227 offset:8
    ds_read_b64_tr_b16 a[246:247], v227 offset:520
    v_mfma_f32_16x16x32_bf16 v[32:35], a[248:251], a[0:3], v[32:35]
    v_mfma_f32_16x16x32_bf16 v[80:83], a[248:251], a[4:7], v[80:83]
    v_mfma_f32_16x16x32_bf16 v[128:131], a[248:251], a[8:11], v[128:131]
    buffer_load_dwordx4 a[100:103], v248, s[16:19], s74 offen
    v_mfma_f32_16x16x32_bf16 v[176:179], a[248:251], a[12:15], v[176:179]
    s_waitcnt lgkmcnt(10)
    ds_read_b64_tr_b16 a[248:249], v228 offset:0
    ds_read_b64_tr_b16 a[250:251], v228 offset:512
    v_mfma_f32_16x16x32_bf16 v[36:39], a[252:255], a[0:3], v[36:39]
    v_mfma_f32_16x16x32_bf16 v[84:87], a[252:255], a[4:7], v[84:87]
    v_mfma_f32_16x16x32_bf16 v[132:135], a[252:255], a[8:11], v[132:135]
    buffer_load_dwordx4 a[100:103], v248, s[12:15], s74 offen offset:1024
    v_mfma_f32_16x16x32_bf16 v[180:183], a[252:255], a[12:15], v[180:183]
    s_waitcnt lgkmcnt(10)
    ds_read_b64_tr_b16 a[252:253], v228 offset:8
    ds_read_b64_tr_b16 a[254:255], v228 offset:520
    v_mfma_f32_16x16x32_bf16 v[40:43], v[240:243], a[0:3], v[40:43]
    v_mfma_f32_16x16x32_bf16 v[88:91], v[240:243], a[4:7], v[88:91]
    v_mfma_f32_16x16x32_bf16 v[136:139], v[240:243], a[8:11], v[136:139]
    s_waitcnt vmcnt(13)
    buffer_load_dwordx4 a[100:103], v248, s[16:19], s74 offen offset:1024
    v_mfma_f32_16x16x32_bf16 v[184:187], v[240:243], a[12:15], v[184:187]
    s_waitcnt lgkmcnt(10)
    ds_read_b128 a[48:51], v225 offset:4096
    ds_read_b128 a[68:71], v226 offset:4096
    v_mfma_f32_16x16x32_bf16 v[44:47], v[244:247], a[0:3], v[44:47]
    ds_read_b64_tr_b16 v[240:241], v227 offset:1024
    ds_read_b64_tr_b16 v[242:243], v227 offset:1536
    v_mfma_f32_16x16x32_bf16 v[92:95], v[244:247], a[4:7], v[92:95]
    v_mfma_f32_16x16x32_bf16 v[140:143], v[244:247], a[8:11], v[140:143]
    buffer_load_dwordx4 a[100:103], v248, s[12:15], s74 offen offset:2048
    v_mfma_f32_16x16x32_bf16 v[188:191], v[244:247], a[12:15], v[188:191]
    s_waitcnt lgkmcnt(10)
    ds_read_b64_tr_b16 v[244:245], v227 offset:1032
    ds_read_b64_tr_b16 v[246:247], v227 offset:1544
    v_mfma_f32_16x16x32_bf16 v[0:3], a[240:243], a[20:23], v[0:3]
    v_mfma_f32_16x16x32_bf16 v[48:51], a[240:243], a[24:27], v[48:51]
    v_mfma_f32_16x16x32_bf16 v[96:99], a[240:243], a[28:31], v[96:99]
    buffer_load_dwordx4 a[100:103], v248, s[16:19], s74 offen offset:2048
    v_mfma_f32_16x16x32_bf16 v[144:147], a[240:243], a[32:35], v[144:147]
    v_mfma_f32_16x16x32_bf16 v[192:195], a[240:243], a[36:39], v[192:195]
    s_waitcnt lgkmcnt(10)
    ds_read_b64_tr_b16 a[240:241], v228 offset:1024
    ds_read_b64_tr_b16 a[242:243], v228 offset:1536
    v_mfma_f32_16x16x32_bf16 v[4:7], a[244:247], a[20:23], v[4:7]
    s_waitcnt vmcnt(13)
    s_barrier
    v_mfma_f32_16x16x32_bf16 v[52:55], a[244:247], a[24:27], v[52:55]
    buffer_load_dwordx4 a[100:103], v248, s[12:15], s74 offen offset:3072
    v_mfma_f32_16x16x32_bf16 v[100:103], a[244:247], a[28:31], v[100:103]
    v_mfma_f32_16x16x32_bf16 v[148:151], a[244:247], a[32:35], v[148:151]
    v_mfma_f32_16x16x32_bf16 v[196:199], a[244:247], a[36:39], v[196:199]
    s_waitcnt lgkmcnt(10)
    ds_read_b64_tr_b16 a[244:245], v228 offset:1032
    ds_read_b64_tr_b16 a[246:247], v228 offset:1544
    v_mfma_f32_16x16x32_bf16 v[8:11], a[248:251], a[20:23], v[8:11]
    buffer_load_dwordx4 a[100:103], v248, s[16:19], s74 offen offset:3072
    v_mfma_f32_16x16x32_bf16 v[56:59], a[248:251], a[24:27], v[56:59]
    s_mov_b32 s74, 45056
    v_mfma_f32_16x16x32_bf16 v[104:107], a[248:251], a[28:31], v[104:107]
    s_waitcnt vmcnt(13)
    ds_read_b128 a[52:55], v225 offset:6144
    ds_read_b128 a[72:75], v226 offset:6144
    v_mfma_f32_16x16x32_bf16 v[152:155], a[248:251], a[32:35], v[152:155]
    v_mfma_f32_16x16x32_bf16 v[200:203], a[248:251], a[36:39], v[200:203]
    s_waitcnt lgkmcnt(12)
    buffer_load_dwordx4 a[100:103], v248, s[12:15], s74 offen
    v_mfma_f32_16x16x32_bf16 v[12:15], a[252:255], a[20:23], v[12:15]
    ds_read_b64_tr_b16 a[248:249], v227 offset:2048
    ds_read_b64_tr_b16 a[250:251], v227 offset:2560
    v_mfma_f32_16x16x32_bf16 v[60:63], a[252:255], a[24:27], v[60:63]
    v_mfma_f32_16x16x32_bf16 v[108:111], a[252:255], a[28:31], v[108:111]
    v_mfma_f32_16x16x32_bf16 v[156:159], a[252:255], a[32:35], v[156:159]
    buffer_load_dwordx4 a[100:103], v248, s[16:19], s74 offen
    v_mfma_f32_16x16x32_bf16 v[204:207], a[252:255], a[36:39], v[204:207]
    s_waitcnt lgkmcnt(10)
    ds_read_b64_tr_b16 a[252:253], v227 offset:2056
    ds_read_b64_tr_b16 a[254:255], v227 offset:2568
    v_mfma_f32_16x16x32_bf16 v[16:19], v[240:243], a[20:23], v[16:19]
    v_add_u32 v227, s27, v227
    v_mfma_f32_16x16x32_bf16 v[64:67], v[240:243], a[24:27], v[64:67]
    v_mfma_f32_16x16x32_bf16 v[112:115], v[240:243], a[28:31], v[112:115]
    buffer_load_dwordx4 a[100:103], v248, s[12:15], s74 offen offset:1024
    v_mfma_f32_16x16x32_bf16 v[160:163], v[240:243], a[32:35], v[160:163]
    v_mfma_f32_16x16x32_bf16 v[208:211], v[240:243], a[36:39], v[208:211]
    s_waitcnt lgkmcnt(10)
    ds_read_b64_tr_b16 v[240:241], v228 offset:2048
    ds_read_b64_tr_b16 v[242:243], v228 offset:2560
    v_mfma_f32_16x16x32_bf16 v[20:23], v[244:247], a[20:23], v[20:23]
    v_mfma_f32_16x16x32_bf16 v[68:71], v[244:247], a[24:27], v[68:71]
    buffer_load_dwordx4 a[100:103], v248, s[16:19], s74 offen offset:1024
    v_mfma_f32_16x16x32_bf16 v[116:119], v[244:247], a[28:31], v[116:119]
    v_mfma_f32_16x16x32_bf16 v[164:167], v[244:247], a[32:35], v[164:167]
    v_mfma_f32_16x16x32_bf16 v[212:215], v[244:247], a[36:39], v[212:215]
    s_waitcnt lgkmcnt(10)
    ds_read_b64_tr_b16 v[244:245], v228 offset:2056
    ds_read_b64_tr_b16 v[246:247], v228 offset:2568
    v_mfma_f32_16x16x32_bf16 v[24:27], a[240:243], a[20:23], v[24:27]
    s_waitcnt vmcnt(15)
    buffer_load_dwordx4 a[100:103], v248, s[12:15], s74 offen offset:2048
    v_mfma_f32_16x16x32_bf16 v[72:75], a[240:243], a[24:27], v[72:75]
    ds_read_b128 a[56:59], v225 offset:8192
    ds_read_b128 a[76:79], v226 offset:8192
    v_mfma_f32_16x16x32_bf16 v[120:123], a[240:243], a[28:31], v[120:123]
    v_add_u32 v228, s27, v228
    v_mfma_f32_16x16x32_bf16 v[168:171], a[240:243], a[32:35], v[168:171]
    s_waitcnt lgkmcnt(12)
    ds_read_b64_tr_b16 a[240:241], v227 offset:0
    ds_read_b64_tr_b16 a[242:243], v227 offset:512
    v_mfma_f32_16x16x32_bf16 v[28:31], a[244:247], a[20:23], v[28:31]
    buffer_load_dwordx4 a[100:103], v248, s[16:19], s74 offen offset:2048
    v_mfma_f32_16x16x32_bf16 v[76:79], a[244:247], a[24:27], v[76:79]
    s_cmp_eq_u32 s51, 4
    s_cselect_b32 s27, s46, 12288
    v_mfma_f32_16x16x32_bf16 v[124:127], a[244:247], a[28:31], v[124:127]
    s_mov_b32 s46, s32
    s_cmp_eq_u32 s51, 4
    s_cselect_b32 s51, 0, s51
    v_mfma_f32_16x16x32_bf16 v[172:175], a[244:247], a[32:35], v[172:175]
    s_waitcnt lgkmcnt(10)
    ds_read_b64_tr_b16 a[244:245], v227 offset:8
    ds_read_b64_tr_b16 a[246:247], v227 offset:520
    v_mfma_f32_16x16x32_bf16 v[32:35], a[248:251], a[20:23], v[32:35]
    buffer_load_dwordx4 a[100:103], v248, s[12:15], s74 offen offset:3072
    v_mfma_f32_16x16x32_bf16 v[80:83], a[248:251], a[24:27], v[80:83]
    v_mfma_f32_16x16x32_bf16 v[128:131], a[248:251], a[28:31], v[128:131]
    v_mfma_f32_16x16x32_bf16 v[176:179], a[248:251], a[32:35], v[176:179]
    s_waitcnt lgkmcnt(10)
    ds_read_b64_tr_b16 a[248:249], v228 offset:0
    ds_read_b64_tr_b16 a[250:251], v228 offset:512
    v_mfma_f32_16x16x32_bf16 v[36:39], a[252:255], a[20:23], v[36:39]
    buffer_load_dwordx4 a[100:103], v248, s[16:19], s74 offen offset:3072
    v_mfma_f32_16x16x32_bf16 v[84:87], a[252:255], a[24:27], v[84:87]
    v_mfma_f32_16x16x32_bf16 v[132:135], a[252:255], a[28:31], v[132:135]
    v_mfma_f32_16x16x32_bf16 v[180:183], a[252:255], a[32:35], v[180:183]
    s_waitcnt lgkmcnt(10)
    ds_read_b64_tr_b16 a[252:253], v228 offset:8
    ds_read_b64_tr_b16 a[254:255], v228 offset:520
    v_mfma_f32_16x16x32_bf16 v[40:43], v[240:243], a[20:23], v[40:43]
    v_mfma_f32_16x16x32_bf16 v[88:91], v[240:243], a[24:27], v[88:91]
    v_mfma_f32_16x16x32_bf16 v[136:139], v[240:243], a[28:31], v[136:139]
    v_mfma_f32_16x16x32_bf16 v[184:187], v[240:243], a[32:35], v[184:187]
    s_waitcnt lgkmcnt(10)
    ds_read_b64_tr_b16 v[240:241], v227 offset:1024
    ds_read_b64_tr_b16 v[242:243], v227 offset:1536
    v_mfma_f32_16x16x32_bf16 v[44:47], v[244:247], a[20:23], v[44:47]
    v_mfma_f32_16x16x32_bf16 v[92:95], v[244:247], a[24:27], v[92:95]
    v_mfma_f32_16x16x32_bf16 v[140:143], v[244:247], a[28:31], v[140:143]
    v_mfma_f32_16x16x32_bf16 v[188:191], v[244:247], a[32:35], v[188:191]
    s_waitcnt lgkmcnt(8)
    ds_read_b64_tr_b16 v[244:245], v227 offset:1032
    ds_read_b64_tr_b16 v[246:247], v227 offset:1544
    v_mfma_f32_16x16x32_bf16 v[0:3], a[240:243], a[40:43], v[0:3]
    v_mfma_f32_16x16x32_bf16 v[48:51], a[240:243], a[44:47], v[48:51]
    v_mfma_f32_16x16x32_bf16 v[96:99], a[240:243], a[48:51], v[96:99]
    v_mfma_f32_16x16x32_bf16 v[144:147], a[240:243], a[52:55], v[144:147]
    v_mfma_f32_16x16x32_bf16 v[192:195], a[240:243], a[56:59], v[192:195]
    s_waitcnt lgkmcnt(8)
    ds_read_b64_tr_b16 a[240:241], v228 offset:1024
    ds_read_b64_tr_b16 a[242:243], v228 offset:1536
    v_mfma_f32_16x16x32_bf16 v[4:7], a[244:247], a[40:43], v[4:7]
    s_waitcnt vmcnt(16)
    s_barrier
    v_mfma_f32_16x16x32_bf16 v[52:55], a[244:247], a[44:47], v[52:55]
    buffer_load_dwordx4 v216, s[12:15], s30 offen nt lds
    v_mfma_f32_16x16x32_bf16 v[100:103], a[244:247], a[48:51], v[100:103]
    v_mfma_f32_16x16x32_bf16 v[148:151], a[244:247], a[52:55], v[148:151]
    v_mfma_f32_16x16x32_bf16 v[196:199], a[244:247], a[56:59], v[196:199]
    s_waitcnt lgkmcnt(8)
    ds_read_b64_tr_b16 a[244:245], v228 offset:1032
    ds_read_b64_tr_b16 a[246:247], v228 offset:1544
    v_mfma_f32_16x16x32_bf16 v[8:11], a[248:251], a[40:43], v[8:11]
    v_mfma_f32_16x16x32_bf16 v[56:59], a[248:251], a[44:47], v[56:59]
    v_mfma_f32_16x16x32_bf16 v[104:107], a[248:251], a[48:51], v[104:107]
    buffer_load_dwordx4 v216, s[12:15], s30 offen offset:3072 nt lds
    v_mfma_f32_16x16x32_bf16 v[152:155], a[248:251], a[52:55], v[152:155]
    s_add_u32 m0, s33, 896
    v_mfma_f32_16x16x32_bf16 v[200:203], a[248:251], a[56:59], v[200:203]
    s_waitcnt lgkmcnt(8)
    ds_read_b64_tr_b16 a[248:249], v227 offset:2048
    ds_read_b64_tr_b16 a[250:251], v227 offset:2560
    v_mfma_f32_16x16x32_bf16 v[12:15], a[252:255], a[40:43], v[12:15]
    v_mfma_f32_16x16x32_bf16 v[60:63], a[252:255], a[44:47], v[60:63]
    v_mfma_f32_16x16x32_bf16 v[108:111], a[252:255], a[48:51], v[108:111]
    v_mfma_f32_16x16x32_bf16 v[156:159], a[252:255], a[52:55], v[156:159]
    buffer_load_dwordx4 v216, s[12:15], s30 offen offset:128 nt lds
    v_mfma_f32_16x16x32_bf16 v[204:207], a[252:255], a[56:59], v[204:207]
    s_waitcnt lgkmcnt(8)
    ds_read_b64_tr_b16 a[252:253], v227 offset:2056
    ds_read_b64_tr_b16 a[254:255], v227 offset:2568
    v_mfma_f32_16x16x32_bf16 v[16:19], v[240:243], a[40:43], v[16:19]
    v_add_u32 v227, s27, v227
    v_mfma_f32_16x16x32_bf16 v[64:67], v[240:243], a[44:47], v[64:67]
    v_mfma_f32_16x16x32_bf16 v[112:115], v[240:243], a[48:51], v[112:115]
    v_mfma_f32_16x16x32_bf16 v[160:163], v[240:243], a[52:55], v[160:163]
    v_mfma_f32_16x16x32_bf16 v[208:211], v[240:243], a[56:59], v[208:211]
    s_waitcnt lgkmcnt(8)
    buffer_load_dwordx4 v216, s[12:15], s30 offen offset:3200 nt lds
    v_mfma_f32_16x16x32_bf16 v[20:23], v[244:247], a[40:43], v[20:23]
    s_add_u32 m0, s33, 1792
    ds_read_b64_tr_b16 v[240:241], v228 offset:2048
    ds_read_b64_tr_b16 v[242:243], v228 offset:2560
    v_mfma_f32_16x16x32_bf16 v[68:71], v[244:247], a[44:47], v[68:71]
    v_mfma_f32_16x16x32_bf16 v[116:119], v[244:247], a[48:51], v[116:119]
    v_mfma_f32_16x16x32_bf16 v[164:167], v[244:247], a[52:55], v[164:167]
    v_mfma_f32_16x16x32_bf16 v[212:215], v[244:247], a[56:59], v[212:215]
    s_waitcnt lgkmcnt(8)
    ds_read_b64_tr_b16 v[244:245], v228 offset:2056
    ds_read_b64_tr_b16 v[246:247], v228 offset:2568
    v_mfma_f32_16x16x32_bf16 v[24:27], a[240:243], a[40:43], v[24:27]
    buffer_load_dwordx4 v216, s[12:15], s30 offen offset:256 nt lds
    v_mfma_f32_16x16x32_bf16 v[72:75], a[240:243], a[44:47], v[72:75]
    v_add_u32 v228, s27, v228
    v_mfma_f32_16x16x32_bf16 v[120:123], a[240:243], a[48:51], v[120:123]
    v_mfma_f32_16x16x32_bf16 v[168:171], a[240:243], a[52:55], v[168:171]
    s_waitcnt lgkmcnt(8)
    ds_read_b64_tr_b16 a[240:241], v227 offset:0
    ds_read_b64_tr_b16 a[242:243], v227 offset:512
    v_mfma_f32_16x16x32_bf16 v[28:31], a[244:247], a[40:43], v[28:31]
    v_mfma_f32_16x16x32_bf16 v[76:79], a[244:247], a[44:47], v[76:79]
    v_mfma_f32_16x16x32_bf16 v[124:127], a[244:247], a[48:51], v[124:127]
    buffer_load_dwordx4 v216, s[12:15], s30 offen offset:3328 nt lds
    v_mfma_f32_16x16x32_bf16 v[172:175], a[244:247], a[52:55], v[172:175]
    s_waitcnt lgkmcnt(8)
    s_add_u32 m0, s39, 0
    ds_read_b64_tr_b16 a[244:245], v227 offset:8
    v_mfma_f32_16x16x32_bf16 v[32:35], a[248:251], a[40:43], v[32:35]
    s_add_u32 s30, s30, 12288
    ds_read_b64_tr_b16 a[246:247], v227 offset:520
    v_mfma_f32_16x16x32_bf16 v[80:83], a[248:251], a[44:47], v[80:83]
    s_cmp_ge_u32 s30, 196608
    s_cselect_b32 s30, 0, s30
    v_mfma_f32_16x16x32_bf16 v[128:131], a[248:251], a[48:51], v[128:131]
    v_mfma_f32_16x16x32_bf16 v[176:179], a[248:251], a[52:55], v[176:179]
    s_waitcnt lgkmcnt(8)
    ds_read_b64_tr_b16 a[248:249], v228 offset:0
    ds_read_b64_tr_b16 a[250:251], v228 offset:512
    v_mfma_f32_16x16x32_bf16 v[36:39], a[252:255], a[40:43], v[36:39]
    v_mfma_f32_16x16x32_bf16 v[84:87], a[252:255], a[44:47], v[84:87]
    v_mfma_f32_16x16x32_bf16 v[132:135], a[252:255], a[48:51], v[132:135]
    v_mfma_f32_16x16x32_bf16 v[180:183], a[252:255], a[52:55], v[180:183]
    s_waitcnt lgkmcnt(8)
    buffer_load_dwordx4 v216, s[16:19], s31 offen nt lds
    v_mfma_f32_16x16x32_bf16 v[40:43], v[240:243], a[40:43], v[40:43]
    ds_read_b64_tr_b16 a[252:253], v228 offset:8
    ds_read_b64_tr_b16 a[254:255], v228 offset:520
    v_mfma_f32_16x16x32_bf16 v[88:91], v[240:243], a[44:47], v[88:91]
    v_mfma_f32_16x16x32_bf16 v[136:139], v[240:243], a[48:51], v[136:139]
    v_mfma_f32_16x16x32_bf16 v[184:187], v[240:243], a[52:55], v[184:187]
    s_waitcnt lgkmcnt(8)
    ds_read_b64_tr_b16 v[240:241], v227 offset:1024
    ds_read_b64_tr_b16 v[242:243], v227 offset:1536
    v_mfma_f32_16x16x32_bf16 v[44:47], v[244:247], a[40:43], v[44:47]
    v_mfma_f32_16x16x32_bf16 v[92:95], v[244:247], a[44:47], v[92:95]
    buffer_load_dwordx4 v216, s[16:19], s31 offen offset:3072 nt lds
    v_mfma_f32_16x16x32_bf16 v[140:143], v[244:247], a[48:51], v[140:143]
    s_add_u32 m0, s39, 896
    v_mfma_f32_16x16x32_bf16 v[188:191], v[244:247], a[52:55], v[188:191]
    s_waitcnt lgkmcnt(8)
    ds_read_b64_tr_b16 v[244:245], v227 offset:1032
    ds_read_b64_tr_b16 v[246:247], v227 offset:1544
    v_mfma_f32_16x16x32_bf16 v[0:3], a[240:243], a[60:63], v[0:3]
    v_mfma_f32_16x16x32_bf16 v[48:51], a[240:243], a[64:67], v[48:51]
    v_mfma_f32_16x16x32_bf16 v[96:99], a[240:243], a[68:71], v[96:99]
    v_mfma_f32_16x16x32_bf16 v[144:147], a[240:243], a[72:75], v[144:147]
    v_mul_f32 v0, s42, v0
    v_mul_f32 v1, s42, v1
    v_mfma_f32_16x16x32_bf16 v[192:195], a[240:243], a[76:79], v[192:195]
    s_waitcnt lgkmcnt(8)
    v_mul_f32 v2, s42, v2
    v_mul_f32 v3, s42, v3
    v_mfma_f32_16x16x32_bf16 v[4:7], a[244:247], a[60:63], v[4:7]
    v_cvt_pk_bf16_f32 v0, v0, v1
    v_cvt_pk_bf16_f32 v1, v2, v3
    v_mfma_f32_16x16x32_bf16 v[52:55], a[244:247], a[64:67], v[52:55]
    v_mul_f32 v48, s42, v48
    v_mul_f32 v49, s42, v49
    v_mfma_f32_16x16x32_bf16 v[100:103], a[244:247], a[68:71], v[100:103]
    v_mul_f32 v50, s42, v50
    v_mul_f32 v51, s42, v51
    v_mfma_f32_16x16x32_bf16 v[148:151], a[244:247], a[72:75], v[148:151]
    v_mul_f32 v6, s42, v6
    v_mul_f32 v7, s42, v7
    v_mfma_f32_16x16x32_bf16 v[196:199], a[244:247], a[76:79], v[196:199]
    s_waitcnt lgkmcnt(6)
    buffer_load_dwordx4 v216, s[16:19], s31 offen offset:128 nt lds
    v_mfma_f32_16x16x32_bf16 v[8:11], a[248:251], a[60:63], v[8:11]
    v_cvt_pk_bf16_f32 v3, v6, v7
    v_mul_f32 v98, s42, v98
    v_mfma_f32_16x16x32_bf16 v[56:59], a[248:251], a[64:67], v[56:59]
    v_mul_f32 v99, s42, v99
    v_mul_f32 v100, s42, v100
    v_mfma_f32_16x16x32_bf16 v[104:107], a[248:251], a[68:71], v[104:107]
    v_mul_f32 v101, s42, v101
    v_mul_f32 v196, s42, v196
    v_mfma_f32_16x16x32_bf16 v[152:155], a[248:251], a[72:75], v[152:155]
    v_mul_f32 v197, s42, v197
    v_mul_f32 v52, s42, v52
    v_mfma_f32_16x16x32_bf16 v[200:203], a[248:251], a[76:79], v[200:203]
    s_waitcnt lgkmcnt(4)
    v_mul_f32 v53, s42, v53
    v_mul_f32 v102, s42, v102
    v_mfma_f32_16x16x32_bf16 v[12:15], a[252:255], a[60:63], v[12:15]
    buffer_load_dwordx4 v216, s[16:19], s31 offen offset:3200 nt lds
    v_mfma_f32_16x16x32_bf16 v[60:63], a[252:255], a[64:67], v[60:63]
    s_add_u32 m0, s39, 1792
    v_mul_f32 v103, s42, v103
    v_mul_f32 v104, s42, v104
    v_mfma_f32_16x16x32_bf16 v[108:111], a[252:255], a[68:71], v[108:111]
    s_add_u32 s39, s33, s35
    v_mul_f32 v200, s42, v200
    v_mul_f32 v201, s42, v201
    v_mfma_f32_16x16x32_bf16 v[156:159], a[252:255], a[72:75], v[156:159]
    v_mul_f32 v12, s42, v12
    v_mul_f32 v13, s42, v13
    v_mfma_f32_16x16x32_bf16 v[204:207], a[252:255], a[76:79], v[204:207]
    s_waitcnt lgkmcnt(2)
    v_cvt_pk_bf16_f32 v6, v12, v13
    v_mul_f32 v105, s42, v105
    v_mfma_f32_16x16x32_bf16 v[16:19], v[240:243], a[60:63], v[16:19]
    v_mul_f32 v106, s42, v106
    v_mul_f32 v107, s42, v107
    v_mfma_f32_16x16x32_bf16 v[64:67], v[240:243], a[64:67], v[64:67]
    buffer_load_dwordx4 v216, s[16:19], s31 offen offset:256 nt lds
    v_mfma_f32_16x16x32_bf16 v[112:115], v[240:243], a[68:71], v[112:115]
    v_mul_f32 v204, s42, v204
    v_mul_f32 v205, s42, v205
    v_mfma_f32_16x16x32_bf16 v[160:163], v[240:243], a[72:75], v[160:163]
    buffer_load_dwordx4 v216, s[16:19], s31 offen offset:3328 nt lds
    v_mfma_f32_16x16x32_bf16 v[208:211], v[240:243], a[76:79], v[208:211]
    s_waitcnt lgkmcnt(0)
    s_add_u32 s31, s31, 12288
    s_add_u32 m0, s39, 0
    v_mfma_f32_16x16x32_bf16 v[20:23], v[244:247], a[60:63], v[20:23]
    s_cmp_ge_u32 s31, 196608
    s_cselect_b32 s31, 0, s31
    v_mfma_f32_16x16x32_bf16 v[68:71], v[244:247], a[64:67], v[68:71]
    v_mul_f32 v4, s42, v4
    v_mul_f32 v5, s42, v5
    v_mfma_f32_16x16x32_bf16 v[116:119], v[244:247], a[68:71], v[116:119]
    v_mul_f32 v208, s42, v208
    v_mul_f32 v209, s42, v209
    v_mfma_f32_16x16x32_bf16 v[164:167], v[244:247], a[72:75], v[164:167]
    v_mul_f32 v96, s42, v96
    v_mul_f32 v97, s42, v97
    v_mfma_f32_16x16x32_bf16 v[212:215], v[244:247], a[76:79], v[212:215]
    v_cvt_pk_bf16_f32 v2, v4, v5
    v_mul_f32 v8, s42, v8
    v_mul_f32 v9, s42, v9
    v_mul_f32 v192, s42, v192
    v_mul_f32 v193, s42, v193
    v_mul_f32 v194, s42, v194
    v_mul_f32 v195, s42, v195
    v_mul_f32 v198, s42, v198
    v_mul_f32 v199, s42, v199
    v_mul_f32 v202, s42, v202
    v_mul_f32 v212, s42, v212
    v_mul_f32 v213, s42, v213
    v_mul_f32 v203, s42, v203
    v_mul_f32 v206, s42, v206
    v_mul_f32 v207, s42, v207
    v_mul_f32 v210, s42, v210
    v_mul_f32 v211, s42, v211
    v_mul_f32 v214, s42, v214
    v_mul_f32 v215, s42, v215
    v_mul_f32 v10, s42, v10
    v_mul_f32 v11, s42, v11
    v_mul_f32 v14, s42, v14
    v_mul_f32 v15, s42, v15
    v_cvt_pk_bf16_f32 v4, v8, v9
    v_mul_f32 v16, s42, v16
    v_mul_f32 v17, s42, v17
    v_mul_f32 v18, s42, v18
    v_mul_f32 v19, s42, v19
    v_cvt_pk_bf16_f32 v5, v10, v11
    v_mul_f32 v20, s42, v20
    v_mul_f32 v21, s42, v21
    v_cvt_pk_bf16_f32 v7, v14, v15
    v_cvt_pk_bf16_f32 v8, v16, v17
    v_cvt_pk_bf16_f32 v9, v18, v19
    v_mul_f32 v22, s42, v22
    v_mul_f32 v23, s42, v23
    v_mul_f32 v54, s42, v54
    v_mul_f32 v55, s42, v55
    v_cvt_pk_bf16_f32 v10, v20, v21
    v_mul_f32 v56, s42, v56
    v_mul_f32 v57, s42, v57
    v_mul_f32 v60, s42, v60
    v_mul_f32 v61, s42, v61
    v_mul_f32 v62, s42, v62
    v_mul_f32 v63, s42, v63
    v_mul_f32 v64, s42, v64
    v_mul_f32 v65, s42, v65
    v_mul_f32 v66, s42, v66
    v_mul_f32 v67, s42, v67
    v_mul_f32 v58, s42, v58
    v_mul_f32 v59, s42, v59
    v_mul_f32 v68, s42, v68
    v_mul_f32 v69, s42, v69
    v_cvt_pk_bf16_f32 v11, v22, v23
    v_mul_f32 v108, s42, v108
    v_mul_f32 v109, s42, v109
    v_mul_f32 v110, s42, v110
    v_mul_f32 v111, s42, v111
    ds_read_b64_tr_b16 a[240:241], v228 offset:1024
    ds_read_b64_tr_b16 a[242:243], v228 offset:1536
    ds_read_b64_tr_b16 a[248:249], v227 offset:2048
    ds_read_b64_tr_b16 a[250:251], v227 offset:2560
    ds_read_b64_tr_b16 v[240:241], v228 offset:2048
    ds_read_b64_tr_b16 v[242:243], v228 offset:2560
    ds_read_b64_tr_b16 a[244:245], v228 offset:1032
    ds_read_b64_tr_b16 a[246:247], v228 offset:1544
    ds_read_b64_tr_b16 a[252:253], v227 offset:2056
    ds_read_b64_tr_b16 a[254:255], v227 offset:2568
    ds_read_b64_tr_b16 v[244:245], v228 offset:2056
    ds_read_b64_tr_b16 v[246:247], v228 offset:2568
    v_mul_f32 v112, s42, v112
    v_mul_f32 v113, s42, v113
    v_mul_f32 v114, s42, v114
    v_mul_f32 v115, s42, v115
    v_mul_f32 v144, s42, v144
    v_mul_f32 v145, s42, v145
    v_mul_f32 v146, s42, v146
    v_mul_f32 v147, s42, v147
    v_mul_f32 v148, s42, v148
    v_mul_f32 v149, s42, v149
    v_mul_f32 v150, s42, v150
    v_mul_f32 v151, s42, v151
    v_mul_f32 v116, s42, v116
    v_mul_f32 v117, s42, v117
    v_mul_f32 v118, s42, v118
    v_mul_f32 v119, s42, v119
    v_mul_f32 v152, s42, v152
    v_mul_f32 v153, s42, v153
    v_mul_f32 v154, s42, v154
    v_mul_f32 v155, s42, v155
    v_mul_f32 v156, s42, v156
    v_mul_f32 v157, s42, v157
    v_mul_f32 v158, s42, v158
    v_mul_f32 v159, s42, v159
    v_mul_f32 v70, s42, v70
    s_waitcnt lgkmcnt(10)
    v_mfma_f32_16x16x32_bf16 v[24:27], a[240:243], a[60:63], v[24:27]
    v_mul_f32 v71, s42, v71
    v_mul_f32 v160, s42, v160
    v_mfma_f32_16x16x32_bf16 v[72:75], a[240:243], a[64:67], v[72:75]
    v_mul_f32 v161, s42, v161
    v_mul_f32 v162, s42, v162
    v_mfma_f32_16x16x32_bf16 v[120:123], a[240:243], a[68:71], v[120:123]
    v_mul_f32 v163, s42, v163
    v_mul_f32 v164, s42, v164
    v_mfma_f32_16x16x32_bf16 v[168:171], a[240:243], a[72:75], v[168:171]
    s_waitcnt lgkmcnt(4)
    v_mul_f32 v24, s42, v24
    v_mul_f32 v25, s42, v25
    v_mfma_f32_16x16x32_bf16 v[28:31], a[244:247], a[60:63], v[28:31]
    v_cvt_pk_bf16_f32 v12, v24, v25
    v_cvt_pk_bf16_f32 v24, v48, v49
    v_mfma_f32_16x16x32_bf16 v[76:79], a[244:247], a[64:67], v[76:79]
    v_cvt_pk_bf16_f32 v25, v50, v51
    v_mul_f32 v26, s42, v26
    v_mfma_f32_16x16x32_bf16 v[124:127], a[244:247], a[68:71], v[124:127]
    v_mul_f32 v27, s42, v27
    v_cvt_pk_bf16_f32 v49, v98, v99
    v_mfma_f32_16x16x32_bf16 v[172:175], a[244:247], a[72:75], v[172:175]
    v_cvt_pk_bf16_f32 v50, v100, v101
    v_cvt_pk_bf16_f32 v13, v26, v27
    v_mfma_f32_16x16x32_bf16 v[32:35], a[248:251], a[60:63], v[32:35]
    v_cvt_pk_bf16_f32 v98, v196, v197
    v_cvt_pk_bf16_f32 v100, v200, v201
    v_mfma_f32_16x16x32_bf16 v[80:83], a[248:251], a[64:67], v[80:83]
    v_cvt_pk_bf16_f32 v26, v52, v53
    v_cvt_pk_bf16_f32 v51, v102, v103
    v_mfma_f32_16x16x32_bf16 v[128:131], a[248:251], a[68:71], v[128:131]
    v_cvt_pk_bf16_f32 v52, v104, v105
    v_cvt_pk_bf16_f32 v102, v204, v205
    v_mfma_f32_16x16x32_bf16 v[176:179], a[248:251], a[72:75], v[176:179]
    s_waitcnt lgkmcnt(2)
    v_cvt_pk_bf16_f32 v104, v208, v209
    v_cvt_pk_bf16_f32 v53, v106, v107
    v_mfma_f32_16x16x32_bf16 v[36:39], a[252:255], a[60:63], v[36:39]
    v_cvt_pk_bf16_f32 v106, v212, v213
    v_cvt_pk_bf16_f32 v48, v96, v97
    v_mfma_f32_16x16x32_bf16 v[84:87], a[252:255], a[64:67], v[84:87]
    v_cvt_pk_bf16_f32 v96, v192, v193
    v_cvt_pk_bf16_f32 v97, v194, v195
    v_mfma_f32_16x16x32_bf16 v[132:135], a[252:255], a[68:71], v[132:135]
    v_cvt_pk_bf16_f32 v99, v198, v199
    v_cvt_pk_bf16_f32 v101, v202, v203
    v_mfma_f32_16x16x32_bf16 v[180:183], a[252:255], a[72:75], v[180:183]
    v_cvt_pk_bf16_f32 v103, v206, v207
    v_cvt_pk_bf16_f32 v105, v210, v211
    v_mfma_f32_16x16x32_bf16 v[40:43], v[240:243], a[60:63], v[40:43]
    v_cvt_pk_bf16_f32 v107, v214, v215
    v_mul_f32 v28, s42, v28
    v_mfma_f32_16x16x32_bf16 v[88:91], v[240:243], a[64:67], v[88:91]
    v_mul_f32 v29, s42, v29
    v_mul_f32 v30, s42, v30
    v_mfma_f32_16x16x32_bf16 v[136:139], v[240:243], a[68:71], v[136:139]
    v_mul_f32 v31, s42, v31
    v_mul_f32 v32, s42, v32
    v_mfma_f32_16x16x32_bf16 v[184:187], v[240:243], a[72:75], v[184:187]
    s_waitcnt lgkmcnt(0)
    v_mul_f32 v33, s42, v33
    v_mul_f32 v36, s42, v36
    v_mfma_f32_16x16x32_bf16 v[44:47], v[244:247], a[60:63], v[44:47]
    v_mul_f32 v37, s42, v37
    v_mul_f32 v34, s42, v34
    v_mfma_f32_16x16x32_bf16 v[92:95], v[244:247], a[64:67], v[92:95]
    v_mul_f32 v35, s42, v35
    v_mul_f32 v38, s42, v38
    v_mfma_f32_16x16x32_bf16 v[140:143], v[244:247], a[68:71], v[140:143]
    v_mul_f32 v39, s42, v39
    v_mul_f32 v40, s42, v40
    v_mfma_f32_16x16x32_bf16 v[188:191], v[244:247], a[72:75], v[188:191]
    s_barrier
    buffer_load_dwordx4 v216, s[16:19], s31 offen nt lds
    buffer_load_dwordx4 v216, s[16:19], s31 offen offset:3072 nt lds
    s_add_u32 m0, s39, 896
    v_mov_b32 v230, 0
    buffer_load_dwordx4 v216, s[16:19], s31 offen offset:128 nt lds
    buffer_load_dwordx4 v216, s[16:19], s31 offen offset:3200 nt lds
    v_mov_b32 v231, 0
    s_add_u32 m0, s39, 1792
    v_mov_b32 v232, 0
    buffer_load_dwordx4 v216, s[16:19], s31 offen offset:256 nt lds
    buffer_load_dwordx4 v216, s[16:19], s31 offen offset:3328 nt lds
    v_mov_b32 v233, 0
    ds_write_b128 v229, v[96:99] offset:0
    ds_write_b128 v229, v[100:103] offset:1024
    ds_write_b128 v229, v[104:107] offset:2048
    v_mul_f32 v41, s42, v41
    v_cvt_pk_bf16_f32 v14, v28, v29
    v_mul_f32 v42, s42, v42
    v_mul_f32 v43, s42, v43
    v_cvt_pk_bf16_f32 v15, v30, v31
    v_cvt_pk_bf16_f32 v16, v32, v33
    v_cvt_pk_bf16_f32 v18, v36, v37
    v_mul_f32 v72, s42, v72
    s_waitcnt lgkmcnt(0)
    s_waitcnt vmcnt(34)
    v_mul_f32 v73, s42, v73
    s_barrier
    v_mul_f32 v74, s42, v74
    s_add_u32 m0, s34, 0
    v_mul_f32 v75, s42, v75
    v_cvt_pk_bf16_f32 v17, v34, v35
    v_mul_f32 v44, s42, v44
    v_mul_f32 v45, s42, v45
    v_cvt_pk_bf16_f32 v19, v38, v39
    v_mul_f32 v76, s42, v76
    v_mul_f32 v77, s42, v77
    v_mul_f32 v78, s42, v78
    v_mul_f32 v79, s42, v79
    v_cvt_pk_bf16_f32 v27, v54, v55
    v_cvt_pk_bf16_f32 v20, v40, v41
    v_mul_f32 v80, s42, v80
    v_mul_f32 v81, s42, v81
    v_mul_f32 v82, s42, v82
    v_mul_f32 v83, s42, v83
    v_mul_f32 v46, s42, v46
    v_mul_f32 v47, s42, v47
    v_cvt_pk_bf16_f32 v28, v56, v57
    v_cvt_pk_bf16_f32 v21, v42, v43
    v_mul_f32 v84, s42, v84
    v_mul_f32 v85, s42, v85
    v_mul_f32 v86, s42, v86
    v_mul_f32 v87, s42, v87
    v_cvt_pk_bf16_f32 v30, v60, v61
    v_mul_f32 v120, s42, v120
    v_mul_f32 v121, s42, v121
    v_mul_f32 v122, s42, v122
    v_mul_f32 v123, s42, v123
    v_cvt_pk_bf16_f32 v31, v62, v63
    v_mul_f32 v124, s42, v124
    v_mul_f32 v125, s42, v125
    v_mul_f32 v126, s42, v126
    v_mul_f32 v127, s42, v127
    v_cvt_pk_bf16_f32 v32, v64, v65
    v_mul_f32 v128, s42, v128
    v_mul_f32 v129, s42, v129
    v_mul_f32 v130, s42, v130
    v_mul_f32 v131, s42, v131
    v_cvt_pk_bf16_f32 v36, v72, v73
    v_cvt_pk_bf16_f32 v37, v74, v75
    v_cvt_pk_bf16_f32 v33, v66, v67
    v_mul_f32 v132, s42, v132
    v_mul_f32 v133, s42, v133
    v_mul_f32 v134, s42, v134
    v_mul_f32 v135, s42, v135
    v_cvt_pk_bf16_f32 v29, v58, v59
    v_cvt_pk_bf16_f32 v34, v68, v69
    v_mul_f32 v136, s42, v136
    v_mul_f32 v137, s42, v137
    v_mul_f32 v138, s42, v138
    v_mul_f32 v139, s42, v139
    v_cvt_pk_bf16_f32 v22, v44, v45
    v_mul_f32 v88, s42, v88
    v_mul_f32 v89, s42, v89
    v_cvt_pk_bf16_f32 v38, v76, v77
    v_cvt_pk_bf16_f32 v39, v78, v79
    v_mul_f32 v90, s42, v90
    v_mul_f32 v91, s42, v91
    v_cvt_pk_bf16_f32 v54, v108, v109
    v_cvt_pk_bf16_f32 v55, v110, v111
    v_cvt_pk_bf16_f32 v40, v80, v81
    v_cvt_pk_bf16_f32 v41, v82, v83
    v_mul_f32 v165, s42, v165
    v_mul_f32 v166, s42, v166
    v_mul_f32 v167, s42, v167
    ds_read_b128 a[240:243], v217 offset:0
    v_cvt_pk_bf16_f32 v23, v46, v47
    v_mul_f32 v92, s42, v92
    v_mul_f32 v93, s42, v93
    ds_read_b128 a[248:251], v217 offset:1024
    ds_read_b128 v[240:243], v217 offset:2048
    v_cvt_pk_bf16_f32 v56, v112, v113
    v_cvt_pk_bf16_f32 v57, v114, v115
    v_mul_f32 v94, s42, v94
    v_mul_f32 v95, s42, v95
    ds_read_b128 a[244:247], v218 offset:0
    ds_read_b128 a[252:255], v218 offset:1024
    ds_read_b128 v[244:247], v218 offset:2048
    v_cvt_pk_bf16_f32 v42, v84, v85
    v_mul_f32 v168, s42, v168
    v_mul_f32 v169, s42, v169
    v_mul_f32 v170, s42, v170
    v_mul_f32 v171, s42, v171
    v_cvt_pk_bf16_f32 v43, v86, v87
    v_mul_f32 v172, s42, v172
    v_mul_f32 v173, s42, v173
    v_mul_f32 v174, s42, v174
    v_mul_f32 v175, s42, v175
    v_cvt_pk_bf16_f32 v60, v120, v121
    v_cvt_pk_bf16_f32 v61, v122, v123
    v_cvt_pk_bf16_f32 v62, v124, v125
    v_cvt_pk_bf16_f32 v63, v126, v127
    v_cvt_pk_bf16_f32 v64, v128, v129
    v_cvt_pk_bf16_f32 v65, v130, v131
    v_cvt_pk_bf16_f32 v72, v144, v145
    v_cvt_pk_bf16_f32 v73, v146, v147
    v_cvt_pk_bf16_f32 v74, v148, v149
    v_cvt_pk_bf16_f32 v75, v150, v151
    v_cvt_pk_bf16_f32 v66, v132, v133
    v_cvt_pk_bf16_f32 v67, v134, v135
    v_cvt_pk_bf16_f32 v58, v116, v117
    s_waitcnt lgkmcnt(5)
    v_mfma_f32_16x16x32_bf16 v[120:123], a[240:243], v[0:3], 0
    v_cvt_pk_bf16_f32 v59, v118, v119
    v_cvt_pk_bf16_f32 v68, v136, v137
    v_mfma_f32_16x16x32_bf16 v[124:127], a[240:243], v[24:27], 0
    s_sub_u32 s36, s32, s34
    v_cvt_pk_bf16_f32 v69, v138, v139
    v_cvt_pk_bf16_f32 v44, v88, v89
    v_mfma_f32_16x16x32_bf16 v[128:131], a[240:243], v[48:51], 0
    s_mov_b32 s37, s36
    v_cvt_pk_bf16_f32 v76, v152, v153
    v_cvt_pk_bf16_f32 v77, v154, v155
    v_mfma_f32_16x16x32_bf16 v[132:135], a[240:243], v[72:75], 0
    s_add_u32 s31, s31, 12288
    v_cvt_pk_bf16_f32 v78, v156, v157
    v_cvt_pk_bf16_f32 v79, v158, v159
    v_mfma_f32_16x16x32_bf16 v[136:139], a[240:243], v[96:99], 0
    s_waitcnt lgkmcnt(2)
    v_mul_f32 v176, s42, v176
    v_mul_f32 v177, s42, v177
    v_mfma_f32_16x16x32_bf16 v[120:123], a[244:247], v[4:7], v[120:123]
    v_mul_f32 v178, s42, v178
    v_mul_f32 v179, s42, v179
    v_mfma_f32_16x16x32_bf16 v[124:127], a[244:247], v[28:31], v[124:127]
    v_cvt_pk_bf16_f32 v45, v90, v91
    v_mul_f32 v180, s42, v180
    v_mfma_f32_16x16x32_bf16 v[128:131], a[244:247], v[52:55], v[128:131]
    v_mul_f32 v181, s42, v181
    v_mul_f32 v182, s42, v182
    v_mfma_f32_16x16x32_bf16 v[132:135], a[244:247], v[76:79], v[132:135]
    v_mul_f32 v183, s42, v183
    ds_read_b128 v[108:111], v229 offset:3072
    v_mfma_f32_16x16x32_bf16 v[136:139], a[244:247], v[100:103], v[136:139]
    v_cvt_pk_bf16_f32 v35, v70, v71
    v_cvt_pk_bf16_f32 v80, v160, v161
    v_mfma_f32_16x16x32_bf16 v[120:123], a[248:251], v[8:11], v[120:123]
    v_cvt_pk_bf16_f32 v81, v162, v163
    v_cvt_pk_bf16_f32 v82, v164, v165
    v_mfma_f32_16x16x32_bf16 v[124:127], a[248:251], v[32:35], v[124:127]
    v_cvt_pk_bf16_f32 v83, v166, v167
    v_mul_f32 v140, s42, v140
    v_mfma_f32_16x16x32_bf16 v[128:131], a[248:251], v[56:59], v[128:131]
    v_mul_f32 v141, s42, v141
    v_mul_f32 v142, s42, v142
    v_mfma_f32_16x16x32_bf16 v[132:135], a[248:251], v[80:83], v[132:135]
    v_mul_f32 v143, s42, v143
    v_cvt_pk_bf16_f32 v46, v92, v93
    v_mfma_f32_16x16x32_bf16 v[136:139], a[248:251], v[104:107], v[136:139]
    s_waitcnt lgkmcnt(2)
    v_mul_f32 v184, s42, v184
    v_mul_f32 v185, s42, v185
    v_mfma_f32_16x16x32_bf16 v[120:123], a[252:255], v[12:15], v[120:123]
    v_mul_f32 v186, s42, v186
    v_mul_f32 v187, s42, v187
    v_mfma_f32_16x16x32_bf16 v[124:127], a[252:255], v[36:39], v[124:127]
    ds_read_b128 v[112:115], v229 offset:4096
    v_cvt_pk_bf16_f32 v47, v94, v95
    v_mfma_f32_16x16x32_bf16 v[128:131], a[252:255], v[60:63], v[128:131]
    v_mul_f32 v188, s42, v188
    v_mul_f32 v189, s42, v189
    v_mul_f32 v190, s42, v190
    v_mul_f32 v191, s42, v191
    v_cvt_pk_bf16_f32 v84, v168, v169
    v_cvt_pk_bf16_f32 v85, v170, v171
    v_cvt_pk_bf16_f32 v86, v172, v173
    v_cvt_pk_bf16_f32 v87, v174, v175
    ds_read_b128 a[240:243], v217 offset:6144
    ds_read_b128 a[248:251], v217 offset:7168
    v_mfma_f32_16x16x32_bf16 v[132:135], a[252:255], v[84:87], v[132:135]
    s_waitcnt lgkmcnt(3)
    ds_read_b128 v[116:119], v229 offset:5120
    ds_read_b128 a[244:247], v218 offset:6144
    v_mfma_f32_16x16x32_bf16 v[136:139], a[252:255], v[108:111], v[136:139]
    ds_read_b128 a[252:255], v218 offset:7168
    v_cvt_pk_bf16_f32 v88, v176, v177
    v_mfma_f32_16x16x32_bf16 v[120:123], v[240:243], v[16:19], v[120:123]
    v_cvt_pk_bf16_f32 v89, v178, v179
    v_cvt_pk_bf16_f32 v90, v180, v181
    v_mfma_f32_16x16x32_bf16 v[124:127], v[240:243], v[40:43], v[124:127]
    v_cvt_pk_bf16_f32 v91, v182, v183
    v_cvt_pk_bf16_f32 v70, v140, v141
    v_mfma_f32_16x16x32_bf16 v[128:131], v[240:243], v[64:67], v[128:131]
    v_cvt_pk_bf16_f32 v71, v142, v143
    v_cvt_pk_bf16_f32 v92, v184, v185
    v_mfma_f32_16x16x32_bf16 v[132:135], v[240:243], v[88:91], v[132:135]
    s_waitcnt lgkmcnt(5)
    v_cvt_pk_bf16_f32 v93, v186, v187
    v_cvt_pk_bf16_f32 v94, v188, v189
    v_mfma_f32_16x16x32_bf16 v[136:139], v[240:243], v[112:115], v[136:139]
    ds_read_b128 v[240:243], v217 offset:8192
    v_cvt_pk_bf16_f32 v95, v190, v191
    v_mfma_f32_16x16x32_bf16 v[120:123], v[244:247], v[20:23], v[120:123]
    v_add_u32 v217, s36, v217
    v_mov_b32 v234, 0
    v_mfma_f32_16x16x32_bf16 v[124:127], v[244:247], v[44:47], v[124:127]
    v_accvgpr_write_b32 a192, 0
    v_accvgpr_write_b32 a193, 0
    v_mfma_f32_16x16x32_bf16 v[128:131], v[244:247], v[68:71], v[128:131]
    v_accvgpr_write_b32 a194, 0
    v_accvgpr_write_b32 a195, 0
    v_mfma_f32_16x16x32_bf16 v[132:135], v[244:247], v[92:95], v[132:135]
    s_waitcnt lgkmcnt(3)
    v_max3_f32 v196, v120, v121, v122
    v_max3_f32 v196, v196, v123, v235
    v_mfma_f32_16x16x32_bf16 v[136:139], v[244:247], v[116:119], v[136:139]
    v_max3_f32 v200, v124, v125, v126
    v_max3_f32 v200, v200, v127, v236
    v_mfma_f32_16x16x32_bf16 v[140:143], a[240:243], v[0:3], 0
    s_waitcnt vmcnt(34)
    s_barrier
    v_max3_f32 v204, v128, v129, v130
    v_mfma_f32_16x16x32_bf16 v[144:147], a[240:243], v[24:27], 0
    v_mov_b32 v197, v196
    v_mov_b32 v201, v200
    v_mfma_f32_16x16x32_bf16 v[148:151], a[240:243], v[48:51], 0
    v_max3_f32 v208, v132, v133, v134
    v_max3_f32 v204, v204, v131, v237
    v_mfma_f32_16x16x32_bf16 v[152:155], a[240:243], v[72:75], 0
    v_permlane32_swap_b32 v196, v197
    v_mfma_f32_16x16x32_bf16 v[156:159], a[240:243], v[96:99], 0
    s_waitcnt lgkmcnt(2)
    v_permlane32_swap_b32 v200, v201
    v_mfma_f32_16x16x32_bf16 v[140:143], a[244:247], v[4:7], v[140:143]
    v_max3_f32 v208, v208, v135, v238
    v_mov_b32 v205, v204
    v_mfma_f32_16x16x32_bf16 v[144:147], a[244:247], v[28:31], v[144:147]
    v_mov_b32 v209, v208
    v_max_f32 v196, v196, v197
    v_mfma_f32_16x16x32_bf16 v[148:151], a[244:247], v[52:55], v[148:151]
    v_max_f32 v200, v200, v201
    v_mov_b32 v197, v196
    v_mfma_f32_16x16x32_bf16 v[152:155], a[244:247], v[76:79], v[152:155]
    v_permlane32_swap_b32 v204, v205
    v_mfma_f32_16x16x32_bf16 v[156:159], a[244:247], v[100:103], v[156:159]
    v_permlane32_swap_b32 v208, v209
    v_mfma_f32_16x16x32_bf16 v[140:143], a[248:251], v[8:11], v[140:143]
    v_mov_b32 v201, v200
    v_max_f32 v204, v204, v205
    v_mfma_f32_16x16x32_bf16 v[144:147], a[248:251], v[32:35], v[144:147]
    v_max_f32 v208, v208, v209
    v_mov_b32 v205, v204
    v_mfma_f32_16x16x32_bf16 v[148:151], a[248:251], v[56:59], v[148:151]
    v_permlane16_swap_b32 v196, v197
    v_mfma_f32_16x16x32_bf16 v[152:155], a[248:251], v[80:83], v[152:155]
    v_permlane16_swap_b32 v200, v201
    v_mfma_f32_16x16x32_bf16 v[156:159], a[248:251], v[104:107], v[156:159]
    s_waitcnt lgkmcnt(1)
    v_mov_b32 v209, v208
    v_max_f32 v196, v196, v197
    v_mfma_f32_16x16x32_bf16 v[140:143], a[252:255], v[12:15], v[140:143]
    v_max_f32 v200, v200, v201
    v_max3_f32 v212, v136, v137, v138
    v_mfma_f32_16x16x32_bf16 v[144:147], a[252:255], v[36:39], v[144:147]
    v_permlane16_swap_b32 v204, v205
    v_mfma_f32_16x16x32_bf16 v[148:151], a[252:255], v[60:63], v[148:151]
    v_permlane16_swap_b32 v208, v209
    v_mfma_f32_16x16x32_bf16 v[152:155], a[252:255], v[84:87], v[152:155]
    v_sub_f32 v197, 0, v196
    v_sub_f32 v201, 0, v200
    v_mfma_f32_16x16x32_bf16 v[156:159], a[252:255], v[108:111], v[156:159]
    s_waitcnt lgkmcnt(0)
    v_max_f32 v204, v204, v205
    v_max_f32 v208, v208, v209
    v_mfma_f32_16x16x32_bf16 v[140:143], v[240:243], v[16:19], v[140:143]
    v_max3_f32 v212, v212, v139, v239
    v_add_f32 v120, v120, v197
    v_mfma_f32_16x16x32_bf16 v[144:147], v[240:243], v[40:43], v[144:147]
    v_add_f32 v124, v124, v201
    v_sub_f32 v205, 0, v204
    v_mfma_f32_16x16x32_bf16 v[148:151], v[240:243], v[64:67], v[148:151]
    v_sub_f32 v209, 0, v208
    v_mov_b32 v213, v212
    v_mfma_f32_16x16x32_bf16 v[152:155], v[240:243], v[88:91], v[152:155]
    v_exp_f32 v120, v120
    v_mfma_f32_16x16x32_bf16 v[156:159], v[240:243], v[112:115], v[156:159]
    v_add_f32 v121, v121, v197
    v_exp_f32 v124, v124
    v_add_f32 v125, v125, v201
    v_add_f32 v128, v128, v205
    v_add_f32 v132, v132, v209
    v_permlane32_swap_b32 v212, v213
    v_exp_f32 v121, v121
    v_add_f32 v122, v122, v197
    v_add_f32 v230, v230, v120
    v_exp_f32 v125, v125
    v_add_f32 v126, v126, v201
    v_add_f32 v231, v231, v124
    v_add_f32 v129, v129, v205
    v_exp_f32 v128, v128
    v_exp_f32 v132, v132
    v_add_f32 v133, v133, v209
    v_max_f32 v212, v212, v213
    v_exp_f32 v122, v122
    v_add_f32 v123, v123, v197
    v_add_f32 v230, v230, v121
    v_add_f32 v127, v127, v201
    v_exp_f32 v126, v126
    v_add_f32 v231, v231, v125
    v_add_f32 v130, v130, v205
    v_exp_f32 v129, v129
    v_add_f32 v232, v232, v128
    v_add_f32 v134, v134, v209
    v_exp_f32 v133, v133
    v_add_f32 v233, v233, v132
    v_mov_b32 v213, v212
    v_exp_f32 v123, v123
    v_add_f32 v230, v230, v122
    v_exp_f32 v127, v127
    v_add_f32 v231, v231, v126
    v_exp_f32 v130, v130
    v_add_f32 v131, v131, v205
    v_add_f32 v232, v232, v129
    v_add_f32 v135, v135, v209
    v_exp_f32 v134, v134
    v_add_f32 v233, v233, v133
    v_permlane16_swap_b32 v212, v213
    v_add_f32 v230, v230, v123
    v_add_f32 v231, v231, v127
    v_exp_f32 v131, v131
    v_add_f32 v232, v232, v130
    v_exp_f32 v135, v135
    v_add_f32 v233, v233, v134
    v_max_f32 v212, v212, v213
    v_add_f32 v232, v232, v131
    v_add_f32 v233, v233, v135
    v_sub_f32 v213, 0, v212
    ds_read_b128 v[244:247], v218 offset:8192
    v_add_f32 v136, v136, v213
    v_add_u32 v218, s36, v218
    v_add_f32 v137, v137, v213
    v_exp_f32 v136, v136
    v_sub_f32 v198, 0, v196
    v_sub_f32 v199, 0, v196
    v_sub_f32 v202, 0, v200
    v_sub_f32 v203, 0, v200
    v_sub_f32 v206, 0, v204
    v_sub_f32 v207, 0, v204
    v_sub_f32 v210, 0, v208
    v_sub_f32 v211, 0, v208
    ds_read_b128 a[240:243], v217 offset:0
    ds_read_b128 a[244:247], v218 offset:0
    ds_read_b128 a[248:251], v217 offset:1024
    v_exp_f32 v137, v137
    v_add_f32 v138, v138, v213
    v_add_f32 v234, v234, v136
    v_sub_f32 v196, 0, v196
    v_cvt_pk_bf16_f32 v160, v120, v121
    v_cvt_pk_bf16_f32 v161, v122, v123
    v_sub_f32 v200, 0, v200
    v_cvt_pk_bf16_f32 v164, v124, v125
    v_cvt_pk_bf16_f32 v165, v126, v127
    ds_read_b128 a[252:255], v218 offset:1024
    v_sub_f32 v204, 0, v204
    v_cvt_pk_bf16_f32 v168, v128, v129
    v_cvt_pk_bf16_f32 v169, v130, v131
    v_sub_f32 v208, 0, v208
    v_cvt_pk_bf16_f32 v172, v132, v133
    v_cvt_pk_bf16_f32 v173, v134, v135
    ds_read_b128 v[240:243], v217 offset:2048
    v_add_f32 v139, v139, v213
    s_waitcnt lgkmcnt(5)
    v_mfma_f32_16x16x32_bf16 v[140:143], v[244:247], v[20:23], v[140:143]
    v_exp_f32 v138, v138
    v_mfma_f32_16x16x32_bf16 v[144:147], v[244:247], v[44:47], v[144:147]
    s_sub_u32 s36, s33, s32
    v_add_f32 v234, v234, v137
    v_add_f32 v234, v234, v138
    v_mfma_f32_16x16x32_bf16 v[148:151], v[244:247], v[68:71], v[148:151]
    s_mov_b32 s32, s33
    v_exp_f32 v139, v139
    v_mfma_f32_16x16x32_bf16 v[152:155], v[244:247], v[92:95], v[152:155]
    s_mov_b32 s33, s34
    v_add_f32 v140, v140, v197
    v_add_f32 v141, v141, v197
    v_mfma_f32_16x16x32_bf16 v[156:159], v[244:247], v[116:119], v[156:159]
    s_waitcnt lgkmcnt(4)
    s_barrier
    v_add_f32 v144, v144, v201
    v_mfma_f32_16x16x32_bf16 v[120:123], a[240:243], v[0:3], v[196:199]
    s_add_u32 s39, s33, s35
    buffer_load_dwordx4 v216, s[12:15], s30 offen nt lds
    v_mfma_f32_16x16x32_bf16 v[124:127], a[240:243], v[24:27], v[200:203]
    v_exp_f32 v140, v140
    v_mfma_f32_16x16x32_bf16 v[128:131], a[240:243], v[48:51], v[204:207]
    v_exp_f32 v144, v144
    v_mfma_f32_16x16x32_bf16 v[132:135], a[240:243], v[72:75], v[208:211]
    s_waitcnt lgkmcnt(3)
    v_add_f32 v145, v145, v201
    v_add_f32 v148, v148, v205
    v_mfma_f32_16x16x32_bf16 v[120:123], a[244:247], v[4:7], v[120:123]
    buffer_load_dwordx4 v216, s[12:15], s30 offen offset:3072 nt lds
    v_mfma_f32_16x16x32_bf16 v[124:127], a[244:247], v[28:31], v[124:127]
    s_add_u32 m0, s34, 896
    v_add_f32 v152, v152, v209
    v_add_f32 v142, v142, v197
    v_mfma_f32_16x16x32_bf16 v[128:131], a[244:247], v[52:55], v[128:131]
    v_exp_f32 v141, v141
    v_mfma_f32_16x16x32_bf16 v[132:135], a[244:247], v[76:79], v[132:135]
    s_waitcnt lgkmcnt(2)
    v_add_f32 v230, v230, v140
    v_add_f32 v146, v146, v201
    v_mfma_f32_16x16x32_bf16 v[120:123], a[248:251], v[8:11], v[120:123]
    v_exp_f32 v145, v145
    v_mfma_f32_16x16x32_bf16 v[124:127], a[248:251], v[32:35], v[124:127]
    v_add_f32 v231, v231, v144
    v_add_f32 v149, v149, v205
    v_mfma_f32_16x16x32_bf16 v[128:131], a[248:251], v[56:59], v[128:131]
    buffer_load_dwordx4 v216, s[12:15], s30 offen offset:128 nt lds
    v_mfma_f32_16x16x32_bf16 v[132:135], a[248:251], v[80:83], v[132:135]
    s_waitcnt lgkmcnt(1)
    v_exp_f32 v148, v148
    v_mfma_f32_16x16x32_bf16 v[120:123], a[252:255], v[12:15], v[120:123]
    v_add_f32 v153, v153, v209
    v_add_f32 v143, v143, v197
    v_mfma_f32_16x16x32_bf16 v[124:127], a[252:255], v[36:39], v[124:127]
    v_exp_f32 v152, v152
    v_mfma_f32_16x16x32_bf16 v[128:131], a[252:255], v[60:63], v[128:131]
    v_exp_f32 v142, v142
    v_mfma_f32_16x16x32_bf16 v[132:135], a[252:255], v[84:87], v[132:135]
    s_waitcnt lgkmcnt(0)
    v_add_f32 v230, v230, v141
    v_add_f32 v147, v147, v201
    v_mfma_f32_16x16x32_bf16 v[120:123], v[240:243], v[16:19], v[120:123]
    v_exp_f32 v146, v146
    v_mfma_f32_16x16x32_bf16 v[124:127], v[240:243], v[40:43], v[124:127]
    v_add_f32 v231, v231, v145
    v_add_f32 v150, v150, v205
    v_mfma_f32_16x16x32_bf16 v[128:131], v[240:243], v[64:67], v[128:131]
    buffer_load_dwordx4 v216, s[12:15], s30 offen offset:3200 nt lds
    v_mfma_f32_16x16x32_bf16 v[132:135], v[240:243], v[88:91], v[132:135]
    s_add_u32 m0, s34, 1792
    v_exp_f32 v149, v149
    v_add_f32 v232, v232, v148
    v_exp_f32 v153, v153
    v_add_f32 v154, v154, v209
    v_add_f32 v233, v233, v152
    v_exp_f32 v143, v143
    v_add_f32 v230, v230, v142
    v_exp_f32 v147, v147
    v_add_f32 v231, v231, v146
    buffer_load_dwordx4 v216, s[12:15], s30 offen offset:256 nt lds
    v_exp_f32 v150, v150
    v_add_f32 v151, v151, v205
    v_add_f32 v232, v232, v149
    v_add_f32 v155, v155, v209
    v_exp_f32 v154, v154
    v_add_f32 v233, v233, v153
    v_add_f32 v230, v230, v143
    v_add_f32 v231, v231, v147
    buffer_load_dwordx4 v216, s[12:15], s30 offen offset:3328 nt lds
    v_exp_f32 v151, v151
    v_add_f32 v232, v232, v150
    v_exp_f32 v155, v155
    v_add_f32 v233, v233, v154
    s_add_u32 s30, s30, 12288
    s_add_u32 m0, s46, 0
    s_cmp_ge_u32 s30, 196608
    s_cselect_b32 s30, 0, s30
    v_add_f32 v232, v232, v151
    ds_read_b128 v[244:247], v218 offset:2048
    v_add_f32 v233, v233, v155
    ds_read_b128 a[240:243], v217 offset:6144
    v_add_f32 v156, v156, v213
    ds_read_b128 a[244:247], v218 offset:6144
    v_add_f32 v157, v157, v213
    v_add_f32 v158, v158, v213
    v_add_f32 v159, v159, v213
    ds_read_b128 a[248:251], v217 offset:7168
    v_cvt_pk_bf16_f32 v162, v140, v141
    v_cvt_pk_bf16_f32 v163, v142, v143
    v_cvt_pk_bf16_f32 v166, v144, v145
    v_cvt_pk_bf16_f32 v167, v146, v147
    v_cvt_pk_bf16_f32 v170, v148, v149
    v_cvt_pk_bf16_f32 v171, v150, v151
    ds_read_b128 a[252:255], v218 offset:7168
    v_cvt_pk_bf16_f32 v174, v152, v153
    v_cvt_pk_bf16_f32 v175, v154, v155
    ds_read_b128 v[240:243], v217 offset:8192
    v_exp_f32 v156, v156
    v_exp_f32 v157, v157
    v_exp_f32 v158, v158
    v_exp_f32 v159, v159
    v_add_f32 v234, v234, v139
    v_cvt_pk_bf16_f32 v192, v136, v137
    v_cvt_pk_bf16_f32 v193, v138, v139
    v_cvt_pk_bf16_f32 v194, v156, v157
    v_cvt_pk_bf16_f32 v195, v158, v159
    v_accvgpr_write_b32 a196, 0
    v_accvgpr_write_b32 a197, 0
    v_accvgpr_write_b32 a198, 0
    v_accvgpr_write_b32 a199, 0
    s_waitcnt lgkmcnt(5)
    v_mfma_f32_16x16x32_bf16 v[120:123], v[244:247], v[20:23], v[120:123]
    v_accvgpr_write_b32 a200, 0
    v_accvgpr_write_b32 a201, 0
    v_mfma_f32_16x16x32_bf16 v[124:127], v[244:247], v[44:47], v[124:127]
    s_mov_b32 s34, s46
    v_accvgpr_write_b32 a202, 0
    v_accvgpr_write_b32 a203, 0
    v_mfma_f32_16x16x32_bf16 v[128:131], v[244:247], v[68:71], v[128:131]
    v_add_f32 v234, v234, v156
    v_accvgpr_write_b32 a204, 0
    v_mfma_f32_16x16x32_bf16 v[132:135], v[244:247], v[92:95], v[132:135]
    s_waitcnt lgkmcnt(4)
    v_exp_f32 v120, v120
    v_mfma_f32_16x16x32_bf16 v[140:143], a[240:243], v[0:3], v[196:199]
    s_waitcnt vmcnt(3)
    s_barrier
    v_add_f32 v230, v230, v120
    v_mfma_f32_16x16x32_bf16 v[144:147], a[240:243], v[24:27], v[200:203]
    v_exp_f32 v124, v124
    v_mfma_f32_16x16x32_bf16 v[148:151], a[240:243], v[48:51], v[204:207]
    v_exp_f32 v121, v121
    v_mfma_f32_16x16x32_bf16 v[152:155], a[240:243], v[72:75], v[208:211]
    s_waitcnt lgkmcnt(3)
    v_exp_f32 v125, v125
    v_mfma_f32_16x16x32_bf16 v[140:143], a[244:247], v[4:7], v[140:143]
    v_add_f32 v231, v231, v124
    v_add_f32 v230, v230, v121
    v_mfma_f32_16x16x32_bf16 v[144:147], a[244:247], v[28:31], v[144:147]
    v_exp_f32 v128, v128
    v_mfma_f32_16x16x32_bf16 v[148:151], a[244:247], v[52:55], v[148:151]
    v_exp_f32 v132, v132
    v_mfma_f32_16x16x32_bf16 v[152:155], a[244:247], v[76:79], v[152:155]
    s_waitcnt lgkmcnt(2)
    v_exp_f32 v122, v122
    v_mfma_f32_16x16x32_bf16 v[140:143], a[248:251], v[8:11], v[140:143]
    v_exp_f32 v126, v126
    v_mfma_f32_16x16x32_bf16 v[144:147], a[248:251], v[32:35], v[144:147]
    v_add_f32 v231, v231, v125
    v_add_f32 v232, v232, v128
    v_mfma_f32_16x16x32_bf16 v[148:151], a[248:251], v[56:59], v[148:151]
    v_exp_f32 v129, v129
    v_mfma_f32_16x16x32_bf16 v[152:155], a[248:251], v[80:83], v[152:155]
    s_waitcnt lgkmcnt(1)
    v_exp_f32 v133, v133
    v_mfma_f32_16x16x32_bf16 v[140:143], a[252:255], v[12:15], v[140:143]
    v_add_f32 v233, v233, v132
    v_add_f32 v230, v230, v122
    v_mfma_f32_16x16x32_bf16 v[144:147], a[252:255], v[36:39], v[144:147]
    v_exp_f32 v123, v123
    v_mfma_f32_16x16x32_bf16 v[148:151], a[252:255], v[60:63], v[148:151]
    v_exp_f32 v127, v127
    v_mfma_f32_16x16x32_bf16 v[152:155], a[252:255], v[84:87], v[152:155]
    s_waitcnt lgkmcnt(0)
    ds_read_b128 v[244:247], v218 offset:8192
    v_add_f32 v231, v231, v126
    v_mfma_f32_16x16x32_bf16 v[140:143], v[240:243], v[16:19], v[140:143]
    s_cmp_eq_u32 s43, 0
    s_cselect_b32 s14, 0, s14
    v_mfma_f32_16x16x32_bf16 v[144:147], v[240:243], v[40:43], v[144:147]
    ds_read_b64_tr_b16 a[240:241], v219 offset:0
    ds_read_b64_tr_b16 a[242:243], v219 offset:6144
    v_mfma_f32_16x16x32_bf16 v[148:151], v[240:243], v[64:67], v[148:151]
    v_exp_f32 v130, v130
    v_mfma_f32_16x16x32_bf16 v[152:155], v[240:243], v[88:91], v[152:155]
    s_waitcnt lgkmcnt(2)
    v_add_f32 v232, v232, v129
    ds_read_b64_tr_b16 a[244:245], v220 offset:0
    v_exp_f32 v134, v134
    ds_read_b64_tr_b16 a[246:247], v220 offset:6144
    v_add_f32 v233, v233, v133
    ds_read_b64_tr_b16 a[248:249], v221 offset:0
    ds_read_b64_tr_b16 a[250:251], v221 offset:6144
    v_add_f32 v230, v230, v123
    ds_read_b64_tr_b16 a[252:253], v222 offset:0
    ds_read_b64_tr_b16 a[254:255], v222 offset:6144
    v_add_f32 v231, v231, v127
    ds_read_b64_tr_b16 v[240:241], v219 offset:1024
    v_exp_f32 v131, v131
    ds_read_b64_tr_b16 v[242:243], v219 offset:7168
    v_add_f32 v232, v232, v130
    v_exp_f32 v135, v135
    v_add_f32 v233, v233, v134
    v_mfma_f32_16x16x32_bf16 v[140:143], v[244:247], v[20:23], v[140:143]
    v_accvgpr_write_b32 a205, 0
    v_accvgpr_write_b32 a206, 0
    v_mfma_f32_16x16x32_bf16 v[144:147], v[244:247], v[44:47], v[144:147]
    v_accvgpr_write_b32 a207, 0
    v_accvgpr_write_b32 a208, 0
    v_mfma_f32_16x16x32_bf16 v[148:151], v[244:247], v[68:71], v[148:151]
    v_accvgpr_write_b32 a209, 0
    v_accvgpr_write_b32 a210, 0
    v_mfma_f32_16x16x32_bf16 v[152:155], v[244:247], v[92:95], v[152:155]
    s_waitcnt lgkmcnt(8)
    v_exp_f32 v140, v140
    v_mfma_f32_16x16x32_bf16 a[0:3], a[240:243], v[160:163], 0
    v_exp_f32 v144, v144
    v_mfma_f32_16x16x32_bf16 a[48:51], a[240:243], v[164:167], 0
    ds_read_b64_tr_b16 v[244:245], v220 offset:1024
    ds_read_b64_tr_b16 v[246:247], v220 offset:7168
    v_mfma_f32_16x16x32_bf16 a[96:99], a[240:243], v[168:171], 0
    v_exp_f32 v141, v141
    v_mfma_f32_16x16x32_bf16 a[144:147], a[240:243], v[172:175], 0
    v_add_f32 v230, v230, v140
    v_accvgpr_write_b32 a211, 0
    v_mfma_f32_16x16x32_bf16 a[192:195], a[240:243], v[192:195], a[192:195]
    s_waitcnt lgkmcnt(8)
    ds_read_b64_tr_b16 a[240:241], v221 offset:1024
    ds_read_b64_tr_b16 a[242:243], v221 offset:7168
    v_mfma_f32_16x16x32_bf16 a[4:7], a[244:247], v[160:163], 0
    v_exp_f32 v145, v145
    v_mfma_f32_16x16x32_bf16 a[52:55], a[244:247], v[164:167], 0
    v_add_f32 v231, v231, v144
    v_accvgpr_write_b32 a212, 0
    v_mfma_f32_16x16x32_bf16 a[100:103], a[244:247], v[168:171], 0
    v_accvgpr_write_b32 a213, 0
    v_accvgpr_write_b32 a214, 0
    v_mfma_f32_16x16x32_bf16 a[148:151], a[244:247], v[172:175], 0
    v_accvgpr_write_b32 a215, 0
    v_add_f32 v232, v232, v131
    v_mfma_f32_16x16x32_bf16 a[196:199], a[244:247], v[192:195], a[196:199]
    s_waitcnt lgkmcnt(8)
    ds_read_b64_tr_b16 a[244:245], v222 offset:1024
    ds_read_b64_tr_b16 a[246:247], v222 offset:7168
    v_mfma_f32_16x16x32_bf16 a[8:11], a[248:251], v[160:163], 0
    v_exp_f32 v148, v148
    v_mfma_f32_16x16x32_bf16 a[56:59], a[248:251], v[164:167], 0
    v_exp_f32 v152, v152
    v_mfma_f32_16x16x32_bf16 a[104:107], a[248:251], v[168:171], 0
    v_add_f32 v233, v233, v135
    v_accvgpr_write_b32 a216, 0
    v_mfma_f32_16x16x32_bf16 a[152:155], a[248:251], v[172:175], 0
    v_accvgpr_write_b32 a217, 0
    v_accvgpr_write_b32 a218, 0
    v_mfma_f32_16x16x32_bf16 a[200:203], a[248:251], v[192:195], a[200:203]
    s_waitcnt lgkmcnt(8)
    ds_read_b64_tr_b16 a[248:249], v219 offset:2048
    ds_read_b64_tr_b16 a[250:251], v219 offset:8192
    v_mfma_f32_16x16x32_bf16 a[12:15], a[252:255], v[160:163], 0
    v_accvgpr_write_b32 a219, 0
    v_add_f32 v234, v234, v157
    v_mfma_f32_16x16x32_bf16 a[60:63], a[252:255], v[164:167], 0
    v_exp_f32 v142, v142
    v_mfma_f32_16x16x32_bf16 a[108:111], a[252:255], v[168:171], 0
    v_add_u32 v217, s36, v217
    v_add_f32 v230, v230, v141
    v_mfma_f32_16x16x32_bf16 a[156:159], a[252:255], v[172:175], 0
    v_accvgpr_write_b32 a220, 0
    v_accvgpr_write_b32 a221, 0
    v_mfma_f32_16x16x32_bf16 a[204:207], a[252:255], v[192:195], a[204:207]
    s_waitcnt lgkmcnt(8)
    ds_read_b64_tr_b16 a[252:253], v220 offset:2048
    ds_read_b64_tr_b16 a[254:255], v220 offset:8192
    v_mfma_f32_16x16x32_bf16 a[16:19], v[240:243], v[160:163], 0
    v_accvgpr_write_b32 a222, 0
    v_accvgpr_write_b32 a223, 0
    v_mfma_f32_16x16x32_bf16 a[64:67], v[240:243], v[164:167], 0
    v_exp_f32 v146, v146
    v_mfma_f32_16x16x32_bf16 a[112:115], v[240:243], v[168:171], 0
    v_add_f32 v231, v231, v145
    v_add_u32 v218, s36, v218
    v_mfma_f32_16x16x32_bf16 a[160:163], v[240:243], v[172:175], 0
    v_accvgpr_write_b32 a224, 0
    v_accvgpr_write_b32 a225, 0
    v_mfma_f32_16x16x32_bf16 a[208:211], v[240:243], v[192:195], a[208:211]
    s_waitcnt lgkmcnt(8)
    ds_read_b64_tr_b16 v[240:241], v221 offset:2048
    ds_read_b64_tr_b16 v[242:243], v221 offset:8192
    v_mfma_f32_16x16x32_bf16 a[20:23], v[244:247], v[160:163], 0
    v_accvgpr_write_b32 a226, 0
    v_accvgpr_write_b32 a227, 0
    v_mfma_f32_16x16x32_bf16 a[68:71], v[244:247], v[164:167], 0
    v_exp_f32 v149, v149
    v_mfma_f32_16x16x32_bf16 a[116:119], v[244:247], v[168:171], 0
    v_exp_f32 v153, v153
    v_mfma_f32_16x16x32_bf16 a[164:167], v[244:247], v[172:175], 0
    v_add_f32 v232, v232, v148
    v_add_f32 v233, v233, v152
    v_mfma_f32_16x16x32_bf16 a[212:215], v[244:247], v[192:195], a[212:215]
    s_waitcnt lgkmcnt(8)
    ds_read_b64_tr_b16 v[244:245], v222 offset:2048
    ds_read_b64_tr_b16 v[246:247], v222 offset:8192
    v_mfma_f32_16x16x32_bf16 a[24:27], a[240:243], v[160:163], 0
    s_waitcnt vmcnt(3)
    s_barrier
    v_sub_f32 v214, 0, v212
    v_mfma_f32_16x16x32_bf16 a[72:75], a[240:243], v[164:167], 0
    buffer_load_dwordx4 v216, s[12:15], s30 offen nt lds
    v_mfma_f32_16x16x32_bf16 a[120:123], a[240:243], v[168:171], 0
    v_sub_f32 v215, 0, v212
    v_add_f32 v234, v234, v158
    v_mfma_f32_16x16x32_bf16 a[168:171], a[240:243], v[172:175], 0
    buffer_load_dwordx4 v216, s[12:15], s30 offen offset:3072 nt lds
    v_mfma_f32_16x16x32_bf16 a[216:219], a[240:243], v[192:195], a[216:219]
    s_waitcnt lgkmcnt(8)
    s_add_u32 m0, s46, 896
    v_accvgpr_write_b32 a228, 0
    v_mfma_f32_16x16x32_bf16 a[28:31], a[244:247], v[160:163], 0
    buffer_load_dwordx4 v216, s[12:15], s30 offen offset:128 nt lds
    v_mfma_f32_16x16x32_bf16 a[76:79], a[244:247], v[164:167], 0
    v_accvgpr_write_b32 a229, 0
    v_accvgpr_write_b32 a230, 0
    v_mfma_f32_16x16x32_bf16 a[124:127], a[244:247], v[168:171], 0
    buffer_load_dwordx4 v216, s[12:15], s30 offen offset:3200 nt lds
    v_mfma_f32_16x16x32_bf16 a[172:175], a[244:247], v[172:175], 0
    s_add_u32 m0, s46, 1792
    v_accvgpr_write_b32 a231, 0
    ds_read_b128 a[240:243], v217 offset:0
    v_mfma_f32_16x16x32_bf16 a[220:223], a[244:247], v[192:195], a[220:223]
    s_waitcnt lgkmcnt(7)
    buffer_load_dwordx4 v216, s[12:15], s30 offen offset:256 nt lds
    v_mfma_f32_16x16x32_bf16 a[32:35], a[248:251], v[160:163], 0
    s_mov_b32 s46, s32
    v_exp_f32 v143, v143
    v_mfma_f32_16x16x32_bf16 a[80:83], a[248:251], v[164:167], 0
    buffer_load_dwordx4 v216, s[12:15], s30 offen offset:3328 nt lds
    v_mfma_f32_16x16x32_bf16 a[128:131], a[248:251], v[168:171], 0
    s_add_u32 s30, s30, 12288
    v_add_f32 v230, v230, v142
    v_accvgpr_write_b32 a232, 0
    v_mfma_f32_16x16x32_bf16 a[176:179], a[248:251], v[172:175], 0
    s_add_u32 m0, s39, 0
    v_exp_f32 v147, v147
    v_mfma_f32_16x16x32_bf16 a[224:227], a[248:251], v[192:195], a[224:227]
    s_waitcnt lgkmcnt(5)
    v_accvgpr_write_b32 a233, 0
    v_accvgpr_write_b32 a234, 0
    v_mfma_f32_16x16x32_bf16 a[36:39], a[252:255], v[160:163], 0
    v_accvgpr_write_b32 a235, 0
    v_add_f32 v231, v231, v146
    v_mfma_f32_16x16x32_bf16 a[84:87], a[252:255], v[164:167], 0
    ds_read_b128 a[244:247], v218 offset:0
    v_add_f32 v232, v232, v149
    v_mfma_f32_16x16x32_bf16 a[132:135], a[252:255], v[168:171], 0
    v_exp_f32 v150, v150
    v_mfma_f32_16x16x32_bf16 a[180:183], a[252:255], v[172:175], 0
    v_exp_f32 v154, v154
    v_mfma_f32_16x16x32_bf16 a[228:231], a[252:255], v[192:195], a[228:231]
    s_waitcnt lgkmcnt(4)
    v_add_f32 v233, v233, v153
    v_accvgpr_write_b32 a236, 0
    v_mfma_f32_16x16x32_bf16 a[40:43], v[240:243], v[160:163], 0
    v_accvgpr_write_b32 a237, 0
    v_accvgpr_write_b32 a238, 0
    v_mfma_f32_16x16x32_bf16 a[88:91], v[240:243], v[164:167], 0
    v_accvgpr_write_b32 a239, 0
    v_sub_f32 v212, 0, v212
    v_mfma_f32_16x16x32_bf16 a[136:139], v[240:243], v[168:171], 0
    v_add_f32 v234, v234, v159
    v_cvt_pk_bf16_f32 v176, v120, v121
    v_mfma_f32_16x16x32_bf16 a[184:187], v[240:243], v[172:175], 0
    v_cvt_pk_bf16_f32 v177, v122, v123
    v_cvt_pk_bf16_f32 v180, v124, v125
    v_mfma_f32_16x16x32_bf16 a[232:235], v[240:243], v[192:195], a[232:235]
    s_waitcnt lgkmcnt(2)
    v_cvt_pk_bf16_f32 v181, v126, v127
    v_cvt_pk_bf16_f32 v184, v128, v129
    v_mfma_f32_16x16x32_bf16 a[44:47], v[244:247], v[160:163], 0
    v_cvt_pk_bf16_f32 v185, v130, v131
    v_cvt_pk_bf16_f32 v188, v132, v133
    v_mfma_f32_16x16x32_bf16 a[92:95], v[244:247], v[164:167], 0
    v_cvt_pk_bf16_f32 v189, v134, v135
    v_add_f32 v230, v230, v143
    v_mfma_f32_16x16x32_bf16 a[140:143], v[244:247], v[168:171], 0
    v_cvt_pk_bf16_f32 v178, v140, v141
    v_cvt_pk_bf16_f32 v179, v142, v143
    v_mfma_f32_16x16x32_bf16 a[188:191], v[244:247], v[172:175], 0
    v_add_f32 v231, v231, v147
    v_cvt_pk_bf16_f32 v182, v144, v145
    v_mfma_f32_16x16x32_bf16 a[236:239], v[244:247], v[192:195], a[236:239]
    s_waitcnt lgkmcnt(1)
    v_cvt_pk_bf16_f32 v183, v146, v147
    v_exp_f32 v151, v151
    v_exp_f32 v155, v155
    v_add_f32 v232, v232, v150
    v_add_f32 v233, v233, v154
    ds_read_b128 a[248:251], v217 offset:1024
    ds_read_b128 a[252:255], v218 offset:1024
    ds_read_b128 v[240:243], v217 offset:2048
    s_cmp_ge_u32 s31, 196608
    s_cselect_b32 s31, 0, s31
    ds_read_b128 v[244:247], v218 offset:2048
K_aj0:
    s_mov_b32 s43, 5
K_al0:
    v_mfma_f32_16x16x32_bf16 v[120:123], a[240:243], v[0:3], v[196:199]
    v_add_f32 v232, v232, v151
    v_cvt_pk_bf16_f32 v186, v148, v149
    v_mfma_f32_16x16x32_bf16 v[124:127], a[240:243], v[24:27], v[200:203]
    v_cvt_pk_bf16_f32 v187, v150, v151
    v_add_f32 v233, v233, v155
    v_mfma_f32_16x16x32_bf16 v[128:131], a[240:243], v[48:51], v[204:207]
    v_cvt_pk_bf16_f32 v190, v152, v153
    v_cvt_pk_bf16_f32 v191, v154, v155
    v_mfma_f32_16x16x32_bf16 v[132:135], a[240:243], v[72:75], v[208:211]
    v_add_u32 v219, s37, v219
    v_add_u32 v220, s37, v220
    v_mfma_f32_16x16x32_bf16 v[136:139], a[240:243], v[96:99], v[212:215]
    s_waitcnt lgkmcnt(4)
    ds_read_b128 a[240:243], v217 offset:6144
    v_add_u32 v221, s37, v221
    v_mfma_f32_16x16x32_bf16 v[120:123], a[244:247], v[4:7], v[120:123]
    s_cmp_ge_u32 s30, 196608
    s_cselect_b32 s30, 0, s30
    v_mfma_f32_16x16x32_bf16 v[124:127], a[244:247], v[28:31], v[124:127]
    v_add_u32 v222, s37, v222
    s_mov_b32 s37, s36
    v_mfma_f32_16x16x32_bf16 v[128:131], a[244:247], v[52:55], v[128:131]
    s_sub_u32 s36, s33, s32
    s_mov_b32 s32, s33
    s_mov_b32 s33, s34
    v_mfma_f32_16x16x32_bf16 v[132:135], a[244:247], v[76:79], v[132:135]
    s_mov_b32 s34, s46
    v_mfma_f32_16x16x32_bf16 v[136:139], a[244:247], v[100:103], v[136:139]
    s_waitcnt lgkmcnt(4)
    ds_read_b128 a[244:247], v218 offset:6144
    v_mfma_f32_16x16x32_bf16 v[120:123], a[248:251], v[8:11], v[120:123]
    v_mfma_f32_16x16x32_bf16 v[124:127], a[248:251], v[32:35], v[124:127]
    v_mfma_f32_16x16x32_bf16 v[128:131], a[248:251], v[56:59], v[128:131]
    v_mfma_f32_16x16x32_bf16 v[132:135], a[248:251], v[80:83], v[132:135]
    v_mfma_f32_16x16x32_bf16 v[136:139], a[248:251], v[104:107], v[136:139]
    s_waitcnt lgkmcnt(4)
    ds_read_b128 a[248:251], v217 offset:7168
    v_mfma_f32_16x16x32_bf16 v[120:123], a[252:255], v[12:15], v[120:123]
    v_mfma_f32_16x16x32_bf16 v[124:127], a[252:255], v[36:39], v[124:127]
    v_mfma_f32_16x16x32_bf16 v[128:131], a[252:255], v[60:63], v[128:131]
    v_mfma_f32_16x16x32_bf16 v[132:135], a[252:255], v[84:87], v[132:135]
    v_mfma_f32_16x16x32_bf16 v[136:139], a[252:255], v[108:111], v[136:139]
    s_waitcnt lgkmcnt(4)
    ds_read_b128 a[252:255], v218 offset:7168
    v_mfma_f32_16x16x32_bf16 v[120:123], v[240:243], v[16:19], v[120:123]
    v_mfma_f32_16x16x32_bf16 v[124:127], v[240:243], v[40:43], v[124:127]
    v_mfma_f32_16x16x32_bf16 v[128:131], v[240:243], v[64:67], v[128:131]
    v_mfma_f32_16x16x32_bf16 v[132:135], v[240:243], v[88:91], v[132:135]
    v_mfma_f32_16x16x32_bf16 v[136:139], v[240:243], v[112:115], v[136:139]
    s_waitcnt lgkmcnt(4)
    s_waitcnt vmcnt(3)
    s_barrier
    v_mfma_f32_16x16x32_bf16 v[120:123], v[244:247], v[20:23], v[120:123]
    buffer_load_dwordx4 v216, s[16:19], s31 offen nt lds
    v_mfma_f32_16x16x32_bf16 v[124:127], v[244:247], v[44:47], v[124:127]
    ds_read_b128 v[240:243], v217 offset:8192
    v_add_u32 v217, s36, v217
    v_mfma_f32_16x16x32_bf16 v[128:131], v[244:247], v[68:71], v[128:131]
    buffer_load_dwordx4 v216, s[16:19], s31 offen offset:3072 nt lds
    v_mfma_f32_16x16x32_bf16 v[132:135], v[244:247], v[92:95], v[132:135]
    s_add_u32 m0, s39, 896
    v_exp_f32 v120, v120
    v_mfma_f32_16x16x32_bf16 v[136:139], v[244:247], v[116:119], v[136:139]
    s_waitcnt lgkmcnt(4)
    buffer_load_dwordx4 v216, s[16:19], s31 offen offset:128 nt lds
    v_mfma_f32_16x16x32_bf16 v[140:143], a[240:243], v[0:3], v[196:199]
    ds_read_b128 v[244:247], v218 offset:8192
    v_add_f32 v230, v230, v120
    v_mfma_f32_16x16x32_bf16 v[144:147], a[240:243], v[24:27], v[200:203]
    buffer_load_dwordx4 v216, s[16:19], s31 offen offset:3200 nt lds
    v_mfma_f32_16x16x32_bf16 v[148:151], a[240:243], v[48:51], v[204:207]
    s_add_u32 m0, s39, 1792
    v_exp_f32 v124, v124
    v_mfma_f32_16x16x32_bf16 v[152:155], a[240:243], v[72:75], v[208:211]
    s_add_u32 s39, s33, s35
    buffer_load_dwordx4 v216, s[16:19], s31 offen offset:256 nt lds
    v_mfma_f32_16x16x32_bf16 v[156:159], a[240:243], v[96:99], v[212:215]
    s_waitcnt lgkmcnt(4)
    ds_read_b64_tr_b16 a[240:241], v219 offset:0
    ds_read_b64_tr_b16 a[242:243], v219 offset:6144
    v_mfma_f32_16x16x32_bf16 v[140:143], a[244:247], v[4:7], v[140:143]
    buffer_load_dwordx4 v216, s[16:19], s31 offen offset:3328 nt lds
    v_mfma_f32_16x16x32_bf16 v[144:147], a[244:247], v[28:31], v[144:147]
    s_add_u32 m0, s46, 0
    v_exp_f32 v128, v128
    v_mfma_f32_16x16x32_bf16 v[148:151], a[244:247], v[52:55], v[148:151]
    s_add_u32 s31, s31, 12288
    v_exp_f32 v132, v132
    v_mfma_f32_16x16x32_bf16 v[152:155], a[244:247], v[76:79], v[152:155]
    v_exp_f32 v121, v121
    v_mfma_f32_16x16x32_bf16 v[156:159], a[244:247], v[100:103], v[156:159]
    s_waitcnt lgkmcnt(5)
    ds_read_b64_tr_b16 a[244:245], v220 offset:0
    ds_read_b64_tr_b16 a[246:247], v220 offset:6144
    v_mfma_f32_16x16x32_bf16 v[140:143], a[248:251], v[8:11], v[140:143]
    v_exp_f32 v125, v125
    v_mfma_f32_16x16x32_bf16 v[144:147], a[248:251], v[32:35], v[144:147]
    v_exp_f32 v129, v129
    v_mfma_f32_16x16x32_bf16 v[148:151], a[248:251], v[56:59], v[148:151]
    v_add_f32 v231, v231, v124
    v_add_f32 v232, v232, v128
    v_mfma_f32_16x16x32_bf16 v[152:155], a[248:251], v[80:83], v[152:155]
    v_exp_f32 v133, v133
    v_mfma_f32_16x16x32_bf16 v[156:159], a[248:251], v[104:107], v[156:159]
    s_waitcnt lgkmcnt(6)
    ds_read_b64_tr_b16 a[248:249], v221 offset:0
    ds_read_b64_tr_b16 a[250:251], v221 offset:6144
    v_mfma_f32_16x16x32_bf16 v[140:143], a[252:255], v[12:15], v[140:143]
    v_add_f32 v233, v233, v132
    v_add_f32 v230, v230, v121
    v_mfma_f32_16x16x32_bf16 v[144:147], a[252:255], v[36:39], v[144:147]
    v_exp_f32 v122, v122
    v_mfma_f32_16x16x32_bf16 v[148:151], a[252:255], v[60:63], v[148:151]
    v_exp_f32 v126, v126
    v_mfma_f32_16x16x32_bf16 v[152:155], a[252:255], v[84:87], v[152:155]
    v_exp_f32 v130, v130
    v_mfma_f32_16x16x32_bf16 v[156:159], a[252:255], v[108:111], v[156:159]
    s_waitcnt lgkmcnt(7)
    ds_read_b64_tr_b16 a[252:253], v222 offset:0
    ds_read_b64_tr_b16 a[254:255], v222 offset:6144
    v_mfma_f32_16x16x32_bf16 v[140:143], v[240:243], v[16:19], v[140:143]
    s_cmp_ge_u32 s31, 196608
    s_cselect_b32 s31, 0, s31
    v_mfma_f32_16x16x32_bf16 v[144:147], v[240:243], v[40:43], v[144:147]
    v_add_f32 v231, v231, v125
    v_add_f32 v232, v232, v129
    v_mfma_f32_16x16x32_bf16 v[148:151], v[240:243], v[64:67], v[148:151]
    v_exp_f32 v134, v134
    v_mfma_f32_16x16x32_bf16 v[152:155], v[240:243], v[88:91], v[152:155]
    v_add_u32 v218, s36, v218
    v_add_f32 v233, v233, v133
    v_mfma_f32_16x16x32_bf16 v[156:159], v[240:243], v[112:115], v[156:159]
    s_waitcnt lgkmcnt(8)
    ds_read_b64_tr_b16 v[240:241], v219 offset:1024
    ds_read_b64_tr_b16 v[242:243], v219 offset:7168
    v_mfma_f32_16x16x32_bf16 v[140:143], v[244:247], v[20:23], v[140:143]
    v_exp_f32 v123, v123
    v_mfma_f32_16x16x32_bf16 v[144:147], v[244:247], v[44:47], v[144:147]
    v_add_f32 v230, v230, v122
    v_add_f32 v231, v231, v126
    v_mfma_f32_16x16x32_bf16 v[148:151], v[244:247], v[68:71], v[148:151]
    v_exp_f32 v127, v127
    v_mfma_f32_16x16x32_bf16 v[152:155], v[244:247], v[92:95], v[152:155]
    v_exp_f32 v131, v131
    v_mfma_f32_16x16x32_bf16 v[156:159], v[244:247], v[116:119], v[156:159]
    s_waitcnt lgkmcnt(8)
    ds_read_b64_tr_b16 v[244:245], v220 offset:1024
    ds_read_b64_tr_b16 v[246:247], v220 offset:7168
    v_mfma_f32_16x16x32_bf16 a[0:3], a[240:243], v[176:179], a[0:3]
    v_add_f32 v232, v232, v130
    v_add_f32 v233, v233, v134
    v_mfma_f32_16x16x32_bf16 a[48:51], a[240:243], v[180:183], a[48:51]
    v_exp_f32 v135, v135
    v_mfma_f32_16x16x32_bf16 a[96:99], a[240:243], v[184:187], a[96:99]
    v_add_f32 v230, v230, v123
    v_cvt_pk_bf16_f32 v160, v120, v121
    v_mfma_f32_16x16x32_bf16 a[144:147], a[240:243], v[188:191], a[144:147]
    s_waitcnt lgkmcnt(8)
    ds_read_b64_tr_b16 a[240:241], v221 offset:1024
    ds_read_b64_tr_b16 a[242:243], v221 offset:7168
    v_mfma_f32_16x16x32_bf16 a[4:7], a[244:247], v[176:179], a[4:7]
    v_cvt_pk_bf16_f32 v161, v122, v123
    v_add_f32 v231, v231, v127
    v_mfma_f32_16x16x32_bf16 a[52:55], a[244:247], v[180:183], a[52:55]
    v_exp_f32 v140, v140
    v_mfma_f32_16x16x32_bf16 a[100:103], a[244:247], v[184:187], a[100:103]
    v_cvt_pk_bf16_f32 v164, v124, v125
    v_cvt_pk_bf16_f32 v165, v126, v127
    v_mfma_f32_16x16x32_bf16 a[148:151], a[244:247], v[188:191], a[148:151]
    s_waitcnt lgkmcnt(8)
    ds_read_b64_tr_b16 a[244:245], v222 offset:1024
    ds_read_b64_tr_b16 a[246:247], v222 offset:7168
    v_mfma_f32_16x16x32_bf16 a[8:11], a[248:251], v[176:179], a[8:11]
    v_add_f32 v232, v232, v131
    v_cvt_pk_bf16_f32 v168, v128, v129
    v_mfma_f32_16x16x32_bf16 a[56:59], a[248:251], v[180:183], a[56:59]
    v_cvt_pk_bf16_f32 v169, v130, v131
    v_add_f32 v233, v233, v135
    v_mfma_f32_16x16x32_bf16 a[104:107], a[248:251], v[184:187], a[104:107]
    v_cvt_pk_bf16_f32 v172, v132, v133
    v_cvt_pk_bf16_f32 v173, v134, v135
    v_mfma_f32_16x16x32_bf16 a[152:155], a[248:251], v[188:191], a[152:155]
    s_waitcnt lgkmcnt(8)
    ds_read_b64_tr_b16 a[248:249], v219 offset:2048
    ds_read_b64_tr_b16 a[250:251], v219 offset:8192
    v_mfma_f32_16x16x32_bf16 a[12:15], a[252:255], v[176:179], a[12:15]
    v_exp_f32 v144, v144
    v_mfma_f32_16x16x32_bf16 a[60:63], a[252:255], v[180:183], a[60:63]
    v_exp_f32 v148, v148
    v_mfma_f32_16x16x32_bf16 a[108:111], a[252:255], v[184:187], a[108:111]
    v_exp_f32 v141, v141
    v_mfma_f32_16x16x32_bf16 a[156:159], a[252:255], v[188:191], a[156:159]
    s_waitcnt lgkmcnt(8)
    ds_read_b64_tr_b16 a[252:253], v220 offset:2048
    ds_read_b64_tr_b16 a[254:255], v220 offset:8192
    v_mfma_f32_16x16x32_bf16 a[16:19], v[240:243], v[176:179], a[16:19]
    v_add_f32 v230, v230, v140
    v_add_f32 v231, v231, v144
    v_mfma_f32_16x16x32_bf16 a[64:67], v[240:243], v[180:183], a[64:67]
    v_exp_f32 v145, v145
    v_mfma_f32_16x16x32_bf16 a[112:115], v[240:243], v[184:187], a[112:115]
    s_waitcnt vmcnt(3)
    s_barrier
    v_add_f32 v232, v232, v148
    v_mfma_f32_16x16x32_bf16 a[160:163], v[240:243], v[188:191], a[160:163]
    s_waitcnt lgkmcnt(8)
    buffer_load_dwordx4 v216, s[12:15], s30 offen nt lds
    v_mfma_f32_16x16x32_bf16 a[20:23], v[244:247], v[176:179], a[20:23]
    ds_read_b64_tr_b16 v[240:241], v221 offset:2048
    ds_read_b64_tr_b16 v[242:243], v221 offset:8192
    v_mfma_f32_16x16x32_bf16 a[68:71], v[244:247], v[180:183], a[68:71]
    buffer_load_dwordx4 v216, s[12:15], s30 offen offset:3072 nt lds
    v_mfma_f32_16x16x32_bf16 a[116:119], v[244:247], v[184:187], a[116:119]
    s_add_u32 m0, s46, 896
    v_exp_f32 v152, v152
    v_mfma_f32_16x16x32_bf16 a[164:167], v[244:247], v[188:191], a[164:167]
    s_waitcnt lgkmcnt(8)
    buffer_load_dwordx4 v216, s[12:15], s30 offen offset:128 nt lds
    v_mfma_f32_16x16x32_bf16 a[24:27], a[240:243], v[176:179], a[24:27]
    ds_read_b64_tr_b16 v[244:245], v222 offset:2048
    ds_read_b64_tr_b16 v[246:247], v222 offset:8192
    v_mfma_f32_16x16x32_bf16 a[72:75], a[240:243], v[180:183], a[72:75]
    buffer_load_dwordx4 v216, s[12:15], s30 offen offset:3200 nt lds
    v_mfma_f32_16x16x32_bf16 a[120:123], a[240:243], v[184:187], a[120:123]
    s_add_u32 m0, s46, 1792
    v_exp_f32 v149, v149
    v_mfma_f32_16x16x32_bf16 a[168:171], a[240:243], v[188:191], a[168:171]
    s_waitcnt lgkmcnt(8)
    buffer_load_dwordx4 v216, s[12:15], s30 offen offset:256 nt lds
    v_mfma_f32_16x16x32_bf16 a[28:31], a[244:247], v[176:179], a[28:31]
    s_mov_b32 s46, s32
    ds_read_b128 a[240:243], v217 offset:0
    v_add_f32 v230, v230, v141
    v_mfma_f32_16x16x32_bf16 a[76:79], a[244:247], v[180:183], a[76:79]
    buffer_load_dwordx4 v216, s[12:15], s30 offen offset:3328 nt lds
    v_mfma_f32_16x16x32_bf16 a[124:127], a[244:247], v[184:187], a[124:127]
    s_add_u32 m0, s39, 0
    v_exp_f32 v142, v142
    v_mfma_f32_16x16x32_bf16 a[172:175], a[244:247], v[188:191], a[172:175]
    s_waitcnt lgkmcnt(7)
    ds_read_b128 a[244:247], v218 offset:0
    v_add_f32 v231, v231, v145
    v_mfma_f32_16x16x32_bf16 a[32:35], a[248:251], v[176:179], a[32:35]
    s_add_u32 s30, s30, 12288
    v_exp_f32 v146, v146
    v_mfma_f32_16x16x32_bf16 a[80:83], a[248:251], v[180:183], a[80:83]
    v_exp_f32 v153, v153
    v_mfma_f32_16x16x32_bf16 a[128:131], a[248:251], v[184:187], a[128:131]
    v_exp_f32 v150, v150
    v_mfma_f32_16x16x32_bf16 a[176:179], a[248:251], v[188:191], a[176:179]
    s_waitcnt lgkmcnt(6)
    ds_read_b128 a[248:251], v217 offset:1024
    v_add_f32 v233, v233, v152
    v_mfma_f32_16x16x32_bf16 a[36:39], a[252:255], v[176:179], a[36:39]
    v_add_f32 v232, v232, v149
    v_add_f32 v230, v230, v142
    v_mfma_f32_16x16x32_bf16 a[84:87], a[252:255], v[180:183], a[84:87]
    v_exp_f32 v143, v143
    v_mfma_f32_16x16x32_bf16 a[132:135], a[252:255], v[184:187], a[132:135]
    v_exp_f32 v147, v147
    v_mfma_f32_16x16x32_bf16 a[180:183], a[252:255], v[188:191], a[180:183]
    s_waitcnt lgkmcnt(5)
    ds_read_b128 a[252:255], v218 offset:1024
    v_add_f32 v231, v231, v146
    v_mfma_f32_16x16x32_bf16 a[40:43], v[240:243], v[176:179], a[40:43]
    v_exp_f32 v154, v154
    v_mfma_f32_16x16x32_bf16 a[88:91], v[240:243], v[180:183], a[88:91]
    v_exp_f32 v151, v151
    v_mfma_f32_16x16x32_bf16 a[136:139], v[240:243], v[184:187], a[136:139]
    v_add_f32 v233, v233, v153
    v_add_f32 v232, v232, v150
    v_mfma_f32_16x16x32_bf16 a[184:187], v[240:243], v[188:191], a[184:187]
    s_waitcnt lgkmcnt(4)
    ds_read_b128 v[240:243], v217 offset:2048
    v_add_f32 v230, v230, v143
    v_mfma_f32_16x16x32_bf16 a[44:47], v[244:247], v[176:179], a[44:47]
    v_cvt_pk_bf16_f32 v162, v140, v141
    v_cvt_pk_bf16_f32 v163, v142, v143
    v_mfma_f32_16x16x32_bf16 a[92:95], v[244:247], v[180:183], a[92:95]
    v_add_f32 v231, v231, v147
    v_cvt_pk_bf16_f32 v166, v144, v145
    v_mfma_f32_16x16x32_bf16 a[140:143], v[244:247], v[184:187], a[140:143]
    v_cvt_pk_bf16_f32 v167, v146, v147
    v_add_f32 v233, v233, v154
    v_mfma_f32_16x16x32_bf16 a[188:191], v[244:247], v[188:191], a[188:191]
    s_waitcnt lgkmcnt(4)
    ds_read_b128 v[244:247], v218 offset:2048
    v_add_f32 v232, v232, v151
    v_mfma_f32_16x16x32_bf16 v[120:123], a[240:243], v[0:3], v[196:199]
    v_exp_f32 v155, v155
    v_mfma_f32_16x16x32_bf16 v[124:127], a[240:243], v[24:27], v[200:203]
    v_cvt_pk_bf16_f32 v170, v148, v149
    v_cvt_pk_bf16_f32 v171, v150, v151
    v_mfma_f32_16x16x32_bf16 v[128:131], a[240:243], v[48:51], v[204:207]
    v_add_f32 v233, v233, v155
    v_cvt_pk_bf16_f32 v174, v152, v153
    v_mfma_f32_16x16x32_bf16 v[132:135], a[240:243], v[72:75], v[208:211]
    s_waitcnt lgkmcnt(4)
    ds_read_b128 a[240:243], v217 offset:6144
    v_cvt_pk_bf16_f32 v175, v154, v155
    v_mfma_f32_16x16x32_bf16 v[120:123], a[244:247], v[4:7], v[120:123]
    v_add_u32 v219, s37, v219
    v_add_u32 v220, s37, v220
    v_mfma_f32_16x16x32_bf16 v[124:127], a[244:247], v[28:31], v[124:127]
    v_add_u32 v221, s37, v221
    v_add_u32 v222, s37, v222
    v_mfma_f32_16x16x32_bf16 v[128:131], a[244:247], v[52:55], v[128:131]
    s_mov_b32 s37, s36
    v_exp_f32 v136, v136
    v_mfma_f32_16x16x32_bf16 v[132:135], a[244:247], v[76:79], v[132:135]
    s_waitcnt lgkmcnt(4)
    ds_read_b128 a[244:247], v218 offset:6144
    v_add_f32 v234, v234, v136
    v_mfma_f32_16x16x32_bf16 v[120:123], a[248:251], v[8:11], v[120:123]
    s_sub_u32 s36, s33, s32
    v_exp_f32 v137, v137
    v_mfma_f32_16x16x32_bf16 v[124:127], a[248:251], v[32:35], v[124:127]
    s_mov_b32 s32, s33
    v_exp_f32 v138, v138
    v_mfma_f32_16x16x32_bf16 v[128:131], a[248:251], v[56:59], v[128:131]
    s_mov_b32 s33, s34
    v_exp_f32 v139, v139
    v_mfma_f32_16x16x32_bf16 v[132:135], a[248:251], v[80:83], v[132:135]
    s_waitcnt lgkmcnt(4)
    ds_read_b128 a[248:251], v217 offset:7168
    v_cvt_pk_bf16_f32 v192, v136, v137
    v_mfma_f32_16x16x32_bf16 v[120:123], a[252:255], v[12:15], v[120:123]
    s_mov_b32 s34, s46
    v_exp_f32 v156, v156
    v_mfma_f32_16x16x32_bf16 v[124:127], a[252:255], v[36:39], v[124:127]
    v_exp_f32 v157, v157
    v_mfma_f32_16x16x32_bf16 v[128:131], a[252:255], v[60:63], v[128:131]
    v_exp_f32 v158, v158
    v_mfma_f32_16x16x32_bf16 v[132:135], a[252:255], v[84:87], v[132:135]
    s_waitcnt lgkmcnt(4)
    ds_read_b128 a[252:255], v218 offset:7168
    v_cvt_pk_bf16_f32 v193, v138, v139
    v_mfma_f32_16x16x32_bf16 v[120:123], v[240:243], v[16:19], v[120:123]
    v_exp_f32 v159, v159
    v_mfma_f32_16x16x32_bf16 v[124:127], v[240:243], v[40:43], v[124:127]
    v_cvt_pk_bf16_f32 v194, v156, v157
    v_cvt_pk_bf16_f32 v195, v158, v159
    v_mfma_f32_16x16x32_bf16 v[128:131], v[240:243], v[64:67], v[128:131]
    s_cmp_ge_u32 s30, 196608
    s_cselect_b32 s30, 0, s30
    v_mfma_f32_16x16x32_bf16 v[132:135], v[240:243], v[88:91], v[132:135]
    s_waitcnt lgkmcnt(4)
    ds_read_b128 v[240:243], v217 offset:8192
    v_add_u32 v217, s36, v217
    v_mfma_f32_16x16x32_bf16 v[120:123], v[244:247], v[20:23], v[120:123]
    v_add_f32 v234, v234, v137
    v_add_f32 v234, v234, v138
    v_mfma_f32_16x16x32_bf16 v[124:127], v[244:247], v[44:47], v[124:127]
    v_add_f32 v234, v234, v139
    v_add_f32 v234, v234, v156
    v_mfma_f32_16x16x32_bf16 v[128:131], v[244:247], v[68:71], v[128:131]
    v_add_f32 v234, v234, v157
    v_add_f32 v234, v234, v158
    v_mfma_f32_16x16x32_bf16 v[132:135], v[244:247], v[92:95], v[132:135]
    s_waitcnt lgkmcnt(4)
    ds_read_b128 v[244:247], v218 offset:8192
    v_add_u32 v218, s36, v218
    v_mfma_f32_16x16x32_bf16 v[140:143], a[240:243], v[0:3], v[196:199]
    s_waitcnt vmcnt(3)
    s_barrier
    v_add_f32 v234, v234, v159
    v_mfma_f32_16x16x32_bf16 v[144:147], a[240:243], v[24:27], v[200:203]
    buffer_load_dwordx4 v216, s[16:19], s31 offen nt lds
    v_mfma_f32_16x16x32_bf16 v[148:151], a[240:243], v[48:51], v[204:207]
    v_exp_f32 v120, v120
    v_mfma_f32_16x16x32_bf16 v[152:155], a[240:243], v[72:75], v[208:211]
    s_waitcnt lgkmcnt(4)
    buffer_load_dwordx4 v216, s[16:19], s31 offen offset:3072 nt lds
    v_mfma_f32_16x16x32_bf16 v[140:143], a[244:247], v[4:7], v[140:143]
    s_add_u32 m0, s39, 896
    ds_read_b64_tr_b16 a[240:241], v219 offset:0
    ds_read_b64_tr_b16 a[242:243], v219 offset:6144
    v_mfma_f32_16x16x32_bf16 v[144:147], a[244:247], v[28:31], v[144:147]
    buffer_load_dwordx4 v216, s[16:19], s31 offen offset:128 nt lds
    v_mfma_f32_16x16x32_bf16 v[148:151], a[244:247], v[52:55], v[148:151]
    v_exp_f32 v124, v124
    v_mfma_f32_16x16x32_bf16 v[152:155], a[244:247], v[76:79], v[152:155]
    s_waitcnt lgkmcnt(5)
    buffer_load_dwordx4 v216, s[16:19], s31 offen offset:3200 nt lds
    v_mfma_f32_16x16x32_bf16 v[140:143], a[248:251], v[8:11], v[140:143]
    s_add_u32 m0, s39, 1792
    ds_read_b64_tr_b16 a[244:245], v220 offset:0
    ds_read_b64_tr_b16 a[246:247], v220 offset:6144
    v_mfma_f32_16x16x32_bf16 v[144:147], a[248:251], v[32:35], v[144:147]
    s_add_u32 s39, s33, s35
    buffer_load_dwordx4 v216, s[16:19], s31 offen offset:256 nt lds
    v_mfma_f32_16x16x32_bf16 v[148:151], a[248:251], v[56:59], v[148:151]
    v_exp_f32 v128, v128
    v_mfma_f32_16x16x32_bf16 v[152:155], a[248:251], v[80:83], v[152:155]
    s_waitcnt lgkmcnt(6)
    buffer_load_dwordx4 v216, s[16:19], s31 offen offset:3328 nt lds
    v_mfma_f32_16x16x32_bf16 v[140:143], a[252:255], v[12:15], v[140:143]
    s_add_u32 m0, s46, 0
    ds_read_b64_tr_b16 a[248:249], v221 offset:0
    ds_read_b64_tr_b16 a[250:251], v221 offset:6144
    v_mfma_f32_16x16x32_bf16 v[144:147], a[252:255], v[36:39], v[144:147]
    s_add_u32 s31, s31, 12288
    v_exp_f32 v132, v132
    v_mfma_f32_16x16x32_bf16 v[148:151], a[252:255], v[60:63], v[148:151]
    v_exp_f32 v121, v121
    v_mfma_f32_16x16x32_bf16 v[152:155], a[252:255], v[84:87], v[152:155]
    s_waitcnt lgkmcnt(7)
    ds_read_b64_tr_b16 a[252:253], v222 offset:0
    ds_read_b64_tr_b16 a[254:255], v222 offset:6144
    v_mfma_f32_16x16x32_bf16 v[140:143], v[240:243], v[16:19], v[140:143]
    s_cmp_eq_u32 s43, 0
    s_cselect_b32 s14, 0, s14
    v_mfma_f32_16x16x32_bf16 v[144:147], v[240:243], v[40:43], v[144:147]
    v_add_f32 v230, v230, v120
    v_add_f32 v231, v231, v124
    v_mfma_f32_16x16x32_bf16 v[148:151], v[240:243], v[64:67], v[148:151]
    v_exp_f32 v125, v125
    v_mfma_f32_16x16x32_bf16 v[152:155], v[240:243], v[88:91], v[152:155]
    s_waitcnt lgkmcnt(8)
    ds_read_b64_tr_b16 v[240:241], v219 offset:1024
    ds_read_b64_tr_b16 v[242:243], v219 offset:7168
    v_mfma_f32_16x16x32_bf16 v[140:143], v[244:247], v[20:23], v[140:143]
    v_exp_f32 v129, v129
    v_mfma_f32_16x16x32_bf16 v[144:147], v[244:247], v[44:47], v[144:147]
    v_add_f32 v232, v232, v128
    v_add_f32 v233, v233, v132
    v_mfma_f32_16x16x32_bf16 v[148:151], v[244:247], v[68:71], v[148:151]
    v_exp_f32 v133, v133
    v_mfma_f32_16x16x32_bf16 v[152:155], v[244:247], v[92:95], v[152:155]
    s_waitcnt lgkmcnt(8)
    ds_read_b64_tr_b16 v[244:245], v220 offset:1024
    ds_read_b64_tr_b16 v[246:247], v220 offset:7168
    v_mfma_f32_16x16x32_bf16 a[0:3], a[240:243], v[160:163], a[0:3]
    v_exp_f32 v122, v122
    v_mfma_f32_16x16x32_bf16 a[48:51], a[240:243], v[164:167], a[48:51]
    v_exp_f32 v126, v126
    v_mfma_f32_16x16x32_bf16 a[96:99], a[240:243], v[168:171], a[96:99]
    s_cmp_ge_u32 s31, 196608
    s_cselect_b32 s31, 0, s31
    v_mfma_f32_16x16x32_bf16 a[144:147], a[240:243], v[172:175], a[144:147]
    v_add_f32 v230, v230, v121
    v_add_f32 v231, v231, v125
    v_mfma_f32_16x16x32_bf16 a[192:195], a[240:243], v[192:195], a[192:195]
    s_waitcnt lgkmcnt(8)
    ds_read_b64_tr_b16 a[240:241], v221 offset:1024
    ds_read_b64_tr_b16 a[242:243], v221 offset:7168
    v_mfma_f32_16x16x32_bf16 a[4:7], a[244:247], v[160:163], a[4:7]
    v_exp_f32 v130, v130
    v_mfma_f32_16x16x32_bf16 a[52:55], a[244:247], v[164:167], a[52:55]
    v_add_f32 v232, v232, v129
    v_add_f32 v233, v233, v133
    v_mfma_f32_16x16x32_bf16 a[100:103], a[244:247], v[168:171], a[100:103]
    v_exp_f32 v134, v134
    v_mfma_f32_16x16x32_bf16 a[148:151], a[244:247], v[172:175], a[148:151]
    v_exp_f32 v123, v123
    v_mfma_f32_16x16x32_bf16 a[196:199], a[244:247], v[192:195], a[196:199]
    s_waitcnt lgkmcnt(8)
    ds_read_b64_tr_b16 a[244:245], v222 offset:1024
    ds_read_b64_tr_b16 a[246:247], v222 offset:7168
    v_mfma_f32_16x16x32_bf16 a[8:11], a[248:251], v[160:163], a[8:11]
    v_exp_f32 v127, v127
    v_mfma_f32_16x16x32_bf16 a[56:59], a[248:251], v[164:167], a[56:59]
    v_add_f32 v230, v230, v122
    v_add_f32 v231, v231, v126
    v_mfma_f32_16x16x32_bf16 a[104:107], a[248:251], v[168:171], a[104:107]
    v_exp_f32 v131, v131
    v_mfma_f32_16x16x32_bf16 a[152:155], a[248:251], v[172:175], a[152:155]
    v_add_f32 v232, v232, v130
    v_add_f32 v233, v233, v134
    v_mfma_f32_16x16x32_bf16 a[200:203], a[248:251], v[192:195], a[200:203]
    s_waitcnt lgkmcnt(8)
    ds_read_b64_tr_b16 a[248:249], v219 offset:2048
    ds_read_b64_tr_b16 a[250:251], v219 offset:8192
    v_mfma_f32_16x16x32_bf16 a[12:15], a[252:255], v[160:163], a[12:15]
    v_exp_f32 v135, v135
    v_mfma_f32_16x16x32_bf16 a[60:63], a[252:255], v[164:167], a[60:63]
    v_add_f32 v230, v230, v123
    v_cvt_pk_bf16_f32 v176, v120, v121
    v_mfma_f32_16x16x32_bf16 a[108:111], a[252:255], v[168:171], a[108:111]
    v_cvt_pk_bf16_f32 v177, v122, v123
    v_add_f32 v231, v231, v127
    v_mfma_f32_16x16x32_bf16 a[156:159], a[252:255], v[172:175], a[156:159]
    v_cvt_pk_bf16_f32 v180, v124, v125
    v_cvt_pk_bf16_f32 v181, v126, v127
    v_mfma_f32_16x16x32_bf16 a[204:207], a[252:255], v[192:195], a[204:207]
    s_waitcnt lgkmcnt(8)
    ds_read_b64_tr_b16 a[252:253], v220 offset:2048
    ds_read_b64_tr_b16 a[254:255], v220 offset:8192
    v_mfma_f32_16x16x32_bf16 a[16:19], v[240:243], v[160:163], a[16:19]
    v_add_f32 v232, v232, v131
    v_cvt_pk_bf16_f32 v184, v128, v129
    v_mfma_f32_16x16x32_bf16 a[64:67], v[240:243], v[164:167], a[64:67]
    v_cvt_pk_bf16_f32 v185, v130, v131
    v_add_f32 v233, v233, v135
    v_mfma_f32_16x16x32_bf16 a[112:115], v[240:243], v[168:171], a[112:115]
    v_exp_f32 v140, v140
    v_mfma_f32_16x16x32_bf16 a[160:163], v[240:243], v[172:175], a[160:163]
    v_cvt_pk_bf16_f32 v188, v132, v133
    v_cvt_pk_bf16_f32 v189, v134, v135
    v_mfma_f32_16x16x32_bf16 a[208:211], v[240:243], v[192:195], a[208:211]
    s_waitcnt lgkmcnt(8)
    ds_read_b64_tr_b16 v[240:241], v221 offset:2048
    ds_read_b64_tr_b16 v[242:243], v221 offset:8192
    v_mfma_f32_16x16x32_bf16 a[20:23], v[244:247], v[160:163], a[20:23]
    v_exp_f32 v144, v144
    v_mfma_f32_16x16x32_bf16 a[68:71], v[244:247], v[164:167], a[68:71]
    v_exp_f32 v148, v148
    v_mfma_f32_16x16x32_bf16 a[116:119], v[244:247], v[168:171], a[116:119]
    v_exp_f32 v141, v141
    v_mfma_f32_16x16x32_bf16 a[164:167], v[244:247], v[172:175], a[164:167]
    v_add_f32 v230, v230, v140
    v_add_f32 v231, v231, v144
    v_mfma_f32_16x16x32_bf16 a[212:215], v[244:247], v[192:195], a[212:215]
    s_waitcnt lgkmcnt(8)
    ds_read_b64_tr_b16 v[244:245], v222 offset:2048
    ds_read_b64_tr_b16 v[246:247], v222 offset:8192
    v_mfma_f32_16x16x32_bf16 a[24:27], a[240:243], v[160:163], a[24:27]
    s_waitcnt vmcnt(3)
    s_barrier
    v_add_f32 v232, v232, v148
    v_mfma_f32_16x16x32_bf16 a[72:75], a[240:243], v[164:167], a[72:75]
    buffer_load_dwordx4 v216, s[12:15], s30 offen nt lds
    v_mfma_f32_16x16x32_bf16 a[120:123], a[240:243], v[168:171], a[120:123]
    v_exp_f32 v152, v152
    v_mfma_f32_16x16x32_bf16 a[168:171], a[240:243], v[172:175], a[168:171]
    buffer_load_dwordx4 v216, s[12:15], s30 offen offset:3072 nt lds
    v_mfma_f32_16x16x32_bf16 a[216:219], a[240:243], v[192:195], a[216:219]
    s_waitcnt lgkmcnt(8)
    s_add_u32 m0, s46, 896
    ds_read_b128 a[240:243], v217 offset:0
    v_mfma_f32_16x16x32_bf16 a[28:31], a[244:247], v[160:163], a[28:31]
    buffer_load_dwordx4 v216, s[12:15], s30 offen offset:128 nt lds
    v_mfma_f32_16x16x32_bf16 a[76:79], a[244:247], v[164:167], a[76:79]
    v_exp_f32 v145, v145
    v_mfma_f32_16x16x32_bf16 a[124:127], a[244:247], v[168:171], a[124:127]
    buffer_load_dwordx4 v216, s[12:15], s30 offen offset:3200 nt lds
    v_mfma_f32_16x16x32_bf16 a[172:175], a[244:247], v[172:175], a[172:175]
    s_add_u32 m0, s46, 1792
    v_exp_f32 v149, v149
    v_mfma_f32_16x16x32_bf16 a[220:223], a[244:247], v[192:195], a[220:223]
    s_waitcnt lgkmcnt(7)
    buffer_load_dwordx4 v216, s[12:15], s30 offen offset:256 nt lds
    v_mfma_f32_16x16x32_bf16 a[32:35], a[248:251], v[160:163], a[32:35]
    s_mov_b32 s46, s32
    ds_read_b128 a[244:247], v218 offset:0
    v_add_f32 v230, v230, v141
    v_mfma_f32_16x16x32_bf16 a[80:83], a[248:251], v[164:167], a[80:83]
    buffer_load_dwordx4 v216, s[12:15], s30 offen offset:3328 nt lds
    v_mfma_f32_16x16x32_bf16 a[128:131], a[248:251], v[168:171], a[128:131]
    s_add_u32 m0, s39, 0
    v_exp_f32 v142, v142
    v_mfma_f32_16x16x32_bf16 a[176:179], a[248:251], v[172:175], a[176:179]
    s_add_u32 s30, s30, 12288
    v_exp_f32 v153, v153
    v_mfma_f32_16x16x32_bf16 a[224:227], a[248:251], v[192:195], a[224:227]
    s_waitcnt lgkmcnt(6)
    ds_read_b128 a[248:251], v217 offset:1024
    v_add_f32 v233, v233, v152
    v_mfma_f32_16x16x32_bf16 a[36:39], a[252:255], v[160:163], a[36:39]
    v_exp_f32 v146, v146
    v_mfma_f32_16x16x32_bf16 a[84:87], a[252:255], v[164:167], a[84:87]
    v_exp_f32 v150, v150
    v_mfma_f32_16x16x32_bf16 a[132:135], a[252:255], v[168:171], a[132:135]
    v_add_f32 v231, v231, v145
    v_add_f32 v232, v232, v149
    v_mfma_f32_16x16x32_bf16 a[180:183], a[252:255], v[172:175], a[180:183]
    v_exp_f32 v143, v143
    v_mfma_f32_16x16x32_bf16 a[228:231], a[252:255], v[192:195], a[228:231]
    s_waitcnt lgkmcnt(5)
    ds_read_b128 a[252:255], v218 offset:1024
    v_add_f32 v230, v230, v142
    v_mfma_f32_16x16x32_bf16 a[40:43], v[240:243], v[160:163], a[40:43]
    v_exp_f32 v154, v154
    v_mfma_f32_16x16x32_bf16 a[88:91], v[240:243], v[164:167], a[88:91]
    v_exp_f32 v147, v147
    v_mfma_f32_16x16x32_bf16 a[136:139], v[240:243], v[168:171], a[136:139]
    v_add_f32 v233, v233, v153
    v_add_f32 v231, v231, v146
    v_mfma_f32_16x16x32_bf16 a[184:187], v[240:243], v[172:175], a[184:187]
    v_exp_f32 v151, v151
    v_mfma_f32_16x16x32_bf16 a[232:235], v[240:243], v[192:195], a[232:235]
    s_waitcnt lgkmcnt(4)
    ds_read_b128 v[240:243], v217 offset:2048
    v_add_f32 v232, v232, v150
    v_mfma_f32_16x16x32_bf16 a[44:47], v[244:247], v[160:163], a[44:47]
    v_add_f32 v230, v230, v143
    v_cvt_pk_bf16_f32 v178, v140, v141
    v_mfma_f32_16x16x32_bf16 a[92:95], v[244:247], v[164:167], a[92:95]
    v_exp_f32 v155, v155
    v_mfma_f32_16x16x32_bf16 a[140:143], v[244:247], v[168:171], a[140:143]
    v_cvt_pk_bf16_f32 v179, v142, v143
    v_add_f32 v233, v233, v154
    v_mfma_f32_16x16x32_bf16 a[188:191], v[244:247], v[172:175], a[188:191]
    v_add_f32 v231, v231, v147
    v_cvt_pk_bf16_f32 v182, v144, v145
    v_mfma_f32_16x16x32_bf16 a[236:239], v[244:247], v[192:195], a[236:239]
    s_waitcnt lgkmcnt(4)
    ds_read_b128 v[244:247], v218 offset:2048
    v_cvt_pk_bf16_f32 v183, v146, v147
    s_sub_u32 s43, s43, 1
    s_cbranch_scc0 K_al0
    v_mfma_f32_16x16x32_bf16 v[120:123], a[240:243], v[0:3], v[196:199]
    s_add_u32 s38, s44, 0
    v_add_f32 v232, v232, v151
    v_cvt_pk_bf16_f32 v186, v148, v149
    v_mfma_f32_16x16x32_bf16 v[124:127], a[240:243], v[24:27], v[200:203]
    v_cvt_pk_bf16_f32 v187, v150, v151
    v_add_f32 v233, v233, v155
    v_mfma_f32_16x16x32_bf16 v[128:131], a[240:243], v[48:51], v[204:207]
    v_cvt_pk_bf16_f32 v190, v152, v153
    v_cvt_pk_bf16_f32 v191, v154, v155
    v_mfma_f32_16x16x32_bf16 v[132:135], a[240:243], v[72:75], v[208:211]
    s_add_u32 s12, s12, 3145728
    s_addc_u32 s13, s13, 0
    v_mfma_f32_16x16x32_bf16 v[136:139], a[240:243], v[96:99], v[212:215]
    s_waitcnt lgkmcnt(4)
    ds_read_b128 a[240:243], v217 offset:6144
    s_mul_i32 s14, s75, 196608
    v_mfma_f32_16x16x32_bf16 v[120:123], a[244:247], v[4:7], v[120:123]
    s_cmp_ge_u32 s30, 196608
    s_cselect_b32 s30, 0, s30
    v_mfma_f32_16x16x32_bf16 v[124:127], a[244:247], v[28:31], v[124:127]
    v_add_u32 v219, s37, v219
    v_add_u32 v220, s37, v220
    v_mfma_f32_16x16x32_bf16 v[128:131], a[244:247], v[52:55], v[128:131]
    v_add_u32 v221, s37, v221
    v_add_u32 v222, s37, v222
    v_mfma_f32_16x16x32_bf16 v[132:135], a[244:247], v[76:79], v[132:135]
    s_mov_b32 s37, s36
    s_sub_u32 s36, s33, s32
    s_mov_b32 s32, s33
    v_mfma_f32_16x16x32_bf16 v[136:139], a[244:247], v[100:103], v[136:139]
    s_waitcnt lgkmcnt(4)
    ds_read_b128 a[244:247], v218 offset:6144
    s_mov_b32 s33, s34
    v_mfma_f32_16x16x32_bf16 v[120:123], a[248:251], v[8:11], v[120:123]
    v_mfma_f32_16x16x32_bf16 v[124:127], a[248:251], v[32:35], v[124:127]
    v_mfma_f32_16x16x32_bf16 v[128:131], a[248:251], v[56:59], v[128:131]
    v_mfma_f32_16x16x32_bf16 v[132:135], a[248:251], v[80:83], v[132:135]
    v_mfma_f32_16x16x32_bf16 v[136:139], a[248:251], v[104:107], v[136:139]
    s_waitcnt lgkmcnt(4)
    ds_read_b128 a[248:251], v217 offset:7168
    v_mfma_f32_16x16x32_bf16 v[120:123], a[252:255], v[12:15], v[120:123]
    v_mfma_f32_16x16x32_bf16 v[124:127], a[252:255], v[36:39], v[124:127]
    v_mfma_f32_16x16x32_bf16 v[128:131], a[252:255], v[60:63], v[128:131]
    v_mfma_f32_16x16x32_bf16 v[132:135], a[252:255], v[84:87], v[132:135]
    v_mfma_f32_16x16x32_bf16 v[136:139], a[252:255], v[108:111], v[136:139]
    s_waitcnt lgkmcnt(4)
    ds_read_b128 a[252:255], v218 offset:7168
    v_mfma_f32_16x16x32_bf16 v[120:123], v[240:243], v[16:19], v[120:123]
    v_mfma_f32_16x16x32_bf16 v[124:127], v[240:243], v[40:43], v[124:127]
    v_mfma_f32_16x16x32_bf16 v[128:131], v[240:243], v[64:67], v[128:131]
    v_mfma_f32_16x16x32_bf16 v[132:135], v[240:243], v[88:91], v[132:135]
    v_mfma_f32_16x16x32_bf16 v[136:139], v[240:243], v[112:115], v[136:139]
    s_waitcnt lgkmcnt(4)
    s_waitcnt vmcnt(18)
    s_barrier
    v_mfma_f32_16x16x32_bf16 v[120:123], v[244:247], v[20:23], v[120:123]
    buffer_load_dwordx4 v216, s[16:19], s31 offen nt lds
    v_mfma_f32_16x16x32_bf16 v[124:127], v[244:247], v[44:47], v[124:127]
    ds_read_b128 v[240:243], v217 offset:8192
    v_add_u32 v217, s36, v217
    v_mfma_f32_16x16x32_bf16 v[128:131], v[244:247], v[68:71], v[128:131]
    v_mfma_f32_16x16x32_bf16 v[132:135], v[244:247], v[92:95], v[132:135]
    buffer_load_dwordx4 v216, s[16:19], s31 offen offset:3072 nt lds
    v_mfma_f32_16x16x32_bf16 v[136:139], v[244:247], v[116:119], v[136:139]
    s_waitcnt lgkmcnt(4)
    s_add_u32 m0, s39, 896
    ds_read_b128 v[244:247], v218 offset:8192
    v_mfma_f32_16x16x32_bf16 v[140:143], a[240:243], v[0:3], v[196:199]
    v_exp_f32 v120, v120
    v_mfma_f32_16x16x32_bf16 v[144:147], a[240:243], v[24:27], v[200:203]
    buffer_load_dwordx4 v216, s[16:19], s31 offen offset:128 nt lds
    v_mfma_f32_16x16x32_bf16 v[148:151], a[240:243], v[48:51], v[204:207]
    v_exp_f32 v124, v124
    v_mfma_f32_16x16x32_bf16 v[152:155], a[240:243], v[72:75], v[208:211]
    v_exp_f32 v128, v128
    v_mfma_f32_16x16x32_bf16 v[156:159], a[240:243], v[96:99], v[212:215]
    s_waitcnt lgkmcnt(4)
    buffer_load_dwordx4 v216, s[16:19], s31 offen offset:3200 nt lds
    v_mfma_f32_16x16x32_bf16 v[140:143], a[244:247], v[4:7], v[140:143]
    s_add_u32 m0, s39, 1792
    ds_read_b64_tr_b16 a[240:241], v219 offset:0
    ds_read_b64_tr_b16 a[242:243], v219 offset:6144
    v_mfma_f32_16x16x32_bf16 v[144:147], a[244:247], v[28:31], v[144:147]
    v_exp_f32 v132, v132
    v_mfma_f32_16x16x32_bf16 v[148:151], a[244:247], v[52:55], v[148:151]
    buffer_load_dwordx4 v216, s[16:19], s31 offen offset:256 nt lds
    v_mfma_f32_16x16x32_bf16 v[152:155], a[244:247], v[76:79], v[152:155]
    v_exp_f32 v121, v121
    v_mfma_f32_16x16x32_bf16 v[156:159], a[244:247], v[100:103], v[156:159]
    s_waitcnt lgkmcnt(5)
    ds_read_b64_tr_b16 a[244:245], v220 offset:0
    ds_read_b64_tr_b16 a[246:247], v220 offset:6144
    v_mfma_f32_16x16x32_bf16 v[140:143], a[248:251], v[8:11], v[140:143]
    buffer_load_dwordx4 v216, s[16:19], s31 offen offset:3328 nt lds
    v_mfma_f32_16x16x32_bf16 v[144:147], a[248:251], v[32:35], v[144:147]
    s_add_u32 m0, s34, 0
    v_add_f32 v230, v230, v120
    v_add_f32 v231, v231, v124
    v_mfma_f32_16x16x32_bf16 v[148:151], a[248:251], v[56:59], v[148:151]
    s_add_u32 s31, s31, 12288
    v_exp_f32 v125, v125
    v_mfma_f32_16x16x32_bf16 v[152:155], a[248:251], v[80:83], v[152:155]
    v_exp_f32 v129, v129
    v_mfma_f32_16x16x32_bf16 v[156:159], a[248:251], v[104:107], v[156:159]
    s_waitcnt lgkmcnt(6)
    ds_read_b64_tr_b16 a[248:249], v221 offset:0
    ds_read_b64_tr_b16 a[250:251], v221 offset:6144
    v_mfma_f32_16x16x32_bf16 v[140:143], a[252:255], v[12:15], v[140:143]
    v_exp_f32 v133, v133
    v_mfma_f32_16x16x32_bf16 v[144:147], a[252:255], v[36:39], v[144:147]
    v_add_f32 v232, v232, v128
    v_add_f32 v233, v233, v132
    v_mfma_f32_16x16x32_bf16 v[148:151], a[252:255], v[60:63], v[148:151]
    v_exp_f32 v122, v122
    v_mfma_f32_16x16x32_bf16 v[152:155], a[252:255], v[84:87], v[152:155]
    v_add_f32 v230, v230, v121
    v_add_f32 v231, v231, v125
    v_mfma_f32_16x16x32_bf16 v[156:159], a[252:255], v[108:111], v[156:159]
    s_waitcnt lgkmcnt(7)
    ds_read_b64_tr_b16 a[252:253], v222 offset:0
    ds_read_b64_tr_b16 a[254:255], v222 offset:6144
    v_mfma_f32_16x16x32_bf16 v[140:143], v[240:243], v[16:19], v[140:143]
    v_exp_f32 v126, v126
    v_mfma_f32_16x16x32_bf16 v[144:147], v[240:243], v[40:43], v[144:147]
    v_exp_f32 v130, v130
    v_mfma_f32_16x16x32_bf16 v[148:151], v[240:243], v[64:67], v[148:151]
    v_add_f32 v232, v232, v129
    v_add_f32 v233, v233, v133
    v_mfma_f32_16x16x32_bf16 v[152:155], v[240:243], v[88:91], v[152:155]
    v_exp_f32 v134, v134
    v_mfma_f32_16x16x32_bf16 v[156:159], v[240:243], v[112:115], v[156:159]
    s_waitcnt lgkmcnt(8)
    buffer_load_dwordx4 v216, s[12:15], s30 offen nt lds
    v_mfma_f32_16x16x32_bf16 v[140:143], v[244:247], v[20:23], v[140:143]
    ds_read_b64_tr_b16 v[240:241], v219 offset:1024
    ds_read_b64_tr_b16 v[242:243], v219 offset:7168
    v_mfma_f32_16x16x32_bf16 v[144:147], v[244:247], v[44:47], v[144:147]
    v_exp_f32 v123, v123
    v_mfma_f32_16x16x32_bf16 v[148:151], v[244:247], v[68:71], v[148:151]
    buffer_load_dwordx4 v216, s[12:15], s30 offen offset:3072 nt lds
    v_mfma_f32_16x16x32_bf16 v[152:155], v[244:247], v[92:95], v[152:155]
    s_add_u32 m0, s34, 896
    v_add_f32 v230, v230, v122
    v_add_f32 v231, v231, v126
    v_mfma_f32_16x16x32_bf16 v[156:159], v[244:247], v[116:119], v[156:159]
    s_waitcnt lgkmcnt(8)
    ds_read_b64_tr_b16 v[244:245], v220 offset:1024
    ds_read_b64_tr_b16 v[246:247], v220 offset:7168
    v_mfma_f32_16x16x32_bf16 a[0:3], a[240:243], v[176:179], a[0:3]
    buffer_load_dwordx4 v216, s[12:15], s30 offen offset:128 nt lds
    v_mfma_f32_16x16x32_bf16 a[48:51], a[240:243], v[180:183], a[48:51]
    v_exp_f32 v127, v127
    v_mfma_f32_16x16x32_bf16 a[96:99], a[240:243], v[184:187], a[96:99]
    v_exp_f32 v131, v131
    v_mfma_f32_16x16x32_bf16 a[144:147], a[240:243], v[188:191], a[144:147]
    s_waitcnt lgkmcnt(8)
    buffer_load_dwordx4 v216, s[12:15], s30 offen offset:3200 nt lds
    v_mfma_f32_16x16x32_bf16 a[4:7], a[244:247], v[176:179], a[4:7]
    s_add_u32 m0, s34, 1792
    ds_read_b64_tr_b16 a[240:241], v221 offset:1024
    ds_read_b64_tr_b16 a[242:243], v221 offset:7168
    v_mfma_f32_16x16x32_bf16 a[52:55], a[244:247], v[180:183], a[52:55]
    s_mov_b32 s34, s46
    v_add_f32 v232, v232, v130
    v_add_u32 v218, s36, v218
    v_mfma_f32_16x16x32_bf16 a[100:103], a[244:247], v[184:187], a[100:103]
    s_mov_b32 s46, s32
    buffer_load_dwordx4 v216, s[12:15], s30 offen offset:256 nt lds
    v_mfma_f32_16x16x32_bf16 a[148:151], a[244:247], v[188:191], a[148:151]
    s_waitcnt lgkmcnt(8)
    ds_read_b64_tr_b16 a[244:245], v222 offset:1024
    ds_read_b64_tr_b16 a[246:247], v222 offset:7168
    v_mfma_f32_16x16x32_bf16 a[8:11], a[248:251], v[176:179], a[8:11]
    v_exp_f32 v135, v135
    v_mfma_f32_16x16x32_bf16 a[56:59], a[248:251], v[180:183], a[56:59]
    buffer_load_dwordx4 v216, s[12:15], s30 offen offset:3328 nt lds
    v_mfma_f32_16x16x32_bf16 a[104:107], a[248:251], v[184:187], a[104:107]
    s_add_u32 s30, s30, 12288
    v_add_f32 v233, v233, v134
    v_add_f32 v230, v230, v123
    v_mfma_f32_16x16x32_bf16 a[152:155], a[248:251], v[188:191], a[152:155]
    s_waitcnt lgkmcnt(8)
    ds_read_b64_tr_b16 a[248:249], v219 offset:2048
    ds_read_b64_tr_b16 a[250:251], v219 offset:8192
    v_mfma_f32_16x16x32_bf16 a[12:15], a[252:255], v[176:179], a[12:15]
    s_add_u32 m0, s32, 0
    v_exp_f32 v140, v140
    v_mfma_f32_16x16x32_bf16 a[60:63], a[252:255], v[180:183], a[60:63]
    s_cmp_ge_u32 s31, 196608
    s_cselect_b32 s31, 0, s31
    v_mfma_f32_16x16x32_bf16 a[108:111], a[252:255], v[184:187], a[108:111]
    v_exp_f32 v144, v144
    v_mfma_f32_16x16x32_bf16 a[156:159], a[252:255], v[188:191], a[156:159]
    s_waitcnt lgkmcnt(8)
    ds_read_b64_tr_b16 a[252:253], v220 offset:2048
    ds_read_b64_tr_b16 a[254:255], v220 offset:8192
    v_mfma_f32_16x16x32_bf16 a[16:19], v[240:243], v[176:179], a[16:19]
    v_exp_f32 v148, v148
    v_mfma_f32_16x16x32_bf16 a[64:67], v[240:243], v[180:183], a[64:67]
    v_add_f32 v231, v231, v127
    v_add_f32 v232, v232, v131
    v_mfma_f32_16x16x32_bf16 a[112:115], v[240:243], v[184:187], a[112:115]
    s_waitcnt vmcnt(24)
    s_barrier
    v_add_f32 v233, v233, v135
    v_mfma_f32_16x16x32_bf16 a[160:163], v[240:243], v[188:191], a[160:163]
    s_waitcnt lgkmcnt(8)
    ds_read_b64_tr_b16 v[240:241], v221 offset:2048
    ds_read_b64_tr_b16 v[242:243], v221 offset:8192
    v_mfma_f32_16x16x32_bf16 a[20:23], v[244:247], v[176:179], a[20:23]
    v_exp_f32 v152, v152
    v_mfma_f32_16x16x32_bf16 a[68:71], v[244:247], v[180:183], a[68:71]
    v_exp_f32 v141, v141
    v_mfma_f32_16x16x32_bf16 a[116:119], v[244:247], v[184:187], a[116:119]
    v_add_f32 v230, v230, v140
    v_cvt_pk_bf16_f32 v160, v120, v121
    v_mfma_f32_16x16x32_bf16 a[164:167], v[244:247], v[188:191], a[164:167]
    s_waitcnt lgkmcnt(8)
    ds_read_b64_tr_b16 v[244:245], v222 offset:2048
    ds_read_b64_tr_b16 v[246:247], v222 offset:8192
    v_mfma_f32_16x16x32_bf16 a[24:27], a[240:243], v[176:179], a[24:27]
    v_cvt_pk_bf16_f32 v161, v122, v123
    v_cvt_pk_bf16_f32 v164, v124, v125
    v_mfma_f32_16x16x32_bf16 a[72:75], a[240:243], v[180:183], a[72:75]
    v_cvt_pk_bf16_f32 v165, v126, v127
    v_add_f32 v231, v231, v144
    v_mfma_f32_16x16x32_bf16 a[120:123], a[240:243], v[184:187], a[120:123]
    v_exp_f32 v145, v145
    v_mfma_f32_16x16x32_bf16 a[168:171], a[240:243], v[188:191], a[168:171]
    s_waitcnt lgkmcnt(8)
    ds_read_b128 a[240:243], v217 offset:0
    v_add_f32 v232, v232, v148
    v_mfma_f32_16x16x32_bf16 a[28:31], a[244:247], v[176:179], a[28:31]
    v_exp_f32 v149, v149
    v_mfma_f32_16x16x32_bf16 a[76:79], a[244:247], v[180:183], a[76:79]
    v_cvt_pk_bf16_f32 v168, v128, v129
    v_cvt_pk_bf16_f32 v169, v130, v131
    v_mfma_f32_16x16x32_bf16 a[124:127], a[244:247], v[184:187], a[124:127]
    v_cvt_pk_bf16_f32 v172, v132, v133
    v_cvt_pk_bf16_f32 v173, v134, v135
    v_mfma_f32_16x16x32_bf16 a[172:175], a[244:247], v[188:191], a[172:175]
    s_waitcnt lgkmcnt(7)
    ds_read_b128 a[244:247], v218 offset:0
    v_add_f32 v233, v233, v152
    v_mfma_f32_16x16x32_bf16 a[32:35], a[248:251], v[176:179], a[32:35]
    v_exp_f32 v153, v153
    v_mfma_f32_16x16x32_bf16 a[80:83], a[248:251], v[180:183], a[80:83]
    s_cmp_ge_u32 s30, 196608
    s_cselect_b32 s30, 0, s30
    v_mfma_f32_16x16x32_bf16 a[128:131], a[248:251], v[184:187], a[128:131]
    s_mov_b32 s30, s48
    v_exp_f32 v142, v142
    v_mfma_f32_16x16x32_bf16 a[176:179], a[248:251], v[188:191], a[176:179]
    s_waitcnt lgkmcnt(6)
    ds_read_b128 a[248:251], v217 offset:1024
    v_add_f32 v230, v230, v141
    v_mfma_f32_16x16x32_bf16 a[36:39], a[252:255], v[176:179], a[36:39]
    v_exp_f32 v146, v146
    v_mfma_f32_16x16x32_bf16 a[84:87], a[252:255], v[180:183], a[84:87]
    v_exp_f32 v150, v150
    v_mfma_f32_16x16x32_bf16 a[132:135], a[252:255], v[184:187], a[132:135]
    v_add_f32 v231, v231, v145
    v_add_f32 v232, v232, v149
    v_mfma_f32_16x16x32_bf16 a[180:183], a[252:255], v[188:191], a[180:183]
    s_waitcnt lgkmcnt(5)
    ds_read_b128 a[252:255], v218 offset:1024
    v_add_f32 v233, v233, v153
    v_mfma_f32_16x16x32_bf16 a[40:43], v[240:243], v[176:179], a[40:43]
    v_exp_f32 v154, v154
    v_mfma_f32_16x16x32_bf16 a[88:91], v[240:243], v[180:183], a[88:91]
    v_exp_f32 v143, v143
    v_mfma_f32_16x16x32_bf16 a[136:139], v[240:243], v[184:187], a[136:139]
    v_exp_f32 v147, v147
    v_mfma_f32_16x16x32_bf16 a[184:187], v[240:243], v[188:191], a[184:187]
    s_waitcnt lgkmcnt(4)
    ds_read_b128 v[240:243], v217 offset:2048
    v_add_f32 v230, v230, v142
    v_mfma_f32_16x16x32_bf16 a[44:47], v[244:247], v[176:179], a[44:47]
    v_exp_f32 v151, v151
    v_mfma_f32_16x16x32_bf16 a[92:95], v[244:247], v[180:183], a[92:95]
    v_add_f32 v231, v231, v146
    v_add_f32 v232, v232, v150
    v_mfma_f32_16x16x32_bf16 a[140:143], v[244:247], v[184:187], a[140:143]
    v_exp_f32 v155, v155
    v_mfma_f32_16x16x32_bf16 a[188:191], v[244:247], v[188:191], a[188:191]
    s_waitcnt lgkmcnt(4)
    ds_read_b128 v[244:247], v218 offset:2048
    v_add_f32 v233, v233, v154
    v_mfma_f32_16x16x32_bf16 v[120:123], a[240:243], v[0:3], v[196:199]
    v_add_f32 v230, v230, v143
    v_cvt_pk_bf16_f32 v162, v140, v141
    v_mfma_f32_16x16x32_bf16 v[124:127], a[240:243], v[24:27], v[200:203]
    v_cvt_pk_bf16_f32 v163, v142, v143
    v_add_u32 v219, s37, v219
    v_mfma_f32_16x16x32_bf16 v[128:131], a[240:243], v[48:51], v[204:207]
    v_add_f32 v231, v231, v147
    v_cvt_pk_bf16_f32 v166, v144, v145
    v_mfma_f32_16x16x32_bf16 v[132:135], a[240:243], v[72:75], v[208:211]
    s_waitcnt lgkmcnt(4)
    ds_read_b128 a[240:243], v217 offset:6144
    v_cvt_pk_bf16_f32 v167, v146, v147
    v_mfma_f32_16x16x32_bf16 v[120:123], a[244:247], v[4:7], v[120:123]
    v_add_f32 v232, v232, v151
    v_cvt_pk_bf16_f32 v170, v148, v149
    v_mfma_f32_16x16x32_bf16 v[124:127], a[244:247], v[28:31], v[124:127]
    v_cvt_pk_bf16_f32 v171, v150, v151
    v_add_f32 v233, v233, v155
    v_mfma_f32_16x16x32_bf16 v[128:131], a[244:247], v[52:55], v[128:131]
    v_cvt_pk_bf16_f32 v174, v152, v153
    v_cvt_pk_bf16_f32 v175, v154, v155
    v_mfma_f32_16x16x32_bf16 v[132:135], a[244:247], v[76:79], v[132:135]
    s_waitcnt lgkmcnt(4)
    ds_read_b128 a[244:247], v218 offset:6144
    v_add_u32 v221, s37, v221
    v_mfma_f32_16x16x32_bf16 v[120:123], a[248:251], v[8:11], v[120:123]
    s_lshl_b32 s74, s0, 3
    v_add_u32 v220, s37, v220
    v_add_u32 v222, s37, v222
    v_mfma_f32_16x16x32_bf16 v[124:127], a[248:251], v[32:35], v[124:127]
    s_mov_b32 s37, s36
    v_exp_f32 v136, v136
    v_mfma_f32_16x16x32_bf16 v[128:131], a[248:251], v[56:59], v[128:131]
    s_sub_u32 s36, s33, s32
    v_exp_f32 v137, v137
    v_mfma_f32_16x16x32_bf16 v[132:135], a[248:251], v[80:83], v[132:135]
    s_waitcnt lgkmcnt(4)
    ds_read_b128 a[248:251], v217 offset:7168
    v_cvt_pk_bf16_f32 v192, v136, v137
    v_mfma_f32_16x16x32_bf16 v[120:123], a[252:255], v[12:15], v[120:123]
    v_exp_f32 v138, v138
    v_mfma_f32_16x16x32_bf16 v[124:127], a[252:255], v[36:39], v[124:127]
    v_exp_f32 v139, v139
    v_mfma_f32_16x16x32_bf16 v[128:131], a[252:255], v[60:63], v[128:131]
    v_exp_f32 v156, v156
    v_mfma_f32_16x16x32_bf16 v[132:135], a[252:255], v[84:87], v[132:135]
    s_waitcnt lgkmcnt(4)
    ds_read_b128 a[252:255], v218 offset:7168
    v_cvt_pk_bf16_f32 v193, v138, v139
    v_mfma_f32_16x16x32_bf16 v[120:123], v[240:243], v[16:19], v[120:123]
    v_exp_f32 v157, v157
    v_mfma_f32_16x16x32_bf16 v[124:127], v[240:243], v[40:43], v[124:127]
    v_exp_f32 v158, v158
    v_mfma_f32_16x16x32_bf16 v[128:131], v[240:243], v[64:67], v[128:131]
    v_exp_f32 v159, v159
    v_mfma_f32_16x16x32_bf16 v[132:135], v[240:243], v[88:91], v[132:135]
    s_waitcnt lgkmcnt(4)
    ds_read_b128 v[240:243], v217 offset:8192
    v_cvt_pk_bf16_f32 v194, v156, v157
    v_mfma_f32_16x16x32_bf16 v[120:123], v[244:247], v[20:23], v[120:123]
    v_cvt_pk_bf16_f32 v195, v158, v159
    v_mov_b32 v252, 0
    v_mfma_f32_16x16x32_bf16 v[124:127], v[244:247], v[44:47], v[124:127]
    v_mov_b32 v254, 0
    v_add_f32 v234, v234, v136
    v_mfma_f32_16x16x32_bf16 v[128:131], v[244:247], v[68:71], v[128:131]
    v_add_f32 v234, v234, v137
    v_add_f32 v234, v234, v138
    v_mfma_f32_16x16x32_bf16 v[132:135], v[244:247], v[92:95], v[132:135]
    s_waitcnt lgkmcnt(4)
    ds_read_b128 v[244:247], v218 offset:8192
    v_add_f32 v234, v234, v139
    v_mfma_f32_16x16x32_bf16 v[140:143], a[240:243], v[0:3], v[196:199]
    s_waitcnt vmcnt(18)
    s_barrier
    v_add_f32 v234, v234, v156
    v_mfma_f32_16x16x32_bf16 v[144:147], a[240:243], v[24:27], v[200:203]
    v_exp_f32 v120, v120
    v_mfma_f32_16x16x32_bf16 v[148:151], a[240:243], v[48:51], v[204:207]
    v_exp_f32 v124, v124
    v_mfma_f32_16x16x32_bf16 v[152:155], a[240:243], v[72:75], v[208:211]
    s_waitcnt lgkmcnt(4)
    ds_read_b64_tr_b16 a[240:241], v219 offset:0
    ds_read_b64_tr_b16 a[242:243], v219 offset:6144
    v_mfma_f32_16x16x32_bf16 v[140:143], a[244:247], v[4:7], v[140:143]
    v_exp_f32 v128, v128
    v_mfma_f32_16x16x32_bf16 v[144:147], a[244:247], v[28:31], v[144:147]
    v_exp_f32 v132, v132
    v_mfma_f32_16x16x32_bf16 v[148:151], a[244:247], v[52:55], v[148:151]
    v_exp_f32 v121, v121
    v_mfma_f32_16x16x32_bf16 v[152:155], a[244:247], v[76:79], v[152:155]
    s_waitcnt lgkmcnt(5)
    ds_read_b64_tr_b16 a[244:245], v220 offset:0
    ds_read_b64_tr_b16 a[246:247], v220 offset:6144
    v_mfma_f32_16x16x32_bf16 v[140:143], a[248:251], v[8:11], v[140:143]
    v_add_f32 v230, v230, v120
    v_add_f32 v231, v231, v124
    v_mfma_f32_16x16x32_bf16 v[144:147], a[248:251], v[32:35], v[144:147]
    v_exp_f32 v125, v125
    v_mfma_f32_16x16x32_bf16 v[148:151], a[248:251], v[56:59], v[148:151]
    v_exp_f32 v129, v129
    v_mfma_f32_16x16x32_bf16 v[152:155], a[248:251], v[80:83], v[152:155]
    s_waitcnt lgkmcnt(6)
    ds_read_b64_tr_b16 a[248:249], v221 offset:0
    ds_read_b64_tr_b16 a[250:251], v221 offset:6144
    v_mfma_f32_16x16x32_bf16 v[140:143], a[252:255], v[12:15], v[140:143]
    v_add_f32 v232, v232, v128
    v_add_f32 v233, v233, v132
    v_mfma_f32_16x16x32_bf16 v[144:147], a[252:255], v[36:39], v[144:147]
    v_exp_f32 v133, v133
    v_mfma_f32_16x16x32_bf16 v[148:151], a[252:255], v[60:63], v[148:151]
    v_exp_f32 v122, v122
    v_mfma_f32_16x16x32_bf16 v[152:155], a[252:255], v[84:87], v[152:155]
    s_waitcnt lgkmcnt(7)
    ds_read_b64_tr_b16 a[252:253], v222 offset:0
    ds_read_b64_tr_b16 a[254:255], v222 offset:6144
    v_mfma_f32_16x16x32_bf16 v[140:143], v[240:243], v[16:19], v[140:143]
    v_add_f32 v230, v230, v121
    v_add_f32 v231, v231, v125
    v_mfma_f32_16x16x32_bf16 v[144:147], v[240:243], v[40:43], v[144:147]
    v_exp_f32 v126, v126
    v_mfma_f32_16x16x32_bf16 v[148:151], v[240:243], v[64:67], v[148:151]
    v_exp_f32 v130, v130
    v_mfma_f32_16x16x32_bf16 v[152:155], v[240:243], v[88:91], v[152:155]
    s_waitcnt lgkmcnt(8)
    ds_read_b64_tr_b16 v[240:241], v219 offset:1024
    ds_read_b64_tr_b16 v[242:243], v219 offset:7168
    v_mfma_f32_16x16x32_bf16 v[140:143], v[244:247], v[20:23], v[140:143]
    v_add_f32 v232, v232, v129
    v_add_f32 v233, v233, v133
    v_mfma_f32_16x16x32_bf16 v[144:147], v[244:247], v[44:47], v[144:147]
    v_exp_f32 v134, v134
    v_mfma_f32_16x16x32_bf16 v[148:151], v[244:247], v[68:71], v[148:151]
    v_exp_f32 v123, v123
    v_mfma_f32_16x16x32_bf16 v[152:155], v[244:247], v[92:95], v[152:155]
    s_waitcnt lgkmcnt(8)
    ds_read_b64_tr_b16 v[244:245], v220 offset:1024
    ds_read_b64_tr_b16 v[246:247], v220 offset:7168
    v_mfma_f32_16x16x32_bf16 a[0:3], a[240:243], v[160:163], a[0:3]
    v_add_f32 v230, v230, v122
    v_add_f32 v231, v231, v126
    v_mfma_f32_16x16x32_bf16 a[48:51], a[240:243], v[164:167], a[48:51]
    v_exp_f32 v127, v127
    v_mfma_f32_16x16x32_bf16 a[96:99], a[240:243], v[168:171], a[96:99]
    v_exp_f32 v131, v131
    v_mfma_f32_16x16x32_bf16 a[144:147], a[240:243], v[172:175], a[144:147]
    v_add_f32 v232, v232, v130
    v_add_f32 v233, v233, v134
    v_mfma_f32_16x16x32_bf16 a[192:195], a[240:243], v[192:195], a[192:195]
    s_waitcnt lgkmcnt(8)
    ds_read_b64_tr_b16 a[240:241], v221 offset:1024
    ds_read_b64_tr_b16 a[242:243], v221 offset:7168
    v_mfma_f32_16x16x32_bf16 a[4:7], a[244:247], v[160:163], a[4:7]
    v_exp_f32 v140, v140
    v_mfma_f32_16x16x32_bf16 a[52:55], a[244:247], v[164:167], a[52:55]
    v_exp_f32 v141, v141
    v_mfma_f32_16x16x32_bf16 a[100:103], a[244:247], v[168:171], a[100:103]
    v_exp_f32 v142, v142
    v_mfma_f32_16x16x32_bf16 a[148:151], a[244:247], v[172:175], a[148:151]
    v_exp_f32 v143, v143
    v_mfma_f32_16x16x32_bf16 a[196:199], a[244:247], v[192:195], a[196:199]
    s_waitcnt lgkmcnt(8)
    ds_read_b64_tr_b16 a[244:245], v222 offset:1024
    ds_read_b64_tr_b16 a[246:247], v222 offset:7168
    v_mfma_f32_16x16x32_bf16 a[8:11], a[248:251], v[160:163], a[8:11]
    v_exp_f32 v144, v144
    v_mfma_f32_16x16x32_bf16 a[56:59], a[248:251], v[164:167], a[56:59]
    v_exp_f32 v145, v145
    v_mfma_f32_16x16x32_bf16 a[104:107], a[248:251], v[168:171], a[104:107]
    v_exp_f32 v146, v146
    v_mfma_f32_16x16x32_bf16 a[152:155], a[248:251], v[172:175], a[152:155]
    v_exp_f32 v147, v147
    v_mfma_f32_16x16x32_bf16 a[200:203], a[248:251], v[192:195], a[200:203]
    s_waitcnt lgkmcnt(8)
    s_barrier
    ds_read_b64_tr_b16 a[248:249], v219 offset:2048
    v_mfma_f32_16x16x32_bf16 a[12:15], a[252:255], v[160:163], a[12:15]
    buffer_load_dwordx4 v216, s[12:15], s30 offen nt lds
    v_mfma_f32_16x16x32_bf16 a[60:63], a[252:255], v[164:167], a[60:63]
    ds_read_b64_tr_b16 a[250:251], v219 offset:8192
    v_add_u32 v219, s37, v219
    v_mfma_f32_16x16x32_bf16 a[108:111], a[252:255], v[168:171], a[108:111]
    v_exp_f32 v135, v135
    v_mfma_f32_16x16x32_bf16 a[156:159], a[252:255], v[172:175], a[156:159]
    buffer_load_dwordx4 v216, s[12:15], s30 offen offset:3072 nt lds
    v_mfma_f32_16x16x32_bf16 a[204:207], a[252:255], v[192:195], a[204:207]
    s_waitcnt lgkmcnt(8)
    s_add_u32 m0, s32, 896
    ds_read_b64_tr_b16 a[252:253], v220 offset:2048
    v_mfma_f32_16x16x32_bf16 a[16:19], v[240:243], v[160:163], a[16:19]
    ds_read_b64_tr_b16 a[254:255], v220 offset:8192
    v_add_u32 v220, s37, v220
    v_mfma_f32_16x16x32_bf16 a[64:67], v[240:243], v[164:167], a[64:67]
    buffer_load_dwordx4 v216, s[12:15], s30 offen offset:128 nt lds
    v_mfma_f32_16x16x32_bf16 a[112:115], v[240:243], v[168:171], a[112:115]
    v_add_f32 v230, v230, v123
    v_add_f32 v231, v231, v127
    v_mfma_f32_16x16x32_bf16 a[160:163], v[240:243], v[172:175], a[160:163]
    v_exp_f32 v148, v148
    v_mfma_f32_16x16x32_bf16 a[208:211], v[240:243], v[192:195], a[208:211]
    s_waitcnt lgkmcnt(8)
    buffer_load_dwordx4 v216, s[12:15], s30 offen offset:3200 nt lds
    v_mfma_f32_16x16x32_bf16 a[20:23], v[244:247], v[160:163], a[20:23]
    s_add_u32 m0, s32, 1792
    ds_read_b64_tr_b16 v[240:241], v221 offset:2048
    ds_read_b64_tr_b16 v[242:243], v221 offset:8192
    v_mfma_f32_16x16x32_bf16 a[68:71], v[244:247], v[164:167], a[68:71]
    s_mov_b32 s32, s33
    v_add_u32 v221, s37, v221
    v_add_f32 v232, v232, v131
    v_mfma_f32_16x16x32_bf16 a[116:119], v[244:247], v[168:171], a[116:119]
    s_mov_b32 s33, s34
    buffer_load_dwordx4 v216, s[12:15], s30 offen offset:256 nt lds
    v_mfma_f32_16x16x32_bf16 a[164:167], v[244:247], v[172:175], a[164:167]
    s_mov_b32 s34, s46
    v_exp_f32 v149, v149
    v_mfma_f32_16x16x32_bf16 a[212:215], v[244:247], v[192:195], a[212:215]
    s_waitcnt lgkmcnt(8)
    ds_read_b64_tr_b16 v[244:245], v222 offset:2048
    ds_read_b64_tr_b16 v[246:247], v222 offset:8192
    v_mfma_f32_16x16x32_bf16 a[24:27], a[240:243], v[160:163], a[24:27]
    buffer_load_dwordx4 v216, s[12:15], s30 offen offset:3328 nt lds
    buffer_load_dword v252, v252, s[76:79], s74 offen sc1
    v_mfma_f32_16x16x32_bf16 a[72:75], a[240:243], v[164:167], a[72:75]
    s_lshr_b32 s74, s71, 1
    s_lshl_b32 s74, s74, 2
    s_xor_b32 s74, s74, 4
    v_mfma_f32_16x16x32_bf16 a[120:123], a[240:243], v[168:171], a[120:123]
    s_add_u32 s30, s30, 12288
    buffer_load_dword v254, v254, s[76:79], s74 offen offset:128 sc1
    v_mfma_f32_16x16x32_bf16 a[168:171], a[240:243], v[172:175], a[168:171]
    v_exp_f32 v150, v150
    v_mfma_f32_16x16x32_bf16 a[216:219], a[240:243], v[192:195], a[216:219]
    s_waitcnt lgkmcnt(8)
    v_exp_f32 v151, v151
    v_mfma_f32_16x16x32_bf16 a[28:31], a[244:247], v[160:163], a[28:31]
    v_exp_f32 v152, v152
    v_mfma_f32_16x16x32_bf16 a[76:79], a[244:247], v[164:167], a[76:79]
    v_exp_f32 v153, v153
    v_mfma_f32_16x16x32_bf16 a[124:127], a[244:247], v[168:171], a[124:127]
    v_exp_f32 v154, v154
    v_mfma_f32_16x16x32_bf16 a[172:175], a[244:247], v[172:175], a[172:175]
    v_exp_f32 v155, v155
    v_mfma_f32_16x16x32_bf16 a[220:223], a[244:247], v[192:195], a[220:223]
    s_waitcnt lgkmcnt(6)
    v_cvt_pk_bf16_f32 v176, v120, v121
    v_cvt_pk_bf16_f32 v177, v122, v123
    v_mfma_f32_16x16x32_bf16 a[32:35], a[248:251], v[160:163], a[32:35]
    v_cvt_pk_bf16_f32 v178, v140, v141
    v_cvt_pk_bf16_f32 v179, v142, v143
    v_mfma_f32_16x16x32_bf16 a[80:83], a[248:251], v[164:167], a[80:83]
    v_add_u32 v222, s37, v222
    v_cvt_pk_bf16_f32 v180, v124, v125
    v_mfma_f32_16x16x32_bf16 a[128:131], a[248:251], v[168:171], a[128:131]
    v_cvt_pk_bf16_f32 v181, v126, v127
    v_cvt_pk_bf16_f32 v182, v144, v145
    v_mfma_f32_16x16x32_bf16 a[176:179], a[248:251], v[172:175], a[176:179]
    v_cvt_pk_bf16_f32 v183, v146, v147
    v_add_f32 v233, v233, v135
    v_mfma_f32_16x16x32_bf16 a[224:227], a[248:251], v[192:195], a[224:227]
    s_waitcnt lgkmcnt(4)
    v_cvt_pk_bf16_f32 v184, v128, v129
    v_cvt_pk_bf16_f32 v185, v130, v131
    v_mfma_f32_16x16x32_bf16 a[36:39], a[252:255], v[160:163], a[36:39]
    v_add_f32 v230, v230, v140
    v_cvt_pk_bf16_f32 v186, v148, v149
    v_mfma_f32_16x16x32_bf16 a[84:87], a[252:255], v[164:167], a[84:87]
    s_waitcnt vmcnt(14)
    s_barrier
    ds_read_b64_tr_b16 a[240:241], v219 offset:0
    v_mfma_f32_16x16x32_bf16 a[132:135], a[252:255], v[168:171], a[132:135]
    ds_read_b64_tr_b16 a[242:243], v219 offset:6144
    ds_read_b64_tr_b16 a[244:245], v220 offset:0
    v_mfma_f32_16x16x32_bf16 a[180:183], a[252:255], v[172:175], a[180:183]
    ds_read_b64_tr_b16 a[246:247], v220 offset:6144
    ds_read_b64_tr_b16 a[248:249], v221 offset:0
    v_mfma_f32_16x16x32_bf16 a[228:231], a[252:255], v[192:195], a[228:231]
    s_waitcnt lgkmcnt(7)
    ds_read_b64_tr_b16 a[250:251], v221 offset:6144
    v_cvt_pk_bf16_f32 v187, v150, v151
    v_mfma_f32_16x16x32_bf16 a[40:43], v[240:243], v[160:163], a[40:43]
    v_add_f32 v231, v231, v144
    v_cvt_pk_bf16_f32 v188, v132, v133
    v_mfma_f32_16x16x32_bf16 a[88:91], v[240:243], v[164:167], a[88:91]
    v_cvt_pk_bf16_f32 v189, v134, v135
    v_add_f32 v232, v232, v148
    v_mfma_f32_16x16x32_bf16 a[136:139], v[240:243], v[168:171], a[136:139]
    v_cvt_pk_bf16_f32 v190, v152, v153
    v_cvt_pk_bf16_f32 v191, v154, v155
    v_mfma_f32_16x16x32_bf16 a[184:187], v[240:243], v[172:175], a[184:187]
    ds_read_b64_tr_b16 a[252:253], v222 offset:0
    ds_read_b64_tr_b16 a[254:255], v222 offset:6144
    v_mfma_f32_16x16x32_bf16 a[232:235], v[240:243], v[192:195], a[232:235]
    s_waitcnt lgkmcnt(8)
    v_add_f32 v233, v233, v152
    v_add_f32 v230, v230, v141
    v_mfma_f32_16x16x32_bf16 a[44:47], v[244:247], v[160:163], a[44:47]
    v_add_f32 v231, v231, v145
    v_add_f32 v232, v232, v149
    v_mfma_f32_16x16x32_bf16 a[92:95], v[244:247], v[164:167], a[92:95]
    v_add_f32 v233, v233, v153
    ds_read_b64_tr_b16 v[240:241], v219 offset:1024
    v_mfma_f32_16x16x32_bf16 a[140:143], v[244:247], v[168:171], a[140:143]
    ds_read_b64_tr_b16 v[242:243], v219 offset:7168
    v_add_f32 v230, v230, v142
    v_mfma_f32_16x16x32_bf16 a[188:191], v[244:247], v[172:175], a[188:191]
    v_add_f32 v231, v231, v146
    v_add_f32 v232, v232, v150
    v_mfma_f32_16x16x32_bf16 a[236:239], v[244:247], v[192:195], a[236:239]
    s_waitcnt lgkmcnt(8)
    v_add_f32 v234, v234, v157
    v_add_f32 v233, v233, v154
    v_mfma_f32_16x16x32_bf16 a[0:3], a[240:243], v[176:179], a[0:3]
    v_add_f32 v230, v230, v143
    ds_read_b64_tr_b16 v[244:245], v220 offset:1024
    v_mfma_f32_16x16x32_bf16 a[48:51], a[240:243], v[180:183], a[48:51]
    ds_read_b64_tr_b16 v[246:247], v220 offset:7168
    v_add_f32 v231, v231, v147
    v_mfma_f32_16x16x32_bf16 a[96:99], a[240:243], v[184:187], a[96:99]
    v_add_f32 v232, v232, v151
    v_add_f32 v234, v234, v158
    v_mfma_f32_16x16x32_bf16 a[144:147], a[240:243], v[188:191], a[144:147]
    s_waitcnt lgkmcnt(8)
    v_add_f32 v233, v233, v155
    v_mov_b32 v235, v230
    v_mfma_f32_16x16x32_bf16 a[4:7], a[244:247], v[176:179], a[4:7]
    s_barrier
    ds_write_b128 v249, a[216:219] offset:0
    v_mfma_f32_16x16x32_bf16 a[52:55], a[244:247], v[180:183], a[52:55]
    ds_write_b128 v249, a[220:223] offset:1024
    v_mfma_f32_16x16x32_bf16 a[100:103], a[244:247], v[184:187], a[100:103]
    ds_write_b128 v249, a[224:227] offset:2048
    v_mfma_f32_16x16x32_bf16 a[148:151], a[244:247], v[188:191], a[148:151]
    s_waitcnt lgkmcnt(9)
    ds_write_b128 v249, a[228:231] offset:3072
    v_mfma_f32_16x16x32_bf16 a[8:11], a[248:251], v[176:179], a[8:11]
    ds_write_b128 v249, a[232:235] offset:4096
    v_mfma_f32_16x16x32_bf16 a[56:59], a[248:251], v[180:183], a[56:59]
    ds_write_b128 v249, a[236:239] offset:5120
    v_mfma_f32_16x16x32_bf16 a[104:107], a[248:251], v[184:187], a[104:107]
    ds_read_b64_tr_b16 a[240:241], v221 offset:1024
    ds_read_b64_tr_b16 a[242:243], v221 offset:7168
    v_mfma_f32_16x16x32_bf16 a[152:155], a[248:251], v[188:191], a[152:155]
    s_waitcnt lgkmcnt(12)
    v_mov_b32 v236, v231
    v_mov_b32 v237, v232
    v_mfma_f32_16x16x32_bf16 a[12:15], a[252:255], v[176:179], a[12:15]
    v_add_f32 v234, v234, v159
    v_mov_b32 v238, v233
    v_mfma_f32_16x16x32_bf16 a[60:63], a[252:255], v[180:183], a[60:63]
    ds_read_b64_tr_b16 a[244:245], v222 offset:1024
    ds_read_b64_tr_b16 a[246:247], v222 offset:7168
    v_mfma_f32_16x16x32_bf16 a[108:111], a[252:255], v[184:187], a[108:111]
    v_permlane32_swap_b32 v230, v235
    v_mfma_f32_16x16x32_bf16 a[156:159], a[252:255], v[188:191], a[156:159]
    s_waitcnt lgkmcnt(12)
    v_permlane32_swap_b32 v231, v236
    v_mfma_f32_16x16x32_bf16 a[16:19], v[240:243], v[176:179], a[16:19]
    v_permlane32_swap_b32 v232, v237
    v_mfma_f32_16x16x32_bf16 a[64:67], v[240:243], v[180:183], a[64:67]
    v_mov_b32 v239, v234
    ds_read_b64_tr_b16 a[248:249], v219 offset:2048
    v_mfma_f32_16x16x32_bf16 a[112:115], v[240:243], v[184:187], a[112:115]
    v_permlane32_swap_b32 v233, v238
    v_mfma_f32_16x16x32_bf16 a[160:163], v[240:243], v[188:191], a[160:163]
    s_waitcnt lgkmcnt(11)
    ds_read_b64_tr_b16 a[250:251], v219 offset:8192
    v_add_f32 v230, v230, v235
    v_mfma_f32_16x16x32_bf16 a[20:23], v[244:247], v[176:179], a[20:23]
    v_add_f32 v231, v231, v236
    v_add_f32 v232, v232, v237
    v_mfma_f32_16x16x32_bf16 a[68:71], v[244:247], v[180:183], a[68:71]
    ds_read_b64_tr_b16 a[252:253], v220 offset:2048
    ds_read_b64_tr_b16 a[254:255], v220 offset:8192
    v_mfma_f32_16x16x32_bf16 a[116:119], v[244:247], v[184:187], a[116:119]
    v_permlane32_swap_b32 v234, v239
    v_mfma_f32_16x16x32_bf16 a[164:167], v[244:247], v[188:191], a[164:167]
    s_waitcnt lgkmcnt(6)
    v_add_f32 v233, v233, v238
    v_mov_b32 v235, v230
    v_mfma_f32_16x16x32_bf16 a[24:27], a[240:243], v[176:179], a[24:27]
    v_mov_b32 v236, v231
    v_mov_b32 v237, v232
    v_mfma_f32_16x16x32_bf16 a[72:75], a[240:243], v[180:183], a[72:75]
    ds_read_b64_tr_b16 v[240:241], v221 offset:2048
    ds_read_b64_tr_b16 v[242:243], v221 offset:8192
    v_mfma_f32_16x16x32_bf16 a[120:123], a[240:243], v[184:187], a[120:123]
    v_add_f32 v234, v234, v239
    v_mov_b32 v238, v233
    v_mfma_f32_16x16x32_bf16 a[168:171], a[240:243], v[188:191], a[168:171]
    s_waitcnt lgkmcnt(6)
    v_permlane16_swap_b32 v230, v235
    v_mfma_f32_16x16x32_bf16 a[28:31], a[244:247], v[176:179], a[28:31]
    v_permlane16_swap_b32 v231, v236
    v_mfma_f32_16x16x32_bf16 a[76:79], a[244:247], v[180:183], a[76:79]
    v_permlane16_swap_b32 v232, v237
    v_mfma_f32_16x16x32_bf16 a[124:127], a[244:247], v[184:187], a[124:127]
    v_mov_b32 v239, v234
    ds_read_b64_tr_b16 v[244:245], v222 offset:2048
    v_mfma_f32_16x16x32_bf16 a[172:175], a[244:247], v[188:191], a[172:175]
    s_waitcnt lgkmcnt(5)
    v_permlane16_swap_b32 v233, v238
    v_mfma_f32_16x16x32_bf16 a[32:35], a[248:251], v[176:179], a[32:35]
    ds_read_b64_tr_b16 v[246:247], v222 offset:8192
    v_add_f32 v230, v230, v235
    v_mfma_f32_16x16x32_bf16 a[80:83], a[248:251], v[180:183], a[80:83]
    v_add_f32 v231, v231, v236
    v_add_f32 v232, v232, v237
    v_mfma_f32_16x16x32_bf16 a[128:131], a[248:251], v[184:187], a[128:131]
    v_permlane16_swap_b32 v234, v239
    v_mfma_f32_16x16x32_bf16 a[176:179], a[248:251], v[188:191], a[176:179]
    s_waitcnt lgkmcnt(4)
    v_add_f32 v233, v233, v238
    v_add_f32 v235, v230, v231
    v_mfma_f32_16x16x32_bf16 a[36:39], a[252:255], v[176:179], a[36:39]
    v_add_f32 v236, v232, v233
    v_add_f32 v234, v234, v239
    v_mfma_f32_16x16x32_bf16 a[84:87], a[252:255], v[180:183], a[84:87]
    ds_write_b32 v249, v234 offset:6144
    v_mfma_f32_16x16x32_bf16 a[132:135], a[252:255], v[184:187], a[132:135]
    v_add_f32 v235, v235, v236
    v_add_f32 v235, v235, v234
    v_mfma_f32_16x16x32_bf16 a[180:183], a[252:255], v[188:191], a[180:183]
    s_waitcnt lgkmcnt(3)
    ds_write_b32 v249, v235 offset:6148
    v_mfma_f32_16x16x32_bf16 a[40:43], v[240:243], v[176:179], a[40:43]
    v_add_u32 v217, s36, v217
    v_add_u32 v218, s36, v218
    v_mfma_f32_16x16x32_bf16 a[88:91], v[240:243], v[180:183], a[88:91]
    s_cmp_ge_u32 s30, 196608
    s_cselect_b32 s30, 0, s30
    v_mfma_f32_16x16x32_bf16 a[136:139], v[240:243], v[184:187], a[136:139]
    v_rcp_f32 v230, v230
    v_mfma_f32_16x16x32_bf16 a[184:187], v[240:243], v[188:191], a[184:187]
    s_waitcnt lgkmcnt(2)
    v_rcp_f32 v231, v231
    v_mfma_f32_16x16x32_bf16 a[44:47], v[244:247], v[176:179], a[44:47]
    v_rcp_f32 v232, v232
    v_mfma_f32_16x16x32_bf16 a[92:95], v[244:247], v[180:183], a[92:95]
    v_accvgpr_read_b32 v148, a0
    v_accvgpr_read_b32 v149, a1
    v_mfma_f32_16x16x32_bf16 a[140:143], v[244:247], v[184:187], a[140:143]
    v_accvgpr_read_b32 v150, a2
    v_accvgpr_read_b32 v151, a3
    v_mfma_f32_16x16x32_bf16 a[188:191], v[244:247], v[188:191], a[188:191]
    s_waitcnt lgkmcnt(0)
    s_barrier
    ds_read_b32 v235, v251 offset:6148
    ds_read_b32 v236, v251 offset:14340
    ds_read_b32 v237, v251 offset:22532
    ds_read_b32 v238, v251 offset:30724
    v_accvgpr_read_b32 v152, a4
    v_accvgpr_read_b32 v153, a5
    v_accvgpr_read_b32 v154, a6
    v_accvgpr_read_b32 v155, a7
    v_rcp_f32 v233, v233
    v_mul_f32 v148, v148, v230
    v_mul_f32 v149, v149, v230
    v_mul_f32 v150, v150, v230
    v_mul_f32 v151, v151, v230
    v_mul_f32 v152, v152, v230
    v_mul_f32 v153, v153, v230
    v_mul_f32 v154, v154, v230
    v_mul_f32 v155, v155, v230
    v_accvgpr_read_b32 v160, a48
    v_accvgpr_read_b32 v161, a49
    v_accvgpr_read_b32 v162, a50
    v_accvgpr_read_b32 v163, a51
    v_accvgpr_read_b32 v164, a52
    v_accvgpr_read_b32 v165, a53
    v_accvgpr_read_b32 v166, a54
    v_accvgpr_read_b32 v167, a55
    v_cvt_pk_bf16_f32 v156, v148, v149
    v_cvt_pk_bf16_f32 v157, v150, v151
    v_cvt_pk_bf16_f32 v158, v152, v153
    v_cvt_pk_bf16_f32 v159, v154, v155
    v_mul_f32 v160, v160, v231
    v_mul_f32 v161, v161, v231
    v_mul_f32 v162, v162, v231
    v_mul_f32 v163, v163, v231
    v_mul_f32 v164, v164, v231
    v_mul_f32 v165, v165, v231
    v_mul_f32 v166, v166, v231
    v_mul_f32 v167, v167, v231
    s_waitcnt lgkmcnt(1)
    v_max3_f32 v235, v235, v236, v237
    s_waitcnt lgkmcnt(0)
    v_max_f32 v235, v235, v238
    v_cmp_lt_f32 vcc, s72, v235
    v_accvgpr_read_b32 v196, a96
    v_accvgpr_read_b32 v197, a97
    v_accvgpr_read_b32 v198, a98
    v_accvgpr_read_b32 v199, a99
    v_accvgpr_read_b32 v200, a100
    v_accvgpr_read_b32 v201, a101
    v_accvgpr_read_b32 v202, a102
    v_accvgpr_read_b32 v203, a103
    buffer_store_dwordx4 v[156:159], v248, s[20:23], s38 offen sc1
    v_cvt_pk_bf16_f32 v168, v160, v161
    v_cvt_pk_bf16_f32 v169, v162, v163
    v_cvt_pk_bf16_f32 v170, v164, v165
    v_cvt_pk_bf16_f32 v171, v166, v167
    v_mul_f32 v196, v196, v232
    v_mul_f32 v197, v197, v232
    v_mul_f32 v198, v198, v232
    v_mul_f32 v199, v199, v232
    v_mul_f32 v200, v200, v232
    v_mul_f32 v201, v201, v232
    v_mul_f32 v202, v202, v232
    v_mul_f32 v203, v203, v232
    v_accvgpr_read_b32 v204, a144
    v_accvgpr_read_b32 v205, a145
    v_accvgpr_read_b32 v206, a146
    v_accvgpr_read_b32 v207, a147
    v_accvgpr_read_b32 v208, a148
    v_accvgpr_read_b32 v209, a149
    v_accvgpr_read_b32 v210, a150
    v_accvgpr_read_b32 v211, a151
    buffer_store_dwordx4 v[168:171], v248, s[20:23], s38 offen offset:1024 sc1
    v_cvt_pk_bf16_f32 v172, v196, v197
    v_cvt_pk_bf16_f32 v173, v198, v199
    v_cvt_pk_bf16_f32 v174, v200, v201
    v_cvt_pk_bf16_f32 v175, v202, v203
    v_mul_f32 v204, v204, v233
    v_mul_f32 v205, v205, v233
    v_mul_f32 v206, v206, v233
    v_mul_f32 v207, v207, v233
    v_mul_f32 v208, v208, v233
    v_mul_f32 v209, v209, v233
    v_mul_f32 v210, v210, v233
    v_mul_f32 v211, v211, v233
    buffer_store_dwordx4 v[172:175], v248, s[20:23], s38 offen offset:2048 sc1
    v_cvt_pk_bf16_f32 v212, v204, v205
    v_cvt_pk_bf16_f32 v213, v206, v207
    v_cvt_pk_bf16_f32 v214, v208, v209
    v_cvt_pk_bf16_f32 v215, v210, v211
    buffer_store_dwordx4 v[212:215], v248, s[20:23], s38 offen offset:3072 sc1
    v_accvgpr_read_b32 v148, a8
    v_accvgpr_read_b32 v149, a9
    v_accvgpr_read_b32 v150, a10
    v_accvgpr_read_b32 v151, a11
    v_accvgpr_read_b32 v152, a12
    v_accvgpr_read_b32 v153, a13
    v_accvgpr_read_b32 v154, a14
    v_accvgpr_read_b32 v155, a15
    v_mul_f32 v148, v148, v230
    v_mul_f32 v149, v149, v230
    v_mul_f32 v150, v150, v230
    v_mul_f32 v151, v151, v230
    v_mul_f32 v152, v152, v230
    v_mul_f32 v153, v153, v230
    v_mul_f32 v154, v154, v230
    v_mul_f32 v155, v155, v230
    v_accvgpr_read_b32 v160, a56
    v_accvgpr_read_b32 v161, a57
    v_accvgpr_read_b32 v162, a58
    v_accvgpr_read_b32 v163, a59
    v_accvgpr_read_b32 v164, a60
    v_accvgpr_read_b32 v165, a61
    v_accvgpr_read_b32 v166, a62
    v_accvgpr_read_b32 v167, a63
    ds_read_b32 v239, v250 offset:6144
    s_add_u32 s38, s44, 18432
    v_cvt_pk_bf16_f32 v156, v148, v149
    v_cvt_pk_bf16_f32 v157, v150, v151
    v_cvt_pk_bf16_f32 v158, v152, v153
    v_cvt_pk_bf16_f32 v159, v154, v155
    v_mul_f32 v160, v160, v231
    v_mul_f32 v161, v161, v231
    v_mul_f32 v162, v162, v231
    v_mul_f32 v163, v163, v231
    v_mul_f32 v164, v164, v231
    v_mul_f32 v165, v165, v231
    v_mul_f32 v166, v166, v231
    v_mul_f32 v167, v167, v231
    v_accvgpr_read_b32 v196, a104
    v_accvgpr_read_b32 v197, a105
    v_accvgpr_read_b32 v198, a106
    v_accvgpr_read_b32 v199, a107
    v_accvgpr_read_b32 v200, a108
    v_accvgpr_read_b32 v201, a109
    v_accvgpr_read_b32 v202, a110
    v_accvgpr_read_b32 v203, a111
    buffer_store_dwordx4 v[156:159], v248, s[20:23], s38 offen sc1
    v_cvt_pk_bf16_f32 v168, v160, v161
    v_cvt_pk_bf16_f32 v169, v162, v163
    v_cvt_pk_bf16_f32 v170, v164, v165
    v_cvt_pk_bf16_f32 v171, v166, v167
    v_mul_f32 v196, v196, v232
    v_mul_f32 v197, v197, v232
    v_mul_f32 v198, v198, v232
    v_mul_f32 v199, v199, v232
    v_mul_f32 v200, v200, v232
    v_mul_f32 v201, v201, v232
    v_mul_f32 v202, v202, v232
    v_mul_f32 v203, v203, v232
    v_accvgpr_read_b32 v204, a152
    v_accvgpr_read_b32 v205, a153
    v_accvgpr_read_b32 v206, a154
    v_accvgpr_read_b32 v207, a155
    v_accvgpr_read_b32 v208, a156
    v_accvgpr_read_b32 v209, a157
    v_accvgpr_read_b32 v210, a158
    v_accvgpr_read_b32 v211, a159
    buffer_store_dwordx4 v[168:171], v248, s[20:23], s38 offen offset:1024 sc1
    v_cvt_pk_bf16_f32 v172, v196, v197
    v_cvt_pk_bf16_f32 v173, v198, v199
    v_cvt_pk_bf16_f32 v174, v200, v201
    v_cvt_pk_bf16_f32 v175, v202, v203
    v_mul_f32 v204, v204, v233
    v_mul_f32 v205, v205, v233
    v_mul_f32 v206, v206, v233
    v_mul_f32 v207, v207, v233
    v_mul_f32 v208, v208, v233
    v_mul_f32 v209, v209, v233
    v_mul_f32 v210, v210, v233
    v_mul_f32 v211, v211, v233
    ds_read_b128 v[124:127], v250 offset:0
    ds_read_b128 v[128:131], v250 offset:1024
    buffer_store_dwordx4 v[172:175], v248, s[20:23], s38 offen offset:2048 sc1
    v_cvt_pk_bf16_f32 v212, v204, v205
    v_cvt_pk_bf16_f32 v213, v206, v207
    v_cvt_pk_bf16_f32 v214, v208, v209
    v_cvt_pk_bf16_f32 v215, v210, v211
    buffer_store_dwordx4 v[212:215], v248, s[20:23], s38 offen offset:3072 sc1
    s_cbranch_vccnz K_fix0
    v_accvgpr_read_b32 v96, a16
    v_accvgpr_read_b32 v97, a17
    v_accvgpr_read_b32 v98, a18
    v_accvgpr_read_b32 v99, a19
    v_accvgpr_read_b32 v100, a20
    v_accvgpr_read_b32 v101, a21
    v_accvgpr_read_b32 v102, a22
    v_accvgpr_read_b32 v103, a23
    ds_read_b128 v[132:135], v250 offset:2048
    ds_read_b128 v[136:139], v250 offset:3072
    s_cmp_eq_u32 s75, 0
    s_cbranch_scc1 K_nohook0
    s_add_u32 s8, s8, 6144
    s_addc_u32 s9, s9, 0
    s_sub_u32 s10, s10, 6144
    s_mov_b32 s50, s41
    s_add_u32 m0, s50, 0
    s_nop 0
    buffer_load_dwordx4 v224, s[8:11], s29 offen lds
    s_add_u32 m0, s50, 896
    s_nop 0
    buffer_load_dwordx4 v224, s[8:11], s29 offen offset:128 lds
    s_add_u32 m0, s50, 1792
    s_nop 0
    buffer_load_dwordx4 v224, s[8:11], s29 offen offset:256 lds
    s_add_u32 s29, s29, 393216
    s_add_u32 s50, s50, 12288
    s_cmp_ge_u32 s50, 86016
    s_cselect_b32 s50, s41, s50
    s_add_u32 s38, s28, 0
    s_add_u32 m0, s40, 0
    s_nop 0
    buffer_load_dwordx4 v223, s[4:7], s38 offen lds
    s_add_u32 s38, s28, 10240
    s_add_u32 m0, s40, 1024
    s_nop 0
    buffer_load_dwordx4 v223, s[4:7], s38 offen lds
    s_add_u32 s38, s28, 20480
    s_add_u32 m0, s40, 2048
    s_nop 0
    buffer_load_dwordx4 v223, s[4:7], s38 offen lds
    s_add_u32 s38, s28, 30720
    s_add_u32 m0, s40, 3072
    s_nop 0
    buffer_load_dwordx4 v223, s[4:7], s38 offen lds
    s_add_u32 s38, s28, 40960
    s_add_u32 m0, s40, 4096
    s_nop 0
    buffer_load_dwordx4 v223, s[4:7], s38 offen lds
    s_add_u32 s38, s28, 51200
    s_add_u32 m0, s40, 5120
    s_nop 0
    buffer_load_dwordx4 v223, s[4:7], s38 offen lds
    s_add_u32 s38, s28, 61440
    s_add_u32 m0, s40, 6144
    s_nop 0
    buffer_load_dwordx4 v223, s[4:7], s38 offen lds
    s_add_u32 s38, s28, 71680
    s_add_u32 m0, s40, 7168
    s_nop 0
    buffer_load_dwordx4 v223, s[4:7], s38 offen lds
    s_add_u32 s38, s28, 163840
    s_add_u32 m0, s40, 8192
    s_nop 0
    buffer_load_dwordx4 v223, s[4:7], s38 offen lds
    s_add_u32 s38, s28, 174080
    s_add_u32 m0, s40, 9216
    s_nop 0
    buffer_load_dwordx4 v223, s[4:7], s38 offen lds
    s_add_u32 s28, s28, 128
    s_cmp_ge_u32 s28, 1280
    s_cselect_b32 s28, 0, s28
    s_add_u32 s16, s16, 3145728
    s_addc_u32 s17, s17, 0
    s_add_u32 s39, s34, s35
    s_add_u32 m0, s39, 0
    s_nop 0
    buffer_load_dwordx4 v216, s[16:19], s31 offen nt lds
    buffer_load_dwordx4 v216, s[16:19], s31 offen offset:3072 nt lds
    s_add_u32 m0, s39, 896
    s_nop 0
    buffer_load_dwordx4 v216, s[16:19], s31 offen offset:128 nt lds
    buffer_load_dwordx4 v216, s[16:19], s31 offen offset:3200 nt lds
    s_add_u32 m0, s39, 1792
    s_nop 0
    buffer_load_dwordx4 v216, s[16:19], s31 offen offset:256 nt lds
    buffer_load_dwordx4 v216, s[16:19], s31 offen offset:3328 nt lds
    s_add_u32 s31, s31, 12288
    s_cmp_ge_u32 s31, 196608
    s_cselect_b32 s31, 0, s31
K_nohook0:
    v_pk_mul_f32 v[96:97], v[96:97], v[230:231] op_sel:[0,0] op_sel_hi:[1,0]
    v_pk_mul_f32 v[98:99], v[98:99], v[230:231] op_sel:[0,0] op_sel_hi:[1,0]
    v_pk_mul_f32 v[100:101], v[100:101], v[230:231] op_sel:[0,0] op_sel_hi:[1,0]
    v_pk_mul_f32 v[102:103], v[102:103], v[230:231] op_sel:[0,0] op_sel_hi:[1,0]
    v_accvgpr_read_b32 v108, a64
    v_accvgpr_read_b32 v109, a65
    v_accvgpr_read_b32 v110, a66
    v_accvgpr_read_b32 v111, a67
    v_accvgpr_read_b32 v112, a68
    v_accvgpr_read_b32 v113, a69
    v_accvgpr_read_b32 v114, a70
    v_accvgpr_read_b32 v115, a71
    s_add_u32 s38, s44, 36864
    v_cvt_pk_bf16_f32 v104, v96, v97
    v_cvt_pk_bf16_f32 v105, v98, v99
    v_cvt_pk_bf16_f32 v106, v100, v101
    v_cvt_pk_bf16_f32 v107, v102, v103
    v_pk_mul_f32 v[108:109], v[108:109], v[230:231] op_sel:[0,1] op_sel_hi:[1,1]
    v_pk_mul_f32 v[110:111], v[110:111], v[230:231] op_sel:[0,1] op_sel_hi:[1,1]
    v_pk_mul_f32 v[112:113], v[112:113], v[230:231] op_sel:[0,1] op_sel_hi:[1,1]
    v_pk_mul_f32 v[114:115], v[114:115], v[230:231] op_sel:[0,1] op_sel_hi:[1,1]
    v_accvgpr_read_b32 v0, a112
    v_accvgpr_read_b32 v1, a113
    v_accvgpr_read_b32 v2, a114
    v_accvgpr_read_b32 v3, a115
    v_accvgpr_read_b32 v4, a116
    v_accvgpr_read_b32 v5, a117
    v_accvgpr_read_b32 v6, a118
    v_accvgpr_read_b32 v7, a119
    buffer_store_dwordx4 v[104:107], v248, s[20:23], s38 offen sc1
    v_cvt_pk_bf16_f32 v116, v108, v109
    v_cvt_pk_bf16_f32 v117, v110, v111
    v_cvt_pk_bf16_f32 v118, v112, v113
    v_cvt_pk_bf16_f32 v119, v114, v115
    v_pk_mul_f32 v[0:1], v[0:1], v[232:233] op_sel:[0,0] op_sel_hi:[1,0]
    v_pk_mul_f32 v[2:3], v[2:3], v[232:233] op_sel:[0,0] op_sel_hi:[1,0]
    v_pk_mul_f32 v[4:5], v[4:5], v[232:233] op_sel:[0,0] op_sel_hi:[1,0]
    v_pk_mul_f32 v[6:7], v[6:7], v[232:233] op_sel:[0,0] op_sel_hi:[1,0]
    v_accvgpr_read_b32 v12, a160
    v_accvgpr_read_b32 v13, a161
    v_accvgpr_read_b32 v14, a162
    v_accvgpr_read_b32 v15, a163
    v_accvgpr_read_b32 v16, a164
    v_accvgpr_read_b32 v17, a165
    v_accvgpr_read_b32 v18, a166
    v_accvgpr_read_b32 v19, a167
    buffer_store_dwordx4 v[116:119], v248, s[20:23], s38 offen offset:1024 sc1
    v_cvt_pk_bf16_f32 v8, v0, v1
    v_cvt_pk_bf16_f32 v9, v2, v3
    v_cvt_pk_bf16_f32 v10, v4, v5
    v_cvt_pk_bf16_f32 v11, v6, v7
    v_pk_mul_f32 v[12:13], v[12:13], v[232:233] op_sel:[0,1] op_sel_hi:[1,1]
    v_pk_mul_f32 v[14:15], v[14:15], v[232:233] op_sel:[0,1] op_sel_hi:[1,1]
    v_pk_mul_f32 v[16:17], v[16:17], v[232:233] op_sel:[0,1] op_sel_hi:[1,1]
    v_pk_mul_f32 v[18:19], v[18:19], v[232:233] op_sel:[0,1] op_sel_hi:[1,1]
    buffer_store_dwordx4 v[8:11], v248, s[20:23], s38 offen offset:2048 sc1
    v_cvt_pk_bf16_f32 v20, v12, v13
    v_cvt_pk_bf16_f32 v21, v14, v15
    v_cvt_pk_bf16_f32 v22, v16, v17
    v_cvt_pk_bf16_f32 v23, v18, v19
    ds_read_b128 v[140:143], v250 offset:4096
    ds_read_b128 v[144:147], v250 offset:5120
    buffer_store_dwordx4 v[20:23], v248, s[20:23], s38 offen offset:3072 sc1
    v_accvgpr_read_b32 v24, a24
    v_accvgpr_read_b32 v25, a25
    v_accvgpr_read_b32 v26, a26
    v_accvgpr_read_b32 v27, a27
    v_accvgpr_read_b32 v28, a28
    v_accvgpr_read_b32 v29, a29
    v_accvgpr_read_b32 v30, a30
    v_accvgpr_read_b32 v31, a31
    v_pk_mul_f32 v[24:25], v[24:25], v[230:231] op_sel:[0,0] op_sel_hi:[1,0]
    v_pk_mul_f32 v[26:27], v[26:27], v[230:231] op_sel:[0,0] op_sel_hi:[1,0]
    v_pk_mul_f32 v[28:29], v[28:29], v[230:231] op_sel:[0,0] op_sel_hi:[1,0]
    v_pk_mul_f32 v[30:31], v[30:31], v[230:231] op_sel:[0,0] op_sel_hi:[1,0]
    v_accvgpr_read_b32 v36, a72
    v_accvgpr_read_b32 v37, a73
    v_accvgpr_read_b32 v38, a74
    v_accvgpr_read_b32 v39, a75
    v_accvgpr_read_b32 v40, a76
    v_accvgpr_read_b32 v41, a77
    v_accvgpr_read_b32 v42, a78
    v_accvgpr_read_b32 v43, a79
    s_add_u32 s38, s44, 55296
    v_cvt_pk_bf16_f32 v32, v24, v25
    v_cvt_pk_bf16_f32 v33, v26, v27
    v_cvt_pk_bf16_f32 v34, v28, v29
    v_cvt_pk_bf16_f32 v35, v30, v31
    v_pk_mul_f32 v[36:37], v[36:37], v[230:231] op_sel:[0,1] op_sel_hi:[1,1]
    v_pk_mul_f32 v[38:39], v[38:39], v[230:231] op_sel:[0,1] op_sel_hi:[1,1]
    v_pk_mul_f32 v[40:41], v[40:41], v[230:231] op_sel:[0,1] op_sel_hi:[1,1]
    v_pk_mul_f32 v[42:43], v[42:43], v[230:231] op_sel:[0,1] op_sel_hi:[1,1]
    v_accvgpr_read_b32 v48, a120
    v_accvgpr_read_b32 v49, a121
    v_accvgpr_read_b32 v50, a122
    v_accvgpr_read_b32 v51, a123
    v_accvgpr_read_b32 v52, a124
    v_accvgpr_read_b32 v53, a125
    v_accvgpr_read_b32 v54, a126
    v_accvgpr_read_b32 v55, a127
    buffer_store_dwordx4 v[32:35], v248, s[20:23], s38 offen sc1
    v_cvt_pk_bf16_f32 v44, v36, v37
    v_cvt_pk_bf16_f32 v45, v38, v39
    v_cvt_pk_bf16_f32 v46, v40, v41
    v_cvt_pk_bf16_f32 v47, v42, v43
    v_pk_mul_f32 v[48:49], v[48:49], v[232:233] op_sel:[0,0] op_sel_hi:[1,0]
    v_pk_mul_f32 v[50:51], v[50:51], v[232:233] op_sel:[0,0] op_sel_hi:[1,0]
    v_pk_mul_f32 v[52:53], v[52:53], v[232:233] op_sel:[0,0] op_sel_hi:[1,0]
    v_pk_mul_f32 v[54:55], v[54:55], v[232:233] op_sel:[0,0] op_sel_hi:[1,0]
    v_accvgpr_read_b32 v60, a168
    v_accvgpr_read_b32 v61, a169
    v_accvgpr_read_b32 v62, a170
    v_accvgpr_read_b32 v63, a171
    v_accvgpr_read_b32 v64, a172
    v_accvgpr_read_b32 v65, a173
    v_accvgpr_read_b32 v66, a174
    v_accvgpr_read_b32 v67, a175
    buffer_store_dwordx4 v[44:47], v248, s[20:23], s38 offen offset:1024 sc1
    v_cvt_pk_bf16_f32 v56, v48, v49
    v_cvt_pk_bf16_f32 v57, v50, v51
    v_cvt_pk_bf16_f32 v58, v52, v53
    v_cvt_pk_bf16_f32 v59, v54, v55
    v_pk_mul_f32 v[60:61], v[60:61], v[232:233] op_sel:[0,1] op_sel_hi:[1,1]
    v_pk_mul_f32 v[62:63], v[62:63], v[232:233] op_sel:[0,1] op_sel_hi:[1,1]
    v_pk_mul_f32 v[64:65], v[64:65], v[232:233] op_sel:[0,1] op_sel_hi:[1,1]
    v_pk_mul_f32 v[66:67], v[66:67], v[232:233] op_sel:[0,1] op_sel_hi:[1,1]
    buffer_store_dwordx4 v[56:59], v248, s[20:23], s38 offen offset:2048 sc1
    v_cvt_pk_bf16_f32 v68, v60, v61
    v_cvt_pk_bf16_f32 v69, v62, v63
    v_cvt_pk_bf16_f32 v70, v64, v65
    v_cvt_pk_bf16_f32 v71, v66, v67
    buffer_store_dwordx4 v[68:71], v248, s[20:23], s38 offen offset:3072 sc1
    v_accvgpr_read_b32 v72, a32
    v_accvgpr_read_b32 v73, a33
    v_accvgpr_read_b32 v74, a34
    v_accvgpr_read_b32 v75, a35
    v_accvgpr_read_b32 v76, a36
    v_accvgpr_read_b32 v77, a37
    v_accvgpr_read_b32 v78, a38
    v_accvgpr_read_b32 v79, a39
    v_pk_mul_f32 v[72:73], v[72:73], v[230:231] op_sel:[0,0] op_sel_hi:[1,0]
    v_pk_mul_f32 v[74:75], v[74:75], v[230:231] op_sel:[0,0] op_sel_hi:[1,0]
    v_pk_mul_f32 v[76:77], v[76:77], v[230:231] op_sel:[0,0] op_sel_hi:[1,0]
    v_pk_mul_f32 v[78:79], v[78:79], v[230:231] op_sel:[0,0] op_sel_hi:[1,0]
    v_accvgpr_read_b32 v84, a80
    v_accvgpr_read_b32 v85, a81
    v_accvgpr_read_b32 v86, a82
    v_accvgpr_read_b32 v87, a83
    v_accvgpr_read_b32 v88, a84
    v_accvgpr_read_b32 v89, a85
    v_accvgpr_read_b32 v90, a86
    v_accvgpr_read_b32 v91, a87
    s_add_u32 s38, s44, 73728
    v_cvt_pk_bf16_f32 v80, v72, v73
    v_cvt_pk_bf16_f32 v81, v74, v75
    v_cvt_pk_bf16_f32 v82, v76, v77
    v_cvt_pk_bf16_f32 v83, v78, v79
    v_pk_mul_f32 v[84:85], v[84:85], v[230:231] op_sel:[0,1] op_sel_hi:[1,1]
    v_pk_mul_f32 v[86:87], v[86:87], v[230:231] op_sel:[0,1] op_sel_hi:[1,1]
    v_pk_mul_f32 v[88:89], v[88:89], v[230:231] op_sel:[0,1] op_sel_hi:[1,1]
    v_pk_mul_f32 v[90:91], v[90:91], v[230:231] op_sel:[0,1] op_sel_hi:[1,1]
    v_accvgpr_read_b32 v96, a128
    v_accvgpr_read_b32 v97, a129
    v_accvgpr_read_b32 v98, a130
    v_accvgpr_read_b32 v99, a131
    v_accvgpr_read_b32 v100, a132
    v_accvgpr_read_b32 v101, a133
    v_accvgpr_read_b32 v102, a134
    v_accvgpr_read_b32 v103, a135
    buffer_store_dwordx4 v[80:83], v248, s[20:23], s38 offen sc1
    v_cvt_pk_bf16_f32 v92, v84, v85
    v_cvt_pk_bf16_f32 v93, v86, v87
    v_cvt_pk_bf16_f32 v94, v88, v89
    v_cvt_pk_bf16_f32 v95, v90, v91
    v_pk_mul_f32 v[96:97], v[96:97], v[232:233] op_sel:[0,0] op_sel_hi:[1,0]
    v_pk_mul_f32 v[98:99], v[98:99], v[232:233] op_sel:[0,0] op_sel_hi:[1,0]
    v_pk_mul_f32 v[100:101], v[100:101], v[232:233] op_sel:[0,0] op_sel_hi:[1,0]
    v_pk_mul_f32 v[102:103], v[102:103], v[232:233] op_sel:[0,0] op_sel_hi:[1,0]
    v_accvgpr_read_b32 v108, a176
    v_accvgpr_read_b32 v109, a177
    v_accvgpr_read_b32 v110, a178
    v_accvgpr_read_b32 v111, a179
    v_accvgpr_read_b32 v112, a180
    v_accvgpr_read_b32 v113, a181
    v_accvgpr_read_b32 v114, a182
    v_accvgpr_read_b32 v115, a183
    buffer_store_dwordx4 v[92:95], v248, s[20:23], s38 offen offset:1024 sc1
    v_cvt_pk_bf16_f32 v104, v96, v97
    v_cvt_pk_bf16_f32 v105, v98, v99
    v_cvt_pk_bf16_f32 v106, v100, v101
    v_cvt_pk_bf16_f32 v107, v102, v103
    v_pk_mul_f32 v[108:109], v[108:109], v[232:233] op_sel:[0,1] op_sel_hi:[1,1]
    v_pk_mul_f32 v[110:111], v[110:111], v[232:233] op_sel:[0,1] op_sel_hi:[1,1]
    v_pk_mul_f32 v[112:113], v[112:113], v[232:233] op_sel:[0,1] op_sel_hi:[1,1]
    v_pk_mul_f32 v[114:115], v[114:115], v[232:233] op_sel:[0,1] op_sel_hi:[1,1]
    buffer_store_dwordx4 v[104:107], v248, s[20:23], s38 offen offset:2048 sc1
    v_cvt_pk_bf16_f32 v116, v108, v109
    v_cvt_pk_bf16_f32 v117, v110, v111
    v_cvt_pk_bf16_f32 v118, v112, v113
    v_cvt_pk_bf16_f32 v119, v114, v115
    buffer_store_dwordx4 v[116:119], v248, s[20:23], s38 offen offset:3072 sc1
    v_accvgpr_read_b32 v0, a40
    v_accvgpr_read_b32 v1, a41
    v_accvgpr_read_b32 v2, a42
    v_accvgpr_read_b32 v3, a43
    v_accvgpr_read_b32 v4, a44
    v_accvgpr_read_b32 v5, a45
    v_accvgpr_read_b32 v6, a46
    v_accvgpr_read_b32 v7, a47
    v_pk_mul_f32 v[0:1], v[0:1], v[230:231] op_sel:[0,0] op_sel_hi:[1,0]
    v_pk_mul_f32 v[2:3], v[2:3], v[230:231] op_sel:[0,0] op_sel_hi:[1,0]
    v_pk_mul_f32 v[4:5], v[4:5], v[230:231] op_sel:[0,0] op_sel_hi:[1,0]
    v_pk_mul_f32 v[6:7], v[6:7], v[230:231] op_sel:[0,0] op_sel_hi:[1,0]
    v_accvgpr_read_b32 v12, a88
    v_accvgpr_read_b32 v13, a89
    v_accvgpr_read_b32 v14, a90
    v_accvgpr_read_b32 v15, a91
    v_accvgpr_read_b32 v16, a92
    v_accvgpr_read_b32 v17, a93
    v_accvgpr_read_b32 v18, a94
    v_accvgpr_read_b32 v19, a95
    s_add_u32 s38, s44, 92160
    v_cvt_pk_bf16_f32 v8, v0, v1
    v_cvt_pk_bf16_f32 v9, v2, v3
    v_cvt_pk_bf16_f32 v10, v4, v5
    v_cvt_pk_bf16_f32 v11, v6, v7
    v_pk_mul_f32 v[12:13], v[12:13], v[230:231] op_sel:[0,1] op_sel_hi:[1,1]
    v_pk_mul_f32 v[14:15], v[14:15], v[230:231] op_sel:[0,1] op_sel_hi:[1,1]
    v_pk_mul_f32 v[16:17], v[16:17], v[230:231] op_sel:[0,1] op_sel_hi:[1,1]
    v_pk_mul_f32 v[18:19], v[18:19], v[230:231] op_sel:[0,1] op_sel_hi:[1,1]
    v_accvgpr_read_b32 v24, a136
    v_accvgpr_read_b32 v25, a137
    v_accvgpr_read_b32 v26, a138
    v_accvgpr_read_b32 v27, a139
    v_accvgpr_read_b32 v28, a140
    v_accvgpr_read_b32 v29, a141
    v_accvgpr_read_b32 v30, a142
    v_accvgpr_read_b32 v31, a143
    buffer_store_dwordx4 v[8:11], v248, s[20:23], s38 offen sc1
    v_cvt_pk_bf16_f32 v20, v12, v13
    v_cvt_pk_bf16_f32 v21, v14, v15
    v_cvt_pk_bf16_f32 v22, v16, v17
    v_cvt_pk_bf16_f32 v23, v18, v19
    v_pk_mul_f32 v[24:25], v[24:25], v[232:233] op_sel:[0,0] op_sel_hi:[1,0]
    v_pk_mul_f32 v[26:27], v[26:27], v[232:233] op_sel:[0,0] op_sel_hi:[1,0]
    v_pk_mul_f32 v[28:29], v[28:29], v[232:233] op_sel:[0,0] op_sel_hi:[1,0]
    v_pk_mul_f32 v[30:31], v[30:31], v[232:233] op_sel:[0,0] op_sel_hi:[1,0]
    v_accvgpr_read_b32 v36, a184
    v_accvgpr_read_b32 v37, a185
    v_accvgpr_read_b32 v38, a186
    v_accvgpr_read_b32 v39, a187
    v_accvgpr_read_b32 v40, a188
    v_accvgpr_read_b32 v41, a189
    v_accvgpr_read_b32 v42, a190
    v_accvgpr_read_b32 v43, a191
    buffer_store_dwordx4 v[20:23], v248, s[20:23], s38 offen offset:1024 sc1
    v_cvt_pk_bf16_f32 v32, v24, v25
    v_cvt_pk_bf16_f32 v33, v26, v27
    v_cvt_pk_bf16_f32 v34, v28, v29
    v_cvt_pk_bf16_f32 v35, v30, v31
    v_pk_mul_f32 v[36:37], v[36:37], v[232:233] op_sel:[0,1] op_sel_hi:[1,1]
    v_pk_mul_f32 v[38:39], v[38:39], v[232:233] op_sel:[0,1] op_sel_hi:[1,1]
    v_pk_mul_f32 v[40:41], v[40:41], v[232:233] op_sel:[0,1] op_sel_hi:[1,1]
    v_pk_mul_f32 v[42:43], v[42:43], v[232:233] op_sel:[0,1] op_sel_hi:[1,1]
    buffer_store_dwordx4 v[32:35], v248, s[20:23], s38 offen offset:2048 sc1
    v_cvt_pk_bf16_f32 v44, v36, v37
    v_cvt_pk_bf16_f32 v45, v38, v39
    v_cvt_pk_bf16_f32 v46, v40, v41
    v_cvt_pk_bf16_f32 v47, v42, v43
    s_waitcnt lgkmcnt(6)
    v_add_f32 v234, v234, v239
    buffer_store_dwordx4 v[44:47], v248, s[20:23], s38 offen offset:3072 sc1
    v_rcp_f32 v234, v234
    v_accvgpr_read_b32 v48, a192
    v_accvgpr_read_b32 v49, a193
    v_accvgpr_read_b32 v50, a194
    v_accvgpr_read_b32 v51, a195
    v_accvgpr_read_b32 v52, a196
    v_accvgpr_read_b32 v53, a197
    v_accvgpr_read_b32 v54, a198
    v_accvgpr_read_b32 v55, a199
    s_waitcnt lgkmcnt(5)
    v_add_f32 v48, v48, v124
    v_add_f32 v49, v49, v125
    v_add_f32 v50, v50, v126
    v_add_f32 v51, v51, v127
    s_waitcnt lgkmcnt(4)
    v_add_f32 v52, v52, v128
    v_add_f32 v53, v53, v129
    v_add_f32 v54, v54, v130
    v_add_f32 v55, v55, v131
    v_pk_mul_f32 v[48:49], v[48:49], v[234:235] op_sel:[0,0] op_sel_hi:[1,0]
    v_pk_mul_f32 v[50:51], v[50:51], v[234:235] op_sel:[0,0] op_sel_hi:[1,0]
    v_pk_mul_f32 v[52:53], v[52:53], v[234:235] op_sel:[0,0] op_sel_hi:[1,0]
    v_pk_mul_f32 v[54:55], v[54:55], v[234:235] op_sel:[0,0] op_sel_hi:[1,0]
    s_add_u32 s38, s45, 0
    v_cvt_pk_bf16_f32 v56, v48, v49
    v_cvt_pk_bf16_f32 v57, v50, v51
    v_cvt_pk_bf16_f32 v58, v52, v53
    v_cvt_pk_bf16_f32 v59, v54, v55
    buffer_store_dwordx4 v[56:59], v248, s[20:23], s38 offen sc1
    v_accvgpr_read_b32 v60, a200
    v_accvgpr_read_b32 v61, a201
    v_accvgpr_read_b32 v62, a202
    v_accvgpr_read_b32 v63, a203
    v_accvgpr_read_b32 v64, a204
    v_accvgpr_read_b32 v65, a205
    v_accvgpr_read_b32 v66, a206
    v_accvgpr_read_b32 v67, a207
    s_waitcnt lgkmcnt(3)
    v_add_f32 v60, v60, v132
    v_add_f32 v61, v61, v133
    v_add_f32 v62, v62, v134
    v_add_f32 v63, v63, v135
    s_waitcnt lgkmcnt(2)
    v_add_f32 v64, v64, v136
    v_add_f32 v65, v65, v137
    v_add_f32 v66, v66, v138
    v_add_f32 v67, v67, v139
    v_pk_mul_f32 v[60:61], v[60:61], v[234:235] op_sel:[0,0] op_sel_hi:[1,0]
    v_pk_mul_f32 v[62:63], v[62:63], v[234:235] op_sel:[0,0] op_sel_hi:[1,0]
    v_pk_mul_f32 v[64:65], v[64:65], v[234:235] op_sel:[0,0] op_sel_hi:[1,0]
    v_pk_mul_f32 v[66:67], v[66:67], v[234:235] op_sel:[0,0] op_sel_hi:[1,0]
    s_add_u32 s38, s45, 18432
    v_cvt_pk_bf16_f32 v68, v60, v61
    v_cvt_pk_bf16_f32 v69, v62, v63
    v_cvt_pk_bf16_f32 v70, v64, v65
    v_cvt_pk_bf16_f32 v71, v66, v67
    buffer_store_dwordx4 v[68:71], v248, s[20:23], s38 offen sc1
    v_accvgpr_read_b32 v72, a208
    v_accvgpr_read_b32 v73, a209
    v_accvgpr_read_b32 v74, a210
    v_accvgpr_read_b32 v75, a211
    v_accvgpr_read_b32 v76, a212
    v_accvgpr_read_b32 v77, a213
    v_accvgpr_read_b32 v78, a214
    v_accvgpr_read_b32 v79, a215
    s_waitcnt lgkmcnt(1)
    v_add_f32 v72, v72, v140
    v_add_f32 v73, v73, v141
    v_add_f32 v74, v74, v142
    v_add_f32 v75, v75, v143
    s_waitcnt lgkmcnt(0)
    v_add_f32 v76, v76, v144
    v_add_f32 v77, v77, v145
    v_add_f32 v78, v78, v146
    v_add_f32 v79, v79, v147
    v_pk_mul_f32 v[72:73], v[72:73], v[234:235] op_sel:[0,0] op_sel_hi:[1,0]
    v_pk_mul_f32 v[74:75], v[74:75], v[234:235] op_sel:[0,0] op_sel_hi:[1,0]
    v_pk_mul_f32 v[76:77], v[76:77], v[234:235] op_sel:[0,0] op_sel_hi:[1,0]
    v_pk_mul_f32 v[78:79], v[78:79], v[234:235] op_sel:[0,0] op_sel_hi:[1,0]
    s_add_u32 s38, s45, 36864
    v_cvt_pk_bf16_f32 v80, v72, v73
    v_cvt_pk_bf16_f32 v81, v74, v75
    v_cvt_pk_bf16_f32 v82, v76, v77
    v_cvt_pk_bf16_f32 v83, v78, v79
    buffer_store_dwordx4 v[80:83], v248, s[20:23], s38 offen sc1
    s_cmp_eq_u32 s75, 0
    s_cbranch_scc1 K_o
    s_mov_b32 s68, 1
    s_branch K_q0
K_fresh1:
    s_add_u32 m0, s50, 0
    s_nop 0
    buffer_load_dwordx4 v224, s[8:11], s29 offen lds
    s_add_u32 m0, s50, 896
    s_nop 0
    buffer_load_dwordx4 v224, s[8:11], s29 offen offset:128 lds
    s_add_u32 m0, s50, 1792
    s_nop 0
    buffer_load_dwordx4 v224, s[8:11], s29 offen offset:256 lds
    s_add_u32 s29, s29, 393216
    s_add_u32 s50, s50, 12288
    s_cmp_ge_u32 s50, 86016
    s_cselect_b32 s50, s41, s50
    s_add_u32 s38, s28, 81920
    s_add_u32 m0, s40, 0
    s_nop 0
    buffer_load_dwordx4 v223, s[4:7], s38 offen lds
    s_add_u32 s38, s28, 92160
    s_add_u32 m0, s40, 1024
    s_nop 0
    buffer_load_dwordx4 v223, s[4:7], s38 offen lds
    s_add_u32 s38, s28, 102400
    s_add_u32 m0, s40, 2048
    s_nop 0
    buffer_load_dwordx4 v223, s[4:7], s38 offen lds
    s_add_u32 s38, s28, 112640
    s_add_u32 m0, s40, 3072
    s_nop 0
    buffer_load_dwordx4 v223, s[4:7], s38 offen lds
    s_add_u32 s38, s28, 122880
    s_add_u32 m0, s40, 4096
    s_nop 0
    buffer_load_dwordx4 v223, s[4:7], s38 offen lds
    s_add_u32 s38, s28, 133120
    s_add_u32 m0, s40, 5120
    s_nop 0
    buffer_load_dwordx4 v223, s[4:7], s38 offen lds
    s_add_u32 s38, s28, 143360
    s_add_u32 m0, s40, 6144
    s_nop 0
    buffer_load_dwordx4 v223, s[4:7], s38 offen lds
    s_add_u32 s38, s28, 153600
    s_add_u32 m0, s40, 7168
    s_nop 0
    buffer_load_dwordx4 v223, s[4:7], s38 offen lds
    s_add_u32 s38, s28, 163840
    s_add_u32 m0, s40, 8192
    s_nop 0
    buffer_load_dwordx4 v223, s[4:7], s38 offen lds
    s_add_u32 s38, s28, 174080
    s_add_u32 m0, s40, 9216
    s_nop 0
    buffer_load_dwordx4 v223, s[4:7], s38 offen lds
    s_add_u32 s28, s28, 128
    s_cmp_ge_u32 s28, 1280
    s_cselect_b32 s28, 0, s28
    s_add_u32 s76, s66, 75497472
    s_addc_u32 s77, s67, 0
    s_mov_b32 s78, 131072
    s_lshr_b32 s36, s71, 1
    s_lshl_b32 s36, s36, 5
    s_add_u32 s36, s36, s2
    s_lshl_b32 s36, s36, 2
    s_add_u32 s36, s36, s24
    s_lshl_b32 s36, s36, 7
    v_mov_b32 v254, 0
    buffer_store_dword v254, v254, s[76:79], s36 offen sc1
    buffer_store_dword v0, v0, s[20:23], 0 offen
    buffer_store_dword v0, v0, s[20:23], 0 offen
    buffer_store_dword v0, v0, s[20:23], 0 offen
    buffer_store_dword v0, v0, s[20:23], 0 offen
    buffer_store_dword v0, v0, s[20:23], 0 offen
    buffer_store_dword v0, v0, s[20:23], 0 offen
    buffer_store_dword v0, v0, s[20:23], 0 offen
    buffer_store_dword v0, v0, s[20:23], 0 offen
    buffer_store_dword v0, v0, s[20:23], 0 offen
    buffer_store_dword v0, v0, s[20:23], 0 offen
    buffer_store_dword v0, v0, s[20:23], 0 offen
    buffer_store_dword v0, v0, s[20:23], 0 offen
    buffer_store_dword v0, v0, s[20:23], 0 offen
    buffer_store_dword v0, v0, s[20:23], 0 offen
    buffer_store_dword v0, v0, s[20:23], 0 offen
    buffer_store_dword v0, v0, s[20:23], 0 offen
    buffer_store_dword v0, v0, s[20:23], 0 offen
    buffer_store_dword v0, v0, s[20:23], 0 offen
    buffer_store_dword v0, v0, s[20:23], 0 offen
    buffer_store_dword v0, v0, s[20:23], 0 offen
    buffer_store_dword v0, v0, s[20:23], 0 offen
    buffer_store_dword v0, v0, s[20:23], 0 offen
    buffer_store_dword v0, v0, s[20:23], 0 offen
    buffer_store_dword v0, v0, s[20:23], 0 offen
K_q1:
    s_lshl_b32 s37, s68, 4
    s_add_u32 s37, s37, s69
    s_and_b32 s36, s100, 7
    s_lshl_b32 s36, s36, 1
    s_add_u32 s36, s36, s25
    s_lshl_b32 s36, s36, 5
    s_add_u32 s36, s36, s37
    s_mul_i32 s36, s36, 196608
    s_add_u32 s12, s54, s36
    s_addc_u32 s13, s55, 0
    s_mov_b32 s15, 0x00020000
    s_add_u32 s16, s56, s36
    s_addc_u32 s17, s57, 0
    s_mov_b32 s19, 0x00020000
    s_mov_b32 s14, 196608
    s_mov_b32 s18, s14
    s_mul_i32 s45, s25, 9216
    s_lshl_b32 s36, s26, 12
    s_add_u32 s44, s45, s36
    s_add_u32 s45, s45, 8192
    s_xor_b32 s75, s68, 1
    s_mul_i32 s30, s26, 6144
    s_mov_b32 s31, s30
    s_cmp_eq_u32 s25, 0
    s_cselect_b32 s38, 0, 151552
    s_mov_b32 s35, -12288
    s_cselect_b32 s35, 12288, s35
    s_lshl_b32 s37, s35, 1
    s_add_u32 s34, s38, s30
    s_add_u32 s32, s34, s37
    s_add_u32 s33, s32, s37
    s_lshl_b32 s47, s24, 13
    s_xor_b32 s48, s47, 0x2000
    s_mul_i32 s36, s25, 6144
    s_add_u32 s36, s36, 73728
    v_mbcnt_lo_u32_b32 v120, -1, 0
    v_mbcnt_hi_u32_b32 v120, -1, v120
    v_lshlrev_b32 v248, 4, v120
    v_add_u32 v229, s36, v248
    v_add_u32 v251, 49152, v248
    v_add_u32 v249, s47, v251
    v_add_u32 v250, s48, v251
    v_lshrrev_b32 v121, 3, v120
    v_and_b32 v122, 7, v120
    v_and_b32 v123, 6, v121
    v_xor_b32 v123, v122, v123
    v_lshlrev_b32 v123, 4, v123
    v_mul_u32_u24 v216, 384, v121
    v_add_u32 v216, v216, v123
    v_and_b32 v121, 15, v120
    v_lshrrev_b32 v122, 4, v120
    v_and_b32 v123, 7, v121
    v_and_b32 v124, 6, v121
    v_xor_b32 v124, v122, v124
    v_lshl_add_u32 v124, v123, 3, v124
    v_lshlrev_b32 v124, 4, v124
    v_xor_b32 v125, 64, v124
    v_lshrrev_b32 v126, 3, v121
    v_mul_u32_u24 v127, 3072, v126
    v_add_u32 v127, s38, v127
    v_add_u32 v217, v127, v124
    v_add_u32 v218, v127, v125
    v_lshlrev_b32 v127, 10, v126
    v_add_u32 v128, s40, v127
    v_add_u32 v225, v128, v124
    v_add_u32 v226, v128, v125
    v_bfe_u32 v123, v120, 2, 2
    v_and_b32 v124, 3, v120
    v_and_b32 v125, 1, v122
    v_lshl_add_u32 v126, v125, 2, v123
    v_and_b32 v127, 6, v126
    v_lshrrev_b32 v128, 1, v124
    v_xor_b32 v127, v127, v128
    v_lshl_add_u32 v127, v126, 3, v127
    v_lshlrev_b32 v127, 4, v127
    v_and_b32 v128, 1, v124
    v_lshl_add_u32 v127, v128, 3, v127
    v_lshrrev_b32 v128, 1, v122
    v_mul_u32_u24 v128, 3072, v128
    s_add_u32 s36, s38, s35
    v_add_u32 v128, s36, v128
    v_xor_b32 v129, 0, v127
    v_add_u32 v219, v128, v129
    v_xor_b32 v129, 32, v127
    v_add_u32 v220, v128, v129
    v_xor_b32 v129, 64, v127
    v_add_u32 v221, v128, v129
    v_xor_b32 v129, 96, v127
    v_add_u32 v222, v128, v129
    v_lshlrev_b32 v127, 2, v125
    v_xor_b32 v127, v127, v124
    v_lshl_add_u32 v127, v123, 3, v127
    v_lshlrev_b32 v127, 4, v127
    v_mul_u32_u24 v128, 3072, v122
    v_add_u32 v128, 36864, v128
    v_add_u32 v227, v128, v127
    v_xor_b32 v127, 64, v127
    v_add_u32 v228, v128, v127
    s_mov_b32 s51, 0
    s_mov_b32 s46, -36864
    s_mov_b32 s42, 0x3dd53b95
    s_mul_i32 s36, s100, 0
    s_mul_i32 s37, s69, 0
    s_add_u32 s36, s36, s37
    s_mul_i32 s37, s25, 0
    s_add_u32 s36, s36, s37
    s_and_b32 s37, s36, 15
    s_mul_i32 s37, s37, 12288
    s_add_u32 s48, s30, s37
    s_add_u32 s36, s36, s68
    s_and_b32 s37, s36, 15
    s_mul_i32 s37, s37, 12288
    s_add_u32 s31, s31, s37
    s_add_u32 s36, s36, s68
    s_and_b32 s37, s36, 15
    s_mul_i32 s37, s37, 12288
    s_add_u32 s30, s30, s37
    s_mov_b32 s76, s60
    s_mov_b32 s77, s61
    s_mul_i32 s78, s68, 7864320
    v_min_u32 v253, 9, v120
    v_lshlrev_b32 v253, 7, v253
    v_mov_b32 v235, 0xff7fffff
    v_mov_b32 v236, 0xff7fffff
    v_mov_b32 v237, 0xff7fffff
    v_mov_b32 v238, 0xff7fffff
    v_mov_b32 v239, 0xff7fffff
    s_mov_b32 s72, 0x4e800000
    s_add_u32 m0, s50, 0
    s_barrier
    buffer_load_dwordx4 v224, s[8:11], s29 offen lds
    s_add_u32 m0, s50, 896
    s_waitcnt vmcnt(26)
    buffer_load_dwordx4 v224, s[8:11], s29 offen offset:128 lds
    s_barrier
    ds_read_b128 a[0:3], v225 offset:0
    ds_read_b64_tr_b16 a[240:241], v227 offset:0
    ds_read_b64_tr_b16 a[242:243], v227 offset:512
    ds_read_b128 a[20:23], v226 offset:0
    s_add_u32 m0, s50, 1792
    s_add_u32 s50, s50, 12288
    buffer_load_dwordx4 v224, s[8:11], s29 offen offset:256 lds
    ds_read_b128 a[4:7], v225 offset:2048
    s_cmp_ge_u32 s50, 86016
    s_cselect_b32 s50, s41, s50
    ds_read_b128 a[8:11], v225 offset:4096
    s_add_u32 s29, s29, 393216
    s_add_u32 m0, s50, 0
    s_cmp_ge_u32 s29, 7864320
    s_cselect_b32 s29, s49, s29
    buffer_load_dwordx4 v224, s[8:11], s29 offen lds
    ds_read_b128 a[12:15], v225 offset:6144
    ds_read_b64_tr_b16 a[244:245], v227 offset:8
    ds_read_b64_tr_b16 a[246:247], v227 offset:520
    ds_read_b128 a[24:27], v226 offset:2048
    s_add_u32 m0, s50, 896
    ds_read_b128 a[28:31], v226 offset:4096
    buffer_load_dwordx4 v224, s[8:11], s29 offen offset:128 lds
    ds_read_b64_tr_b16 a[248:249], v228 offset:0
    ds_read_b64_tr_b16 a[250:251], v228 offset:512
    s_add_u32 m0, s50, 1792
    ds_read_b128 a[32:35], v226 offset:6144
    buffer_load_dwordx4 v224, s[8:11], s29 offen offset:256 lds
    s_add_u32 m0, s40, 0
    s_add_u32 s38, s28, 81920
    ds_read_b64_tr_b16 a[252:253], v228 offset:8
    ds_read_b64_tr_b16 a[254:255], v228 offset:520
    ds_read_b128 a[16:19], v225 offset:8192
    ds_read_b128 a[36:39], v226 offset:8192
    s_waitcnt lgkmcnt(15)
    v_mfma_f32_16x16x32_bf16 v[0:3], a[240:243], a[0:3], 0
    s_waitcnt lgkmcnt(13)
    buffer_load_dwordx4 v223, s[4:7], s38 offen lds
    s_add_u32 m0, s40, 1024
    s_add_u32 s38, s28, 92160
    v_mfma_f32_16x16x32_bf16 v[48:51], a[240:243], a[4:7], 0
    s_waitcnt lgkmcnt(12)
    buffer_load_dwordx4 v223, s[4:7], s38 offen lds
    v_mfma_f32_16x16x32_bf16 v[96:99], a[240:243], a[8:11], 0
    s_waitcnt lgkmcnt(11)
    s_add_u32 m0, s40, 2048
    s_add_u32 s38, s28, 102400
    ds_read_b64_tr_b16 v[240:241], v227 offset:1024
    ds_read_b64_tr_b16 v[242:243], v227 offset:1536
    v_mfma_f32_16x16x32_bf16 v[144:147], a[240:243], a[12:15], 0
    s_waitcnt lgkmcnt(11)
    ds_read_b64_tr_b16 v[244:245], v227 offset:1032
    ds_read_b64_tr_b16 v[246:247], v227 offset:1544
    v_mfma_f32_16x16x32_bf16 v[4:7], a[244:247], a[0:3], 0
    s_add_u32 s50, s50, 12288
    s_waitcnt lgkmcnt(12)
    buffer_load_dwordx4 v223, s[4:7], s38 offen lds
    v_mfma_f32_16x16x32_bf16 v[52:55], a[244:247], a[4:7], 0
    s_add_u32 m0, s40, 3072
    s_add_u32 s38, s28, 112640
    buffer_load_dwordx4 v223, s[4:7], s38 offen lds
    v_mfma_f32_16x16x32_bf16 v[100:103], a[244:247], a[8:11], 0
    s_add_u32 m0, s40, 4096
    s_add_u32 s38, s28, 122880
    ds_read_b64_tr_b16 a[240:241], v228 offset:1024
    v_mfma_f32_16x16x32_bf16 v[148:151], a[244:247], a[12:15], 0
    s_waitcnt lgkmcnt(10)
    buffer_load_dwordx4 v223, s[4:7], s38 offen lds
    v_mfma_f32_16x16x32_bf16 v[8:11], a[248:251], a[0:3], 0
    s_add_u32 m0, s40, 5120
    s_add_u32 s38, s28, 133120
    buffer_load_dwordx4 v223, s[4:7], s38 offen lds
    v_mfma_f32_16x16x32_bf16 v[56:59], a[248:251], a[4:7], 0
    s_add_u32 m0, s40, 6144
    s_add_u32 s38, s28, 143360
    ds_read_b64_tr_b16 a[242:243], v228 offset:1536
    v_mfma_f32_16x16x32_bf16 v[104:107], a[248:251], a[8:11], 0
    s_add_u32 s29, s29, 393216
    s_waitcnt lgkmcnt(10)
    buffer_load_dwordx4 v223, s[4:7], s38 offen lds
    v_mfma_f32_16x16x32_bf16 v[152:155], a[248:251], a[12:15], 0
    s_waitcnt lgkmcnt(8)
    s_add_u32 m0, s40, 7168
    s_add_u32 s38, s28, 153600
    buffer_load_dwordx4 v223, s[4:7], s38 offen lds
    v_mfma_f32_16x16x32_bf16 v[12:15], a[252:255], a[0:3], 0
    s_add_u32 m0, s40, 8192
    s_add_u32 s38, s28, 163840
    ds_read_b64_tr_b16 a[244:245], v228 offset:1032
    v_mfma_f32_16x16x32_bf16 v[60:63], a[252:255], a[4:7], 0
    s_add_u32 s51, s51, 1
    s_waitcnt lgkmcnt(7)
    buffer_load_dwordx4 v223, s[4:7], s38 offen lds
    v_mfma_f32_16x16x32_bf16 v[108:111], a[252:255], a[8:11], 0
    s_add_u32 m0, s40, 9216
    s_add_u32 s38, s28, 174080
    buffer_load_dwordx4 v223, s[4:7], s38 offen lds
    v_mfma_f32_16x16x32_bf16 v[156:159], a[252:255], a[12:15], 0
    s_waitcnt lgkmcnt(5)
    ds_read_b64_tr_b16 a[246:247], v228 offset:1544
    ds_read_b64_tr_b16 a[248:249], v227 offset:2048
    v_mfma_f32_16x16x32_bf16 v[16:19], v[240:243], a[0:3], 0
    s_add_u32 s28, s28, 128
    ds_read_b64_tr_b16 a[250:251], v227 offset:2560
    ds_read_b64_tr_b16 a[252:253], v227 offset:2056
    v_mfma_f32_16x16x32_bf16 v[64:67], v[240:243], a[4:7], 0
    s_add_u32 s74, s3, 0
    ds_read_b64_tr_b16 a[254:255], v227 offset:2568
    v_mfma_f32_16x16x32_bf16 v[112:115], v[240:243], a[8:11], 0
    s_cmp_ge_u32 s50, 86016
    s_cselect_b32 s50, s41, s50
    v_mfma_f32_16x16x32_bf16 v[160:163], v[240:243], a[12:15], 0
    s_waitcnt lgkmcnt(8)
    s_add_u32 m0, s50, 0
    ds_read_b64_tr_b16 v[240:241], v228 offset:2048
    v_mfma_f32_16x16x32_bf16 v[20:23], v[244:247], a[0:3], 0
    ds_read_b64_tr_b16 v[242:243], v228 offset:2560
    v_mfma_f32_16x16x32_bf16 v[68:71], v[244:247], a[4:7], 0
    s_cmp_eq_u32 s51, 4
    s_cselect_b32 s27, s46, 12288
    v_mfma_f32_16x16x32_bf16 v[116:119], v[244:247], a[8:11], 0
    v_add_u32 v227, s27, v227
    v_mfma_f32_16x16x32_bf16 v[164:167], v[244:247], a[12:15], 0
    s_waitcnt lgkmcnt(8)
    ds_read_b64_tr_b16 v[244:245], v228 offset:2056
    ds_read_b64_tr_b16 v[246:247], v228 offset:2568
    v_mfma_f32_16x16x32_bf16 v[24:27], a[240:243], a[0:3], 0
    s_waitcnt vmcnt(13)
    s_barrier
    v_add_u32 v228, s27, v228
    v_mfma_f32_16x16x32_bf16 v[72:75], a[240:243], a[4:7], 0
    buffer_load_dwordx4 v224, s[8:11], s29 offen lds
    v_mfma_f32_16x16x32_bf16 v[120:123], a[240:243], a[8:11], 0
    s_add_u32 m0, s50, 896
    s_cmp_ge_u32 s28, 1280
    s_cselect_b32 s28, 0, s28
    v_mfma_f32_16x16x32_bf16 v[168:171], a[240:243], a[12:15], 0
    s_add_u32 s38, s28, 81920
    buffer_load_dwordx4 v224, s[8:11], s29 offen offset:128 lds
    v_mfma_f32_16x16x32_bf16 v[192:195], a[240:243], a[16:19], 0
    s_waitcnt lgkmcnt(8)
    s_add_u32 m0, s50, 1792
    ds_read_b64_tr_b16 a[240:241], v227 offset:0
    v_mfma_f32_16x16x32_bf16 v[28:31], a[244:247], a[0:3], 0
    s_add_u32 s50, s50, 12288
    buffer_load_dwordx4 v224, s[8:11], s29 offen offset:256 lds
    v_mfma_f32_16x16x32_bf16 v[76:79], a[244:247], a[4:7], 0
    s_add_u32 s29, s29, 393216
    ds_read_b64_tr_b16 a[242:243], v227 offset:512
    v_mfma_f32_16x16x32_bf16 v[124:127], a[244:247], a[8:11], 0
    s_cmp_ge_u32 s50, 86016
    s_cselect_b32 s50, s41, s50
    v_mfma_f32_16x16x32_bf16 v[172:175], a[244:247], a[12:15], 0
    s_add_u32 m0, s50, 0
    s_cmp_ge_u32 s29, 7864320
    s_cselect_b32 s29, s49, s29
    v_mfma_f32_16x16x32_bf16 v[196:199], a[244:247], a[16:19], 0
    s_waitcnt lgkmcnt(8)
    ds_read_b64_tr_b16 a[244:245], v227 offset:8
    ds_read_b64_tr_b16 a[246:247], v227 offset:520
    v_mfma_f32_16x16x32_bf16 v[32:35], a[248:251], a[0:3], 0
    s_cmp_eq_u32 s51, 4
    s_cselect_b32 s51, 0, s51
    v_mfma_f32_16x16x32_bf16 v[80:83], a[248:251], a[4:7], 0
    s_add_u32 s51, s51, 1
    s_cmp_eq_u32 s51, 4
    s_cselect_b32 s27, s46, 12288
    v_mfma_f32_16x16x32_bf16 v[128:131], a[248:251], a[8:11], 0
    s_cmp_eq_u32 s51, 4
    s_cselect_b32 s51, 0, s51
    v_mfma_f32_16x16x32_bf16 v[176:179], a[248:251], a[12:15], 0
    s_add_u32 s51, s51, 1
    v_mfma_f32_16x16x32_bf16 v[200:203], a[248:251], a[16:19], 0
    s_waitcnt lgkmcnt(8)
    ds_read_b64_tr_b16 a[248:249], v228 offset:0
    ds_read_b64_tr_b16 a[250:251], v228 offset:512
    v_mfma_f32_16x16x32_bf16 v[36:39], a[252:255], a[0:3], 0
    v_mfma_f32_16x16x32_bf16 v[84:87], a[252:255], a[4:7], 0
    v_mfma_f32_16x16x32_bf16 v[132:135], a[252:255], a[8:11], 0
    v_mfma_f32_16x16x32_bf16 v[180:183], a[252:255], a[12:15], 0
    v_mfma_f32_16x16x32_bf16 v[204:207], a[252:255], a[16:19], 0
    s_waitcnt lgkmcnt(8)
    ds_read_b64_tr_b16 a[252:253], v228 offset:8
    ds_read_b64_tr_b16 a[254:255], v228 offset:520
    v_mfma_f32_16x16x32_bf16 v[40:43], v[240:243], a[0:3], 0
    v_mfma_f32_16x16x32_bf16 v[88:91], v[240:243], a[4:7], 0
    v_mfma_f32_16x16x32_bf16 v[136:139], v[240:243], a[8:11], 0
    v_mfma_f32_16x16x32_bf16 v[184:187], v[240:243], a[12:15], 0
    v_mfma_f32_16x16x32_bf16 v[208:211], v[240:243], a[16:19], 0
    s_waitcnt lgkmcnt(8)
    ds_read_b64_tr_b16 v[240:241], v227 offset:1024
    ds_read_b64_tr_b16 v[242:243], v227 offset:1536
    v_mfma_f32_16x16x32_bf16 v[44:47], v[244:247], a[0:3], 0
    v_mfma_f32_16x16x32_bf16 v[92:95], v[244:247], a[4:7], 0
    v_mfma_f32_16x16x32_bf16 v[140:143], v[244:247], a[8:11], 0
    v_mfma_f32_16x16x32_bf16 v[188:191], v[244:247], a[12:15], 0
    v_mfma_f32_16x16x32_bf16 v[212:215], v[244:247], a[16:19], 0
    s_waitcnt lgkmcnt(8)
    ds_read_b64_tr_b16 v[244:245], v227 offset:1032
    ds_read_b64_tr_b16 v[246:247], v227 offset:1544
    v_mfma_f32_16x16x32_bf16 v[0:3], a[240:243], a[20:23], v[0:3]
    v_mfma_f32_16x16x32_bf16 v[48:51], a[240:243], a[24:27], v[48:51]
    v_mfma_f32_16x16x32_bf16 v[96:99], a[240:243], a[28:31], v[96:99]
    s_waitcnt vmcnt(11)
    ds_read_b128 a[40:43], v225 offset:0
    ds_read_b128 a[60:63], v226 offset:0
    v_mfma_f32_16x16x32_bf16 v[144:147], a[240:243], a[32:35], v[144:147]
    s_waitcnt lgkmcnt(10)
    ds_read_b64_tr_b16 a[240:241], v228 offset:1024
    ds_read_b64_tr_b16 a[242:243], v228 offset:1536
    v_mfma_f32_16x16x32_bf16 v[4:7], a[244:247], a[20:23], v[4:7]
    v_mfma_f32_16x16x32_bf16 v[52:55], a[244:247], a[24:27], v[52:55]
    s_waitcnt vmcnt(11)
    s_barrier
    v_mfma_f32_16x16x32_bf16 v[100:103], a[244:247], a[28:31], v[100:103]
    buffer_load_dwordx4 v224, s[8:11], s29 offen lds
    v_mfma_f32_16x16x32_bf16 v[148:151], a[244:247], a[32:35], v[148:151]
    s_waitcnt lgkmcnt(10)
    s_add_u32 m0, s50, 896
    ds_read_b64_tr_b16 a[244:245], v228 offset:1032
    v_mfma_f32_16x16x32_bf16 v[8:11], a[248:251], a[20:23], v[8:11]
    buffer_load_dwordx4 v224, s[8:11], s29 offen offset:128 lds
    v_mfma_f32_16x16x32_bf16 v[56:59], a[248:251], a[24:27], v[56:59]
    s_add_u32 m0, s50, 1792
    ds_read_b64_tr_b16 a[246:247], v228 offset:1544
    s_add_u32 s50, s50, 12288
    v_mfma_f32_16x16x32_bf16 v[104:107], a[248:251], a[28:31], v[104:107]
    s_waitcnt vmcnt(11)
    buffer_load_dwordx4 v224, s[8:11], s29 offen offset:256 lds
    v_mfma_f32_16x16x32_bf16 v[152:155], a[248:251], a[32:35], v[152:155]
    s_waitcnt lgkmcnt(10)
    ds_read_b128 a[44:47], v225 offset:2048
    ds_read_b128 a[64:67], v226 offset:2048
    v_mfma_f32_16x16x32_bf16 v[12:15], a[252:255], a[20:23], v[12:15]
    s_add_u32 m0, s40, 0
    ds_read_b64_tr_b16 a[248:249], v227 offset:2048
    ds_read_b64_tr_b16 a[250:251], v227 offset:2560
    v_mfma_f32_16x16x32_bf16 v[60:63], a[252:255], a[24:27], v[60:63]
    s_add_u32 s29, s29, 393216
    s_waitcnt lgkmcnt(8)
    buffer_load_dwordx4 v223, s[4:7], s38 offen lds
    v_mfma_f32_16x16x32_bf16 v[108:111], a[252:255], a[28:31], v[108:111]
    s_add_u32 m0, s40, 1024
    s_add_u32 s38, s28, 92160
    v_mfma_f32_16x16x32_bf16 v[156:159], a[252:255], a[32:35], v[156:159]
    buffer_load_dwordx4 v223, s[4:7], s38 offen lds
    v_mfma_f32_16x16x32_bf16 v[16:19], v[240:243], a[20:23], v[16:19]
    s_add_u32 m0, s40, 2048
    s_add_u32 s38, s28, 102400
    ds_read_b64_tr_b16 a[252:253], v227 offset:2056
    v_mfma_f32_16x16x32_bf16 v[64:67], v[240:243], a[24:27], v[64:67]
    ds_read_b64_tr_b16 a[254:255], v227 offset:2568
    v_add_u32 v227, s27, v227
    v_mfma_f32_16x16x32_bf16 v[112:115], v[240:243], a[28:31], v[112:115]
    s_waitcnt vmcnt(12)
    ds_read_b128 a[48:51], v225 offset:4096
    ds_read_b128 a[68:71], v226 offset:4096
    v_mfma_f32_16x16x32_bf16 v[160:163], v[240:243], a[32:35], v[160:163]
    ds_read_b64_tr_b16 v[240:241], v228 offset:2048
    ds_read_b64_tr_b16 v[242:243], v228 offset:2560
    v_mfma_f32_16x16x32_bf16 v[20:23], v[244:247], a[20:23], v[20:23]
    s_cmp_ge_u32 s50, 86016
    s_cselect_b32 s50, s41, s50
    v_mfma_f32_16x16x32_bf16 v[68:71], v[244:247], a[24:27], v[68:71]
    s_waitcnt lgkmcnt(8)
    buffer_load_dwordx4 v223, s[4:7], s38 offen lds
    v_mfma_f32_16x16x32_bf16 v[116:119], v[244:247], a[28:31], v[116:119]
    s_add_u32 m0, s40, 3072
    s_add_u32 s38, s28, 112640
    v_mfma_f32_16x16x32_bf16 v[164:167], v[244:247], a[32:35], v[164:167]
    buffer_load_dwordx4 v223, s[4:7], s38 offen lds
    v_mfma_f32_16x16x32_bf16 v[24:27], a[240:243], a[20:23], v[24:27]
    s_add_u32 m0, s40, 4096
    s_add_u32 s38, s28, 122880
    ds_read_b64_tr_b16 v[244:245], v228 offset:2056
    v_mfma_f32_16x16x32_bf16 v[72:75], a[240:243], a[24:27], v[72:75]
    ds_read_b64_tr_b16 v[246:247], v228 offset:2568
    v_add_u32 v228, s27, v228
    v_mfma_f32_16x16x32_bf16 v[120:123], a[240:243], a[28:31], v[120:123]
    s_waitcnt vmcnt(12)
    ds_read_b128 a[52:55], v225 offset:6144
    ds_read_b128 a[72:75], v226 offset:6144
    v_mfma_f32_16x16x32_bf16 v[168:171], a[240:243], a[32:35], v[168:171]
    s_cmp_eq_u32 s51, 4
    s_cselect_b32 s27, s46, 12288
    v_mfma_f32_16x16x32_bf16 v[192:195], a[240:243], a[36:39], v[192:195]
    s_waitcnt lgkmcnt(6)
    buffer_load_dwordx4 v223, s[4:7], s38 offen lds
    v_mfma_f32_16x16x32_bf16 v[28:31], a[244:247], a[20:23], v[28:31]
    s_add_u32 m0, s40, 5120
    s_add_u32 s38, s28, 133120
    ds_read_b64_tr_b16 a[240:241], v227 offset:0
    v_mfma_f32_16x16x32_bf16 v[76:79], a[244:247], a[24:27], v[76:79]
    buffer_load_dwordx4 v223, s[4:7], s38 offen lds
    v_mfma_f32_16x16x32_bf16 v[124:127], a[244:247], a[28:31], v[124:127]
    s_add_u32 m0, s40, 6144
    s_add_u32 s38, s28, 143360
    ds_read_b64_tr_b16 a[242:243], v227 offset:512
    v_mfma_f32_16x16x32_bf16 v[172:175], a[244:247], a[32:35], v[172:175]
    s_cmp_eq_u32 s51, 4
    s_cselect_b32 s51, 0, s51
    v_mfma_f32_16x16x32_bf16 v[196:199], a[244:247], a[36:39], v[196:199]
    ds_read_b64_tr_b16 a[244:245], v227 offset:8
    ds_read_b64_tr_b16 a[246:247], v227 offset:520
    v_mfma_f32_16x16x32_bf16 v[32:35], a[248:251], a[20:23], v[32:35]
    s_waitcnt vmcnt(12)
    ds_read_b128 a[56:59], v225 offset:8192
    ds_read_b128 a[76:79], v226 offset:8192
    v_mfma_f32_16x16x32_bf16 v[80:83], a[248:251], a[24:27], v[80:83]
    s_add_u32 s51, s51, 1
    v_mfma_f32_16x16x32_bf16 v[128:131], a[248:251], a[28:31], v[128:131]
    s_waitcnt lgkmcnt(6)
    buffer_load_dwordx4 v223, s[4:7], s38 offen lds
    v_mfma_f32_16x16x32_bf16 v[176:179], a[248:251], a[32:35], v[176:179]
    s_add_u32 m0, s40, 7168
    s_add_u32 s38, s28, 153600
    v_mfma_f32_16x16x32_bf16 v[200:203], a[248:251], a[36:39], v[200:203]
    buffer_load_dwordx4 v223, s[4:7], s38 offen lds
    v_mfma_f32_16x16x32_bf16 v[36:39], a[252:255], a[20:23], v[36:39]
    s_add_u32 m0, s40, 8192
    s_add_u32 s38, s28, 163840
    ds_read_b64_tr_b16 a[248:249], v228 offset:0
    v_mfma_f32_16x16x32_bf16 v[84:87], a[252:255], a[24:27], v[84:87]
    ds_read_b64_tr_b16 a[250:251], v228 offset:512
    v_mfma_f32_16x16x32_bf16 v[132:135], a[252:255], a[28:31], v[132:135]
    v_mfma_f32_16x16x32_bf16 v[180:183], a[252:255], a[32:35], v[180:183]
    v_mfma_f32_16x16x32_bf16 v[204:207], a[252:255], a[36:39], v[204:207]
    ds_read_b64_tr_b16 a[252:253], v228 offset:8
    ds_read_b64_tr_b16 a[254:255], v228 offset:520
    v_mfma_f32_16x16x32_bf16 v[40:43], v[240:243], a[20:23], v[40:43]
    s_waitcnt lgkmcnt(4)
    buffer_load_dwordx4 v223, s[4:7], s38 offen lds
    v_mfma_f32_16x16x32_bf16 v[88:91], v[240:243], a[24:27], v[88:91]
    s_add_u32 m0, s40, 9216
    s_add_u32 s38, s28, 174080
    s_add_u32 s28, s28, 128
    v_mfma_f32_16x16x32_bf16 v[136:139], v[240:243], a[28:31], v[136:139]
    buffer_load_dwordx4 v223, s[4:7], s38 offen lds
    v_mfma_f32_16x16x32_bf16 v[184:187], v[240:243], a[32:35], v[184:187]
    s_add_u32 m0, s50, 0
    s_cmp_ge_u32 s28, 1280
    s_cselect_b32 s28, 0, s28
    v_mfma_f32_16x16x32_bf16 v[208:211], v[240:243], a[36:39], v[208:211]
    ds_read_b64_tr_b16 v[240:241], v227 offset:1024
    ds_read_b64_tr_b16 v[242:243], v227 offset:1536
    v_mfma_f32_16x16x32_bf16 v[44:47], v[244:247], a[20:23], v[44:47]
    s_add_u32 s38, s28, 81920
    v_mfma_f32_16x16x32_bf16 v[92:95], v[244:247], a[24:27], v[92:95]
    v_mfma_f32_16x16x32_bf16 v[140:143], v[244:247], a[28:31], v[140:143]
    v_mfma_f32_16x16x32_bf16 v[188:191], v[244:247], a[32:35], v[188:191]
    v_mfma_f32_16x16x32_bf16 v[212:215], v[244:247], a[36:39], v[212:215]
    ds_read_b64_tr_b16 v[244:245], v227 offset:1032
    ds_read_b64_tr_b16 v[246:247], v227 offset:1544
    v_mfma_f32_16x16x32_bf16 v[0:3], a[240:243], a[40:43], v[0:3]
    v_mfma_f32_16x16x32_bf16 v[48:51], a[240:243], a[44:47], v[48:51]
    v_mfma_f32_16x16x32_bf16 v[96:99], a[240:243], a[48:51], v[96:99]
    v_mfma_f32_16x16x32_bf16 v[144:147], a[240:243], a[52:55], v[144:147]
    ds_read_b64_tr_b16 a[240:241], v228 offset:1024
    ds_read_b64_tr_b16 a[242:243], v228 offset:1536
    v_mfma_f32_16x16x32_bf16 v[4:7], a[244:247], a[40:43], v[4:7]
    v_mfma_f32_16x16x32_bf16 v[52:55], a[244:247], a[44:47], v[52:55]
    s_waitcnt vmcnt(13)
    s_barrier
    v_mfma_f32_16x16x32_bf16 v[100:103], a[244:247], a[48:51], v[100:103]
    buffer_load_dwordx4 v224, s[8:11], s29 offen lds
    v_mfma_f32_16x16x32_bf16 v[148:151], a[244:247], a[52:55], v[148:151]
    s_waitcnt lgkmcnt(8)
    s_add_u32 m0, s50, 896
    ds_read_b64_tr_b16 a[244:245], v228 offset:1032
    v_mfma_f32_16x16x32_bf16 v[8:11], a[248:251], a[40:43], v[8:11]
    buffer_load_dwordx4 v224, s[8:11], s29 offen offset:128 lds
    v_mfma_f32_16x16x32_bf16 v[56:59], a[248:251], a[44:47], v[56:59]
    s_add_u32 m0, s50, 1792
    ds_read_b64_tr_b16 a[246:247], v228 offset:1544
    s_add_u32 s50, s50, 12288
    v_mfma_f32_16x16x32_bf16 v[104:107], a[248:251], a[48:51], v[104:107]
    buffer_load_dwordx4 v224, s[8:11], s29 offen offset:256 lds
    v_mfma_f32_16x16x32_bf16 v[152:155], a[248:251], a[52:55], v[152:155]
    s_waitcnt lgkmcnt(8)
    s_add_u32 m0, s40, 0
    ds_read_b64_tr_b16 a[248:249], v227 offset:2048
    v_mfma_f32_16x16x32_bf16 v[12:15], a[252:255], a[40:43], v[12:15]
    s_waitcnt vmcnt(11)
    ds_read_b128 a[0:3], v225 offset:0
    ds_read_b128 a[20:23], v226 offset:0
    v_mfma_f32_16x16x32_bf16 v[60:63], a[252:255], a[44:47], v[60:63]
    s_add_u32 s29, s29, 393216
    ds_read_b64_tr_b16 a[250:251], v227 offset:2560
    v_mfma_f32_16x16x32_bf16 v[108:111], a[252:255], a[48:51], v[108:111]
    s_cmp_ge_u32 s50, 86016
    s_cselect_b32 s50, s41, s50
    v_mfma_f32_16x16x32_bf16 v[156:159], a[252:255], a[52:55], v[156:159]
    s_waitcnt lgkmcnt(10)
    ds_read_b64_tr_b16 a[252:253], v227 offset:2056
    ds_read_b64_tr_b16 a[254:255], v227 offset:2568
    v_mfma_f32_16x16x32_bf16 v[16:19], v[240:243], a[40:43], v[16:19]
    v_add_u32 v227, s27, v227
    v_mfma_f32_16x16x32_bf16 v[64:67], v[240:243], a[44:47], v[64:67]
    s_cmp_ge_u32 s29, 7864320
    s_cselect_b32 s29, s49, s29
    v_mfma_f32_16x16x32_bf16 v[112:115], v[240:243], a[48:51], v[112:115]
    v_mfma_f32_16x16x32_bf16 v[160:163], v[240:243], a[52:55], v[160:163]
    s_waitcnt lgkmcnt(10)
    ds_read_b64_tr_b16 v[240:241], v228 offset:2048
    ds_read_b64_tr_b16 v[242:243], v228 offset:2560
    v_mfma_f32_16x16x32_bf16 v[20:23], v[244:247], a[40:43], v[20:23]
    v_mfma_f32_16x16x32_bf16 v[68:71], v[244:247], a[44:47], v[68:71]
    v_mfma_f32_16x16x32_bf16 v[116:119], v[244:247], a[48:51], v[116:119]
    s_waitcnt lgkmcnt(5)
    buffer_load_dwordx4 v223, s[4:7], s38 offen lds
    v_mfma_f32_16x16x32_bf16 v[164:167], v[244:247], a[52:55], v[164:167]
    s_add_u32 m0, s40, 1024
    s_add_u32 s38, s28, 92160
    v_mfma_f32_16x16x32_bf16 v[24:27], a[240:243], a[40:43], v[24:27]
    buffer_load_dwordx4 v223, s[4:7], s38 offen lds
    v_mfma_f32_16x16x32_bf16 v[72:75], a[240:243], a[44:47], v[72:75]
    s_add_u32 m0, s40, 2048
    buffer_load_dword v255, v253, s[76:79], s74 offen
    v_mfma_f32_16x16x32_bf16 v[120:123], a[240:243], a[48:51], v[120:123]
    s_add_u32 s38, s28, 102400
    ds_read_b64_tr_b16 v[244:245], v228 offset:2056
    ds_read_b64_tr_b16 v[246:247], v228 offset:2568
    v_mfma_f32_16x16x32_bf16 v[168:171], a[240:243], a[52:55], v[168:171]
    s_mov_b32 s76, s64
    v_add_u32 v228, s27, v228
    s_mov_b32 s77, s65
    v_mfma_f32_16x16x32_bf16 v[192:195], a[240:243], a[56:59], v[192:195]
    ds_read_b64_tr_b16 a[240:241], v227 offset:0
    ds_read_b64_tr_b16 a[242:243], v227 offset:512
    v_mfma_f32_16x16x32_bf16 v[28:31], a[244:247], a[40:43], v[28:31]
    s_mov_b32 s78, 256
    s_cmp_eq_u32 s51, 4
    s_cselect_b32 s27, s46, 12288
    v_mfma_f32_16x16x32_bf16 v[76:79], a[244:247], a[44:47], v[76:79]
    s_waitcnt vmcnt(12)
    ds_read_b128 a[4:7], v225 offset:2048
    ds_read_b128 a[24:27], v226 offset:2048
    v_mfma_f32_16x16x32_bf16 v[124:127], a[244:247], a[48:51], v[124:127]
    s_cmp_eq_u32 s51, 4
    s_cselect_b32 s51, 0, s51
    v_mfma_f32_16x16x32_bf16 v[172:175], a[244:247], a[52:55], v[172:175]
    v_mfma_f32_16x16x32_bf16 v[196:199], a[244:247], a[56:59], v[196:199]
    s_waitcnt lgkmcnt(10)
    ds_read_b64_tr_b16 a[244:245], v227 offset:8
    ds_read_b64_tr_b16 a[246:247], v227 offset:520
    v_mfma_f32_16x16x32_bf16 v[32:35], a[248:251], a[40:43], v[32:35]
    v_mfma_f32_16x16x32_bf16 v[80:83], a[248:251], a[44:47], v[80:83]
    v_mfma_f32_16x16x32_bf16 v[128:131], a[248:251], a[48:51], v[128:131]
    v_mfma_f32_16x16x32_bf16 v[176:179], a[248:251], a[52:55], v[176:179]
    v_mfma_f32_16x16x32_bf16 v[200:203], a[248:251], a[56:59], v[200:203]
    s_waitcnt lgkmcnt(10)
    ds_read_b64_tr_b16 a[248:249], v228 offset:0
    ds_read_b64_tr_b16 a[250:251], v228 offset:512
    v_mfma_f32_16x16x32_bf16 v[36:39], a[252:255], a[40:43], v[36:39]
    v_mfma_f32_16x16x32_bf16 v[84:87], a[252:255], a[44:47], v[84:87]
    s_waitcnt lgkmcnt(4)
    buffer_load_dwordx4 v223, s[4:7], s38 offen lds
    v_mfma_f32_16x16x32_bf16 v[132:135], a[252:255], a[48:51], v[132:135]
    s_add_u32 m0, s40, 3072
    s_add_u32 s38, s28, 112640
    v_mfma_f32_16x16x32_bf16 v[180:183], a[252:255], a[52:55], v[180:183]
    buffer_load_dwordx4 v223, s[4:7], s38 offen lds
    v_mfma_f32_16x16x32_bf16 v[204:207], a[252:255], a[56:59], v[204:207]
    ds_read_b64_tr_b16 a[252:253], v228 offset:8
    ds_read_b64_tr_b16 a[254:255], v228 offset:520
    v_mfma_f32_16x16x32_bf16 v[40:43], v[240:243], a[40:43], v[40:43]
    s_add_u32 m0, s40, 4096
    s_add_u32 s38, s28, 122880
    v_mfma_f32_16x16x32_bf16 v[88:91], v[240:243], a[44:47], v[88:91]
    v_mfma_f32_16x16x32_bf16 v[136:139], v[240:243], a[48:51], v[136:139]
    v_mfma_f32_16x16x32_bf16 v[184:187], v[240:243], a[52:55], v[184:187]
    v_mfma_f32_16x16x32_bf16 v[208:211], v[240:243], a[56:59], v[208:211]
    s_waitcnt vmcnt(12)
    ds_read_b128 a[8:11], v225 offset:4096
    v_mfma_f32_16x16x32_bf16 v[44:47], v[244:247], a[40:43], v[44:47]
    ds_read_b128 a[28:31], v226 offset:4096
    ds_read_b64_tr_b16 v[240:241], v227 offset:1024
    v_mfma_f32_16x16x32_bf16 v[92:95], v[244:247], a[44:47], v[92:95]
    ds_read_b64_tr_b16 v[242:243], v227 offset:1536
    v_mfma_f32_16x16x32_bf16 v[140:143], v[244:247], a[48:51], v[140:143]
    v_mfma_f32_16x16x32_bf16 v[188:191], v[244:247], a[52:55], v[188:191]
    v_mfma_f32_16x16x32_bf16 v[212:215], v[244:247], a[56:59], v[212:215]
    ds_read_b64_tr_b16 v[244:245], v227 offset:1032
    ds_read_b64_tr_b16 v[246:247], v227 offset:1544
    v_mfma_f32_16x16x32_bf16 v[0:3], a[240:243], a[60:63], v[0:3]
    v_mfma_f32_16x16x32_bf16 v[48:51], a[240:243], a[64:67], v[48:51]
    v_mfma_f32_16x16x32_bf16 v[96:99], a[240:243], a[68:71], v[96:99]
    v_mfma_f32_16x16x32_bf16 v[144:147], a[240:243], a[72:75], v[144:147]
    s_waitcnt lgkmcnt(10)
    ds_read_b64_tr_b16 a[240:241], v228 offset:1024
    ds_read_b64_tr_b16 a[242:243], v228 offset:1536
    v_mfma_f32_16x16x32_bf16 v[4:7], a[244:247], a[60:63], v[4:7]
    s_waitcnt lgkmcnt(6)
    buffer_load_dwordx4 v223, s[4:7], s38 offen lds
    v_mfma_f32_16x16x32_bf16 v[52:55], a[244:247], a[64:67], v[52:55]
    s_waitcnt vmcnt(13)
    s_barrier
    s_add_u32 m0, s40, 5120
    v_mfma_f32_16x16x32_bf16 v[100:103], a[244:247], a[68:71], v[100:103]
    s_add_u32 s38, s28, 133120
    buffer_load_dwordx4 v223, s[4:7], s38 offen lds
    v_mfma_f32_16x16x32_bf16 v[148:151], a[244:247], a[72:75], v[148:151]
    s_add_u32 m0, s50, 0
    ds_read_b64_tr_b16 a[244:245], v228 offset:1032
    v_mfma_f32_16x16x32_bf16 v[8:11], a[248:251], a[60:63], v[8:11]
    s_add_u32 s38, s28, 143360
    buffer_load_dwordx4 v224, s[8:11], s29 offen lds
    v_mfma_f32_16x16x32_bf16 v[56:59], a[248:251], a[64:67], v[56:59]
    s_add_u32 m0, s50, 896
    ds_read_b64_tr_b16 a[246:247], v228 offset:1544
    v_mfma_f32_16x16x32_bf16 v[104:107], a[248:251], a[68:71], v[104:107]
    buffer_load_dwordx4 v224, s[8:11], s29 offen offset:128 lds
    v_mfma_f32_16x16x32_bf16 v[152:155], a[248:251], a[72:75], v[152:155]
    s_add_u32 m0, s50, 1792
    ds_read_b64_tr_b16 a[248:249], v227 offset:2048
    v_mfma_f32_16x16x32_bf16 v[12:15], a[252:255], a[60:63], v[12:15]
    s_waitcnt vmcnt(14)
    ds_read_b128 a[12:15], v225 offset:6144
    ds_read_b128 a[32:35], v226 offset:6144
    v_mfma_f32_16x16x32_bf16 v[60:63], a[252:255], a[64:67], v[60:63]
    s_add_u32 s50, s50, 12288
    buffer_load_dwordx4 v224, s[8:11], s29 offen offset:256 lds
    v_mfma_f32_16x16x32_bf16 v[108:111], a[252:255], a[68:71], v[108:111]
    s_add_u32 m0, s40, 6144
    ds_read_b64_tr_b16 a[250:251], v227 offset:2560
    s_add_u32 s29, s29, 393216
    v_mfma_f32_16x16x32_bf16 v[156:159], a[252:255], a[72:75], v[156:159]
    s_waitcnt lgkmcnt(10)
    ds_read_b64_tr_b16 a[252:253], v227 offset:2056
    ds_read_b64_tr_b16 a[254:255], v227 offset:2568
    v_mfma_f32_16x16x32_bf16 v[16:19], v[240:243], a[60:63], v[16:19]
    v_add_u32 v227, s27, v227
    v_mfma_f32_16x16x32_bf16 v[64:67], v[240:243], a[64:67], v[64:67]
    s_cmp_ge_u32 s50, 86016
    s_cselect_b32 s50, s41, s50
    v_mfma_f32_16x16x32_bf16 v[112:115], v[240:243], a[68:71], v[112:115]
    v_mfma_f32_16x16x32_bf16 v[160:163], v[240:243], a[72:75], v[160:163]
    s_waitcnt lgkmcnt(10)
    ds_read_b64_tr_b16 v[240:241], v228 offset:2048
    ds_read_b64_tr_b16 v[242:243], v228 offset:2560
    v_mfma_f32_16x16x32_bf16 v[20:23], v[244:247], a[60:63], v[20:23]
    v_mfma_f32_16x16x32_bf16 v[68:71], v[244:247], a[64:67], v[68:71]
    v_mfma_f32_16x16x32_bf16 v[116:119], v[244:247], a[68:71], v[116:119]
    s_waitcnt lgkmcnt(5)
    buffer_load_dwordx4 v223, s[4:7], s38 offen lds
    v_mfma_f32_16x16x32_bf16 v[164:167], v[244:247], a[72:75], v[164:167]
    s_add_u32 m0, s40, 7168
    s_add_u32 s38, s28, 153600
    v_mfma_f32_16x16x32_bf16 v[24:27], a[240:243], a[60:63], v[24:27]
    buffer_load_dwordx4 v223, s[4:7], s38 offen lds
    v_mfma_f32_16x16x32_bf16 v[72:75], a[240:243], a[64:67], v[72:75]
    s_add_u32 m0, s40, 8192
    ds_read_b64_tr_b16 v[244:245], v228 offset:2056
    ds_read_b64_tr_b16 v[246:247], v228 offset:2568
    v_mfma_f32_16x16x32_bf16 v[120:123], a[240:243], a[68:71], v[120:123]
    s_add_u32 s38, s28, 163840
    v_add_u32 v228, s27, v228
    v_mfma_f32_16x16x32_bf16 v[168:171], a[240:243], a[72:75], v[168:171]
    v_mfma_f32_16x16x32_bf16 v[192:195], a[240:243], a[76:79], v[192:195]
    ds_read_b64_tr_b16 a[240:241], v227 offset:0
    ds_read_b64_tr_b16 a[242:243], v227 offset:512
    v_mfma_f32_16x16x32_bf16 v[28:31], a[244:247], a[60:63], v[28:31]
    v_mfma_f32_16x16x32_bf16 v[76:79], a[244:247], a[64:67], v[76:79]
    s_waitcnt vmcnt(15)
    ds_read_b128 a[16:19], v225 offset:8192
    ds_read_b128 a[36:39], v226 offset:8192
    v_mfma_f32_16x16x32_bf16 v[124:127], a[244:247], a[68:71], v[124:127]
    v_mfma_f32_16x16x32_bf16 v[172:175], a[244:247], a[72:75], v[172:175]
    v_mfma_f32_16x16x32_bf16 v[196:199], a[244:247], a[76:79], v[196:199]
    s_waitcnt lgkmcnt(10)
    ds_read_b64_tr_b16 a[244:245], v227 offset:8
    ds_read_b64_tr_b16 a[246:247], v227 offset:520
    v_mfma_f32_16x16x32_bf16 v[32:35], a[248:251], a[60:63], v[32:35]
    v_mfma_f32_16x16x32_bf16 v[80:83], a[248:251], a[64:67], v[80:83]
    v_mfma_f32_16x16x32_bf16 v[128:131], a[248:251], a[68:71], v[128:131]
    v_mfma_f32_16x16x32_bf16 v[176:179], a[248:251], a[72:75], v[176:179]
    v_mfma_f32_16x16x32_bf16 v[200:203], a[248:251], a[76:79], v[200:203]
    s_waitcnt lgkmcnt(10)
    ds_read_b64_tr_b16 a[248:249], v228 offset:0
    ds_read_b64_tr_b16 a[250:251], v228 offset:512
    v_mfma_f32_16x16x32_bf16 v[36:39], a[252:255], a[60:63], v[36:39]
    v_mfma_f32_16x16x32_bf16 v[84:87], a[252:255], a[64:67], v[84:87]
    s_waitcnt lgkmcnt(4)
    buffer_load_dwordx4 v223, s[4:7], s38 offen lds
    v_mfma_f32_16x16x32_bf16 v[132:135], a[252:255], a[68:71], v[132:135]
    s_add_u32 m0, s40, 9216
    s_add_u32 s38, s28, 174080
    s_add_u32 s28, s28, 128
    v_mfma_f32_16x16x32_bf16 v[180:183], a[252:255], a[72:75], v[180:183]
    buffer_load_dwordx4 v223, s[4:7], s38 offen lds
    v_mfma_f32_16x16x32_bf16 v[204:207], a[252:255], a[76:79], v[204:207]
    ds_read_b64_tr_b16 a[252:253], v228 offset:8
    ds_read_b64_tr_b16 a[254:255], v228 offset:520
    v_mfma_f32_16x16x32_bf16 v[40:43], v[240:243], a[60:63], v[40:43]
    s_cmp_ge_u32 s28, 1280
    s_cselect_b32 s28, 0, s28
    v_mfma_f32_16x16x32_bf16 v[88:91], v[240:243], a[64:67], v[88:91]
    v_mfma_f32_16x16x32_bf16 v[136:139], v[240:243], a[68:71], v[136:139]
    v_mfma_f32_16x16x32_bf16 v[184:187], v[240:243], a[72:75], v[184:187]
    v_mfma_f32_16x16x32_bf16 v[208:211], v[240:243], a[76:79], v[208:211]
    ds_read_b64_tr_b16 v[240:241], v227 offset:1024
    ds_read_b64_tr_b16 v[242:243], v227 offset:1536
    v_mfma_f32_16x16x32_bf16 v[44:47], v[244:247], a[60:63], v[44:47]
    v_mfma_f32_16x16x32_bf16 v[92:95], v[244:247], a[64:67], v[92:95]
    v_mfma_f32_16x16x32_bf16 v[140:143], v[244:247], a[68:71], v[140:143]
    v_mfma_f32_16x16x32_bf16 v[188:191], v[244:247], a[72:75], v[188:191]
    v_mfma_f32_16x16x32_bf16 v[212:215], v[244:247], a[76:79], v[212:215]
    ds_read_b64_tr_b16 v[244:245], v227 offset:1032
    ds_read_b64_tr_b16 v[246:247], v227 offset:1544
    s_mov_b32 s43, 2
K_ql1:
    s_cmp_lg_u32 s43, 2
    s_cbranch_scc1 K_kvs1_0
    s_cmp_lg_u32 s68, 0
    s_cbranch_scc1 K_kvs1_0
    s_mov_b32 s36, m0
    s_mov_b32 s37, s39
    s_add_u32 m0, s34, 0
    s_nop 0
    buffer_load_dwordx4 v216, s[12:15], s30 offen nt lds
    buffer_load_dwordx4 v216, s[12:15], s30 offen offset:3072 nt lds
    s_add_u32 m0, s34, 896
    s_nop 0
    buffer_load_dwordx4 v216, s[12:15], s30 offen offset:128 nt lds
    buffer_load_dwordx4 v216, s[12:15], s30 offen offset:3200 nt lds
    s_add_u32 m0, s34, 1792
    s_nop 0
    buffer_load_dwordx4 v216, s[12:15], s30 offen offset:256 nt lds
    buffer_load_dwordx4 v216, s[12:15], s30 offen offset:3328 nt lds
    s_add_u32 s30, s30, 12288
    s_cmp_ge_u32 s30, 196608
    s_cselect_b32 s30, 6144, s30
    s_mov_b32 m0, s36
    s_mov_b32 s39, s37
K_kvs1_0:
    s_cmp_lg_u32 s43, 1
    s_cbranch_scc1 K_kvs1_1
    s_cmp_lg_u32 s68, 0
    s_cbranch_scc1 K_kvs1_1
    s_mov_b32 s36, m0
    s_mov_b32 s37, s39
    s_add_u32 m0, s32, 0
    s_nop 0
    buffer_load_dwordx4 v216, s[12:15], s30 offen nt lds
    buffer_load_dwordx4 v216, s[12:15], s30 offen offset:3072 nt lds
    s_add_u32 m0, s32, 896
    s_nop 0
    buffer_load_dwordx4 v216, s[12:15], s30 offen offset:128 nt lds
    buffer_load_dwordx4 v216, s[12:15], s30 offen offset:3200 nt lds
    s_add_u32 m0, s32, 1792
    s_nop 0
    buffer_load_dwordx4 v216, s[12:15], s30 offen offset:256 nt lds
    buffer_load_dwordx4 v216, s[12:15], s30 offen offset:3328 nt lds
    s_add_u32 s30, s30, 12288
    s_cmp_ge_u32 s30, 196608
    s_cselect_b32 s30, 6144, s30
    s_mov_b32 m0, s36
    s_mov_b32 s39, s37
K_kvs1_1:
    s_cmp_lg_u32 s43, 0
    s_cbranch_scc1 K_kvs1_2
    s_cmp_lg_u32 s68, 0
    s_cbranch_scc1 K_kvs1_2
    s_mov_b32 s36, m0
    s_mov_b32 s37, s39
    s_add_u32 s39, s34, s35
    s_add_u32 m0, s39, 0
    s_nop 0
    buffer_load_dwordx4 v216, s[16:19], s31 offen nt lds
    buffer_load_dwordx4 v216, s[16:19], s31 offen offset:3072 nt lds
    s_add_u32 m0, s39, 896
    s_nop 0
    buffer_load_dwordx4 v216, s[16:19], s31 offen offset:128 nt lds
    buffer_load_dwordx4 v216, s[16:19], s31 offen offset:3200 nt lds
    s_add_u32 m0, s39, 1792
    s_nop 0
    buffer_load_dwordx4 v216, s[16:19], s31 offen offset:256 nt lds
    buffer_load_dwordx4 v216, s[16:19], s31 offen offset:3328 nt lds
    s_add_u32 s31, s31, 12288
    s_cmp_ge_u32 s31, 196608
    s_cselect_b32 s31, 6144, s31
    s_mov_b32 m0, s36
    s_mov_b32 s39, s37
K_kvs1_2:
    v_mfma_f32_16x16x32_bf16 v[0:3], a[240:243], a[0:3], v[0:3]
    s_add_u32 m0, s50, 0
    s_add_u32 s38, s28, 81920
    s_add_u32 s51, s51, 1
    v_mfma_f32_16x16x32_bf16 v[48:51], a[240:243], a[4:7], v[48:51]
    s_cmp_eq_u32 s51, 4
    s_cselect_b32 s27, s46, 12288
    v_mfma_f32_16x16x32_bf16 v[96:99], a[240:243], a[8:11], v[96:99]
    s_cmp_eq_u32 s51, 4
    s_cselect_b32 s51, 0, s51
    v_mfma_f32_16x16x32_bf16 v[144:147], a[240:243], a[12:15], v[144:147]
    s_waitcnt lgkmcnt(8)
    ds_read_b64_tr_b16 a[240:241], v228 offset:1024
    ds_read_b64_tr_b16 a[242:243], v228 offset:1536
    v_mfma_f32_16x16x32_bf16 v[4:7], a[244:247], a[0:3], v[4:7]
    s_add_u32 s51, s51, 1
    v_mfma_f32_16x16x32_bf16 v[52:55], a[244:247], a[4:7], v[52:55]
    s_waitcnt vmcnt(13)
    s_barrier
    v_mfma_f32_16x16x32_bf16 v[100:103], a[244:247], a[8:11], v[100:103]
    buffer_load_dwordx4 v224, s[8:11], s29 offen lds
    v_mfma_f32_16x16x32_bf16 v[148:151], a[244:247], a[12:15], v[148:151]
    s_waitcnt lgkmcnt(8)
    s_add_u32 m0, s50, 896
    ds_read_b64_tr_b16 a[244:245], v228 offset:1032
    v_mfma_f32_16x16x32_bf16 v[8:11], a[248:251], a[0:3], v[8:11]
    buffer_load_dwordx4 v224, s[8:11], s29 offen offset:128 lds
    v_mfma_f32_16x16x32_bf16 v[56:59], a[248:251], a[4:7], v[56:59]
    s_add_u32 m0, s50, 1792
    ds_read_b64_tr_b16 a[246:247], v228 offset:1544
    s_add_u32 s50, s50, 12288
    v_mfma_f32_16x16x32_bf16 v[104:107], a[248:251], a[8:11], v[104:107]
    buffer_load_dwordx4 v224, s[8:11], s29 offen offset:256 lds
    v_mfma_f32_16x16x32_bf16 v[152:155], a[248:251], a[12:15], v[152:155]
    s_waitcnt lgkmcnt(8)
    s_add_u32 m0, s40, 0
    ds_read_b64_tr_b16 a[248:249], v227 offset:2048
    v_mfma_f32_16x16x32_bf16 v[12:15], a[252:255], a[0:3], v[12:15]
    s_waitcnt vmcnt(14)
    ds_read_b128 a[40:43], v225 offset:0
    ds_read_b128 a[60:63], v226 offset:0
    v_mfma_f32_16x16x32_bf16 v[60:63], a[252:255], a[4:7], v[60:63]
    s_add_u32 s29, s29, 393216
    ds_read_b64_tr_b16 a[250:251], v227 offset:2560
    v_mfma_f32_16x16x32_bf16 v[108:111], a[252:255], a[8:11], v[108:111]
    s_cmp_ge_u32 s50, 86016
    s_cselect_b32 s50, s41, s50
    v_mfma_f32_16x16x32_bf16 v[156:159], a[252:255], a[12:15], v[156:159]
    s_waitcnt lgkmcnt(10)
    ds_read_b64_tr_b16 a[252:253], v227 offset:2056
    ds_read_b64_tr_b16 a[254:255], v227 offset:2568
    v_mfma_f32_16x16x32_bf16 v[16:19], v[240:243], a[0:3], v[16:19]
    v_add_u32 v227, s27, v227
    v_mfma_f32_16x16x32_bf16 v[64:67], v[240:243], a[4:7], v[64:67]
    s_cmp_ge_u32 s29, 7864320
    s_cselect_b32 s29, s49, s29
    v_mfma_f32_16x16x32_bf16 v[112:115], v[240:243], a[8:11], v[112:115]
    v_mfma_f32_16x16x32_bf16 v[160:163], v[240:243], a[12:15], v[160:163]
    s_waitcnt lgkmcnt(10)
    ds_read_b64_tr_b16 v[240:241], v228 offset:2048
    ds_read_b64_tr_b16 v[242:243], v228 offset:2560
    v_mfma_f32_16x16x32_bf16 v[20:23], v[244:247], a[0:3], v[20:23]
    v_mfma_f32_16x16x32_bf16 v[68:71], v[244:247], a[4:7], v[68:71]
    v_mfma_f32_16x16x32_bf16 v[116:119], v[244:247], a[8:11], v[116:119]
    s_waitcnt lgkmcnt(5)
    buffer_load_dwordx4 v223, s[4:7], s38 offen lds
    v_mfma_f32_16x16x32_bf16 v[164:167], v[244:247], a[12:15], v[164:167]
    s_add_u32 m0, s40, 1024
    s_add_u32 s38, s28, 92160
    v_mfma_f32_16x16x32_bf16 v[24:27], a[240:243], a[0:3], v[24:27]
    buffer_load_dwordx4 v223, s[4:7], s38 offen lds
    v_mfma_f32_16x16x32_bf16 v[72:75], a[240:243], a[4:7], v[72:75]
    s_add_u32 m0, s40, 2048
    ds_read_b64_tr_b16 v[244:245], v228 offset:2056
    ds_read_b64_tr_b16 v[246:247], v228 offset:2568
    v_mfma_f32_16x16x32_bf16 v[120:123], a[240:243], a[8:11], v[120:123]
    s_add_u32 s38, s28, 102400
    v_add_u32 v228, s27, v228
    v_mfma_f32_16x16x32_bf16 v[168:171], a[240:243], a[12:15], v[168:171]
    s_cmp_eq_u32 s51, 4
    s_cselect_b32 s27, s46, 12288
    v_mfma_f32_16x16x32_bf16 v[192:195], a[240:243], a[16:19], v[192:195]
    ds_read_b64_tr_b16 a[240:241], v227 offset:0
    ds_read_b64_tr_b16 a[242:243], v227 offset:512
    v_mfma_f32_16x16x32_bf16 v[28:31], a[244:247], a[0:3], v[28:31]
    s_cmp_eq_u32 s51, 4
    s_cselect_b32 s51, 0, s51
    v_mfma_f32_16x16x32_bf16 v[76:79], a[244:247], a[4:7], v[76:79]
    s_waitcnt vmcnt(14)
    ds_read_b128 a[44:47], v225 offset:2048
    ds_read_b128 a[64:67], v226 offset:2048
    v_mfma_f32_16x16x32_bf16 v[124:127], a[244:247], a[8:11], v[124:127]
    s_add_u32 s51, s51, 1
    v_mfma_f32_16x16x32_bf16 v[172:175], a[244:247], a[12:15], v[172:175]
    v_mfma_f32_16x16x32_bf16 v[196:199], a[244:247], a[16:19], v[196:199]
    s_waitcnt lgkmcnt(10)
    ds_read_b64_tr_b16 a[244:245], v227 offset:8
    ds_read_b64_tr_b16 a[246:247], v227 offset:520
    v_mfma_f32_16x16x32_bf16 v[32:35], a[248:251], a[0:3], v[32:35]
    v_mfma_f32_16x16x32_bf16 v[80:83], a[248:251], a[4:7], v[80:83]
    v_mfma_f32_16x16x32_bf16 v[128:131], a[248:251], a[8:11], v[128:131]
    v_mfma_f32_16x16x32_bf16 v[176:179], a[248:251], a[12:15], v[176:179]
    v_mfma_f32_16x16x32_bf16 v[200:203], a[248:251], a[16:19], v[200:203]
    s_waitcnt lgkmcnt(10)
    ds_read_b64_tr_b16 a[248:249], v228 offset:0
    ds_read_b64_tr_b16 a[250:251], v228 offset:512
    v_mfma_f32_16x16x32_bf16 v[36:39], a[252:255], a[0:3], v[36:39]
    v_mfma_f32_16x16x32_bf16 v[84:87], a[252:255], a[4:7], v[84:87]
    s_waitcnt lgkmcnt(4)
    buffer_load_dwordx4 v223, s[4:7], s38 offen lds
    v_mfma_f32_16x16x32_bf16 v[132:135], a[252:255], a[8:11], v[132:135]
    s_add_u32 m0, s40, 3072
    s_add_u32 s38, s28, 112640
    v_mfma_f32_16x16x32_bf16 v[180:183], a[252:255], a[12:15], v[180:183]
    buffer_load_dwordx4 v223, s[4:7], s38 offen lds
    v_mfma_f32_16x16x32_bf16 v[204:207], a[252:255], a[16:19], v[204:207]
    ds_read_b64_tr_b16 a[252:253], v228 offset:8
    ds_read_b64_tr_b16 a[254:255], v228 offset:520
    v_mfma_f32_16x16x32_bf16 v[40:43], v[240:243], a[0:3], v[40:43]
    s_add_u32 m0, s40, 4096
    s_add_u32 s38, s28, 122880
    v_mfma_f32_16x16x32_bf16 v[88:91], v[240:243], a[4:7], v[88:91]
    v_mfma_f32_16x16x32_bf16 v[136:139], v[240:243], a[8:11], v[136:139]
    v_mfma_f32_16x16x32_bf16 v[184:187], v[240:243], a[12:15], v[184:187]
    v_mfma_f32_16x16x32_bf16 v[208:211], v[240:243], a[16:19], v[208:211]
    s_waitcnt vmcnt(14)
    ds_read_b128 a[48:51], v225 offset:4096
    v_mfma_f32_16x16x32_bf16 v[44:47], v[244:247], a[0:3], v[44:47]
    ds_read_b128 a[68:71], v226 offset:4096
    ds_read_b64_tr_b16 v[240:241], v227 offset:1024
    v_mfma_f32_16x16x32_bf16 v[92:95], v[244:247], a[4:7], v[92:95]
    ds_read_b64_tr_b16 v[242:243], v227 offset:1536
    v_mfma_f32_16x16x32_bf16 v[140:143], v[244:247], a[8:11], v[140:143]
    v_mfma_f32_16x16x32_bf16 v[188:191], v[244:247], a[12:15], v[188:191]
    v_mfma_f32_16x16x32_bf16 v[212:215], v[244:247], a[16:19], v[212:215]
    ds_read_b64_tr_b16 v[244:245], v227 offset:1032
    ds_read_b64_tr_b16 v[246:247], v227 offset:1544
    v_mfma_f32_16x16x32_bf16 v[0:3], a[240:243], a[20:23], v[0:3]
    v_mfma_f32_16x16x32_bf16 v[48:51], a[240:243], a[24:27], v[48:51]
    v_mfma_f32_16x16x32_bf16 v[96:99], a[240:243], a[28:31], v[96:99]
    v_mfma_f32_16x16x32_bf16 v[144:147], a[240:243], a[32:35], v[144:147]
    s_waitcnt lgkmcnt(10)
    ds_read_b64_tr_b16 a[240:241], v228 offset:1024
    ds_read_b64_tr_b16 a[242:243], v228 offset:1536
    v_mfma_f32_16x16x32_bf16 v[4:7], a[244:247], a[20:23], v[4:7]
    s_waitcnt lgkmcnt(6)
    buffer_load_dwordx4 v223, s[4:7], s38 offen lds
    v_mfma_f32_16x16x32_bf16 v[52:55], a[244:247], a[24:27], v[52:55]
    s_waitcnt vmcnt(12)
    s_barrier
    s_add_u32 m0, s40, 5120
    v_mfma_f32_16x16x32_bf16 v[100:103], a[244:247], a[28:31], v[100:103]
    s_add_u32 s38, s28, 133120
    buffer_load_dwordx4 v223, s[4:7], s38 offen lds
    v_mfma_f32_16x16x32_bf16 v[148:151], a[244:247], a[32:35], v[148:151]
    s_add_u32 m0, s50, 0
    ds_read_b64_tr_b16 a[244:245], v228 offset:1032
    v_mfma_f32_16x16x32_bf16 v[8:11], a[248:251], a[20:23], v[8:11]
    s_add_u32 s38, s28, 143360
    buffer_load_dwordx4 v224, s[8:11], s29 offen lds
    v_mfma_f32_16x16x32_bf16 v[56:59], a[248:251], a[24:27], v[56:59]
    s_add_u32 m0, s50, 896
    ds_read_b64_tr_b16 a[246:247], v228 offset:1544
    v_mfma_f32_16x16x32_bf16 v[104:107], a[248:251], a[28:31], v[104:107]
    buffer_load_dwordx4 v224, s[8:11], s29 offen offset:128 lds
    v_mfma_f32_16x16x32_bf16 v[152:155], a[248:251], a[32:35], v[152:155]
    s_add_u32 m0, s50, 1792
    ds_read_b64_tr_b16 a[248:249], v227 offset:2048
    v_mfma_f32_16x16x32_bf16 v[12:15], a[252:255], a[20:23], v[12:15]
    s_waitcnt vmcnt(13)
    ds_read_b128 a[52:55], v225 offset:6144
    ds_read_b128 a[72:75], v226 offset:6144
    v_mfma_f32_16x16x32_bf16 v[60:63], a[252:255], a[24:27], v[60:63]
    s_add_u32 s50, s50, 12288
    buffer_load_dwordx4 v224, s[8:11], s29 offen offset:256 lds
    v_mfma_f32_16x16x32_bf16 v[108:111], a[252:255], a[28:31], v[108:111]
    s_add_u32 m0, s40, 6144
    ds_read_b64_tr_b16 a[250:251], v227 offset:2560
    s_add_u32 s29, s29, 393216
    v_mfma_f32_16x16x32_bf16 v[156:159], a[252:255], a[32:35], v[156:159]
    s_waitcnt lgkmcnt(10)
    ds_read_b64_tr_b16 a[252:253], v227 offset:2056
    ds_read_b64_tr_b16 a[254:255], v227 offset:2568
    v_mfma_f32_16x16x32_bf16 v[16:19], v[240:243], a[20:23], v[16:19]
    v_add_u32 v227, s27, v227
    v_mfma_f32_16x16x32_bf16 v[64:67], v[240:243], a[24:27], v[64:67]
    s_cmp_ge_u32 s50, 86016
    s_cselect_b32 s50, s41, s50
    v_mfma_f32_16x16x32_bf16 v[112:115], v[240:243], a[28:31], v[112:115]
    v_mfma_f32_16x16x32_bf16 v[160:163], v[240:243], a[32:35], v[160:163]
    s_waitcnt lgkmcnt(10)
    ds_read_b64_tr_b16 v[240:241], v228 offset:2048
    ds_read_b64_tr_b16 v[242:243], v228 offset:2560
    v_mfma_f32_16x16x32_bf16 v[20:23], v[244:247], a[20:23], v[20:23]
    v_mfma_f32_16x16x32_bf16 v[68:71], v[244:247], a[24:27], v[68:71]
    v_mfma_f32_16x16x32_bf16 v[116:119], v[244:247], a[28:31], v[116:119]
    s_waitcnt lgkmcnt(5)
    buffer_load_dwordx4 v223, s[4:7], s38 offen lds
    v_mfma_f32_16x16x32_bf16 v[164:167], v[244:247], a[32:35], v[164:167]
    s_add_u32 m0, s40, 7168
    s_add_u32 s38, s28, 153600
    v_mfma_f32_16x16x32_bf16 v[24:27], a[240:243], a[20:23], v[24:27]
    buffer_load_dwordx4 v223, s[4:7], s38 offen lds
    v_mfma_f32_16x16x32_bf16 v[72:75], a[240:243], a[24:27], v[72:75]
    s_add_u32 m0, s40, 8192
    ds_read_b64_tr_b16 v[244:245], v228 offset:2056
    ds_read_b64_tr_b16 v[246:247], v228 offset:2568
    v_mfma_f32_16x16x32_bf16 v[120:123], a[240:243], a[28:31], v[120:123]
    s_add_u32 s38, s28, 163840
    v_add_u32 v228, s27, v228
    v_mfma_f32_16x16x32_bf16 v[168:171], a[240:243], a[32:35], v[168:171]
    s_cmp_eq_u32 s51, 4
    s_cselect_b32 s27, s46, 12288
    v_mfma_f32_16x16x32_bf16 v[192:195], a[240:243], a[36:39], v[192:195]
    ds_read_b64_tr_b16 a[240:241], v227 offset:0
    ds_read_b64_tr_b16 a[242:243], v227 offset:512
    v_mfma_f32_16x16x32_bf16 v[28:31], a[244:247], a[20:23], v[28:31]
    s_cmp_eq_u32 s51, 4
    s_cselect_b32 s51, 0, s51
    v_mfma_f32_16x16x32_bf16 v[76:79], a[244:247], a[24:27], v[76:79]
    s_waitcnt vmcnt(14)
    ds_read_b128 a[56:59], v225 offset:8192
    ds_read_b128 a[76:79], v226 offset:8192
    v_mfma_f32_16x16x32_bf16 v[124:127], a[244:247], a[28:31], v[124:127]
    s_add_u32 s51, s51, 1
    v_mfma_f32_16x16x32_bf16 v[172:175], a[244:247], a[32:35], v[172:175]
    v_mfma_f32_16x16x32_bf16 v[196:199], a[244:247], a[36:39], v[196:199]
    s_waitcnt lgkmcnt(10)
    ds_read_b64_tr_b16 a[244:245], v227 offset:8
    ds_read_b64_tr_b16 a[246:247], v227 offset:520
    v_mfma_f32_16x16x32_bf16 v[32:35], a[248:251], a[20:23], v[32:35]
    v_mfma_f32_16x16x32_bf16 v[80:83], a[248:251], a[24:27], v[80:83]
    v_mfma_f32_16x16x32_bf16 v[128:131], a[248:251], a[28:31], v[128:131]
    v_mfma_f32_16x16x32_bf16 v[176:179], a[248:251], a[32:35], v[176:179]
    v_mfma_f32_16x16x32_bf16 v[200:203], a[248:251], a[36:39], v[200:203]
    s_waitcnt lgkmcnt(10)
    ds_read_b64_tr_b16 a[248:249], v228 offset:0
    ds_read_b64_tr_b16 a[250:251], v228 offset:512
    v_mfma_f32_16x16x32_bf16 v[36:39], a[252:255], a[20:23], v[36:39]
    v_mfma_f32_16x16x32_bf16 v[84:87], a[252:255], a[24:27], v[84:87]
    s_waitcnt lgkmcnt(4)
    buffer_load_dwordx4 v223, s[4:7], s38 offen lds
    v_mfma_f32_16x16x32_bf16 v[132:135], a[252:255], a[28:31], v[132:135]
    s_add_u32 m0, s40, 9216
    s_add_u32 s38, s28, 174080
    s_add_u32 s28, s28, 128
    v_mfma_f32_16x16x32_bf16 v[180:183], a[252:255], a[32:35], v[180:183]
    buffer_load_dwordx4 v223, s[4:7], s38 offen lds
    v_mfma_f32_16x16x32_bf16 v[204:207], a[252:255], a[36:39], v[204:207]
    ds_read_b64_tr_b16 a[252:253], v228 offset:8
    ds_read_b64_tr_b16 a[254:255], v228 offset:520
    v_mfma_f32_16x16x32_bf16 v[40:43], v[240:243], a[20:23], v[40:43]
    s_add_u32 m0, s50, 0
    s_cmp_ge_u32 s28, 1280
    s_cselect_b32 s28, 0, s28
    v_mfma_f32_16x16x32_bf16 v[88:91], v[240:243], a[24:27], v[88:91]
    s_add_u32 s38, s28, 81920
    v_mfma_f32_16x16x32_bf16 v[136:139], v[240:243], a[28:31], v[136:139]
    v_mfma_f32_16x16x32_bf16 v[184:187], v[240:243], a[32:35], v[184:187]
    v_mfma_f32_16x16x32_bf16 v[208:211], v[240:243], a[36:39], v[208:211]
    ds_read_b64_tr_b16 v[240:241], v227 offset:1024
    ds_read_b64_tr_b16 v[242:243], v227 offset:1536
    v_mfma_f32_16x16x32_bf16 v[44:47], v[244:247], a[20:23], v[44:47]
    v_mfma_f32_16x16x32_bf16 v[92:95], v[244:247], a[24:27], v[92:95]
    v_mfma_f32_16x16x32_bf16 v[140:143], v[244:247], a[28:31], v[140:143]
    v_mfma_f32_16x16x32_bf16 v[188:191], v[244:247], a[32:35], v[188:191]
    v_mfma_f32_16x16x32_bf16 v[212:215], v[244:247], a[36:39], v[212:215]
    ds_read_b64_tr_b16 v[244:245], v227 offset:1032
    ds_read_b64_tr_b16 v[246:247], v227 offset:1544
    v_mfma_f32_16x16x32_bf16 v[0:3], a[240:243], a[40:43], v[0:3]
    v_mfma_f32_16x16x32_bf16 v[48:51], a[240:243], a[44:47], v[48:51]
    v_mfma_f32_16x16x32_bf16 v[96:99], a[240:243], a[48:51], v[96:99]
    v_mfma_f32_16x16x32_bf16 v[144:147], a[240:243], a[52:55], v[144:147]
    s_waitcnt lgkmcnt(8)
    ds_read_b64_tr_b16 a[240:241], v228 offset:1024
    ds_read_b64_tr_b16 a[242:243], v228 offset:1536
    v_mfma_f32_16x16x32_bf16 v[4:7], a[244:247], a[40:43], v[4:7]
    v_mfma_f32_16x16x32_bf16 v[52:55], a[244:247], a[44:47], v[52:55]
    s_waitcnt vmcnt(13)
    s_barrier
    v_mfma_f32_16x16x32_bf16 v[100:103], a[244:247], a[48:51], v[100:103]
    buffer_load_dwordx4 v224, s[8:11], s29 offen lds
    v_mfma_f32_16x16x32_bf16 v[148:151], a[244:247], a[52:55], v[148:151]
    s_waitcnt lgkmcnt(8)
    s_add_u32 m0, s50, 896
    ds_read_b64_tr_b16 a[244:245], v228 offset:1032
    v_mfma_f32_16x16x32_bf16 v[8:11], a[248:251], a[40:43], v[8:11]
    buffer_load_dwordx4 v224, s[8:11], s29 offen offset:128 lds
    v_mfma_f32_16x16x32_bf16 v[56:59], a[248:251], a[44:47], v[56:59]
    s_add_u32 m0, s50, 1792
    ds_read_b64_tr_b16 a[246:247], v228 offset:1544
    s_add_u32 s50, s50, 12288
    v_mfma_f32_16x16x32_bf16 v[104:107], a[248:251], a[48:51], v[104:107]
    buffer_load_dwordx4 v224, s[8:11], s29 offen offset:256 lds
    v_mfma_f32_16x16x32_bf16 v[152:155], a[248:251], a[52:55], v[152:155]
    s_waitcnt lgkmcnt(8)
    s_add_u32 m0, s40, 0
    ds_read_b64_tr_b16 a[248:249], v227 offset:2048
    v_mfma_f32_16x16x32_bf16 v[12:15], a[252:255], a[40:43], v[12:15]
    s_waitcnt vmcnt(14)
    ds_read_b128 a[0:3], v225 offset:0
    ds_read_b128 a[20:23], v226 offset:0
    v_mfma_f32_16x16x32_bf16 v[60:63], a[252:255], a[44:47], v[60:63]
    s_add_u32 s29, s29, 393216
    ds_read_b64_tr_b16 a[250:251], v227 offset:2560
    v_mfma_f32_16x16x32_bf16 v[108:111], a[252:255], a[48:51], v[108:111]
    s_cmp_ge_u32 s50, 86016
    s_cselect_b32 s50, s41, s50
    v_mfma_f32_16x16x32_bf16 v[156:159], a[252:255], a[52:55], v[156:159]
    s_waitcnt lgkmcnt(10)
    ds_read_b64_tr_b16 a[252:253], v227 offset:2056
    ds_read_b64_tr_b16 a[254:255], v227 offset:2568
    v_mfma_f32_16x16x32_bf16 v[16:19], v[240:243], a[40:43], v[16:19]
    v_add_u32 v227, s27, v227
    v_mfma_f32_16x16x32_bf16 v[64:67], v[240:243], a[44:47], v[64:67]
    s_cmp_ge_u32 s29, 7864320
    s_cselect_b32 s29, s49, s29
    v_mfma_f32_16x16x32_bf16 v[112:115], v[240:243], a[48:51], v[112:115]
    v_mfma_f32_16x16x32_bf16 v[160:163], v[240:243], a[52:55], v[160:163]
    s_waitcnt lgkmcnt(10)
    ds_read_b64_tr_b16 v[240:241], v228 offset:2048
    ds_read_b64_tr_b16 v[242:243], v228 offset:2560
    v_mfma_f32_16x16x32_bf16 v[20:23], v[244:247], a[40:43], v[20:23]
    v_mfma_f32_16x16x32_bf16 v[68:71], v[244:247], a[44:47], v[68:71]
    v_mfma_f32_16x16x32_bf16 v[116:119], v[244:247], a[48:51], v[116:119]
    s_waitcnt lgkmcnt(5)
    buffer_load_dwordx4 v223, s[4:7], s38 offen lds
    v_mfma_f32_16x16x32_bf16 v[164:167], v[244:247], a[52:55], v[164:167]
    s_add_u32 m0, s40, 1024
    s_add_u32 s38, s28, 92160
    v_mfma_f32_16x16x32_bf16 v[24:27], a[240:243], a[40:43], v[24:27]
    buffer_load_dwordx4 v223, s[4:7], s38 offen lds
    v_mfma_f32_16x16x32_bf16 v[72:75], a[240:243], a[44:47], v[72:75]
    s_add_u32 m0, s40, 2048
    ds_read_b64_tr_b16 v[244:245], v228 offset:2056
    ds_read_b64_tr_b16 v[246:247], v228 offset:2568
    v_mfma_f32_16x16x32_bf16 v[120:123], a[240:243], a[48:51], v[120:123]
    s_add_u32 s38, s28, 102400
    v_add_u32 v228, s27, v228
    v_mfma_f32_16x16x32_bf16 v[168:171], a[240:243], a[52:55], v[168:171]
    s_cmp_eq_u32 s51, 4
    s_cselect_b32 s27, s46, 12288
    v_mfma_f32_16x16x32_bf16 v[192:195], a[240:243], a[56:59], v[192:195]
    ds_read_b64_tr_b16 a[240:241], v227 offset:0
    ds_read_b64_tr_b16 a[242:243], v227 offset:512
    v_mfma_f32_16x16x32_bf16 v[28:31], a[244:247], a[40:43], v[28:31]
    s_cmp_eq_u32 s51, 4
    s_cselect_b32 s51, 0, s51
    v_mfma_f32_16x16x32_bf16 v[76:79], a[244:247], a[44:47], v[76:79]
    s_waitcnt vmcnt(14)
    ds_read_b128 a[4:7], v225 offset:2048
    ds_read_b128 a[24:27], v226 offset:2048
    v_mfma_f32_16x16x32_bf16 v[124:127], a[244:247], a[48:51], v[124:127]
    v_mfma_f32_16x16x32_bf16 v[172:175], a[244:247], a[52:55], v[172:175]
    v_mfma_f32_16x16x32_bf16 v[196:199], a[244:247], a[56:59], v[196:199]
    s_waitcnt lgkmcnt(10)
    ds_read_b64_tr_b16 a[244:245], v227 offset:8
    ds_read_b64_tr_b16 a[246:247], v227 offset:520
    v_mfma_f32_16x16x32_bf16 v[32:35], a[248:251], a[40:43], v[32:35]
    v_mfma_f32_16x16x32_bf16 v[80:83], a[248:251], a[44:47], v[80:83]
    v_mfma_f32_16x16x32_bf16 v[128:131], a[248:251], a[48:51], v[128:131]
    v_mfma_f32_16x16x32_bf16 v[176:179], a[248:251], a[52:55], v[176:179]
    v_mfma_f32_16x16x32_bf16 v[200:203], a[248:251], a[56:59], v[200:203]
    s_waitcnt lgkmcnt(10)
    ds_read_b64_tr_b16 a[248:249], v228 offset:0
    ds_read_b64_tr_b16 a[250:251], v228 offset:512
    v_mfma_f32_16x16x32_bf16 v[36:39], a[252:255], a[40:43], v[36:39]
    v_mfma_f32_16x16x32_bf16 v[84:87], a[252:255], a[44:47], v[84:87]
    s_waitcnt lgkmcnt(4)
    buffer_load_dwordx4 v223, s[4:7], s38 offen lds
    v_mfma_f32_16x16x32_bf16 v[132:135], a[252:255], a[48:51], v[132:135]
    s_add_u32 m0, s40, 3072
    s_add_u32 s38, s28, 112640
    v_mfma_f32_16x16x32_bf16 v[180:183], a[252:255], a[52:55], v[180:183]
    buffer_load_dwordx4 v223, s[4:7], s38 offen lds
    v_mfma_f32_16x16x32_bf16 v[204:207], a[252:255], a[56:59], v[204:207]
    ds_read_b64_tr_b16 a[252:253], v228 offset:8
    ds_read_b64_tr_b16 a[254:255], v228 offset:520
    v_mfma_f32_16x16x32_bf16 v[40:43], v[240:243], a[40:43], v[40:43]
    s_add_u32 m0, s40, 4096
    s_add_u32 s38, s28, 122880
    v_mfma_f32_16x16x32_bf16 v[88:91], v[240:243], a[44:47], v[88:91]
    v_mfma_f32_16x16x32_bf16 v[136:139], v[240:243], a[48:51], v[136:139]
    v_mfma_f32_16x16x32_bf16 v[184:187], v[240:243], a[52:55], v[184:187]
    v_mfma_f32_16x16x32_bf16 v[208:211], v[240:243], a[56:59], v[208:211]
    s_waitcnt vmcnt(14)
    ds_read_b128 a[8:11], v225 offset:4096
    v_mfma_f32_16x16x32_bf16 v[44:47], v[244:247], a[40:43], v[44:47]
    ds_read_b128 a[28:31], v226 offset:4096
    ds_read_b64_tr_b16 v[240:241], v227 offset:1024
    v_mfma_f32_16x16x32_bf16 v[92:95], v[244:247], a[44:47], v[92:95]
    ds_read_b64_tr_b16 v[242:243], v227 offset:1536
    v_mfma_f32_16x16x32_bf16 v[140:143], v[244:247], a[48:51], v[140:143]
    v_mfma_f32_16x16x32_bf16 v[188:191], v[244:247], a[52:55], v[188:191]
    v_mfma_f32_16x16x32_bf16 v[212:215], v[244:247], a[56:59], v[212:215]
    ds_read_b64_tr_b16 v[244:245], v227 offset:1032
    ds_read_b64_tr_b16 v[246:247], v227 offset:1544
    v_mfma_f32_16x16x32_bf16 v[0:3], a[240:243], a[60:63], v[0:3]
    v_mfma_f32_16x16x32_bf16 v[48:51], a[240:243], a[64:67], v[48:51]
    v_mfma_f32_16x16x32_bf16 v[96:99], a[240:243], a[68:71], v[96:99]
    v_mfma_f32_16x16x32_bf16 v[144:147], a[240:243], a[72:75], v[144:147]
    s_waitcnt lgkmcnt(10)
    ds_read_b64_tr_b16 a[240:241], v228 offset:1024
    ds_read_b64_tr_b16 a[242:243], v228 offset:1536
    v_mfma_f32_16x16x32_bf16 v[4:7], a[244:247], a[60:63], v[4:7]
    s_waitcnt lgkmcnt(6)
    buffer_load_dwordx4 v223, s[4:7], s38 offen lds
    v_mfma_f32_16x16x32_bf16 v[52:55], a[244:247], a[64:67], v[52:55]
    s_waitcnt vmcnt(12)
    s_barrier
    s_add_u32 m0, s40, 5120
    v_mfma_f32_16x16x32_bf16 v[100:103], a[244:247], a[68:71], v[100:103]
    s_add_u32 s38, s28, 133120
    buffer_load_dwordx4 v223, s[4:7], s38 offen lds
    v_mfma_f32_16x16x32_bf16 v[148:151], a[244:247], a[72:75], v[148:151]
    s_add_u32 m0, s50, 0
    ds_read_b64_tr_b16 a[244:245], v228 offset:1032
    v_mfma_f32_16x16x32_bf16 v[8:11], a[248:251], a[60:63], v[8:11]
    s_add_u32 s38, s28, 143360
    buffer_load_dwordx4 v224, s[8:11], s29 offen lds
    v_mfma_f32_16x16x32_bf16 v[56:59], a[248:251], a[64:67], v[56:59]
    s_add_u32 m0, s50, 896
    ds_read_b64_tr_b16 a[246:247], v228 offset:1544
    v_mfma_f32_16x16x32_bf16 v[104:107], a[248:251], a[68:71], v[104:107]
    buffer_load_dwordx4 v224, s[8:11], s29 offen offset:128 lds
    v_mfma_f32_16x16x32_bf16 v[152:155], a[248:251], a[72:75], v[152:155]
    s_add_u32 m0, s50, 1792
    ds_read_b64_tr_b16 a[248:249], v227 offset:2048
    v_mfma_f32_16x16x32_bf16 v[12:15], a[252:255], a[60:63], v[12:15]
    s_waitcnt vmcnt(13)
    ds_read_b128 a[12:15], v225 offset:6144
    ds_read_b128 a[32:35], v226 offset:6144
    v_mfma_f32_16x16x32_bf16 v[60:63], a[252:255], a[64:67], v[60:63]
    s_add_u32 s50, s50, 12288
    buffer_load_dwordx4 v224, s[8:11], s29 offen offset:256 lds
    v_mfma_f32_16x16x32_bf16 v[108:111], a[252:255], a[68:71], v[108:111]
    s_add_u32 m0, s40, 6144
    ds_read_b64_tr_b16 a[250:251], v227 offset:2560
    s_add_u32 s29, s29, 393216
    v_mfma_f32_16x16x32_bf16 v[156:159], a[252:255], a[72:75], v[156:159]
    s_waitcnt lgkmcnt(10)
    ds_read_b64_tr_b16 a[252:253], v227 offset:2056
    ds_read_b64_tr_b16 a[254:255], v227 offset:2568
    v_mfma_f32_16x16x32_bf16 v[16:19], v[240:243], a[60:63], v[16:19]
    v_add_u32 v227, s27, v227
    v_mfma_f32_16x16x32_bf16 v[64:67], v[240:243], a[64:67], v[64:67]
    s_cmp_ge_u32 s50, 86016
    s_cselect_b32 s50, s41, s50
    v_mfma_f32_16x16x32_bf16 v[112:115], v[240:243], a[68:71], v[112:115]
    v_mfma_f32_16x16x32_bf16 v[160:163], v[240:243], a[72:75], v[160:163]
    s_waitcnt lgkmcnt(10)
    ds_read_b64_tr_b16 v[240:241], v228 offset:2048
    ds_read_b64_tr_b16 v[242:243], v228 offset:2560
    v_mfma_f32_16x16x32_bf16 v[20:23], v[244:247], a[60:63], v[20:23]
    v_mfma_f32_16x16x32_bf16 v[68:71], v[244:247], a[64:67], v[68:71]
    v_mfma_f32_16x16x32_bf16 v[116:119], v[244:247], a[68:71], v[116:119]
    s_waitcnt lgkmcnt(5)
    buffer_load_dwordx4 v223, s[4:7], s38 offen lds
    v_mfma_f32_16x16x32_bf16 v[164:167], v[244:247], a[72:75], v[164:167]
    s_add_u32 m0, s40, 7168
    s_add_u32 s38, s28, 153600
    v_mfma_f32_16x16x32_bf16 v[24:27], a[240:243], a[60:63], v[24:27]
    buffer_load_dwordx4 v223, s[4:7], s38 offen lds
    v_mfma_f32_16x16x32_bf16 v[72:75], a[240:243], a[64:67], v[72:75]
    s_add_u32 m0, s40, 8192
    ds_read_b64_tr_b16 v[244:245], v228 offset:2056
    ds_read_b64_tr_b16 v[246:247], v228 offset:2568
    v_mfma_f32_16x16x32_bf16 v[120:123], a[240:243], a[68:71], v[120:123]
    s_add_u32 s38, s28, 163840
    v_add_u32 v228, s27, v228
    v_mfma_f32_16x16x32_bf16 v[168:171], a[240:243], a[72:75], v[168:171]
    v_mfma_f32_16x16x32_bf16 v[192:195], a[240:243], a[76:79], v[192:195]
    ds_read_b64_tr_b16 a[240:241], v227 offset:0
    ds_read_b64_tr_b16 a[242:243], v227 offset:512
    v_mfma_f32_16x16x32_bf16 v[28:31], a[244:247], a[60:63], v[28:31]
    v_mfma_f32_16x16x32_bf16 v[76:79], a[244:247], a[64:67], v[76:79]
    s_waitcnt vmcnt(14)
    ds_read_b128 a[16:19], v225 offset:8192
    ds_read_b128 a[36:39], v226 offset:8192
    v_mfma_f32_16x16x32_bf16 v[124:127], a[244:247], a[68:71], v[124:127]
    v_mfma_f32_16x16x32_bf16 v[172:175], a[244:247], a[72:75], v[172:175]
    v_mfma_f32_16x16x32_bf16 v[196:199], a[244:247], a[76:79], v[196:199]
    s_waitcnt lgkmcnt(10)
    ds_read_b64_tr_b16 a[244:245], v227 offset:8
    ds_read_b64_tr_b16 a[246:247], v227 offset:520
    v_mfma_f32_16x16x32_bf16 v[32:35], a[248:251], a[60:63], v[32:35]
    v_mfma_f32_16x16x32_bf16 v[80:83], a[248:251], a[64:67], v[80:83]
    v_mfma_f32_16x16x32_bf16 v[128:131], a[248:251], a[68:71], v[128:131]
    v_mfma_f32_16x16x32_bf16 v[176:179], a[248:251], a[72:75], v[176:179]
    v_mfma_f32_16x16x32_bf16 v[200:203], a[248:251], a[76:79], v[200:203]
    s_waitcnt lgkmcnt(10)
    ds_read_b64_tr_b16 a[248:249], v228 offset:0
    ds_read_b64_tr_b16 a[250:251], v228 offset:512
    v_mfma_f32_16x16x32_bf16 v[36:39], a[252:255], a[60:63], v[36:39]
    v_mfma_f32_16x16x32_bf16 v[84:87], a[252:255], a[64:67], v[84:87]
    s_waitcnt lgkmcnt(4)
    buffer_load_dwordx4 v223, s[4:7], s38 offen lds
    v_mfma_f32_16x16x32_bf16 v[132:135], a[252:255], a[68:71], v[132:135]
    s_add_u32 m0, s40, 9216
    s_add_u32 s38, s28, 174080
    s_add_u32 s28, s28, 128
    v_mfma_f32_16x16x32_bf16 v[180:183], a[252:255], a[72:75], v[180:183]
    buffer_load_dwordx4 v223, s[4:7], s38 offen lds
    v_mfma_f32_16x16x32_bf16 v[204:207], a[252:255], a[76:79], v[204:207]
    ds_read_b64_tr_b16 a[252:253], v228 offset:8
    ds_read_b64_tr_b16 a[254:255], v228 offset:520
    v_mfma_f32_16x16x32_bf16 v[40:43], v[240:243], a[60:63], v[40:43]
    s_cmp_ge_u32 s28, 1280
    s_cselect_b32 s28, 0, s28
    v_mfma_f32_16x16x32_bf16 v[88:91], v[240:243], a[64:67], v[88:91]
    v_mfma_f32_16x16x32_bf16 v[136:139], v[240:243], a[68:71], v[136:139]
    v_mfma_f32_16x16x32_bf16 v[184:187], v[240:243], a[72:75], v[184:187]
    v_mfma_f32_16x16x32_bf16 v[208:211], v[240:243], a[76:79], v[208:211]
    ds_read_b64_tr_b16 v[240:241], v227 offset:1024
    ds_read_b64_tr_b16 v[242:243], v227 offset:1536
    v_mfma_f32_16x16x32_bf16 v[44:47], v[244:247], a[60:63], v[44:47]
    v_mfma_f32_16x16x32_bf16 v[92:95], v[244:247], a[64:67], v[92:95]
    v_mfma_f32_16x16x32_bf16 v[140:143], v[244:247], a[68:71], v[140:143]
    v_mfma_f32_16x16x32_bf16 v[188:191], v[244:247], a[72:75], v[188:191]
    v_mfma_f32_16x16x32_bf16 v[212:215], v[244:247], a[76:79], v[212:215]
    ds_read_b64_tr_b16 v[244:245], v227 offset:1032
    ds_read_b64_tr_b16 v[246:247], v227 offset:1544
    s_sub_u32 s43, s43, 1
    s_cbranch_scc0 K_ql1
    v_mfma_f32_16x16x32_bf16 v[0:3], a[240:243], a[0:3], v[0:3]
    s_add_u32 m0, s50, 0
    s_add_u32 s39, s32, s35
    s_add_u32 s51, s51, 1
    v_mfma_f32_16x16x32_bf16 v[48:51], a[240:243], a[4:7], v[48:51]
    s_cmp_eq_u32 s51, 4
    s_cselect_b32 s27, s46, 12288
    v_mfma_f32_16x16x32_bf16 v[96:99], a[240:243], a[8:11], v[96:99]
    s_cmp_eq_u32 s51, 4
    s_cselect_b32 s51, 0, s51
    v_mfma_f32_16x16x32_bf16 v[144:147], a[240:243], a[12:15], v[144:147]
    s_waitcnt lgkmcnt(8)
    ds_read_b64_tr_b16 a[240:241], v228 offset:1024
    ds_read_b64_tr_b16 a[242:243], v228 offset:1536
    v_mfma_f32_16x16x32_bf16 v[4:7], a[244:247], a[0:3], v[4:7]
    s_add_u32 s51, s51, 1
    v_mfma_f32_16x16x32_bf16 v[52:55], a[244:247], a[4:7], v[52:55]
    s_waitcnt vmcnt(13)
    s_barrier
    v_mfma_f32_16x16x32_bf16 v[100:103], a[244:247], a[8:11], v[100:103]
    buffer_load_dwordx4 v224, s[8:11], s29 offen lds
    v_mfma_f32_16x16x32_bf16 v[148:151], a[244:247], a[12:15], v[148:151]
    s_waitcnt lgkmcnt(8)
    s_add_u32 m0, s50, 896
    ds_read_b64_tr_b16 a[244:245], v228 offset:1032
    v_mfma_f32_16x16x32_bf16 v[8:11], a[248:251], a[0:3], v[8:11]
    buffer_load_dwordx4 v224, s[8:11], s29 offen offset:128 lds
    v_mfma_f32_16x16x32_bf16 v[56:59], a[248:251], a[4:7], v[56:59]
    s_add_u32 m0, s50, 1792
    ds_read_b64_tr_b16 a[246:247], v228 offset:1544
    s_add_u32 s50, s50, 12288
    v_mfma_f32_16x16x32_bf16 v[104:107], a[248:251], a[8:11], v[104:107]
    buffer_load_dwordx4 v224, s[8:11], s29 offen offset:256 lds
    v_mfma_f32_16x16x32_bf16 v[152:155], a[248:251], a[12:15], v[152:155]
    s_waitcnt lgkmcnt(8)
    s_cmp_eq_u32 s68, 0
    s_cbranch_scc1 K_s0_1
    s_cmp_lg_u32 s24, 0
    s_cbranch_scc1 K_s0_1
    v_mov_b32 v252, 1
    v_mov_b32 v254, 0
    s_mov_b64 exec, 1
    buffer_atomic_add v252, v254, s[76:79], s73 offen sc1
    s_lshl_b32 s74, 1, s2
    v_mov_b32 v231, s74
    s_lshr_b32 s74, s71, 1
    s_lshl_b32 s74, s74, 2
    buffer_atomic_or v231, v254, s[76:79], s74 offen offset:128 sc1
    s_mov_b64 exec, -1
K_s0_1:
    s_add_u32 m0, s33, 0
    s_mul_i32 s74, s68, 1769472
    v_mfma_f32_16x16x32_bf16 v[12:15], a[252:255], a[0:3], v[12:15]
    s_waitcnt vmcnt(14)
    s_add_u32 s20, s20, s74
    s_addc_u32 s21, s21, 0
    v_mfma_f32_16x16x32_bf16 v[60:63], a[252:255], a[4:7], v[60:63]
    s_mov_b32 s74, 40960
    ds_read_b128 a[40:43], v225 offset:0
    ds_read_b128 a[60:63], v226 offset:0
    v_mfma_f32_16x16x32_bf16 v[108:111], a[252:255], a[8:11], v[108:111]
    s_mov_b32 s22, 110592
    ds_read_b64_tr_b16 a[248:249], v227 offset:2048
    ds_read_b64_tr_b16 a[250:251], v227 offset:2560
    v_mfma_f32_16x16x32_bf16 v[156:159], a[252:255], a[12:15], v[156:159]
    s_waitcnt lgkmcnt(10)
    ds_read_b64_tr_b16 a[252:253], v227 offset:2056
    ds_read_b64_tr_b16 a[254:255], v227 offset:2568
    v_mfma_f32_16x16x32_bf16 v[16:19], v[240:243], a[0:3], v[16:19]
    s_add_u32 s29, s29, 393216
    v_add_u32 v227, s27, v227
    v_mfma_f32_16x16x32_bf16 v[64:67], v[240:243], a[4:7], v[64:67]
    s_cmp_ge_u32 s29, 7864320
    s_cselect_b32 s29, s49, s29
    v_mfma_f32_16x16x32_bf16 v[112:115], v[240:243], a[8:11], v[112:115]
    s_cmp_ge_u32 s50, 86016
    s_cselect_b32 s50, s41, s50
    v_mfma_f32_16x16x32_bf16 v[160:163], v[240:243], a[12:15], v[160:163]
    s_waitcnt lgkmcnt(10)
    ds_read_b64_tr_b16 v[240:241], v228 offset:2048
    ds_read_b64_tr_b16 v[242:243], v228 offset:2560
    v_mfma_f32_16x16x32_bf16 v[20:23], v[244:247], a[0:3], v[20:23]
    v_mfma_f32_16x16x32_bf16 v[68:71], v[244:247], a[4:7], v[68:71]
    v_mfma_f32_16x16x32_bf16 v[116:119], v[244:247], a[8:11], v[116:119]
    v_mfma_f32_16x16x32_bf16 v[164:167], v[244:247], a[12:15], v[164:167]
    s_waitcnt lgkmcnt(10)
    ds_read_b64_tr_b16 v[244:245], v228 offset:2056
    ds_read_b64_tr_b16 v[246:247], v228 offset:2568
    v_mfma_f32_16x16x32_bf16 v[24:27], a[240:243], a[0:3], v[24:27]
    v_add_u32 v228, s27, v228
    v_mfma_f32_16x16x32_bf16 v[72:75], a[240:243], a[4:7], v[72:75]
    s_cmp_eq_u32 s51, 4
    s_cselect_b32 s27, s46, 12288
    v_mfma_f32_16x16x32_bf16 v[120:123], a[240:243], a[8:11], v[120:123]
    s_cmp_eq_u32 s51, 4
    s_cselect_b32 s51, 0, s51
    v_mfma_f32_16x16x32_bf16 v[168:171], a[240:243], a[12:15], v[168:171]
    s_add_u32 s51, s51, 1
    v_mfma_f32_16x16x32_bf16 v[192:195], a[240:243], a[16:19], v[192:195]
    s_waitcnt lgkmcnt(10)
    ds_read_b64_tr_b16 a[240:241], v227 offset:0
    ds_read_b64_tr_b16 a[242:243], v227 offset:512
    v_mfma_f32_16x16x32_bf16 v[28:31], a[244:247], a[0:3], v[28:31]
    v_mfma_f32_16x16x32_bf16 v[76:79], a[244:247], a[4:7], v[76:79]
    s_waitcnt vmcnt(12)
    ds_read_b128 a[44:47], v225 offset:2048
    ds_read_b128 a[64:67], v226 offset:2048
    v_mfma_f32_16x16x32_bf16 v[124:127], a[244:247], a[8:11], v[124:127]
    v_mfma_f32_16x16x32_bf16 v[172:175], a[244:247], a[12:15], v[172:175]
    v_mfma_f32_16x16x32_bf16 v[196:199], a[244:247], a[16:19], v[196:199]
    s_waitcnt lgkmcnt(10)
    ds_read_b64_tr_b16 a[244:245], v227 offset:8
    ds_read_b64_tr_b16 a[246:247], v227 offset:520
    v_mfma_f32_16x16x32_bf16 v[32:35], a[248:251], a[0:3], v[32:35]
    v_mfma_f32_16x16x32_bf16 v[80:83], a[248:251], a[4:7], v[80:83]
    v_mfma_f32_16x16x32_bf16 v[128:131], a[248:251], a[8:11], v[128:131]
    buffer_load_dwordx4 a[100:103], v248, s[12:15], s74 offen
    v_mfma_f32_16x16x32_bf16 v[176:179], a[248:251], a[12:15], v[176:179]
    v_mfma_f32_16x16x32_bf16 v[200:203], a[248:251], a[16:19], v[200:203]
    s_waitcnt lgkmcnt(10)
    ds_read_b64_tr_b16 a[248:249], v228 offset:0
    ds_read_b64_tr_b16 a[250:251], v228 offset:512
    v_mfma_f32_16x16x32_bf16 v[36:39], a[252:255], a[0:3], v[36:39]
    v_mfma_f32_16x16x32_bf16 v[84:87], a[252:255], a[4:7], v[84:87]
    buffer_load_dwordx4 a[100:103], v248, s[16:19], s74 offen
    v_mfma_f32_16x16x32_bf16 v[132:135], a[252:255], a[8:11], v[132:135]
    v_mfma_f32_16x16x32_bf16 v[180:183], a[252:255], a[12:15], v[180:183]
    v_mfma_f32_16x16x32_bf16 v[204:207], a[252:255], a[16:19], v[204:207]
    s_waitcnt lgkmcnt(10)
    ds_read_b64_tr_b16 a[252:253], v228 offset:8
    ds_read_b64_tr_b16 a[254:255], v228 offset:520
    v_mfma_f32_16x16x32_bf16 v[40:43], v[240:243], a[0:3], v[40:43]
    buffer_load_dwordx4 a[100:103], v248, s[12:15], s74 offen offset:1024
    v_mfma_f32_16x16x32_bf16 v[88:91], v[240:243], a[4:7], v[88:91]
    v_mfma_f32_16x16x32_bf16 v[136:139], v[240:243], a[8:11], v[136:139]
    v_mfma_f32_16x16x32_bf16 v[184:187], v[240:243], a[12:15], v[184:187]
    v_mfma_f32_16x16x32_bf16 v[208:211], v[240:243], a[16:19], v[208:211]
    s_waitcnt lgkmcnt(10)
    s_waitcnt vmcnt(13)
    ds_read_b128 a[48:51], v225 offset:4096
    v_mfma_f32_16x16x32_bf16 v[44:47], v[244:247], a[0:3], v[44:47]
    buffer_load_dwordx4 a[100:103], v248, s[16:19], s74 offen offset:1024
    v_mfma_f32_16x16x32_bf16 v[92:95], v[244:247], a[4:7], v[92:95]
    ds_read_b128 a[68:71], v226 offset:4096
    ds_read_b64_tr_b16 v[240:241], v227 offset:1024
    v_mfma_f32_16x16x32_bf16 v[140:143], v[244:247], a[8:11], v[140:143]
    ds_read_b64_tr_b16 v[242:243], v227 offset:1536
    v_mfma_f32_16x16x32_bf16 v[188:191], v[244:247], a[12:15], v[188:191]
    buffer_load_dwordx4 a[100:103], v248, s[12:15], s74 offen offset:2048
    v_mfma_f32_16x16x32_bf16 v[212:215], v[244:247], a[16:19], v[212:215]
    s_waitcnt lgkmcnt(12)
    ds_read_b64_tr_b16 v[244:245], v227 offset:1032
    ds_read_b64_tr_b16 v[246:247], v227 offset:1544
    v_mfma_f32_16x16x32_bf16 v[0:3], a[240:243], a[20:23], v[0:3]
    v_mfma_f32_16x16x32_bf16 v[48:51], a[240:243], a[24:27], v[48:51]
    v_mfma_f32_16x16x32_bf16 v[96:99], a[240:243], a[28:31], v[96:99]
    buffer_load_dwordx4 a[100:103], v248, s[16:19], s74 offen offset:2048
    v_mfma_f32_16x16x32_bf16 v[144:147], a[240:243], a[32:35], v[144:147]
    s_waitcnt lgkmcnt(10)
    ds_read_b64_tr_b16 a[240:241], v228 offset:1024
    ds_read_b64_tr_b16 a[242:243], v228 offset:1536
    v_mfma_f32_16x16x32_bf16 v[4:7], a[244:247], a[20:23], v[4:7]
    v_mfma_f32_16x16x32_bf16 v[52:55], a[244:247], a[24:27], v[52:55]
    s_waitcnt vmcnt(13)
    s_barrier
    v_mfma_f32_16x16x32_bf16 v[100:103], a[244:247], a[28:31], v[100:103]
    buffer_load_dwordx4 a[100:103], v248, s[12:15], s74 offen offset:3072
    v_mfma_f32_16x16x32_bf16 v[148:151], a[244:247], a[32:35], v[148:151]
    s_waitcnt lgkmcnt(10)
    ds_read_b64_tr_b16 a[244:245], v228 offset:1032
    ds_read_b64_tr_b16 a[246:247], v228 offset:1544
    v_mfma_f32_16x16x32_bf16 v[8:11], a[248:251], a[20:23], v[8:11]
    v_mfma_f32_16x16x32_bf16 v[56:59], a[248:251], a[24:27], v[56:59]
    v_mfma_f32_16x16x32_bf16 v[104:107], a[248:251], a[28:31], v[104:107]
    buffer_load_dwordx4 a[100:103], v248, s[16:19], s74 offen offset:3072
    v_mfma_f32_16x16x32_bf16 v[152:155], a[248:251], a[32:35], v[152:155]
    s_waitcnt lgkmcnt(10)
    s_mov_b32 s74, 49152
    ds_read_b64_tr_b16 a[248:249], v227 offset:2048
    v_mfma_f32_16x16x32_bf16 v[12:15], a[252:255], a[20:23], v[12:15]
    s_waitcnt vmcnt(13)
    ds_read_b128 a[52:55], v225 offset:6144
    ds_read_b128 a[72:75], v226 offset:6144
    v_mfma_f32_16x16x32_bf16 v[60:63], a[252:255], a[24:27], v[60:63]
    ds_read_b64_tr_b16 a[250:251], v227 offset:2560
    v_mfma_f32_16x16x32_bf16 v[108:111], a[252:255], a[28:31], v[108:111]
    buffer_load_dwordx4 a[100:103], v248, s[12:15], s74 offen
    v_mfma_f32_16x16x32_bf16 v[156:159], a[252:255], a[32:35], v[156:159]
    s_waitcnt lgkmcnt(10)
    ds_read_b64_tr_b16 a[252:253], v227 offset:2056
    ds_read_b64_tr_b16 a[254:255], v227 offset:2568
    v_mfma_f32_16x16x32_bf16 v[16:19], v[240:243], a[20:23], v[16:19]
    v_add_u32 v227, s27, v227
    v_mfma_f32_16x16x32_bf16 v[64:67], v[240:243], a[24:27], v[64:67]
    v_mfma_f32_16x16x32_bf16 v[112:115], v[240:243], a[28:31], v[112:115]
    buffer_load_dwordx4 a[100:103], v248, s[16:19], s74 offen
    v_mfma_f32_16x16x32_bf16 v[160:163], v[240:243], a[32:35], v[160:163]
    s_waitcnt lgkmcnt(10)
    ds_read_b64_tr_b16 v[240:241], v228 offset:2048
    ds_read_b64_tr_b16 v[242:243], v228 offset:2560
    v_mfma_f32_16x16x32_bf16 v[20:23], v[244:247], a[20:23], v[20:23]
    v_mfma_f32_16x16x32_bf16 v[68:71], v[244:247], a[24:27], v[68:71]
    v_mfma_f32_16x16x32_bf16 v[116:119], v[244:247], a[28:31], v[116:119]
    buffer_load_dwordx4 a[100:103], v248, s[12:15], s74 offen offset:1024
    v_mfma_f32_16x16x32_bf16 v[164:167], v[244:247], a[32:35], v[164:167]
    s_waitcnt lgkmcnt(10)
    ds_read_b64_tr_b16 v[244:245], v228 offset:2056
    ds_read_b64_tr_b16 v[246:247], v228 offset:2568
    v_mfma_f32_16x16x32_bf16 v[24:27], a[240:243], a[20:23], v[24:27]
    v_add_u32 v228, s27, v228
    v_mfma_f32_16x16x32_bf16 v[72:75], a[240:243], a[24:27], v[72:75]
    s_cmp_eq_u32 s51, 4
    s_cselect_b32 s27, s46, 12288
    v_mfma_f32_16x16x32_bf16 v[120:123], a[240:243], a[28:31], v[120:123]
    s_mov_b32 s46, s32
    buffer_load_dwordx4 a[100:103], v248, s[16:19], s74 offen offset:1024
    v_mfma_f32_16x16x32_bf16 v[168:171], a[240:243], a[32:35], v[168:171]
    s_cmp_eq_u32 s51, 4
    s_cselect_b32 s51, 0, s51
    v_mfma_f32_16x16x32_bf16 v[192:195], a[240:243], a[36:39], v[192:195]
    s_waitcnt lgkmcnt(10)
    ds_read_b64_tr_b16 a[240:241], v227 offset:0
    ds_read_b64_tr_b16 a[242:243], v227 offset:512
    v_mfma_f32_16x16x32_bf16 v[28:31], a[244:247], a[20:23], v[28:31]
    v_mfma_f32_16x16x32_bf16 v[76:79], a[244:247], a[24:27], v[76:79]
    s_waitcnt vmcnt(15)
    buffer_load_dwordx4 a[100:103], v248, s[12:15], s74 offen offset:2048
    v_mfma_f32_16x16x32_bf16 v[124:127], a[244:247], a[28:31], v[124:127]
    ds_read_b128 a[56:59], v225 offset:8192
    ds_read_b128 a[76:79], v226 offset:8192
    v_mfma_f32_16x16x32_bf16 v[172:175], a[244:247], a[32:35], v[172:175]
    v_mfma_f32_16x16x32_bf16 v[196:199], a[244:247], a[36:39], v[196:199]
    s_waitcnt lgkmcnt(10)
    ds_read_b64_tr_b16 a[244:245], v227 offset:8
    ds_read_b64_tr_b16 a[246:247], v227 offset:520
    v_mfma_f32_16x16x32_bf16 v[32:35], a[248:251], a[20:23], v[32:35]
    buffer_load_dwordx4 a[100:103], v248, s[16:19], s74 offen offset:2048
    v_mfma_f32_16x16x32_bf16 v[80:83], a[248:251], a[24:27], v[80:83]
    v_mfma_f32_16x16x32_bf16 v[128:131], a[248:251], a[28:31], v[128:131]
    v_mfma_f32_16x16x32_bf16 v[176:179], a[248:251], a[32:35], v[176:179]
    v_mfma_f32_16x16x32_bf16 v[200:203], a[248:251], a[36:39], v[200:203]
    s_waitcnt lgkmcnt(10)
    buffer_load_dwordx4 a[100:103], v248, s[12:15], s74 offen offset:3072
    v_mfma_f32_16x16x32_bf16 v[36:39], a[252:255], a[20:23], v[36:39]
    ds_read_b64_tr_b16 a[248:249], v228 offset:0
    ds_read_b64_tr_b16 a[250:251], v228 offset:512
    v_mfma_f32_16x16x32_bf16 v[84:87], a[252:255], a[24:27], v[84:87]
    v_mfma_f32_16x16x32_bf16 v[132:135], a[252:255], a[28:31], v[132:135]
    v_mfma_f32_16x16x32_bf16 v[180:183], a[252:255], a[32:35], v[180:183]
    buffer_load_dwordx4 a[100:103], v248, s[16:19], s74 offen offset:3072
    v_mfma_f32_16x16x32_bf16 v[204:207], a[252:255], a[36:39], v[204:207]
    s_waitcnt lgkmcnt(10)
    ds_read_b64_tr_b16 a[252:253], v228 offset:8
    ds_read_b64_tr_b16 a[254:255], v228 offset:520
    v_mfma_f32_16x16x32_bf16 v[40:43], v[240:243], a[20:23], v[40:43]
    v_mfma_f32_16x16x32_bf16 v[88:91], v[240:243], a[24:27], v[88:91]
    v_mfma_f32_16x16x32_bf16 v[136:139], v[240:243], a[28:31], v[136:139]
    v_mfma_f32_16x16x32_bf16 v[184:187], v[240:243], a[32:35], v[184:187]
    v_mfma_f32_16x16x32_bf16 v[208:211], v[240:243], a[36:39], v[208:211]
    s_waitcnt lgkmcnt(10)
    ds_read_b64_tr_b16 v[240:241], v227 offset:1024
    ds_read_b64_tr_b16 v[242:243], v227 offset:1536
    v_mfma_f32_16x16x32_bf16 v[44:47], v[244:247], a[20:23], v[44:47]
    v_mfma_f32_16x16x32_bf16 v[92:95], v[244:247], a[24:27], v[92:95]
    v_mfma_f32_16x16x32_bf16 v[140:143], v[244:247], a[28:31], v[140:143]
    v_mfma_f32_16x16x32_bf16 v[188:191], v[244:247], a[32:35], v[188:191]
    v_mfma_f32_16x16x32_bf16 v[212:215], v[244:247], a[36:39], v[212:215]
    s_waitcnt lgkmcnt(10)
    ds_read_b64_tr_b16 v[244:245], v227 offset:1032
    ds_read_b64_tr_b16 v[246:247], v227 offset:1544
    v_mfma_f32_16x16x32_bf16 v[0:3], a[240:243], a[40:43], v[0:3]
    v_mfma_f32_16x16x32_bf16 v[48:51], a[240:243], a[44:47], v[48:51]
    v_mfma_f32_16x16x32_bf16 v[96:99], a[240:243], a[48:51], v[96:99]
    v_mfma_f32_16x16x32_bf16 v[144:147], a[240:243], a[52:55], v[144:147]
    s_waitcnt lgkmcnt(8)
    ds_read_b64_tr_b16 a[240:241], v228 offset:1024
    ds_read_b64_tr_b16 a[242:243], v228 offset:1536
    v_mfma_f32_16x16x32_bf16 v[4:7], a[244:247], a[40:43], v[4:7]
    v_mfma_f32_16x16x32_bf16 v[52:55], a[244:247], a[44:47], v[52:55]
    s_waitcnt vmcnt(16)
    s_barrier
    v_mfma_f32_16x16x32_bf16 v[100:103], a[244:247], a[48:51], v[100:103]
    buffer_load_dwordx4 v216, s[12:15], s30 offen nt lds
    v_mfma_f32_16x16x32_bf16 v[148:151], a[244:247], a[52:55], v[148:151]
    s_waitcnt lgkmcnt(8)
    ds_read_b64_tr_b16 a[244:245], v228 offset:1032
    ds_read_b64_tr_b16 a[246:247], v228 offset:1544
    v_mfma_f32_16x16x32_bf16 v[8:11], a[248:251], a[40:43], v[8:11]
    v_mfma_f32_16x16x32_bf16 v[56:59], a[248:251], a[44:47], v[56:59]
    v_mfma_f32_16x16x32_bf16 v[104:107], a[248:251], a[48:51], v[104:107]
    v_mfma_f32_16x16x32_bf16 v[152:155], a[248:251], a[52:55], v[152:155]
    s_waitcnt lgkmcnt(8)
    ds_read_b64_tr_b16 a[248:249], v227 offset:2048
    ds_read_b64_tr_b16 a[250:251], v227 offset:2560
    v_mfma_f32_16x16x32_bf16 v[12:15], a[252:255], a[40:43], v[12:15]
    buffer_load_dwordx4 v216, s[12:15], s30 offen offset:3072 nt lds
    v_mfma_f32_16x16x32_bf16 v[60:63], a[252:255], a[44:47], v[60:63]
    s_add_u32 m0, s33, 896
    v_mfma_f32_16x16x32_bf16 v[108:111], a[252:255], a[48:51], v[108:111]
    v_mfma_f32_16x16x32_bf16 v[156:159], a[252:255], a[52:55], v[156:159]
    s_waitcnt lgkmcnt(8)
    ds_read_b64_tr_b16 a[252:253], v227 offset:2056
    ds_read_b64_tr_b16 a[254:255], v227 offset:2568
    v_mfma_f32_16x16x32_bf16 v[16:19], v[240:243], a[40:43], v[16:19]
    v_add_u32 v227, s27, v227
    v_mfma_f32_16x16x32_bf16 v[64:67], v[240:243], a[44:47], v[64:67]
    v_mfma_f32_16x16x32_bf16 v[112:115], v[240:243], a[48:51], v[112:115]
    buffer_load_dwordx4 v216, s[12:15], s30 offen offset:128 nt lds
    v_mfma_f32_16x16x32_bf16 v[160:163], v[240:243], a[52:55], v[160:163]
    s_waitcnt lgkmcnt(8)
    ds_read_b64_tr_b16 v[240:241], v228 offset:2048
    ds_read_b64_tr_b16 v[242:243], v228 offset:2560
    v_mfma_f32_16x16x32_bf16 v[20:23], v[244:247], a[40:43], v[20:23]
    v_mfma_f32_16x16x32_bf16 v[68:71], v[244:247], a[44:47], v[68:71]
    v_mfma_f32_16x16x32_bf16 v[116:119], v[244:247], a[48:51], v[116:119]
    v_mfma_f32_16x16x32_bf16 v[164:167], v[244:247], a[52:55], v[164:167]
    s_waitcnt lgkmcnt(8)
    ds_read_b64_tr_b16 v[244:245], v228 offset:2056
    ds_read_b64_tr_b16 v[246:247], v228 offset:2568
    v_mfma_f32_16x16x32_bf16 v[24:27], a[240:243], a[40:43], v[24:27]
    buffer_load_dwordx4 v216, s[12:15], s30 offen offset:3200 nt lds
    v_mfma_f32_16x16x32_bf16 v[72:75], a[240:243], a[44:47], v[72:75]
    s_add_u32 m0, s33, 1792
    v_add_u32 v228, s27, v228
    v_mfma_f32_16x16x32_bf16 v[120:123], a[240:243], a[48:51], v[120:123]
    v_mfma_f32_16x16x32_bf16 v[168:171], a[240:243], a[52:55], v[168:171]
    v_mfma_f32_16x16x32_bf16 v[192:195], a[240:243], a[56:59], v[192:195]
    s_waitcnt lgkmcnt(8)
    ds_read_b64_tr_b16 a[240:241], v227 offset:0
    ds_read_b64_tr_b16 a[242:243], v227 offset:512
    v_mfma_f32_16x16x32_bf16 v[28:31], a[244:247], a[40:43], v[28:31]
    v_mfma_f32_16x16x32_bf16 v[76:79], a[244:247], a[44:47], v[76:79]
    buffer_load_dwordx4 v216, s[12:15], s30 offen offset:256 nt lds
    v_mfma_f32_16x16x32_bf16 v[124:127], a[244:247], a[48:51], v[124:127]
    v_mfma_f32_16x16x32_bf16 v[172:175], a[244:247], a[52:55], v[172:175]
    v_mfma_f32_16x16x32_bf16 v[196:199], a[244:247], a[56:59], v[196:199]
    s_waitcnt lgkmcnt(8)
    ds_read_b64_tr_b16 a[244:245], v227 offset:8
    ds_read_b64_tr_b16 a[246:247], v227 offset:520
    v_mfma_f32_16x16x32_bf16 v[32:35], a[248:251], a[40:43], v[32:35]
    v_mfma_f32_16x16x32_bf16 v[80:83], a[248:251], a[44:47], v[80:83]
    v_mfma_f32_16x16x32_bf16 v[128:131], a[248:251], a[48:51], v[128:131]
    buffer_load_dwordx4 v216, s[12:15], s30 offen offset:3328 nt lds
    v_mfma_f32_16x16x32_bf16 v[176:179], a[248:251], a[52:55], v[176:179]
    s_add_u32 m0, s39, 0
    s_add_u32 s30, s30, 12288
    v_mfma_f32_16x16x32_bf16 v[200:203], a[248:251], a[56:59], v[200:203]
    s_waitcnt lgkmcnt(8)
    ds_read_b64_tr_b16 a[248:249], v228 offset:0
    ds_read_b64_tr_b16 a[250:251], v228 offset:512
    v_mfma_f32_16x16x32_bf16 v[36:39], a[252:255], a[40:43], v[36:39]
    s_cmp_ge_u32 s30, 196608
    s_cselect_b32 s30, 6144, s30
    v_mfma_f32_16x16x32_bf16 v[84:87], a[252:255], a[44:47], v[84:87]
    v_mfma_f32_16x16x32_bf16 v[132:135], a[252:255], a[48:51], v[132:135]
    v_mfma_f32_16x16x32_bf16 v[180:183], a[252:255], a[52:55], v[180:183]
    v_mfma_f32_16x16x32_bf16 v[204:207], a[252:255], a[56:59], v[204:207]
    s_waitcnt lgkmcnt(8)
    ds_read_b64_tr_b16 a[252:253], v228 offset:8
    ds_read_b64_tr_b16 a[254:255], v228 offset:520
    v_mfma_f32_16x16x32_bf16 v[40:43], v[240:243], a[40:43], v[40:43]
    v_mfma_f32_16x16x32_bf16 v[88:91], v[240:243], a[44:47], v[88:91]
    buffer_load_dwordx4 v216, s[16:19], s31 offen nt lds
    v_mfma_f32_16x16x32_bf16 v[136:139], v[240:243], a[48:51], v[136:139]
    v_mfma_f32_16x16x32_bf16 v[184:187], v[240:243], a[52:55], v[184:187]
    v_mfma_f32_16x16x32_bf16 v[208:211], v[240:243], a[56:59], v[208:211]
    s_waitcnt lgkmcnt(8)
    ds_read_b64_tr_b16 v[240:241], v227 offset:1024
    ds_read_b64_tr_b16 v[242:243], v227 offset:1536
    v_mfma_f32_16x16x32_bf16 v[44:47], v[244:247], a[40:43], v[44:47]
    v_mfma_f32_16x16x32_bf16 v[92:95], v[244:247], a[44:47], v[92:95]
    v_mfma_f32_16x16x32_bf16 v[140:143], v[244:247], a[48:51], v[140:143]
    buffer_load_dwordx4 v216, s[16:19], s31 offen offset:3072 nt lds
    v_mfma_f32_16x16x32_bf16 v[188:191], v[244:247], a[52:55], v[188:191]
    s_add_u32 m0, s39, 896
    v_mfma_f32_16x16x32_bf16 v[212:215], v[244:247], a[56:59], v[212:215]
    s_waitcnt lgkmcnt(8)
    ds_read_b64_tr_b16 v[244:245], v227 offset:1032
    ds_read_b64_tr_b16 v[246:247], v227 offset:1544
    v_mfma_f32_16x16x32_bf16 v[0:3], a[240:243], a[60:63], v[0:3]
    v_mfma_f32_16x16x32_bf16 v[48:51], a[240:243], a[64:67], v[48:51]
    v_mfma_f32_16x16x32_bf16 v[96:99], a[240:243], a[68:71], v[96:99]
    v_mfma_f32_16x16x32_bf16 v[144:147], a[240:243], a[72:75], v[144:147]
    s_waitcnt lgkmcnt(8)
    v_mul_f32 v0, s42, v0
    v_mul_f32 v1, s42, v1
    v_mfma_f32_16x16x32_bf16 v[4:7], a[244:247], a[60:63], v[4:7]
    v_mul_f32 v2, s42, v2
    v_mul_f32 v3, s42, v3
    v_mfma_f32_16x16x32_bf16 v[52:55], a[244:247], a[64:67], v[52:55]
    v_cvt_pk_bf16_f32 v0, v0, v1
    v_cvt_pk_bf16_f32 v1, v2, v3
    v_mfma_f32_16x16x32_bf16 v[100:103], a[244:247], a[68:71], v[100:103]
    buffer_load_dwordx4 v216, s[16:19], s31 offen offset:128 nt lds
    v_mfma_f32_16x16x32_bf16 v[148:151], a[244:247], a[72:75], v[148:151]
    s_waitcnt lgkmcnt(6)
    v_mul_f32 v6, s42, v6
    v_mul_f32 v7, s42, v7
    v_mfma_f32_16x16x32_bf16 v[8:11], a[248:251], a[60:63], v[8:11]
    v_cvt_pk_bf16_f32 v3, v6, v7
    v_mul_f32 v54, s42, v54
    v_mfma_f32_16x16x32_bf16 v[56:59], a[248:251], a[64:67], v[56:59]
    v_mul_f32 v55, s42, v55
    v_mul_f32 v4, s42, v4
    v_mfma_f32_16x16x32_bf16 v[104:107], a[248:251], a[68:71], v[104:107]
    buffer_load_dwordx4 v216, s[16:19], s31 offen offset:3200 nt lds
    v_mfma_f32_16x16x32_bf16 v[152:155], a[248:251], a[72:75], v[152:155]
    s_waitcnt lgkmcnt(4)
    s_add_u32 m0, s39, 1792
    s_add_u32 s39, s33, s35
    v_mfma_f32_16x16x32_bf16 v[12:15], a[252:255], a[60:63], v[12:15]
    v_mul_f32 v56, s42, v56
    v_mul_f32 v57, s42, v57
    v_mfma_f32_16x16x32_bf16 v[60:63], a[252:255], a[64:67], v[60:63]
    v_mul_f32 v58, s42, v58
    v_mul_f32 v59, s42, v59
    v_mfma_f32_16x16x32_bf16 v[108:111], a[252:255], a[68:71], v[108:111]
    v_mul_f32 v5, s42, v5
    v_cvt_pk_bf16_f32 v2, v4, v5
    v_mfma_f32_16x16x32_bf16 v[156:159], a[252:255], a[72:75], v[156:159]
    s_waitcnt lgkmcnt(2)
    v_mul_f32 v12, s42, v12
    v_mul_f32 v13, s42, v13
    v_mfma_f32_16x16x32_bf16 v[16:19], v[240:243], a[60:63], v[16:19]
    v_mul_f32 v14, s42, v14
    v_mul_f32 v15, s42, v15
    v_mfma_f32_16x16x32_bf16 v[64:67], v[240:243], a[64:67], v[64:67]
    v_cvt_pk_bf16_f32 v6, v12, v13
    v_cvt_pk_bf16_f32 v7, v14, v15
    v_mfma_f32_16x16x32_bf16 v[112:115], v[240:243], a[68:71], v[112:115]
    v_mul_f32 v110, s42, v110
    v_mul_f32 v111, s42, v111
    v_mfma_f32_16x16x32_bf16 v[160:163], v[240:243], a[72:75], v[160:163]
    s_waitcnt lgkmcnt(0)
    buffer_load_dwordx4 v216, s[16:19], s31 offen offset:256 nt lds
    v_mfma_f32_16x16x32_bf16 v[20:23], v[244:247], a[60:63], v[20:23]
    v_mul_f32 v8, s42, v8
    v_mul_f32 v9, s42, v9
    v_mfma_f32_16x16x32_bf16 v[68:71], v[244:247], a[64:67], v[68:71]
    v_mul_f32 v112, s42, v112
    v_mul_f32 v113, s42, v113
    v_mfma_f32_16x16x32_bf16 v[116:119], v[244:247], a[68:71], v[116:119]
    v_mul_f32 v114, s42, v114
    v_mul_f32 v115, s42, v115
    v_mfma_f32_16x16x32_bf16 v[164:167], v[244:247], a[72:75], v[164:167]
    buffer_load_dwordx4 v216, s[16:19], s31 offen offset:3328 nt lds
    s_add_u32 s31, s31, 12288
    s_add_u32 m0, s39, 0
    s_cmp_ge_u32 s31, 196608
    s_cselect_b32 s31, 6144, s31
    v_mul_f32 v116, s42, v116
    v_mul_f32 v117, s42, v117
    v_mul_f32 v118, s42, v118
    v_mul_f32 v119, s42, v119
    v_mul_f32 v108, s42, v108
    v_mul_f32 v109, s42, v109
    v_mul_f32 v10, s42, v10
    v_mul_f32 v11, s42, v11
    v_cvt_pk_bf16_f32 v4, v8, v9
    v_mul_f32 v16, s42, v16
    v_mul_f32 v17, s42, v17
    v_mul_f32 v18, s42, v18
    v_mul_f32 v19, s42, v19
    v_cvt_pk_bf16_f32 v5, v10, v11
    v_mul_f32 v20, s42, v20
    v_mul_f32 v21, s42, v21
    v_mul_f32 v48, s42, v48
    v_mul_f32 v49, s42, v49
    v_mul_f32 v50, s42, v50
    v_mul_f32 v51, s42, v51
    v_cvt_pk_bf16_f32 v8, v16, v17
    v_cvt_pk_bf16_f32 v9, v18, v19
    v_mul_f32 v22, s42, v22
    v_mul_f32 v23, s42, v23
    v_mul_f32 v52, s42, v52
    v_mul_f32 v53, s42, v53
    v_cvt_pk_bf16_f32 v10, v20, v21
    v_mul_f32 v96, s42, v96
    v_mul_f32 v97, s42, v97
    v_mul_f32 v98, s42, v98
    v_mul_f32 v99, s42, v99
    v_mul_f32 v60, s42, v60
    v_mul_f32 v61, s42, v61
    v_mul_f32 v100, s42, v100
    v_mul_f32 v101, s42, v101
    v_mul_f32 v102, s42, v102
    v_mul_f32 v103, s42, v103
    v_mul_f32 v62, s42, v62
    v_mul_f32 v63, s42, v63
    v_mul_f32 v64, s42, v64
    v_mul_f32 v65, s42, v65
    v_mul_f32 v66, s42, v66
    v_mul_f32 v67, s42, v67
    v_mul_f32 v68, s42, v68
    v_mul_f32 v69, s42, v69
    v_cvt_pk_bf16_f32 v11, v22, v23
    v_mul_f32 v104, s42, v104
    v_mul_f32 v105, s42, v105
    v_mul_f32 v106, s42, v106
    v_mul_f32 v107, s42, v107
    ds_read_b64_tr_b16 a[240:241], v228 offset:1024
    ds_read_b64_tr_b16 a[242:243], v228 offset:1536
    ds_read_b64_tr_b16 a[244:245], v228 offset:1032
    ds_read_b64_tr_b16 a[246:247], v228 offset:1544
    ds_read_b64_tr_b16 a[248:249], v227 offset:2048
    ds_read_b64_tr_b16 a[250:251], v227 offset:2560
    ds_read_b64_tr_b16 v[240:241], v228 offset:2048
    ds_read_b64_tr_b16 v[242:243], v228 offset:2560
    ds_read_b64_tr_b16 a[252:253], v227 offset:2056
    ds_read_b64_tr_b16 a[254:255], v227 offset:2568
    ds_read_b64_tr_b16 v[244:245], v228 offset:2056
    ds_read_b64_tr_b16 v[246:247], v228 offset:2568
    v_mul_f32 v144, s42, v144
    v_mul_f32 v145, s42, v145
    v_mul_f32 v146, s42, v146
    v_mul_f32 v147, s42, v147
    v_mul_f32 v148, s42, v148
    v_mul_f32 v149, s42, v149
    v_mul_f32 v150, s42, v150
    v_mul_f32 v151, s42, v151
    v_mul_f32 v152, s42, v152
    v_mul_f32 v153, s42, v153
    v_mul_f32 v154, s42, v154
    v_mul_f32 v155, s42, v155
    v_mul_f32 v156, s42, v156
    v_mul_f32 v157, s42, v157
    v_mul_f32 v158, s42, v158
    v_mul_f32 v159, s42, v159
    v_mul_f32 v70, s42, v70
    v_mul_f32 v71, s42, v71
    v_mul_f32 v160, s42, v160
    v_mul_f32 v161, s42, v161
    v_mul_f32 v162, s42, v162
    v_mul_f32 v163, s42, v163
    v_mul_f32 v164, s42, v164
    v_mul_f32 v165, s42, v165
    v_mul_f32 v166, s42, v166
    s_waitcnt lgkmcnt(10)
    v_mfma_f32_16x16x32_bf16 v[24:27], a[240:243], a[60:63], v[24:27]
    v_mul_f32 v167, s42, v167
    v_mfma_f32_16x16x32_bf16 v[72:75], a[240:243], a[64:67], v[72:75]
    v_mfma_f32_16x16x32_bf16 v[120:123], a[240:243], a[68:71], v[120:123]
    v_mfma_f32_16x16x32_bf16 v[168:171], a[240:243], a[72:75], v[168:171]
    v_mul_f32 v26, s42, v26
    v_mul_f32 v27, s42, v27
    v_mfma_f32_16x16x32_bf16 v[192:195], a[240:243], a[76:79], v[192:195]
    s_waitcnt lgkmcnt(8)
    v_cvt_pk_bf16_f32 v13, v26, v27
    v_cvt_pk_bf16_f32 v27, v54, v55
    v_mfma_f32_16x16x32_bf16 v[28:31], a[244:247], a[60:63], v[28:31]
    v_cvt_pk_bf16_f32 v55, v110, v111
    v_mul_f32 v24, s42, v24
    v_mfma_f32_16x16x32_bf16 v[76:79], a[244:247], a[64:67], v[76:79]
    v_mul_f32 v25, s42, v25
    v_cvt_pk_bf16_f32 v54, v108, v109
    v_mfma_f32_16x16x32_bf16 v[124:127], a[244:247], a[68:71], v[124:127]
    v_mul_f32 v192, s42, v192
    v_mul_f32 v193, s42, v193
    v_mfma_f32_16x16x32_bf16 v[172:175], a[244:247], a[72:75], v[172:175]
    v_mul_f32 v28, s42, v28
    v_mul_f32 v29, s42, v29
    v_mfma_f32_16x16x32_bf16 v[196:199], a[244:247], a[76:79], v[196:199]
    s_waitcnt lgkmcnt(6)
    v_cvt_pk_bf16_f32 v14, v28, v29
    v_cvt_pk_bf16_f32 v28, v56, v57
    v_mfma_f32_16x16x32_bf16 v[32:35], a[248:251], a[60:63], v[32:35]
    v_cvt_pk_bf16_f32 v56, v112, v113
    v_cvt_pk_bf16_f32 v57, v114, v115
    v_mfma_f32_16x16x32_bf16 v[80:83], a[248:251], a[64:67], v[80:83]
    v_cvt_pk_bf16_f32 v29, v58, v59
    v_cvt_pk_bf16_f32 v58, v116, v117
    v_mfma_f32_16x16x32_bf16 v[128:131], a[248:251], a[68:71], v[128:131]
    v_mul_f32 v196, s42, v196
    v_mul_f32 v197, s42, v197
    v_mfma_f32_16x16x32_bf16 v[176:179], a[248:251], a[72:75], v[176:179]
    v_cvt_pk_bf16_f32 v110, v196, v197
    v_cvt_pk_bf16_f32 v59, v118, v119
    v_mfma_f32_16x16x32_bf16 v[200:203], a[248:251], a[76:79], v[200:203]
    s_waitcnt lgkmcnt(2)
    v_mul_f32 v194, s42, v194
    v_mul_f32 v195, s42, v195
    v_mfma_f32_16x16x32_bf16 v[36:39], a[252:255], a[60:63], v[36:39]
    v_mul_f32 v198, s42, v198
    v_mul_f32 v199, s42, v199
    v_mfma_f32_16x16x32_bf16 v[84:87], a[252:255], a[64:67], v[84:87]
    v_cvt_pk_bf16_f32 v12, v24, v25
    v_mul_f32 v30, s42, v30
    v_mfma_f32_16x16x32_bf16 v[132:135], a[252:255], a[68:71], v[132:135]
    v_mul_f32 v200, s42, v200
    v_mul_f32 v201, s42, v201
    v_mfma_f32_16x16x32_bf16 v[180:183], a[252:255], a[72:75], v[180:183]
    v_cvt_pk_bf16_f32 v112, v200, v201
    v_mul_f32 v202, s42, v202
    v_mfma_f32_16x16x32_bf16 v[204:207], a[252:255], a[76:79], v[204:207]
    v_mul_f32 v203, s42, v203
    v_mul_f32 v31, s42, v31
    v_mfma_f32_16x16x32_bf16 v[40:43], v[240:243], a[60:63], v[40:43]
    v_mul_f32 v32, s42, v32
    v_mul_f32 v33, s42, v33
    v_mfma_f32_16x16x32_bf16 v[88:91], v[240:243], a[64:67], v[88:91]
    v_cvt_pk_bf16_f32 v108, v192, v193
    v_cvt_pk_bf16_f32 v109, v194, v195
    v_mfma_f32_16x16x32_bf16 v[136:139], v[240:243], a[68:71], v[136:139]
    v_mul_f32 v204, s42, v204
    v_mul_f32 v205, s42, v205
    v_mfma_f32_16x16x32_bf16 v[184:187], v[240:243], a[72:75], v[184:187]
    v_cvt_pk_bf16_f32 v114, v204, v205
    v_mul_f32 v206, s42, v206
    v_mfma_f32_16x16x32_bf16 v[208:211], v[240:243], a[76:79], v[208:211]
    s_waitcnt lgkmcnt(0)
    v_mul_f32 v207, s42, v207
    v_cvt_pk_bf16_f32 v111, v198, v199
    v_mfma_f32_16x16x32_bf16 v[44:47], v[244:247], a[60:63], v[44:47]
    v_cvt_pk_bf16_f32 v113, v202, v203
    v_cvt_pk_bf16_f32 v115, v206, v207
    v_mfma_f32_16x16x32_bf16 v[92:95], v[244:247], a[64:67], v[92:95]
    v_mul_f32 v36, s42, v36
    v_mul_f32 v37, s42, v37
    v_mfma_f32_16x16x32_bf16 v[140:143], v[244:247], a[68:71], v[140:143]
    v_mul_f32 v208, s42, v208
    v_mul_f32 v209, s42, v209
    v_mfma_f32_16x16x32_bf16 v[188:191], v[244:247], a[72:75], v[188:191]
    v_cvt_pk_bf16_f32 v116, v208, v209
    v_mul_f32 v210, s42, v210
    v_mfma_f32_16x16x32_bf16 v[212:215], v[244:247], a[76:79], v[212:215]
    s_barrier
    buffer_load_dwordx4 v216, s[16:19], s31 offen nt lds
    buffer_load_dwordx4 v216, s[16:19], s31 offen offset:3072 nt lds
    s_add_u32 m0, s39, 896
    v_mov_b32 v230, 0
    buffer_load_dwordx4 v216, s[16:19], s31 offen offset:128 nt lds
    buffer_load_dwordx4 v216, s[16:19], s31 offen offset:3200 nt lds
    s_nop 0
    v_mul_f32 v212, s42, v212
    v_mul_f32 v213, s42, v213
    v_cvt_pk_bf16_f32 v118, v212, v213
    v_mul_f32 v211, s42, v211
    v_mul_f32 v214, s42, v214
    v_mul_f32 v215, s42, v215
    v_mov_b32 v231, 0
    v_cvt_pk_bf16_f32 v117, v210, v211
    s_add_u32 m0, s39, 1792
    v_cvt_pk_bf16_f32 v119, v214, v215
    buffer_load_dwordx4 v216, s[16:19], s31 offen offset:256 nt lds
    buffer_load_dwordx4 v216, s[16:19], s31 offen offset:3328 nt lds
    v_mul_f32 v34, s42, v34
    v_mul_f32 v35, s42, v35
    v_mul_f32 v38, s42, v38
    v_mul_f32 v39, s42, v39
    v_mul_f32 v40, s42, v40
    v_mul_f32 v41, s42, v41
    v_mov_b32 v232, 0
    v_cvt_pk_bf16_f32 v24, v48, v49
    v_mul_f32 v42, s42, v42
    v_mul_f32 v43, s42, v43
    v_cvt_pk_bf16_f32 v15, v30, v31
    v_cvt_pk_bf16_f32 v25, v50, v51
    v_cvt_pk_bf16_f32 v16, v32, v33
    ds_write_b128 v229, v[108:111] offset:3072
    ds_write_b128 v229, v[112:115] offset:4096
    ds_write_b128 v229, v[116:119] offset:5120
    v_cvt_pk_bf16_f32 v18, v36, v37
    v_mul_f32 v72, s42, v72
    v_mul_f32 v73, s42, v73
    v_mul_f32 v74, s42, v74
    v_mul_f32 v75, s42, v75
    v_cvt_pk_bf16_f32 v17, v34, v35
    v_mul_f32 v44, s42, v44
    v_mul_f32 v45, s42, v45
    v_cvt_pk_bf16_f32 v26, v52, v53
    v_cvt_pk_bf16_f32 v19, v38, v39
    v_mul_f32 v76, s42, v76
    v_mul_f32 v77, s42, v77
    v_mul_f32 v78, s42, v78
    v_mul_f32 v79, s42, v79
    v_cvt_pk_bf16_f32 v20, v40, v41
    v_mul_f32 v80, s42, v80
    v_mul_f32 v81, s42, v81
    v_mul_f32 v82, s42, v82
    v_mul_f32 v83, s42, v83
    v_mul_f32 v46, s42, v46
    v_mul_f32 v47, s42, v47
    v_cvt_pk_bf16_f32 v48, v96, v97
    v_cvt_pk_bf16_f32 v49, v98, v99
    v_cvt_pk_bf16_f32 v21, v42, v43
    v_mul_f32 v84, s42, v84
    v_mul_f32 v85, s42, v85
    v_mul_f32 v86, s42, v86
    v_mul_f32 v87, s42, v87
    v_mov_b32 v233, 0
    v_cvt_pk_bf16_f32 v30, v60, v61
    v_mul_f32 v120, s42, v120
    v_mul_f32 v121, s42, v121
    v_mul_f32 v122, s42, v122
    v_mul_f32 v123, s42, v123
    v_cvt_pk_bf16_f32 v50, v100, v101
    v_cvt_pk_bf16_f32 v51, v102, v103
    v_cvt_pk_bf16_f32 v31, v62, v63
    v_mul_f32 v124, s42, v124
    v_mul_f32 v125, s42, v125
    v_mul_f32 v126, s42, v126
    v_mul_f32 v127, s42, v127
    v_cvt_pk_bf16_f32 v32, v64, v65
    v_mul_f32 v128, s42, v128
    s_waitcnt lgkmcnt(0)
    s_waitcnt vmcnt(34)
    v_mul_f32 v129, s42, v129
    s_barrier
    v_mul_f32 v130, s42, v130
    s_add_u32 m0, s34, 0
    v_mul_f32 v131, s42, v131
    v_cvt_pk_bf16_f32 v36, v72, v73
    v_cvt_pk_bf16_f32 v37, v74, v75
    v_cvt_pk_bf16_f32 v33, v66, v67
    v_mul_f32 v132, s42, v132
    v_mul_f32 v133, s42, v133
    v_mul_f32 v134, s42, v134
    v_mul_f32 v135, s42, v135
    v_cvt_pk_bf16_f32 v34, v68, v69
    v_mul_f32 v136, s42, v136
    v_mul_f32 v137, s42, v137
    v_mul_f32 v138, s42, v138
    v_mul_f32 v139, s42, v139
    v_cvt_pk_bf16_f32 v22, v44, v45
    v_mul_f32 v88, s42, v88
    v_mul_f32 v89, s42, v89
    v_cvt_pk_bf16_f32 v52, v104, v105
    v_cvt_pk_bf16_f32 v53, v106, v107
    v_mul_f32 v90, s42, v90
    v_mul_f32 v91, s42, v91
    v_cvt_pk_bf16_f32 v38, v76, v77
    v_cvt_pk_bf16_f32 v39, v78, v79
    v_cvt_pk_bf16_f32 v40, v80, v81
    v_cvt_pk_bf16_f32 v41, v82, v83
    v_cvt_pk_bf16_f32 v23, v46, v47
    v_mul_f32 v92, s42, v92
    v_mul_f32 v93, s42, v93
    ds_read_b128 a[240:243], v217 offset:0
    v_mul_f32 v94, s42, v94
    v_mul_f32 v95, s42, v95
    ds_read_b128 v[96:99], v229 offset:0
    ds_read_b128 a[244:247], v218 offset:0
    v_cvt_pk_bf16_f32 v42, v84, v85
    v_mul_f32 v168, s42, v168
    v_mul_f32 v169, s42, v169
    v_mul_f32 v170, s42, v170
    v_mul_f32 v171, s42, v171
    v_cvt_pk_bf16_f32 v43, v86, v87
    v_mul_f32 v172, s42, v172
    v_mul_f32 v173, s42, v173
    v_mul_f32 v174, s42, v174
    v_mul_f32 v175, s42, v175
    ds_read_b128 a[248:251], v217 offset:1024
    ds_read_b128 v[240:243], v217 offset:2048
    v_cvt_pk_bf16_f32 v60, v120, v121
    v_cvt_pk_bf16_f32 v61, v122, v123
    ds_read_b128 v[100:103], v229 offset:1024
    v_cvt_pk_bf16_f32 v62, v124, v125
    v_cvt_pk_bf16_f32 v63, v126, v127
    v_cvt_pk_bf16_f32 v64, v128, v129
    v_cvt_pk_bf16_f32 v65, v130, v131
    v_cvt_pk_bf16_f32 v72, v144, v145
    v_cvt_pk_bf16_f32 v73, v146, v147
    v_cvt_pk_bf16_f32 v74, v148, v149
    v_cvt_pk_bf16_f32 v75, v150, v151
    ds_read_b128 a[252:255], v218 offset:1024
    v_cvt_pk_bf16_f32 v66, v132, v133
    v_cvt_pk_bf16_f32 v67, v134, v135
    ds_read_b128 v[244:247], v218 offset:2048
    v_cvt_pk_bf16_f32 v68, v136, v137
    v_cvt_pk_bf16_f32 v69, v138, v139
    v_cvt_pk_bf16_f32 v44, v88, v89
    v_mul_f32 v176, s42, v176
    s_waitcnt lgkmcnt(7)
    v_mfma_f32_16x16x32_bf16 v[120:123], a[240:243], v[0:3], 0
    v_mul_f32 v177, s42, v177
    ds_read_b128 v[104:107], v229 offset:2048
    v_mfma_f32_16x16x32_bf16 v[124:127], a[240:243], v[24:27], 0
    s_sub_u32 s36, s32, s34
    v_mul_f32 v178, s42, v178
    v_mul_f32 v179, s42, v179
    v_mfma_f32_16x16x32_bf16 v[128:131], a[240:243], v[48:51], 0
    s_mov_b32 s37, s36
    v_cvt_pk_bf16_f32 v45, v90, v91
    v_mul_f32 v180, s42, v180
    v_mfma_f32_16x16x32_bf16 v[132:135], a[240:243], v[72:75], 0
    s_waitcnt lgkmcnt(7)
    v_mul_f32 v181, s42, v181
    v_mul_f32 v182, s42, v182
    v_mfma_f32_16x16x32_bf16 v[136:139], a[240:243], v[96:99], 0
    s_waitcnt lgkmcnt(6)
    v_mul_f32 v183, s42, v183
    v_cvt_pk_bf16_f32 v76, v152, v153
    v_mfma_f32_16x16x32_bf16 v[120:123], a[244:247], v[4:7], v[120:123]
    s_add_u32 s31, s31, 12288
    v_cvt_pk_bf16_f32 v77, v154, v155
    v_cvt_pk_bf16_f32 v78, v156, v157
    v_mfma_f32_16x16x32_bf16 v[124:127], a[244:247], v[28:31], v[124:127]
    v_cvt_pk_bf16_f32 v79, v158, v159
    v_cvt_pk_bf16_f32 v35, v70, v71
    v_mfma_f32_16x16x32_bf16 v[128:131], a[244:247], v[52:55], v[128:131]
    v_cvt_pk_bf16_f32 v80, v160, v161
    v_cvt_pk_bf16_f32 v81, v162, v163
    v_mfma_f32_16x16x32_bf16 v[132:135], a[244:247], v[76:79], v[132:135]
    s_waitcnt lgkmcnt(3)
    v_cvt_pk_bf16_f32 v82, v164, v165
    v_cvt_pk_bf16_f32 v83, v166, v167
    v_mfma_f32_16x16x32_bf16 v[136:139], a[244:247], v[100:103], v[136:139]
    v_mul_f32 v140, s42, v140
    v_mul_f32 v141, s42, v141
    v_mfma_f32_16x16x32_bf16 v[120:123], a[248:251], v[8:11], v[120:123]
    v_mul_f32 v142, s42, v142
    v_mul_f32 v143, s42, v143
    v_mfma_f32_16x16x32_bf16 v[124:127], a[248:251], v[32:35], v[124:127]
    v_cvt_pk_bf16_f32 v46, v92, v93
    v_mul_f32 v184, s42, v184
    v_mfma_f32_16x16x32_bf16 v[128:131], a[248:251], v[56:59], v[128:131]
    v_mul_f32 v185, s42, v185
    v_mul_f32 v186, s42, v186
    v_mfma_f32_16x16x32_bf16 v[132:135], a[248:251], v[80:83], v[132:135]
    s_waitcnt lgkmcnt(0)
    v_mul_f32 v187, s42, v187
    v_cvt_pk_bf16_f32 v47, v94, v95
    v_mfma_f32_16x16x32_bf16 v[136:139], a[248:251], v[104:107], v[136:139]
    v_mul_f32 v188, s42, v188
    v_mul_f32 v189, s42, v189
    v_mfma_f32_16x16x32_bf16 v[120:123], a[252:255], v[12:15], v[120:123]
    v_mul_f32 v190, s42, v190
    v_mul_f32 v191, s42, v191
    v_mfma_f32_16x16x32_bf16 v[124:127], a[252:255], v[36:39], v[124:127]
    v_cvt_pk_bf16_f32 v84, v168, v169
    v_cvt_pk_bf16_f32 v85, v170, v171
    v_mfma_f32_16x16x32_bf16 v[128:131], a[252:255], v[60:63], v[128:131]
    v_cvt_pk_bf16_f32 v86, v172, v173
    v_cvt_pk_bf16_f32 v87, v174, v175
    ds_read_b128 a[240:243], v217 offset:6144
    v_cvt_pk_bf16_f32 v88, v176, v177
    v_mfma_f32_16x16x32_bf16 v[132:135], a[252:255], v[84:87], v[132:135]
    v_cvt_pk_bf16_f32 v89, v178, v179
    v_cvt_pk_bf16_f32 v90, v180, v181
    v_mfma_f32_16x16x32_bf16 v[136:139], a[252:255], v[108:111], v[136:139]
    v_cvt_pk_bf16_f32 v91, v182, v183
    ds_read_b128 a[248:251], v217 offset:7168
    v_mfma_f32_16x16x32_bf16 v[120:123], v[240:243], v[16:19], v[120:123]
    ds_read_b128 a[244:247], v218 offset:6144
    ds_read_b128 a[252:255], v218 offset:7168
    v_mfma_f32_16x16x32_bf16 v[124:127], v[240:243], v[40:43], v[124:127]
    v_cvt_pk_bf16_f32 v70, v140, v141
    v_cvt_pk_bf16_f32 v71, v142, v143
    v_mfma_f32_16x16x32_bf16 v[128:131], v[240:243], v[64:67], v[128:131]
    v_cvt_pk_bf16_f32 v92, v184, v185
    v_cvt_pk_bf16_f32 v93, v186, v187
    v_mfma_f32_16x16x32_bf16 v[132:135], v[240:243], v[88:91], v[132:135]
    v_cvt_pk_bf16_f32 v94, v188, v189
    v_cvt_pk_bf16_f32 v95, v190, v191
    v_mfma_f32_16x16x32_bf16 v[136:139], v[240:243], v[112:115], v[136:139]
    ds_read_b128 v[240:243], v217 offset:8192
    v_add_u32 v217, s36, v217
    v_mfma_f32_16x16x32_bf16 v[120:123], v[244:247], v[20:23], v[120:123]
    v_mov_b32 v234, 0
    v_accvgpr_write_b32 a192, 0
    v_mfma_f32_16x16x32_bf16 v[124:127], v[244:247], v[44:47], v[124:127]
    v_accvgpr_write_b32 a193, 0
    v_accvgpr_write_b32 a194, 0
    v_mfma_f32_16x16x32_bf16 v[128:131], v[244:247], v[68:71], v[128:131]
    v_accvgpr_write_b32 a195, 0
    v_accvgpr_write_b32 a196, 0
    v_mfma_f32_16x16x32_bf16 v[132:135], v[244:247], v[92:95], v[132:135]
    v_max3_f32 v196, v120, v121, v122
    v_max3_f32 v196, v196, v123, v235
    v_mfma_f32_16x16x32_bf16 v[136:139], v[244:247], v[116:119], v[136:139]
    s_waitcnt lgkmcnt(4)
    v_max3_f32 v200, v124, v125, v126
    v_max3_f32 v200, v200, v127, v236
    v_mfma_f32_16x16x32_bf16 v[140:143], a[240:243], v[0:3], 0
    s_waitcnt vmcnt(34)
    s_barrier
    v_max3_f32 v204, v128, v129, v130
    v_mfma_f32_16x16x32_bf16 v[144:147], a[240:243], v[24:27], 0
    v_mov_b32 v197, v196
    v_mov_b32 v201, v200
    v_mfma_f32_16x16x32_bf16 v[148:151], a[240:243], v[48:51], 0
    v_max3_f32 v204, v204, v131, v237
    v_max3_f32 v208, v132, v133, v134
    v_mfma_f32_16x16x32_bf16 v[152:155], a[240:243], v[72:75], 0
    v_permlane32_swap_b32 v196, v197
    v_mfma_f32_16x16x32_bf16 v[156:159], a[240:243], v[96:99], 0
    s_waitcnt lgkmcnt(2)
    v_permlane32_swap_b32 v200, v201
    v_mfma_f32_16x16x32_bf16 v[140:143], a[244:247], v[4:7], v[140:143]
    v_mov_b32 v205, v204
    v_max3_f32 v208, v208, v135, v238
    v_mfma_f32_16x16x32_bf16 v[144:147], a[244:247], v[28:31], v[144:147]
    v_max_f32 v196, v196, v197
    v_max_f32 v200, v200, v201
    v_mfma_f32_16x16x32_bf16 v[148:151], a[244:247], v[52:55], v[148:151]
    v_permlane32_swap_b32 v204, v205
    v_mfma_f32_16x16x32_bf16 v[152:155], a[244:247], v[76:79], v[152:155]
    v_mov_b32 v209, v208
    v_mov_b32 v197, v196
    v_mfma_f32_16x16x32_bf16 v[156:159], a[244:247], v[100:103], v[156:159]
    v_mov_b32 v201, v200
    v_max_f32 v204, v204, v205
    v_mfma_f32_16x16x32_bf16 v[140:143], a[248:251], v[8:11], v[140:143]
    v_permlane32_swap_b32 v208, v209
    v_mfma_f32_16x16x32_bf16 v[144:147], a[248:251], v[32:35], v[144:147]
    v_permlane16_swap_b32 v196, v197
    v_mfma_f32_16x16x32_bf16 v[148:151], a[248:251], v[56:59], v[148:151]
    v_permlane16_swap_b32 v200, v201
    v_mfma_f32_16x16x32_bf16 v[152:155], a[248:251], v[80:83], v[152:155]
    v_mov_b32 v205, v204
    v_max_f32 v208, v208, v209
    v_mfma_f32_16x16x32_bf16 v[156:159], a[248:251], v[104:107], v[156:159]
    s_waitcnt lgkmcnt(1)
    v_max_f32 v196, v196, v197
    v_max_f32 v200, v200, v201
    v_mfma_f32_16x16x32_bf16 v[140:143], a[252:255], v[12:15], v[140:143]
    v_permlane16_swap_b32 v204, v205
    v_mfma_f32_16x16x32_bf16 v[144:147], a[252:255], v[36:39], v[144:147]
    v_mov_b32 v209, v208
    v_sub_f32 v197, 0, v196
    v_mfma_f32_16x16x32_bf16 v[148:151], a[252:255], v[60:63], v[148:151]
    v_sub_f32 v201, 0, v200
    v_max_f32 v204, v204, v205
    v_mfma_f32_16x16x32_bf16 v[152:155], a[252:255], v[84:87], v[152:155]
    v_permlane16_swap_b32 v208, v209
    v_mfma_f32_16x16x32_bf16 v[156:159], a[252:255], v[108:111], v[156:159]
    s_waitcnt lgkmcnt(0)
    v_add_f32 v120, v120, v197
    v_add_f32 v124, v124, v201
    v_mfma_f32_16x16x32_bf16 v[140:143], v[240:243], v[16:19], v[140:143]
    v_max3_f32 v212, v136, v137, v138
    v_sub_f32 v205, 0, v204
    v_mfma_f32_16x16x32_bf16 v[144:147], v[240:243], v[40:43], v[144:147]
    v_max_f32 v208, v208, v209
    v_add_f32 v121, v121, v197
    v_mfma_f32_16x16x32_bf16 v[148:151], v[240:243], v[64:67], v[148:151]
    v_exp_f32 v120, v120
    v_mfma_f32_16x16x32_bf16 v[152:155], v[240:243], v[88:91], v[152:155]
    v_add_f32 v125, v125, v201
    v_max3_f32 v212, v212, v139, v239
    v_mfma_f32_16x16x32_bf16 v[156:159], v[240:243], v[112:115], v[156:159]
    v_exp_f32 v124, v124
    v_add_f32 v128, v128, v205
    v_sub_f32 v209, 0, v208
    v_add_f32 v122, v122, v197
    v_exp_f32 v121, v121
    v_add_f32 v230, v230, v120
    v_exp_f32 v125, v125
    v_add_f32 v126, v126, v201
    v_add_f32 v231, v231, v124
    v_mov_b32 v213, v212
    v_exp_f32 v128, v128
    v_add_f32 v129, v129, v205
    v_add_f32 v132, v132, v209
    v_exp_f32 v122, v122
    v_add_f32 v123, v123, v197
    v_add_f32 v230, v230, v121
    v_add_f32 v127, v127, v201
    v_exp_f32 v126, v126
    v_add_f32 v231, v231, v125
    v_permlane32_swap_b32 v212, v213
    v_add_f32 v130, v130, v205
    v_exp_f32 v129, v129
    v_add_f32 v232, v232, v128
    v_exp_f32 v132, v132
    v_add_f32 v133, v133, v209
    v_exp_f32 v123, v123
    v_add_f32 v230, v230, v122
    v_exp_f32 v127, v127
    v_add_f32 v231, v231, v126
    v_max_f32 v212, v212, v213
    v_add_f32 v131, v131, v205
    v_exp_f32 v130, v130
    v_add_f32 v232, v232, v129
    v_add_f32 v134, v134, v209
    v_exp_f32 v133, v133
    v_add_f32 v233, v233, v132
    v_add_f32 v230, v230, v123
    v_add_f32 v231, v231, v127
    v_mov_b32 v213, v212
    v_exp_f32 v131, v131
    v_add_f32 v232, v232, v130
    v_add_f32 v135, v135, v209
    v_exp_f32 v134, v134
    v_add_f32 v233, v233, v133
    v_permlane16_swap_b32 v212, v213
    ds_read_b128 v[244:247], v218 offset:8192
    v_add_f32 v232, v232, v131
    v_exp_f32 v135, v135
    v_add_f32 v233, v233, v134
    v_max_f32 v212, v212, v213
    v_add_u32 v218, s36, v218
    v_sub_f32 v198, 0, v196
    v_sub_f32 v199, 0, v196
    v_sub_f32 v202, 0, v200
    v_sub_f32 v203, 0, v200
    v_add_f32 v233, v233, v135
    v_sub_f32 v206, 0, v204
    v_sub_f32 v207, 0, v204
    v_sub_f32 v210, 0, v208
    v_sub_f32 v211, 0, v208
    ds_read_b128 a[240:243], v217 offset:0
    v_sub_f32 v213, 0, v212
    v_sub_f32 v214, 0, v212
    v_sub_f32 v215, 0, v212
    ds_read_b128 a[244:247], v218 offset:0
    v_sub_f32 v196, 0, v196
    v_cvt_pk_bf16_f32 v160, v120, v121
    v_cvt_pk_bf16_f32 v161, v122, v123
    ds_read_b128 a[248:251], v217 offset:1024
    v_sub_f32 v200, 0, v200
    v_cvt_pk_bf16_f32 v164, v124, v125
    v_cvt_pk_bf16_f32 v165, v126, v127
    v_sub_f32 v204, 0, v204
    v_cvt_pk_bf16_f32 v168, v128, v129
    v_cvt_pk_bf16_f32 v169, v130, v131
    v_sub_f32 v208, 0, v208
    v_cvt_pk_bf16_f32 v172, v132, v133
    v_cvt_pk_bf16_f32 v173, v134, v135
    v_sub_f32 v212, 0, v212
    v_add_f32 v136, v136, v213
    s_waitcnt lgkmcnt(3)
    v_mfma_f32_16x16x32_bf16 v[140:143], v[244:247], v[20:23], v[140:143]
    v_add_f32 v137, v137, v213
    v_add_f32 v138, v138, v213
    v_mfma_f32_16x16x32_bf16 v[144:147], v[244:247], v[44:47], v[144:147]
    s_sub_u32 s36, s33, s32
    v_add_f32 v139, v139, v213
    ds_read_b128 a[252:255], v218 offset:1024
    v_mfma_f32_16x16x32_bf16 v[148:151], v[244:247], v[68:71], v[148:151]
    s_mov_b32 s32, s33
    ds_read_b128 v[240:243], v217 offset:2048
    v_accvgpr_write_b32 a197, 0
    v_mfma_f32_16x16x32_bf16 v[152:155], v[244:247], v[92:95], v[152:155]
    s_mov_b32 s33, s34
    v_add_f32 v140, v140, v197
    v_add_f32 v141, v141, v197
    v_mfma_f32_16x16x32_bf16 v[156:159], v[244:247], v[116:119], v[156:159]
    s_waitcnt lgkmcnt(4)
    s_barrier
    v_add_f32 v144, v144, v201
    v_mfma_f32_16x16x32_bf16 v[120:123], a[240:243], v[0:3], v[196:199]
    s_add_u32 s39, s33, s35
    buffer_load_dwordx4 v216, s[12:15], s30 offen nt lds
    v_mfma_f32_16x16x32_bf16 v[124:127], a[240:243], v[24:27], v[200:203]
    v_exp_f32 v140, v140
    v_mfma_f32_16x16x32_bf16 v[128:131], a[240:243], v[48:51], v[204:207]
    buffer_load_dwordx4 v216, s[12:15], s30 offen offset:3072 nt lds
    v_mfma_f32_16x16x32_bf16 v[132:135], a[240:243], v[72:75], v[208:211]
    s_add_u32 m0, s34, 896
    v_add_f32 v145, v145, v201
    v_add_f32 v148, v148, v205
    v_mfma_f32_16x16x32_bf16 v[136:139], a[240:243], v[96:99], v[212:215]
    s_waitcnt lgkmcnt(3)
    v_exp_f32 v144, v144
    v_mfma_f32_16x16x32_bf16 v[120:123], a[244:247], v[4:7], v[120:123]
    v_add_f32 v142, v142, v197
    v_add_f32 v146, v146, v201
    v_mfma_f32_16x16x32_bf16 v[124:127], a[244:247], v[28:31], v[124:127]
    v_exp_f32 v141, v141
    v_mfma_f32_16x16x32_bf16 v[128:131], a[244:247], v[52:55], v[128:131]
    v_add_f32 v230, v230, v140
    v_add_f32 v231, v231, v144
    v_mfma_f32_16x16x32_bf16 v[132:135], a[244:247], v[76:79], v[132:135]
    buffer_load_dwordx4 v216, s[12:15], s30 offen offset:128 nt lds
    v_mfma_f32_16x16x32_bf16 v[136:139], a[244:247], v[100:103], v[136:139]
    s_waitcnt lgkmcnt(2)
    v_exp_f32 v145, v145
    v_mfma_f32_16x16x32_bf16 v[120:123], a[248:251], v[8:11], v[120:123]
    v_exp_f32 v148, v148
    v_mfma_f32_16x16x32_bf16 v[124:127], a[248:251], v[32:35], v[124:127]
    v_add_f32 v149, v149, v205
    v_add_f32 v152, v152, v209
    v_mfma_f32_16x16x32_bf16 v[128:131], a[248:251], v[56:59], v[128:131]
    v_add_f32 v143, v143, v197
    v_add_f32 v147, v147, v201
    v_mfma_f32_16x16x32_bf16 v[132:135], a[248:251], v[80:83], v[132:135]
    v_exp_f32 v142, v142
    v_mfma_f32_16x16x32_bf16 v[136:139], a[248:251], v[104:107], v[136:139]
    s_waitcnt lgkmcnt(1)
    v_exp_f32 v146, v146
    v_mfma_f32_16x16x32_bf16 v[120:123], a[252:255], v[12:15], v[120:123]
    v_add_f32 v230, v230, v141
    v_add_f32 v231, v231, v145
    v_mfma_f32_16x16x32_bf16 v[124:127], a[252:255], v[36:39], v[124:127]
    buffer_load_dwordx4 v216, s[12:15], s30 offen offset:3200 nt lds
    v_mfma_f32_16x16x32_bf16 v[128:131], a[252:255], v[60:63], v[128:131]
    s_add_u32 m0, s34, 1792
    v_add_f32 v150, v150, v205
    v_add_f32 v232, v232, v148
    v_mfma_f32_16x16x32_bf16 v[132:135], a[252:255], v[84:87], v[132:135]
    s_mov_b32 s34, s46
    v_exp_f32 v149, v149
    v_mfma_f32_16x16x32_bf16 v[136:139], a[252:255], v[108:111], v[136:139]
    s_waitcnt lgkmcnt(0)
    v_exp_f32 v152, v152
    v_mfma_f32_16x16x32_bf16 v[120:123], v[240:243], v[16:19], v[120:123]
    buffer_load_dwordx4 v216, s[12:15], s30 offen offset:256 nt lds
    buffer_load_dwordx4 v216, s[12:15], s30 offen offset:3328 nt lds
    v_mfma_f32_16x16x32_bf16 v[124:127], v[240:243], v[40:43], v[124:127]
    s_add_u32 s30, s30, 12288
    v_add_f32 v153, v153, v209
    v_add_f32 v230, v230, v142
    v_mfma_f32_16x16x32_bf16 v[128:131], v[240:243], v[64:67], v[128:131]
    s_add_u32 m0, s46, 0
    v_exp_f32 v143, v143
    v_mfma_f32_16x16x32_bf16 v[132:135], v[240:243], v[88:91], v[132:135]
    v_exp_f32 v147, v147
    v_mfma_f32_16x16x32_bf16 v[136:139], v[240:243], v[112:115], v[136:139]
    s_waitcnt vmcnt(3)
    s_barrier
    v_add_f32 v231, v231, v146
    v_exp_f32 v150, v150
    v_add_f32 v151, v151, v205
    v_add_f32 v232, v232, v149
    v_add_f32 v154, v154, v209
    v_exp_f32 v153, v153
    v_add_f32 v233, v233, v152
    v_add_f32 v230, v230, v143
    v_add_f32 v231, v231, v147
    v_exp_f32 v151, v151
    v_add_f32 v232, v232, v150
    v_add_f32 v155, v155, v209
    v_exp_f32 v154, v154
    v_add_f32 v233, v233, v153
    s_cmp_ge_u32 s30, 196608
    s_cselect_b32 s30, 6144, s30
    v_add_f32 v232, v232, v151
    ds_read_b128 v[244:247], v218 offset:2048
    v_exp_f32 v155, v155
    v_add_f32 v233, v233, v154
    ds_read_b128 a[240:243], v217 offset:6144
    ds_read_b128 a[244:247], v218 offset:6144
    ds_read_b128 a[248:251], v217 offset:7168
    v_cvt_pk_bf16_f32 v162, v140, v141
    v_cvt_pk_bf16_f32 v163, v142, v143
    v_cvt_pk_bf16_f32 v166, v144, v145
    v_cvt_pk_bf16_f32 v167, v146, v147
    v_add_f32 v233, v233, v155
    v_cvt_pk_bf16_f32 v170, v148, v149
    v_cvt_pk_bf16_f32 v171, v150, v151
    ds_read_b128 a[252:255], v218 offset:7168
    v_cvt_pk_bf16_f32 v174, v152, v153
    v_cvt_pk_bf16_f32 v175, v154, v155
    ds_read_b128 v[240:243], v217 offset:8192
    v_add_f32 v156, v156, v213
    v_add_f32 v157, v157, v213
    v_add_f32 v158, v158, v213
    v_add_f32 v159, v159, v213
    v_add_u32 v217, s36, v217
    v_accvgpr_write_b32 a198, 0
    v_accvgpr_write_b32 a199, 0
    v_accvgpr_write_b32 a200, 0
    v_accvgpr_write_b32 a201, 0
    v_accvgpr_write_b32 a202, 0
    v_accvgpr_write_b32 a203, 0
    v_accvgpr_write_b32 a204, 0
    v_accvgpr_write_b32 a205, 0
    v_accvgpr_write_b32 a206, 0
    v_accvgpr_write_b32 a207, 0
    v_accvgpr_write_b32 a208, 0
    v_accvgpr_write_b32 a209, 0
    v_accvgpr_write_b32 a210, 0
    s_waitcnt lgkmcnt(5)
    v_mfma_f32_16x16x32_bf16 v[120:123], v[244:247], v[20:23], v[120:123]
    v_accvgpr_write_b32 a211, 0
    v_accvgpr_write_b32 a212, 0
    v_mfma_f32_16x16x32_bf16 v[124:127], v[244:247], v[44:47], v[124:127]
    v_accvgpr_write_b32 a213, 0
    v_accvgpr_write_b32 a214, 0
    v_mfma_f32_16x16x32_bf16 v[128:131], v[244:247], v[68:71], v[128:131]
    v_accvgpr_write_b32 a215, 0
    v_accvgpr_write_b32 a216, 0
    v_mfma_f32_16x16x32_bf16 v[132:135], v[244:247], v[92:95], v[132:135]
    v_exp_f32 v120, v120
    v_mfma_f32_16x16x32_bf16 v[136:139], v[244:247], v[116:119], v[136:139]
    s_waitcnt lgkmcnt(4)
    v_exp_f32 v124, v124
    v_mfma_f32_16x16x32_bf16 v[140:143], a[240:243], v[0:3], v[196:199]
    v_exp_f32 v121, v121
    v_mfma_f32_16x16x32_bf16 v[144:147], a[240:243], v[24:27], v[200:203]
    v_exp_f32 v125, v125
    v_mfma_f32_16x16x32_bf16 v[148:151], a[240:243], v[48:51], v[204:207]
    v_add_f32 v230, v230, v120
    v_add_f32 v231, v231, v124
    v_mfma_f32_16x16x32_bf16 v[152:155], a[240:243], v[72:75], v[208:211]
    v_exp_f32 v128, v128
    v_mfma_f32_16x16x32_bf16 v[156:159], a[240:243], v[96:99], v[212:215]
    s_waitcnt lgkmcnt(3)
    v_exp_f32 v122, v122
    v_mfma_f32_16x16x32_bf16 v[140:143], a[244:247], v[4:7], v[140:143]
    v_exp_f32 v126, v126
    v_mfma_f32_16x16x32_bf16 v[144:147], a[244:247], v[28:31], v[144:147]
    v_add_f32 v230, v230, v121
    v_add_f32 v231, v231, v125
    v_mfma_f32_16x16x32_bf16 v[148:151], a[244:247], v[52:55], v[148:151]
    v_exp_f32 v129, v129
    v_mfma_f32_16x16x32_bf16 v[152:155], a[244:247], v[76:79], v[152:155]
    v_add_f32 v232, v232, v128
    ds_read_b128 v[244:247], v218 offset:8192
    v_mfma_f32_16x16x32_bf16 v[156:159], a[244:247], v[100:103], v[156:159]
    s_waitcnt lgkmcnt(3)
    v_exp_f32 v132, v132
    v_mfma_f32_16x16x32_bf16 v[140:143], a[248:251], v[8:11], v[140:143]
    s_cmp_eq_u32 s43, 0
    s_cselect_b32 s14, 0, s14
    v_mfma_f32_16x16x32_bf16 v[144:147], a[248:251], v[32:35], v[144:147]
    v_exp_f32 v123, v123
    v_mfma_f32_16x16x32_bf16 v[148:151], a[248:251], v[56:59], v[148:151]
    v_add_f32 v230, v230, v122
    ds_read_b64_tr_b16 a[240:241], v219 offset:0
    v_mfma_f32_16x16x32_bf16 v[152:155], a[248:251], v[80:83], v[152:155]
    v_exp_f32 v127, v127
    v_mfma_f32_16x16x32_bf16 v[156:159], a[248:251], v[104:107], v[156:159]
    s_waitcnt lgkmcnt(3)
    v_exp_f32 v130, v130
    v_mfma_f32_16x16x32_bf16 v[140:143], a[252:255], v[12:15], v[140:143]
    v_add_f32 v231, v231, v126
    v_add_f32 v232, v232, v129
    v_mfma_f32_16x16x32_bf16 v[144:147], a[252:255], v[36:39], v[144:147]
    ds_read_b64_tr_b16 a[242:243], v219 offset:6144
    v_add_f32 v233, v233, v132
    v_mfma_f32_16x16x32_bf16 v[148:151], a[252:255], v[60:63], v[148:151]
    v_exp_f32 v133, v133
    v_mfma_f32_16x16x32_bf16 v[152:155], a[252:255], v[84:87], v[152:155]
    ds_read_b64_tr_b16 a[244:245], v220 offset:0
    ds_read_b64_tr_b16 a[246:247], v220 offset:6144
    v_mfma_f32_16x16x32_bf16 v[156:159], a[252:255], v[108:111], v[156:159]
    s_waitcnt lgkmcnt(5)
    ds_read_b64_tr_b16 a[248:249], v221 offset:0
    ds_read_b64_tr_b16 a[250:251], v221 offset:6144
    v_mfma_f32_16x16x32_bf16 v[140:143], v[240:243], v[16:19], v[140:143]
    v_add_f32 v230, v230, v123
    v_add_f32 v231, v231, v127
    v_mfma_f32_16x16x32_bf16 v[144:147], v[240:243], v[40:43], v[144:147]
    v_exp_f32 v131, v131
    v_mfma_f32_16x16x32_bf16 v[148:151], v[240:243], v[64:67], v[148:151]
    v_add_f32 v232, v232, v130
    v_add_f32 v233, v233, v133
    v_mfma_f32_16x16x32_bf16 v[152:155], v[240:243], v[88:91], v[152:155]
    v_exp_f32 v134, v134
    v_mfma_f32_16x16x32_bf16 v[156:159], v[240:243], v[112:115], v[156:159]
    s_waitcnt lgkmcnt(6)
    ds_read_b64_tr_b16 a[252:253], v222 offset:0
    ds_read_b64_tr_b16 a[254:255], v222 offset:6144
    v_mfma_f32_16x16x32_bf16 v[140:143], v[244:247], v[20:23], v[140:143]
    ds_read_b64_tr_b16 v[240:241], v219 offset:1024
    ds_read_b64_tr_b16 v[242:243], v219 offset:7168
    v_mfma_f32_16x16x32_bf16 v[144:147], v[244:247], v[44:47], v[144:147]
    v_add_f32 v232, v232, v131
    v_add_f32 v233, v233, v134
    v_mfma_f32_16x16x32_bf16 v[148:151], v[244:247], v[68:71], v[148:151]
    v_exp_f32 v135, v135
    v_mfma_f32_16x16x32_bf16 v[152:155], v[244:247], v[92:95], v[152:155]
    v_exp_f32 v140, v140
    v_mfma_f32_16x16x32_bf16 v[156:159], v[244:247], v[116:119], v[156:159]
    s_waitcnt lgkmcnt(8)
    v_exp_f32 v144, v144
    v_mfma_f32_16x16x32_bf16 a[0:3], a[240:243], v[160:163], 0
    ds_read_b64_tr_b16 v[244:245], v220 offset:1024
    ds_read_b64_tr_b16 v[246:247], v220 offset:7168
    v_mfma_f32_16x16x32_bf16 a[48:51], a[240:243], v[164:167], 0
    v_exp_f32 v141, v141
    v_mfma_f32_16x16x32_bf16 a[96:99], a[240:243], v[168:171], 0
    v_exp_f32 v145, v145
    v_mfma_f32_16x16x32_bf16 a[144:147], a[240:243], v[172:175], 0
    s_waitcnt lgkmcnt(8)
    ds_read_b64_tr_b16 a[240:241], v221 offset:1024
    ds_read_b64_tr_b16 a[242:243], v221 offset:7168
    v_mfma_f32_16x16x32_bf16 a[4:7], a[244:247], v[160:163], 0
    v_add_f32 v230, v230, v140
    v_add_f32 v231, v231, v144
    v_mfma_f32_16x16x32_bf16 a[52:55], a[244:247], v[164:167], 0
    v_exp_f32 v148, v148
    v_mfma_f32_16x16x32_bf16 a[100:103], a[244:247], v[168:171], 0
    v_exp_f32 v142, v142
    v_mfma_f32_16x16x32_bf16 a[148:151], a[244:247], v[172:175], 0
    s_waitcnt lgkmcnt(8)
    ds_read_b64_tr_b16 a[244:245], v222 offset:1024
    ds_read_b64_tr_b16 a[246:247], v222 offset:7168
    v_mfma_f32_16x16x32_bf16 a[8:11], a[248:251], v[160:163], 0
    v_exp_f32 v146, v146
    v_mfma_f32_16x16x32_bf16 a[56:59], a[248:251], v[164:167], 0
    v_add_f32 v230, v230, v141
    v_add_f32 v231, v231, v145
    v_mfma_f32_16x16x32_bf16 a[104:107], a[248:251], v[168:171], 0
    v_exp_f32 v149, v149
    v_mfma_f32_16x16x32_bf16 a[152:155], a[248:251], v[172:175], 0
    s_waitcnt lgkmcnt(8)
    ds_read_b64_tr_b16 a[248:249], v219 offset:2048
    ds_read_b64_tr_b16 a[250:251], v219 offset:8192
    v_mfma_f32_16x16x32_bf16 a[12:15], a[252:255], v[160:163], 0
    v_add_u32 v218, s36, v218
    v_add_f32 v232, v232, v148
    v_mfma_f32_16x16x32_bf16 a[60:63], a[252:255], v[164:167], 0
    v_exp_f32 v152, v152
    v_mfma_f32_16x16x32_bf16 a[108:111], a[252:255], v[168:171], 0
    v_add_f32 v233, v233, v135
    v_add_f32 v230, v230, v142
    v_mfma_f32_16x16x32_bf16 a[156:159], a[252:255], v[172:175], 0
    s_waitcnt lgkmcnt(8)
    ds_read_b64_tr_b16 a[252:253], v220 offset:2048
    ds_read_b64_tr_b16 a[254:255], v220 offset:8192
    v_mfma_f32_16x16x32_bf16 a[16:19], v[240:243], v[160:163], 0
    v_exp_f32 v143, v143
    v_mfma_f32_16x16x32_bf16 a[64:67], v[240:243], v[164:167], 0
    v_exp_f32 v147, v147
    v_mfma_f32_16x16x32_bf16 a[112:115], v[240:243], v[168:171], 0
    s_waitcnt vmcnt(3)
    s_barrier
    v_add_f32 v231, v231, v146
    v_mfma_f32_16x16x32_bf16 a[160:163], v[240:243], v[172:175], 0
    s_waitcnt lgkmcnt(8)
    buffer_load_dwordx4 v216, s[12:15], s30 offen nt lds
    v_mfma_f32_16x16x32_bf16 a[20:23], v[244:247], v[160:163], 0
    ds_read_b64_tr_b16 v[240:241], v221 offset:2048
    ds_read_b64_tr_b16 v[242:243], v221 offset:8192
    v_mfma_f32_16x16x32_bf16 a[68:71], v[244:247], v[164:167], 0
    buffer_load_dwordx4 v216, s[12:15], s30 offen offset:3072 nt lds
    v_mfma_f32_16x16x32_bf16 a[116:119], v[244:247], v[168:171], 0
    s_add_u32 m0, s46, 896
    v_exp_f32 v150, v150
    v_mfma_f32_16x16x32_bf16 a[164:167], v[244:247], v[172:175], 0
    s_waitcnt lgkmcnt(8)
    buffer_load_dwordx4 v216, s[12:15], s30 offen offset:128 nt lds
    v_mfma_f32_16x16x32_bf16 a[24:27], a[240:243], v[160:163], 0
    ds_read_b64_tr_b16 v[244:245], v222 offset:2048
    ds_read_b64_tr_b16 v[246:247], v222 offset:8192
    v_mfma_f32_16x16x32_bf16 a[72:75], a[240:243], v[164:167], 0
    buffer_load_dwordx4 v216, s[12:15], s30 offen offset:3200 nt lds
    v_mfma_f32_16x16x32_bf16 a[120:123], a[240:243], v[168:171], 0
    s_add_u32 m0, s46, 1792
    v_add_f32 v232, v232, v149
    v_add_f32 v233, v233, v152
    v_mfma_f32_16x16x32_bf16 a[168:171], a[240:243], v[172:175], 0
    s_waitcnt lgkmcnt(8)
    buffer_load_dwordx4 v216, s[12:15], s30 offen offset:256 nt lds
    v_mfma_f32_16x16x32_bf16 a[28:31], a[244:247], v[160:163], 0
    s_mov_b32 s46, s32
    ds_read_b128 a[240:243], v217 offset:0
    v_accvgpr_write_b32 a217, 0
    v_mfma_f32_16x16x32_bf16 a[76:79], a[244:247], v[164:167], 0
    buffer_load_dwordx4 v216, s[12:15], s30 offen offset:3328 nt lds
    v_mfma_f32_16x16x32_bf16 a[124:127], a[244:247], v[168:171], 0
    s_add_u32 s30, s30, 12288
    v_exp_f32 v153, v153
    v_mfma_f32_16x16x32_bf16 a[172:175], a[244:247], v[172:175], 0
    s_waitcnt lgkmcnt(7)
    ds_read_b128 a[244:247], v218 offset:0
    v_accvgpr_write_b32 a218, 0
    v_mfma_f32_16x16x32_bf16 a[32:35], a[248:251], v[160:163], 0
    s_add_u32 m0, s39, 0
    v_accvgpr_write_b32 a219, 0
    v_accvgpr_write_b32 a220, 0
    v_mfma_f32_16x16x32_bf16 a[80:83], a[248:251], v[164:167], 0
    v_accvgpr_write_b32 a221, 0
    v_accvgpr_write_b32 a222, 0
    v_mfma_f32_16x16x32_bf16 a[128:131], a[248:251], v[168:171], 0
    v_accvgpr_write_b32 a223, 0
    v_accvgpr_write_b32 a224, 0
    v_mfma_f32_16x16x32_bf16 a[176:179], a[248:251], v[172:175], 0
    s_waitcnt lgkmcnt(6)
    ds_read_b128 a[248:251], v217 offset:1024
    v_accvgpr_write_b32 a225, 0
    v_mfma_f32_16x16x32_bf16 a[36:39], a[252:255], v[160:163], 0
    v_accvgpr_write_b32 a226, 0
    v_accvgpr_write_b32 a227, 0
    v_mfma_f32_16x16x32_bf16 a[84:87], a[252:255], v[164:167], 0
    v_accvgpr_write_b32 a228, 0
    v_accvgpr_write_b32 a229, 0
    v_mfma_f32_16x16x32_bf16 a[132:135], a[252:255], v[168:171], 0
    v_accvgpr_write_b32 a230, 0
    v_accvgpr_write_b32 a231, 0
    v_mfma_f32_16x16x32_bf16 a[180:183], a[252:255], v[172:175], 0
    s_waitcnt lgkmcnt(5)
    v_accvgpr_write_b32 a232, 0
    v_accvgpr_write_b32 a233, 0
    v_mfma_f32_16x16x32_bf16 a[40:43], v[240:243], v[160:163], 0
    v_accvgpr_write_b32 a234, 0
    v_accvgpr_write_b32 a235, 0
    v_mfma_f32_16x16x32_bf16 a[88:91], v[240:243], v[164:167], 0
    v_accvgpr_write_b32 a236, 0
    v_accvgpr_write_b32 a237, 0
    v_mfma_f32_16x16x32_bf16 a[136:139], v[240:243], v[168:171], 0
    v_accvgpr_write_b32 a238, 0
    v_accvgpr_write_b32 a239, 0
    v_mfma_f32_16x16x32_bf16 a[184:187], v[240:243], v[172:175], 0
    s_waitcnt lgkmcnt(3)
    v_cvt_pk_bf16_f32 v176, v120, v121
    v_cvt_pk_bf16_f32 v177, v122, v123
    v_mfma_f32_16x16x32_bf16 a[44:47], v[244:247], v[160:163], 0
    v_cvt_pk_bf16_f32 v180, v124, v125
    v_cvt_pk_bf16_f32 v181, v126, v127
    v_mfma_f32_16x16x32_bf16 a[92:95], v[244:247], v[164:167], 0
    v_cvt_pk_bf16_f32 v184, v128, v129
    v_cvt_pk_bf16_f32 v185, v130, v131
    v_mfma_f32_16x16x32_bf16 a[140:143], v[244:247], v[168:171], 0
    v_cvt_pk_bf16_f32 v188, v132, v133
    v_cvt_pk_bf16_f32 v189, v134, v135
    v_mfma_f32_16x16x32_bf16 a[188:191], v[244:247], v[172:175], 0
    s_waitcnt lgkmcnt(2)
    v_add_f32 v230, v230, v143
    v_cvt_pk_bf16_f32 v178, v140, v141
    v_cvt_pk_bf16_f32 v179, v142, v143
    v_add_f32 v231, v231, v147
    v_cvt_pk_bf16_f32 v182, v144, v145
    v_exp_f32 v151, v151
    v_cvt_pk_bf16_f32 v183, v146, v147
    v_add_f32 v232, v232, v150
    v_exp_f32 v154, v154
    v_add_f32 v233, v233, v153
    ds_read_b128 a[252:255], v218 offset:1024
    ds_read_b128 v[240:243], v217 offset:2048
    s_cmp_ge_u32 s31, 196608
    s_cselect_b32 s31, 6144, s31
    ds_read_b128 v[244:247], v218 offset:2048
K_aj1:
    s_mov_b32 s43, 5
K_al1:
    v_mfma_f32_16x16x32_bf16 v[120:123], a[240:243], v[0:3], v[196:199]
    v_exp_f32 v155, v155
    v_mfma_f32_16x16x32_bf16 v[124:127], a[240:243], v[24:27], v[200:203]
    v_add_f32 v233, v233, v154
    v_add_f32 v232, v232, v151
    v_mfma_f32_16x16x32_bf16 v[128:131], a[240:243], v[48:51], v[204:207]
    v_cvt_pk_bf16_f32 v186, v148, v149
    v_cvt_pk_bf16_f32 v187, v150, v151
    v_mfma_f32_16x16x32_bf16 v[132:135], a[240:243], v[72:75], v[208:211]
    s_waitcnt lgkmcnt(4)
    ds_read_b128 a[240:243], v217 offset:6144
    v_add_f32 v233, v233, v155
    v_mfma_f32_16x16x32_bf16 v[120:123], a[244:247], v[4:7], v[120:123]
    v_cvt_pk_bf16_f32 v190, v152, v153
    v_cvt_pk_bf16_f32 v191, v154, v155
    v_mfma_f32_16x16x32_bf16 v[124:127], a[244:247], v[28:31], v[124:127]
    v_add_u32 v219, s37, v219
    v_add_u32 v220, s37, v220
    v_mfma_f32_16x16x32_bf16 v[128:131], a[244:247], v[52:55], v[128:131]
    v_add_u32 v221, s37, v221
    v_add_u32 v222, s37, v222
    v_mfma_f32_16x16x32_bf16 v[132:135], a[244:247], v[76:79], v[132:135]
    s_waitcnt lgkmcnt(4)
    ds_read_b128 a[244:247], v218 offset:6144
    s_mov_b32 s37, s36
    v_mfma_f32_16x16x32_bf16 v[120:123], a[248:251], v[8:11], v[120:123]
    s_sub_u32 s36, s33, s32
    v_exp_f32 v136, v136
    v_mfma_f32_16x16x32_bf16 v[124:127], a[248:251], v[32:35], v[124:127]
    s_mov_b32 s32, s33
    v_exp_f32 v137, v137
    v_mfma_f32_16x16x32_bf16 v[128:131], a[248:251], v[56:59], v[128:131]
    s_mov_b32 s33, s34
    v_exp_f32 v138, v138
    v_mfma_f32_16x16x32_bf16 v[132:135], a[248:251], v[80:83], v[132:135]
    s_waitcnt lgkmcnt(4)
    ds_read_b128 a[248:251], v217 offset:7168
    v_cvt_pk_bf16_f32 v192, v136, v137
    v_mfma_f32_16x16x32_bf16 v[120:123], a[252:255], v[12:15], v[120:123]
    s_mov_b32 s34, s46
    v_exp_f32 v139, v139
    v_mfma_f32_16x16x32_bf16 v[124:127], a[252:255], v[36:39], v[124:127]
    v_exp_f32 v156, v156
    v_mfma_f32_16x16x32_bf16 v[128:131], a[252:255], v[60:63], v[128:131]
    v_exp_f32 v157, v157
    v_mfma_f32_16x16x32_bf16 v[132:135], a[252:255], v[84:87], v[132:135]
    s_waitcnt lgkmcnt(4)
    ds_read_b128 a[252:255], v218 offset:7168
    v_cvt_pk_bf16_f32 v193, v138, v139
    v_mfma_f32_16x16x32_bf16 v[120:123], v[240:243], v[16:19], v[120:123]
    v_exp_f32 v158, v158
    v_mfma_f32_16x16x32_bf16 v[124:127], v[240:243], v[40:43], v[124:127]
    v_exp_f32 v159, v159
    v_mfma_f32_16x16x32_bf16 v[128:131], v[240:243], v[64:67], v[128:131]
    v_cvt_pk_bf16_f32 v194, v156, v157
    v_cvt_pk_bf16_f32 v195, v158, v159
    v_mfma_f32_16x16x32_bf16 v[132:135], v[240:243], v[88:91], v[132:135]
    s_waitcnt lgkmcnt(4)
    ds_read_b128 v[240:243], v217 offset:8192
    v_add_f32 v234, v234, v136
    v_mfma_f32_16x16x32_bf16 v[120:123], v[244:247], v[20:23], v[120:123]
    s_cmp_ge_u32 s30, 196608
    s_cselect_b32 s30, 6144, s30
    v_mfma_f32_16x16x32_bf16 v[124:127], v[244:247], v[44:47], v[124:127]
    v_add_u32 v217, s36, v217
    v_add_f32 v234, v234, v137
    v_mfma_f32_16x16x32_bf16 v[128:131], v[244:247], v[68:71], v[128:131]
    v_add_f32 v234, v234, v138
    v_add_f32 v234, v234, v139
    v_mfma_f32_16x16x32_bf16 v[132:135], v[244:247], v[92:95], v[132:135]
    s_waitcnt lgkmcnt(4)
    ds_read_b128 v[244:247], v218 offset:8192
    v_add_u32 v218, s36, v218
    v_mfma_f32_16x16x32_bf16 v[140:143], a[240:243], v[0:3], v[196:199]
    s_waitcnt vmcnt(3)
    s_barrier
    v_add_f32 v234, v234, v156
    v_mfma_f32_16x16x32_bf16 v[144:147], a[240:243], v[24:27], v[200:203]
    buffer_load_dwordx4 v216, s[16:19], s31 offen nt lds
    v_mfma_f32_16x16x32_bf16 v[148:151], a[240:243], v[48:51], v[204:207]
    v_exp_f32 v120, v120
    v_mfma_f32_16x16x32_bf16 v[152:155], a[240:243], v[72:75], v[208:211]
    s_waitcnt lgkmcnt(4)
    buffer_load_dwordx4 v216, s[16:19], s31 offen offset:3072 nt lds
    v_mfma_f32_16x16x32_bf16 v[140:143], a[244:247], v[4:7], v[140:143]
    s_add_u32 m0, s39, 896
    ds_read_b64_tr_b16 a[240:241], v219 offset:0
    ds_read_b64_tr_b16 a[242:243], v219 offset:6144
    v_mfma_f32_16x16x32_bf16 v[144:147], a[244:247], v[28:31], v[144:147]
    buffer_load_dwordx4 v216, s[16:19], s31 offen offset:128 nt lds
    v_mfma_f32_16x16x32_bf16 v[148:151], a[244:247], v[52:55], v[148:151]
    v_exp_f32 v124, v124
    v_mfma_f32_16x16x32_bf16 v[152:155], a[244:247], v[76:79], v[152:155]
    s_waitcnt lgkmcnt(5)
    buffer_load_dwordx4 v216, s[16:19], s31 offen offset:3200 nt lds
    v_mfma_f32_16x16x32_bf16 v[140:143], a[248:251], v[8:11], v[140:143]
    s_add_u32 m0, s39, 1792
    ds_read_b64_tr_b16 a[244:245], v220 offset:0
    ds_read_b64_tr_b16 a[246:247], v220 offset:6144
    v_mfma_f32_16x16x32_bf16 v[144:147], a[248:251], v[32:35], v[144:147]
    s_add_u32 s39, s33, s35
    buffer_load_dwordx4 v216, s[16:19], s31 offen offset:256 nt lds
    v_mfma_f32_16x16x32_bf16 v[148:151], a[248:251], v[56:59], v[148:151]
    v_exp_f32 v128, v128
    v_mfma_f32_16x16x32_bf16 v[152:155], a[248:251], v[80:83], v[152:155]
    s_waitcnt lgkmcnt(6)
    buffer_load_dwordx4 v216, s[16:19], s31 offen offset:3328 nt lds
    v_mfma_f32_16x16x32_bf16 v[140:143], a[252:255], v[12:15], v[140:143]
    s_add_u32 m0, s46, 0
    ds_read_b64_tr_b16 a[248:249], v221 offset:0
    ds_read_b64_tr_b16 a[250:251], v221 offset:6144
    v_mfma_f32_16x16x32_bf16 v[144:147], a[252:255], v[36:39], v[144:147]
    s_add_u32 s31, s31, 12288
    v_exp_f32 v132, v132
    v_mfma_f32_16x16x32_bf16 v[148:151], a[252:255], v[60:63], v[148:151]
    v_exp_f32 v121, v121
    v_mfma_f32_16x16x32_bf16 v[152:155], a[252:255], v[84:87], v[152:155]
    s_waitcnt lgkmcnt(7)
    ds_read_b64_tr_b16 a[252:253], v222 offset:0
    ds_read_b64_tr_b16 a[254:255], v222 offset:6144
    v_mfma_f32_16x16x32_bf16 v[140:143], v[240:243], v[16:19], v[140:143]
    v_add_f32 v230, v230, v120
    v_add_f32 v231, v231, v124
    v_mfma_f32_16x16x32_bf16 v[144:147], v[240:243], v[40:43], v[144:147]
    v_exp_f32 v125, v125
    v_mfma_f32_16x16x32_bf16 v[148:151], v[240:243], v[64:67], v[148:151]
    v_exp_f32 v129, v129
    v_mfma_f32_16x16x32_bf16 v[152:155], v[240:243], v[88:91], v[152:155]
    s_waitcnt lgkmcnt(8)
    ds_read_b64_tr_b16 v[240:241], v219 offset:1024
    ds_read_b64_tr_b16 v[242:243], v219 offset:7168
    v_mfma_f32_16x16x32_bf16 v[140:143], v[244:247], v[20:23], v[140:143]
    v_add_f32 v232, v232, v128
    v_add_f32 v233, v233, v132
    v_mfma_f32_16x16x32_bf16 v[144:147], v[244:247], v[44:47], v[144:147]
    v_exp_f32 v133, v133
    v_mfma_f32_16x16x32_bf16 v[148:151], v[244:247], v[68:71], v[148:151]
    v_exp_f32 v122, v122
    v_mfma_f32_16x16x32_bf16 v[152:155], v[244:247], v[92:95], v[152:155]
    s_waitcnt lgkmcnt(8)
    ds_read_b64_tr_b16 v[244:245], v220 offset:1024
    ds_read_b64_tr_b16 v[246:247], v220 offset:7168
    v_mfma_f32_16x16x32_bf16 a[0:3], a[240:243], v[176:179], a[0:3]
    v_exp_f32 v126, v126
    v_mfma_f32_16x16x32_bf16 a[48:51], a[240:243], v[180:183], a[48:51]
    s_cmp_ge_u32 s31, 196608
    s_cselect_b32 s31, 6144, s31
    v_mfma_f32_16x16x32_bf16 a[96:99], a[240:243], v[184:187], a[96:99]
    v_add_f32 v230, v230, v121
    v_add_f32 v231, v231, v125
    v_mfma_f32_16x16x32_bf16 a[144:147], a[240:243], v[188:191], a[144:147]
    v_exp_f32 v130, v130
    v_mfma_f32_16x16x32_bf16 a[192:195], a[240:243], v[192:195], a[192:195]
    s_waitcnt lgkmcnt(8)
    ds_read_b64_tr_b16 a[240:241], v221 offset:1024
    ds_read_b64_tr_b16 a[242:243], v221 offset:7168
    v_mfma_f32_16x16x32_bf16 a[4:7], a[244:247], v[176:179], a[4:7]
    v_add_f32 v232, v232, v129
    v_add_f32 v233, v233, v133
    v_mfma_f32_16x16x32_bf16 a[52:55], a[244:247], v[180:183], a[52:55]
    v_exp_f32 v134, v134
    v_mfma_f32_16x16x32_bf16 a[100:103], a[244:247], v[184:187], a[100:103]
    v_exp_f32 v123, v123
    v_mfma_f32_16x16x32_bf16 a[148:151], a[244:247], v[188:191], a[148:151]
    v_exp_f32 v127, v127
    v_mfma_f32_16x16x32_bf16 a[196:199], a[244:247], v[192:195], a[196:199]
    s_waitcnt lgkmcnt(8)
    ds_read_b64_tr_b16 a[244:245], v222 offset:1024
    ds_read_b64_tr_b16 a[246:247], v222 offset:7168
    v_mfma_f32_16x16x32_bf16 a[8:11], a[248:251], v[176:179], a[8:11]
    v_add_f32 v230, v230, v122
    v_add_f32 v231, v231, v126
    v_mfma_f32_16x16x32_bf16 a[56:59], a[248:251], v[180:183], a[56:59]
    v_exp_f32 v131, v131
    v_mfma_f32_16x16x32_bf16 a[104:107], a[248:251], v[184:187], a[104:107]
    v_add_f32 v232, v232, v130
    v_add_f32 v233, v233, v134
    v_mfma_f32_16x16x32_bf16 a[152:155], a[248:251], v[188:191], a[152:155]
    v_exp_f32 v135, v135
    v_mfma_f32_16x16x32_bf16 a[200:203], a[248:251], v[192:195], a[200:203]
    s_waitcnt lgkmcnt(8)
    ds_read_b64_tr_b16 a[248:249], v219 offset:2048
    ds_read_b64_tr_b16 a[250:251], v219 offset:8192
    v_mfma_f32_16x16x32_bf16 a[12:15], a[252:255], v[176:179], a[12:15]
    v_add_f32 v230, v230, v123
    v_cvt_pk_bf16_f32 v160, v120, v121
    v_mfma_f32_16x16x32_bf16 a[60:63], a[252:255], v[180:183], a[60:63]
    v_cvt_pk_bf16_f32 v161, v122, v123
    v_add_f32 v231, v231, v127
    v_mfma_f32_16x16x32_bf16 a[108:111], a[252:255], v[184:187], a[108:111]
    v_cvt_pk_bf16_f32 v164, v124, v125
    v_cvt_pk_bf16_f32 v165, v126, v127
    v_mfma_f32_16x16x32_bf16 a[156:159], a[252:255], v[188:191], a[156:159]
    v_add_f32 v232, v232, v131
    v_cvt_pk_bf16_f32 v168, v128, v129
    v_mfma_f32_16x16x32_bf16 a[204:207], a[252:255], v[192:195], a[204:207]
    s_waitcnt lgkmcnt(8)
    ds_read_b64_tr_b16 a[252:253], v220 offset:2048
    ds_read_b64_tr_b16 a[254:255], v220 offset:8192
    v_mfma_f32_16x16x32_bf16 a[16:19], v[240:243], v[176:179], a[16:19]
    v_cvt_pk_bf16_f32 v169, v130, v131
    v_add_f32 v233, v233, v135
    v_mfma_f32_16x16x32_bf16 a[64:67], v[240:243], v[180:183], a[64:67]
    v_exp_f32 v140, v140
    v_mfma_f32_16x16x32_bf16 a[112:115], v[240:243], v[184:187], a[112:115]
    v_cvt_pk_bf16_f32 v172, v132, v133
    v_cvt_pk_bf16_f32 v173, v134, v135
    v_mfma_f32_16x16x32_bf16 a[160:163], v[240:243], v[188:191], a[160:163]
    v_exp_f32 v144, v144
    v_mfma_f32_16x16x32_bf16 a[208:211], v[240:243], v[192:195], a[208:211]
    s_waitcnt lgkmcnt(8)
    ds_read_b64_tr_b16 v[240:241], v221 offset:2048
    ds_read_b64_tr_b16 v[242:243], v221 offset:8192
    v_mfma_f32_16x16x32_bf16 a[20:23], v[244:247], v[176:179], a[20:23]
    v_exp_f32 v148, v148
    v_mfma_f32_16x16x32_bf16 a[68:71], v[244:247], v[180:183], a[68:71]
    v_exp_f32 v141, v141
    v_mfma_f32_16x16x32_bf16 a[116:119], v[244:247], v[184:187], a[116:119]
    v_add_f32 v230, v230, v140
    v_add_f32 v231, v231, v144
    v_mfma_f32_16x16x32_bf16 a[164:167], v[244:247], v[188:191], a[164:167]
    v_exp_f32 v152, v152
    v_mfma_f32_16x16x32_bf16 a[212:215], v[244:247], v[192:195], a[212:215]
    s_waitcnt lgkmcnt(8)
    ds_read_b64_tr_b16 v[244:245], v222 offset:2048
    ds_read_b64_tr_b16 v[246:247], v222 offset:8192
    v_mfma_f32_16x16x32_bf16 a[24:27], a[240:243], v[176:179], a[24:27]
    s_waitcnt vmcnt(3)
    s_barrier
    v_add_f32 v232, v232, v148
    v_mfma_f32_16x16x32_bf16 a[72:75], a[240:243], v[180:183], a[72:75]
    buffer_load_dwordx4 v216, s[12:15], s30 offen nt lds
    v_mfma_f32_16x16x32_bf16 a[120:123], a[240:243], v[184:187], a[120:123]
    v_exp_f32 v145, v145
    v_mfma_f32_16x16x32_bf16 a[168:171], a[240:243], v[188:191], a[168:171]
    buffer_load_dwordx4 v216, s[12:15], s30 offen offset:3072 nt lds
    v_mfma_f32_16x16x32_bf16 a[216:219], a[240:243], v[192:195], a[216:219]
    s_waitcnt lgkmcnt(8)
    s_add_u32 m0, s46, 896
    ds_read_b128 a[240:243], v217 offset:0
    v_mfma_f32_16x16x32_bf16 a[28:31], a[244:247], v[176:179], a[28:31]
    buffer_load_dwordx4 v216, s[12:15], s30 offen offset:128 nt lds
    v_mfma_f32_16x16x32_bf16 a[76:79], a[244:247], v[180:183], a[76:79]
    v_exp_f32 v149, v149
    v_mfma_f32_16x16x32_bf16 a[124:127], a[244:247], v[184:187], a[124:127]
    buffer_load_dwordx4 v216, s[12:15], s30 offen offset:3200 nt lds
    v_mfma_f32_16x16x32_bf16 a[172:175], a[244:247], v[188:191], a[172:175]
    s_add_u32 m0, s46, 1792
    v_exp_f32 v142, v142
    v_mfma_f32_16x16x32_bf16 a[220:223], a[244:247], v[192:195], a[220:223]
    s_waitcnt lgkmcnt(7)
    buffer_load_dwordx4 v216, s[12:15], s30 offen offset:256 nt lds
    v_mfma_f32_16x16x32_bf16 a[32:35], a[248:251], v[176:179], a[32:35]
    s_mov_b32 s46, s32
    ds_read_b128 a[244:247], v218 offset:0
    v_add_f32 v230, v230, v141
    v_mfma_f32_16x16x32_bf16 a[80:83], a[248:251], v[180:183], a[80:83]
    buffer_load_dwordx4 v216, s[12:15], s30 offen offset:3328 nt lds
    v_mfma_f32_16x16x32_bf16 a[128:131], a[248:251], v[184:187], a[128:131]
    s_add_u32 m0, s39, 0
    v_exp_f32 v153, v153
    v_mfma_f32_16x16x32_bf16 a[176:179], a[248:251], v[188:191], a[176:179]
    s_add_u32 s30, s30, 12288
    v_exp_f32 v146, v146
    v_mfma_f32_16x16x32_bf16 a[224:227], a[248:251], v[192:195], a[224:227]
    s_waitcnt lgkmcnt(6)
    ds_read_b128 a[248:251], v217 offset:1024
    v_add_f32 v233, v233, v152
    v_mfma_f32_16x16x32_bf16 a[36:39], a[252:255], v[176:179], a[36:39]
    v_exp_f32 v150, v150
    v_mfma_f32_16x16x32_bf16 a[84:87], a[252:255], v[180:183], a[84:87]
    v_add_f32 v231, v231, v145
    v_add_f32 v232, v232, v149
    v_mfma_f32_16x16x32_bf16 a[132:135], a[252:255], v[184:187], a[132:135]
    v_exp_f32 v143, v143
    v_mfma_f32_16x16x32_bf16 a[180:183], a[252:255], v[188:191], a[180:183]
    v_add_f32 v230, v230, v142
    v_add_f32 v233, v233, v153
    v_mfma_f32_16x16x32_bf16 a[228:231], a[252:255], v[192:195], a[228:231]
    s_waitcnt lgkmcnt(5)
    ds_read_b128 a[252:255], v218 offset:1024
    v_add_f32 v231, v231, v146
    v_mfma_f32_16x16x32_bf16 a[40:43], v[240:243], v[176:179], a[40:43]
    v_exp_f32 v154, v154
    v_mfma_f32_16x16x32_bf16 a[88:91], v[240:243], v[180:183], a[88:91]
    v_exp_f32 v147, v147
    v_mfma_f32_16x16x32_bf16 a[136:139], v[240:243], v[184:187], a[136:139]
    v_exp_f32 v151, v151
    v_mfma_f32_16x16x32_bf16 a[184:187], v[240:243], v[188:191], a[184:187]
    v_add_f32 v232, v232, v150
    v_add_f32 v230, v230, v143
    v_mfma_f32_16x16x32_bf16 a[232:235], v[240:243], v[192:195], a[232:235]
    s_waitcnt lgkmcnt(4)
    ds_read_b128 v[240:243], v217 offset:2048
    v_cvt_pk_bf16_f32 v162, v140, v141
    v_mfma_f32_16x16x32_bf16 a[44:47], v[244:247], v[176:179], a[44:47]
    v_exp_f32 v155, v155
    v_mfma_f32_16x16x32_bf16 a[92:95], v[244:247], v[180:183], a[92:95]
    v_cvt_pk_bf16_f32 v163, v142, v143
    v_add_f32 v233, v233, v154
    v_mfma_f32_16x16x32_bf16 a[140:143], v[244:247], v[184:187], a[140:143]
    v_add_f32 v231, v231, v147
    v_cvt_pk_bf16_f32 v166, v144, v145
    v_mfma_f32_16x16x32_bf16 a[188:191], v[244:247], v[188:191], a[188:191]
    v_cvt_pk_bf16_f32 v167, v146, v147
    v_add_f32 v232, v232, v151
    v_mfma_f32_16x16x32_bf16 a[236:239], v[244:247], v[192:195], a[236:239]
    s_waitcnt lgkmcnt(4)
    ds_read_b128 v[244:247], v218 offset:2048
    v_cvt_pk_bf16_f32 v170, v148, v149
    v_mfma_f32_16x16x32_bf16 v[120:123], a[240:243], v[0:3], v[196:199]
    v_cvt_pk_bf16_f32 v171, v150, v151
    v_add_f32 v233, v233, v155
    v_mfma_f32_16x16x32_bf16 v[124:127], a[240:243], v[24:27], v[200:203]
    v_cvt_pk_bf16_f32 v174, v152, v153
    v_cvt_pk_bf16_f32 v175, v154, v155
    v_mfma_f32_16x16x32_bf16 v[128:131], a[240:243], v[48:51], v[204:207]
    v_add_f32 v234, v234, v157
    v_add_f32 v234, v234, v158
    v_mfma_f32_16x16x32_bf16 v[132:135], a[240:243], v[72:75], v[208:211]
    v_add_f32 v234, v234, v159
    v_add_u32 v219, s37, v219
    v_mfma_f32_16x16x32_bf16 v[136:139], a[240:243], v[96:99], v[212:215]
    s_waitcnt lgkmcnt(4)
    ds_read_b128 a[240:243], v217 offset:6144
    v_add_u32 v220, s37, v220
    v_mfma_f32_16x16x32_bf16 v[120:123], a[244:247], v[4:7], v[120:123]
    v_add_u32 v221, s37, v221
    v_add_u32 v222, s37, v222
    v_mfma_f32_16x16x32_bf16 v[124:127], a[244:247], v[28:31], v[124:127]
    s_mov_b32 s37, s36
    s_cmp_ge_u32 s30, 196608
    s_cselect_b32 s30, 6144, s30
    v_mfma_f32_16x16x32_bf16 v[128:131], a[244:247], v[52:55], v[128:131]
    s_sub_u32 s36, s33, s32
    s_mov_b32 s32, s33
    s_mov_b32 s33, s34
    v_mfma_f32_16x16x32_bf16 v[132:135], a[244:247], v[76:79], v[132:135]
    s_mov_b32 s34, s46
    v_mfma_f32_16x16x32_bf16 v[136:139], a[244:247], v[100:103], v[136:139]
    s_waitcnt lgkmcnt(4)
    ds_read_b128 a[244:247], v218 offset:6144
    v_mfma_f32_16x16x32_bf16 v[120:123], a[248:251], v[8:11], v[120:123]
    v_mfma_f32_16x16x32_bf16 v[124:127], a[248:251], v[32:35], v[124:127]
    v_mfma_f32_16x16x32_bf16 v[128:131], a[248:251], v[56:59], v[128:131]
    v_mfma_f32_16x16x32_bf16 v[132:135], a[248:251], v[80:83], v[132:135]
    v_mfma_f32_16x16x32_bf16 v[136:139], a[248:251], v[104:107], v[136:139]
    s_waitcnt lgkmcnt(4)
    ds_read_b128 a[248:251], v217 offset:7168
    v_mfma_f32_16x16x32_bf16 v[120:123], a[252:255], v[12:15], v[120:123]
    v_mfma_f32_16x16x32_bf16 v[124:127], a[252:255], v[36:39], v[124:127]
    v_mfma_f32_16x16x32_bf16 v[128:131], a[252:255], v[60:63], v[128:131]
    v_mfma_f32_16x16x32_bf16 v[132:135], a[252:255], v[84:87], v[132:135]
    v_mfma_f32_16x16x32_bf16 v[136:139], a[252:255], v[108:111], v[136:139]
    s_waitcnt lgkmcnt(4)
    ds_read_b128 a[252:255], v218 offset:7168
    v_mfma_f32_16x16x32_bf16 v[120:123], v[240:243], v[16:19], v[120:123]
    v_mfma_f32_16x16x32_bf16 v[124:127], v[240:243], v[40:43], v[124:127]
    v_mfma_f32_16x16x32_bf16 v[128:131], v[240:243], v[64:67], v[128:131]
    v_mfma_f32_16x16x32_bf16 v[132:135], v[240:243], v[88:91], v[132:135]
    v_mfma_f32_16x16x32_bf16 v[136:139], v[240:243], v[112:115], v[136:139]
    s_waitcnt lgkmcnt(4)
    s_waitcnt vmcnt(3)
    s_barrier
    v_mfma_f32_16x16x32_bf16 v[120:123], v[244:247], v[20:23], v[120:123]
    buffer_load_dwordx4 v216, s[16:19], s31 offen nt lds
    v_mfma_f32_16x16x32_bf16 v[124:127], v[244:247], v[44:47], v[124:127]
    ds_read_b128 v[240:243], v217 offset:8192
    v_add_u32 v217, s36, v217
    v_mfma_f32_16x16x32_bf16 v[128:131], v[244:247], v[68:71], v[128:131]
    buffer_load_dwordx4 v216, s[16:19], s31 offen offset:3072 nt lds
    v_mfma_f32_16x16x32_bf16 v[132:135], v[244:247], v[92:95], v[132:135]
    s_add_u32 m0, s39, 896
    v_exp_f32 v120, v120
    v_mfma_f32_16x16x32_bf16 v[136:139], v[244:247], v[116:119], v[136:139]
    s_waitcnt lgkmcnt(4)
    buffer_load_dwordx4 v216, s[16:19], s31 offen offset:128 nt lds
    v_mfma_f32_16x16x32_bf16 v[140:143], a[240:243], v[0:3], v[196:199]
    ds_read_b128 v[244:247], v218 offset:8192
    v_add_f32 v230, v230, v120
    v_mfma_f32_16x16x32_bf16 v[144:147], a[240:243], v[24:27], v[200:203]
    buffer_load_dwordx4 v216, s[16:19], s31 offen offset:3200 nt lds
    v_mfma_f32_16x16x32_bf16 v[148:151], a[240:243], v[48:51], v[204:207]
    s_add_u32 m0, s39, 1792
    v_exp_f32 v124, v124
    v_mfma_f32_16x16x32_bf16 v[152:155], a[240:243], v[72:75], v[208:211]
    s_add_u32 s39, s33, s35
    buffer_load_dwordx4 v216, s[16:19], s31 offen offset:256 nt lds
    v_mfma_f32_16x16x32_bf16 v[156:159], a[240:243], v[96:99], v[212:215]
    s_waitcnt lgkmcnt(4)
    ds_read_b64_tr_b16 a[240:241], v219 offset:0
    ds_read_b64_tr_b16 a[242:243], v219 offset:6144
    v_mfma_f32_16x16x32_bf16 v[140:143], a[244:247], v[4:7], v[140:143]
    buffer_load_dwordx4 v216, s[16:19], s31 offen offset:3328 nt lds
    v_mfma_f32_16x16x32_bf16 v[144:147], a[244:247], v[28:31], v[144:147]
    s_add_u32 m0, s46, 0
    v_exp_f32 v128, v128
    v_mfma_f32_16x16x32_bf16 v[148:151], a[244:247], v[52:55], v[148:151]
    s_add_u32 s31, s31, 12288
    v_exp_f32 v132, v132
    v_mfma_f32_16x16x32_bf16 v[152:155], a[244:247], v[76:79], v[152:155]
    v_exp_f32 v121, v121
    v_mfma_f32_16x16x32_bf16 v[156:159], a[244:247], v[100:103], v[156:159]
    s_waitcnt lgkmcnt(5)
    ds_read_b64_tr_b16 a[244:245], v220 offset:0
    ds_read_b64_tr_b16 a[246:247], v220 offset:6144
    v_mfma_f32_16x16x32_bf16 v[140:143], a[248:251], v[8:11], v[140:143]
    s_cmp_eq_u32 s43, 0
    s_cselect_b32 s14, 0, s14
    v_mfma_f32_16x16x32_bf16 v[144:147], a[248:251], v[32:35], v[144:147]
    v_exp_f32 v125, v125
    v_mfma_f32_16x16x32_bf16 v[148:151], a[248:251], v[56:59], v[148:151]
    v_exp_f32 v129, v129
    v_mfma_f32_16x16x32_bf16 v[152:155], a[248:251], v[80:83], v[152:155]
    v_add_f32 v231, v231, v124
    v_add_f32 v232, v232, v128
    v_mfma_f32_16x16x32_bf16 v[156:159], a[248:251], v[104:107], v[156:159]
    s_waitcnt lgkmcnt(6)
    ds_read_b64_tr_b16 a[248:249], v221 offset:0
    ds_read_b64_tr_b16 a[250:251], v221 offset:6144
    v_mfma_f32_16x16x32_bf16 v[140:143], a[252:255], v[12:15], v[140:143]
    v_exp_f32 v133, v133
    v_mfma_f32_16x16x32_bf16 v[144:147], a[252:255], v[36:39], v[144:147]
    v_add_f32 v233, v233, v132
    v_add_f32 v230, v230, v121
    v_mfma_f32_16x16x32_bf16 v[148:151], a[252:255], v[60:63], v[148:151]
    v_exp_f32 v122, v122
    v_mfma_f32_16x16x32_bf16 v[152:155], a[252:255], v[84:87], v[152:155]
    v_exp_f32 v126, v126
    v_mfma_f32_16x16x32_bf16 v[156:159], a[252:255], v[108:111], v[156:159]
    s_waitcnt lgkmcnt(7)
    ds_read_b64_tr_b16 a[252:253], v222 offset:0
    ds_read_b64_tr_b16 a[254:255], v222 offset:6144
    v_mfma_f32_16x16x32_bf16 v[140:143], v[240:243], v[16:19], v[140:143]
    v_exp_f32 v130, v130
    v_mfma_f32_16x16x32_bf16 v[144:147], v[240:243], v[40:43], v[144:147]
    s_cmp_ge_u32 s31, 196608
    s_cselect_b32 s31, 6144, s31
    v_mfma_f32_16x16x32_bf16 v[148:151], v[240:243], v[64:67], v[148:151]
    v_add_f32 v231, v231, v125
    v_add_f32 v232, v232, v129
    v_mfma_f32_16x16x32_bf16 v[152:155], v[240:243], v[88:91], v[152:155]
    v_exp_f32 v134, v134
    v_mfma_f32_16x16x32_bf16 v[156:159], v[240:243], v[112:115], v[156:159]
    s_waitcnt lgkmcnt(8)
    ds_read_b64_tr_b16 v[240:241], v219 offset:1024
    ds_read_b64_tr_b16 v[242:243], v219 offset:7168
    v_mfma_f32_16x16x32_bf16 v[140:143], v[244:247], v[20:23], v[140:143]
    v_add_u32 v218, s36, v218
    v_add_f32 v233, v233, v133
    v_mfma_f32_16x16x32_bf16 v[144:147], v[244:247], v[44:47], v[144:147]
    v_exp_f32 v123, v123
    v_mfma_f32_16x16x32_bf16 v[148:151], v[244:247], v[68:71], v[148:151]
    v_add_f32 v230, v230, v122
    v_add_f32 v231, v231, v126
    v_mfma_f32_16x16x32_bf16 v[152:155], v[244:247], v[92:95], v[152:155]
    v_exp_f32 v127, v127
    v_mfma_f32_16x16x32_bf16 v[156:159], v[244:247], v[116:119], v[156:159]
    s_waitcnt lgkmcnt(8)
    ds_read_b64_tr_b16 v[244:245], v220 offset:1024
    ds_read_b64_tr_b16 v[246:247], v220 offset:7168
    v_mfma_f32_16x16x32_bf16 a[0:3], a[240:243], v[160:163], a[0:3]
    v_exp_f32 v131, v131
    v_mfma_f32_16x16x32_bf16 a[48:51], a[240:243], v[164:167], a[48:51]
    v_add_f32 v232, v232, v130
    v_add_f32 v233, v233, v134
    v_mfma_f32_16x16x32_bf16 a[96:99], a[240:243], v[168:171], a[96:99]
    v_exp_f32 v135, v135
    v_mfma_f32_16x16x32_bf16 a[144:147], a[240:243], v[172:175], a[144:147]
    s_waitcnt lgkmcnt(8)
    ds_read_b64_tr_b16 a[240:241], v221 offset:1024
    ds_read_b64_tr_b16 a[242:243], v221 offset:7168
    v_mfma_f32_16x16x32_bf16 a[4:7], a[244:247], v[160:163], a[4:7]
    v_add_f32 v230, v230, v123
    v_cvt_pk_bf16_f32 v176, v120, v121
    v_mfma_f32_16x16x32_bf16 a[52:55], a[244:247], v[164:167], a[52:55]
    v_cvt_pk_bf16_f32 v177, v122, v123
    v_add_f32 v231, v231, v127
    v_mfma_f32_16x16x32_bf16 a[100:103], a[244:247], v[168:171], a[100:103]
    v_exp_f32 v140, v140
    v_mfma_f32_16x16x32_bf16 a[148:151], a[244:247], v[172:175], a[148:151]
    s_waitcnt lgkmcnt(8)
    ds_read_b64_tr_b16 a[244:245], v222 offset:1024
    ds_read_b64_tr_b16 a[246:247], v222 offset:7168
    v_mfma_f32_16x16x32_bf16 a[8:11], a[248:251], v[160:163], a[8:11]
    v_cvt_pk_bf16_f32 v180, v124, v125
    v_cvt_pk_bf16_f32 v181, v126, v127
    v_mfma_f32_16x16x32_bf16 a[56:59], a[248:251], v[164:167], a[56:59]
    v_add_f32 v232, v232, v131
    v_cvt_pk_bf16_f32 v184, v128, v129
    v_mfma_f32_16x16x32_bf16 a[104:107], a[248:251], v[168:171], a[104:107]
    v_cvt_pk_bf16_f32 v185, v130, v131
    v_add_f32 v233, v233, v135
    v_mfma_f32_16x16x32_bf16 a[152:155], a[248:251], v[172:175], a[152:155]
    s_waitcnt lgkmcnt(8)
    ds_read_b64_tr_b16 a[248:249], v219 offset:2048
    ds_read_b64_tr_b16 a[250:251], v219 offset:8192
    v_mfma_f32_16x16x32_bf16 a[12:15], a[252:255], v[160:163], a[12:15]
    v_cvt_pk_bf16_f32 v188, v132, v133
    v_cvt_pk_bf16_f32 v189, v134, v135
    v_mfma_f32_16x16x32_bf16 a[60:63], a[252:255], v[164:167], a[60:63]
    v_exp_f32 v144, v144
    v_mfma_f32_16x16x32_bf16 a[108:111], a[252:255], v[168:171], a[108:111]
    v_exp_f32 v148, v148
    v_mfma_f32_16x16x32_bf16 a[156:159], a[252:255], v[172:175], a[156:159]
    s_waitcnt lgkmcnt(8)
    ds_read_b64_tr_b16 a[252:253], v220 offset:2048
    ds_read_b64_tr_b16 a[254:255], v220 offset:8192
    v_mfma_f32_16x16x32_bf16 a[16:19], v[240:243], v[160:163], a[16:19]
    v_exp_f32 v141, v141
    v_mfma_f32_16x16x32_bf16 a[64:67], v[240:243], v[164:167], a[64:67]
    v_add_f32 v230, v230, v140
    v_add_f32 v231, v231, v144
    v_mfma_f32_16x16x32_bf16 a[112:115], v[240:243], v[168:171], a[112:115]
    s_waitcnt vmcnt(3)
    s_barrier
    v_add_f32 v232, v232, v148
    v_mfma_f32_16x16x32_bf16 a[160:163], v[240:243], v[172:175], a[160:163]
    s_waitcnt lgkmcnt(8)
    buffer_load_dwordx4 v216, s[12:15], s30 offen nt lds
    v_mfma_f32_16x16x32_bf16 a[20:23], v[244:247], v[160:163], a[20:23]
    ds_read_b64_tr_b16 v[240:241], v221 offset:2048
    ds_read_b64_tr_b16 v[242:243], v221 offset:8192
    v_mfma_f32_16x16x32_bf16 a[68:71], v[244:247], v[164:167], a[68:71]
    buffer_load_dwordx4 v216, s[12:15], s30 offen offset:3072 nt lds
    v_mfma_f32_16x16x32_bf16 a[116:119], v[244:247], v[168:171], a[116:119]
    s_add_u32 m0, s46, 896
    v_exp_f32 v145, v145
    v_mfma_f32_16x16x32_bf16 a[164:167], v[244:247], v[172:175], a[164:167]
    s_waitcnt lgkmcnt(8)
    buffer_load_dwordx4 v216, s[12:15], s30 offen offset:128 nt lds
    v_mfma_f32_16x16x32_bf16 a[24:27], a[240:243], v[160:163], a[24:27]
    ds_read_b64_tr_b16 v[244:245], v222 offset:2048
    ds_read_b64_tr_b16 v[246:247], v222 offset:8192
    v_mfma_f32_16x16x32_bf16 a[72:75], a[240:243], v[164:167], a[72:75]
    buffer_load_dwordx4 v216, s[12:15], s30 offen offset:3200 nt lds
    v_mfma_f32_16x16x32_bf16 a[120:123], a[240:243], v[168:171], a[120:123]
    s_add_u32 m0, s46, 1792
    v_exp_f32 v152, v152
    v_mfma_f32_16x16x32_bf16 a[168:171], a[240:243], v[172:175], a[168:171]
    s_waitcnt lgkmcnt(8)
    buffer_load_dwordx4 v216, s[12:15], s30 offen offset:256 nt lds
    v_mfma_f32_16x16x32_bf16 a[28:31], a[244:247], v[160:163], a[28:31]
    s_mov_b32 s46, s32
    ds_read_b128 a[240:243], v217 offset:0
    v_add_f32 v230, v230, v141
    v_mfma_f32_16x16x32_bf16 a[76:79], a[244:247], v[164:167], a[76:79]
    buffer_load_dwordx4 v216, s[12:15], s30 offen offset:3328 nt lds
    v_mfma_f32_16x16x32_bf16 a[124:127], a[244:247], v[168:171], a[124:127]
    s_add_u32 m0, s39, 0
    v_exp_f32 v149, v149
    v_mfma_f32_16x16x32_bf16 a[172:175], a[244:247], v[172:175], a[172:175]
    s_waitcnt lgkmcnt(7)
    ds_read_b128 a[244:247], v218 offset:0
    v_add_f32 v231, v231, v145
    v_mfma_f32_16x16x32_bf16 a[32:35], a[248:251], v[160:163], a[32:35]
    s_add_u32 s30, s30, 12288
    v_exp_f32 v142, v142
    v_mfma_f32_16x16x32_bf16 a[80:83], a[248:251], v[164:167], a[80:83]
    v_exp_f32 v146, v146
    v_mfma_f32_16x16x32_bf16 a[128:131], a[248:251], v[168:171], a[128:131]
    v_exp_f32 v153, v153
    v_mfma_f32_16x16x32_bf16 a[176:179], a[248:251], v[172:175], a[176:179]
    s_waitcnt lgkmcnt(6)
    ds_read_b128 a[248:251], v217 offset:1024
    v_add_f32 v233, v233, v152
    v_mfma_f32_16x16x32_bf16 a[36:39], a[252:255], v[160:163], a[36:39]
    v_exp_f32 v150, v150
    v_mfma_f32_16x16x32_bf16 a[84:87], a[252:255], v[164:167], a[84:87]
    v_add_f32 v232, v232, v149
    v_add_f32 v230, v230, v142
    v_mfma_f32_16x16x32_bf16 a[132:135], a[252:255], v[168:171], a[132:135]
    v_exp_f32 v143, v143
    v_mfma_f32_16x16x32_bf16 a[180:183], a[252:255], v[172:175], a[180:183]
    s_waitcnt lgkmcnt(5)
    ds_read_b128 a[252:255], v218 offset:1024
    v_add_f32 v231, v231, v146
    v_mfma_f32_16x16x32_bf16 a[40:43], v[240:243], v[160:163], a[40:43]
    v_exp_f32 v147, v147
    v_mfma_f32_16x16x32_bf16 a[88:91], v[240:243], v[164:167], a[88:91]
    v_exp_f32 v154, v154
    v_mfma_f32_16x16x32_bf16 a[136:139], v[240:243], v[168:171], a[136:139]
    v_exp_f32 v151, v151
    v_mfma_f32_16x16x32_bf16 a[184:187], v[240:243], v[172:175], a[184:187]
    s_waitcnt lgkmcnt(4)
    ds_read_b128 v[240:243], v217 offset:2048
    v_add_f32 v233, v233, v153
    v_mfma_f32_16x16x32_bf16 a[44:47], v[244:247], v[160:163], a[44:47]
    v_add_f32 v232, v232, v150
    v_add_f32 v230, v230, v143
    v_mfma_f32_16x16x32_bf16 a[92:95], v[244:247], v[164:167], a[92:95]
    v_cvt_pk_bf16_f32 v178, v140, v141
    v_cvt_pk_bf16_f32 v179, v142, v143
    v_mfma_f32_16x16x32_bf16 a[140:143], v[244:247], v[168:171], a[140:143]
    v_add_f32 v231, v231, v147
    v_cvt_pk_bf16_f32 v182, v144, v145
    v_mfma_f32_16x16x32_bf16 a[188:191], v[244:247], v[172:175], a[188:191]
    s_waitcnt lgkmcnt(4)
    ds_read_b128 v[244:247], v218 offset:2048
    v_cvt_pk_bf16_f32 v183, v146, v147
    s_sub_u32 s43, s43, 1
    s_cbranch_scc0 K_al1
    v_mfma_f32_16x16x32_bf16 v[120:123], a[240:243], v[0:3], v[196:199]
    s_add_u32 s38, s44, 0
    v_exp_f32 v155, v155
    v_mfma_f32_16x16x32_bf16 v[124:127], a[240:243], v[24:27], v[200:203]
    v_add_f32 v233, v233, v154
    v_add_f32 v232, v232, v151
    v_mfma_f32_16x16x32_bf16 v[128:131], a[240:243], v[48:51], v[204:207]
    v_cvt_pk_bf16_f32 v186, v148, v149
    v_cvt_pk_bf16_f32 v187, v150, v151
    v_mfma_f32_16x16x32_bf16 v[132:135], a[240:243], v[72:75], v[208:211]
    s_waitcnt lgkmcnt(4)
    ds_read_b128 a[240:243], v217 offset:6144
    v_add_f32 v233, v233, v155
    v_mfma_f32_16x16x32_bf16 v[120:123], a[244:247], v[4:7], v[120:123]
    v_cvt_pk_bf16_f32 v190, v152, v153
    v_cvt_pk_bf16_f32 v191, v154, v155
    v_mfma_f32_16x16x32_bf16 v[124:127], a[244:247], v[28:31], v[124:127]
    v_add_u32 v219, s37, v219
    v_add_u32 v220, s37, v220
    v_mfma_f32_16x16x32_bf16 v[128:131], a[244:247], v[52:55], v[128:131]
    v_add_u32 v221, s37, v221
    v_add_u32 v222, s37, v222
    v_mfma_f32_16x16x32_bf16 v[132:135], a[244:247], v[76:79], v[132:135]
    s_waitcnt lgkmcnt(4)
    ds_read_b128 a[244:247], v218 offset:6144
    s_mov_b32 s37, s36
    v_mfma_f32_16x16x32_bf16 v[120:123], a[248:251], v[8:11], v[120:123]
    s_sub_u32 s36, s33, s32
    v_exp_f32 v136, v136
    v_mfma_f32_16x16x32_bf16 v[124:127], a[248:251], v[32:35], v[124:127]
    s_mov_b32 s32, s33
    v_exp_f32 v137, v137
    v_mfma_f32_16x16x32_bf16 v[128:131], a[248:251], v[56:59], v[128:131]
    s_mov_b32 s33, s34
    v_exp_f32 v138, v138
    v_mfma_f32_16x16x32_bf16 v[132:135], a[248:251], v[80:83], v[132:135]
    s_waitcnt lgkmcnt(4)
    ds_read_b128 a[248:251], v217 offset:7168
    v_cvt_pk_bf16_f32 v192, v136, v137
    v_mfma_f32_16x16x32_bf16 v[120:123], a[252:255], v[12:15], v[120:123]
    v_exp_f32 v139, v139
    v_mfma_f32_16x16x32_bf16 v[124:127], a[252:255], v[36:39], v[124:127]
    v_exp_f32 v156, v156
    v_mfma_f32_16x16x32_bf16 v[128:131], a[252:255], v[60:63], v[128:131]
    v_exp_f32 v157, v157
    v_mfma_f32_16x16x32_bf16 v[132:135], a[252:255], v[84:87], v[132:135]
    s_waitcnt lgkmcnt(4)
    ds_read_b128 a[252:255], v218 offset:7168
    v_cvt_pk_bf16_f32 v193, v138, v139
    v_mfma_f32_16x16x32_bf16 v[120:123], v[240:243], v[16:19], v[120:123]
    v_exp_f32 v158, v158
    v_mfma_f32_16x16x32_bf16 v[124:127], v[240:243], v[40:43], v[124:127]
    v_exp_f32 v159, v159
    v_mfma_f32_16x16x32_bf16 v[128:131], v[240:243], v[64:67], v[128:131]
    v_cvt_pk_bf16_f32 v194, v156, v157
    v_cvt_pk_bf16_f32 v195, v158, v159
    v_mfma_f32_16x16x32_bf16 v[132:135], v[240:243], v[88:91], v[132:135]
    s_waitcnt lgkmcnt(4)
    ds_read_b128 v[240:243], v217 offset:8192
    v_add_f32 v234, v234, v136
    v_mfma_f32_16x16x32_bf16 v[120:123], v[244:247], v[20:23], v[120:123]
    s_add_u32 s12, s12, 3145728
    s_addc_u32 s13, s13, 0
    v_mfma_f32_16x16x32_bf16 v[124:127], v[244:247], v[44:47], v[124:127]
    s_mul_i32 s14, s75, 196608
    s_cmp_ge_u32 s30, 196608
    s_cselect_b32 s30, 6144, s30
    v_mfma_f32_16x16x32_bf16 v[128:131], v[244:247], v[68:71], v[128:131]
    v_add_u32 v217, s36, v217
    v_add_f32 v234, v234, v137
    v_mfma_f32_16x16x32_bf16 v[132:135], v[244:247], v[92:95], v[132:135]
    s_waitcnt lgkmcnt(4)
    ds_read_b128 v[244:247], v218 offset:8192
    v_add_u32 v218, s36, v218
    v_mfma_f32_16x16x32_bf16 v[140:143], a[240:243], v[0:3], v[196:199]
    s_waitcnt vmcnt(18)
    s_barrier
    v_add_f32 v234, v234, v138
    v_mfma_f32_16x16x32_bf16 v[144:147], a[240:243], v[24:27], v[200:203]
    buffer_load_dwordx4 v216, s[16:19], s31 offen nt lds
    v_mfma_f32_16x16x32_bf16 v[148:151], a[240:243], v[48:51], v[204:207]
    v_exp_f32 v120, v120
    v_mfma_f32_16x16x32_bf16 v[152:155], a[240:243], v[72:75], v[208:211]
    s_waitcnt lgkmcnt(4)
    ds_read_b64_tr_b16 a[240:241], v219 offset:0
    ds_read_b64_tr_b16 a[242:243], v219 offset:6144
    v_mfma_f32_16x16x32_bf16 v[140:143], a[244:247], v[4:7], v[140:143]
    buffer_load_dwordx4 v216, s[16:19], s31 offen offset:3072 nt lds
    v_mfma_f32_16x16x32_bf16 v[144:147], a[244:247], v[28:31], v[144:147]
    s_add_u32 m0, s39, 896
    v_exp_f32 v124, v124
    v_mfma_f32_16x16x32_bf16 v[148:151], a[244:247], v[52:55], v[148:151]
    v_exp_f32 v128, v128
    v_mfma_f32_16x16x32_bf16 v[152:155], a[244:247], v[76:79], v[152:155]
    s_waitcnt lgkmcnt(5)
    buffer_load_dwordx4 v216, s[16:19], s31 offen offset:128 nt lds
    v_mfma_f32_16x16x32_bf16 v[140:143], a[248:251], v[8:11], v[140:143]
    ds_read_b64_tr_b16 a[244:245], v220 offset:0
    ds_read_b64_tr_b16 a[246:247], v220 offset:6144
    v_mfma_f32_16x16x32_bf16 v[144:147], a[248:251], v[32:35], v[144:147]
    v_exp_f32 v132, v132
    v_mfma_f32_16x16x32_bf16 v[148:151], a[248:251], v[56:59], v[148:151]
    buffer_load_dwordx4 v216, s[16:19], s31 offen offset:3200 nt lds
    v_mfma_f32_16x16x32_bf16 v[152:155], a[248:251], v[80:83], v[152:155]
    s_waitcnt lgkmcnt(6)
    s_add_u32 m0, s39, 1792
    ds_read_b64_tr_b16 a[248:249], v221 offset:0
    v_mfma_f32_16x16x32_bf16 v[140:143], a[252:255], v[12:15], v[140:143]
    ds_read_b64_tr_b16 a[250:251], v221 offset:6144
    v_add_f32 v230, v230, v120
    v_mfma_f32_16x16x32_bf16 v[144:147], a[252:255], v[36:39], v[144:147]
    buffer_load_dwordx4 v216, s[16:19], s31 offen offset:256 nt lds
    v_mfma_f32_16x16x32_bf16 v[148:151], a[252:255], v[60:63], v[148:151]
    v_exp_f32 v121, v121
    v_mfma_f32_16x16x32_bf16 v[152:155], a[252:255], v[84:87], v[152:155]
    s_waitcnt lgkmcnt(7)
    ds_read_b64_tr_b16 a[252:253], v222 offset:0
    ds_read_b64_tr_b16 a[254:255], v222 offset:6144
    v_mfma_f32_16x16x32_bf16 v[140:143], v[240:243], v[16:19], v[140:143]
    buffer_load_dwordx4 v216, s[16:19], s31 offen offset:3328 nt lds
    v_mfma_f32_16x16x32_bf16 v[144:147], v[240:243], v[40:43], v[144:147]
    s_add_u32 m0, s34, 0
    v_exp_f32 v125, v125
    v_mfma_f32_16x16x32_bf16 v[148:151], v[240:243], v[64:67], v[148:151]
    s_add_u32 s31, s31, 12288
    v_add_f32 v231, v231, v124
    v_add_f32 v232, v232, v128
    v_mfma_f32_16x16x32_bf16 v[152:155], v[240:243], v[88:91], v[152:155]
    s_waitcnt lgkmcnt(8)
    ds_read_b64_tr_b16 v[240:241], v219 offset:1024
    ds_read_b64_tr_b16 v[242:243], v219 offset:7168
    v_mfma_f32_16x16x32_bf16 v[140:143], v[244:247], v[20:23], v[140:143]
    v_exp_f32 v129, v129
    v_mfma_f32_16x16x32_bf16 v[144:147], v[244:247], v[44:47], v[144:147]
    v_exp_f32 v133, v133
    v_mfma_f32_16x16x32_bf16 v[148:151], v[244:247], v[68:71], v[148:151]
    v_add_f32 v233, v233, v132
    v_add_f32 v230, v230, v121
    v_mfma_f32_16x16x32_bf16 v[152:155], v[244:247], v[92:95], v[152:155]
    s_waitcnt lgkmcnt(8)
    ds_read_b64_tr_b16 v[244:245], v220 offset:1024
    ds_read_b64_tr_b16 v[246:247], v220 offset:7168
    v_mfma_f32_16x16x32_bf16 a[0:3], a[240:243], v[176:179], a[0:3]
    v_exp_f32 v122, v122
    v_mfma_f32_16x16x32_bf16 a[48:51], a[240:243], v[180:183], a[48:51]
    v_exp_f32 v126, v126
    v_mfma_f32_16x16x32_bf16 a[96:99], a[240:243], v[184:187], a[96:99]
    v_exp_f32 v130, v130
    v_mfma_f32_16x16x32_bf16 a[144:147], a[240:243], v[188:191], a[144:147]
    v_add_f32 v231, v231, v125
    v_add_f32 v232, v232, v129
    v_mfma_f32_16x16x32_bf16 a[192:195], a[240:243], v[192:195], a[192:195]
    s_waitcnt lgkmcnt(8)
    ds_read_b64_tr_b16 a[240:241], v221 offset:1024
    ds_read_b64_tr_b16 a[242:243], v221 offset:7168
    v_mfma_f32_16x16x32_bf16 a[4:7], a[244:247], v[176:179], a[4:7]
    s_cmp_ge_u32 s31, 196608
    s_cselect_b32 s31, 6144, s31
    v_mfma_f32_16x16x32_bf16 a[52:55], a[244:247], v[180:183], a[52:55]
    buffer_load_dwordx4 v216, s[12:15], s30 offen nt lds
    v_mfma_f32_16x16x32_bf16 a[100:103], a[244:247], v[184:187], a[100:103]
    v_exp_f32 v134, v134
    v_mfma_f32_16x16x32_bf16 a[148:151], a[244:247], v[188:191], a[148:151]
    v_add_f32 v233, v233, v133
    v_add_f32 v230, v230, v122
    v_mfma_f32_16x16x32_bf16 a[196:199], a[244:247], v[192:195], a[196:199]
    s_waitcnt lgkmcnt(8)
    buffer_load_dwordx4 v216, s[12:15], s30 offen offset:3072 nt lds
    v_mfma_f32_16x16x32_bf16 a[8:11], a[248:251], v[176:179], a[8:11]
    s_add_u32 m0, s34, 896
    ds_read_b64_tr_b16 a[244:245], v222 offset:1024
    ds_read_b64_tr_b16 a[246:247], v222 offset:7168
    v_mfma_f32_16x16x32_bf16 a[56:59], a[248:251], v[180:183], a[56:59]
    v_exp_f32 v123, v123
    v_mfma_f32_16x16x32_bf16 a[104:107], a[248:251], v[184:187], a[104:107]
    buffer_load_dwordx4 v216, s[12:15], s30 offen offset:128 nt lds
    v_mfma_f32_16x16x32_bf16 a[152:155], a[248:251], v[188:191], a[152:155]
    v_exp_f32 v127, v127
    v_mfma_f32_16x16x32_bf16 a[200:203], a[248:251], v[192:195], a[200:203]
    s_waitcnt lgkmcnt(8)
    ds_read_b64_tr_b16 a[248:249], v219 offset:2048
    ds_read_b64_tr_b16 a[250:251], v219 offset:8192
    v_mfma_f32_16x16x32_bf16 a[12:15], a[252:255], v[176:179], a[12:15]
    buffer_load_dwordx4 v216, s[12:15], s30 offen offset:3200 nt lds
    v_mfma_f32_16x16x32_bf16 a[60:63], a[252:255], v[180:183], a[60:63]
    s_add_u32 m0, s34, 1792
    v_add_f32 v231, v231, v126
    v_add_f32 v232, v232, v130
    v_mfma_f32_16x16x32_bf16 a[108:111], a[252:255], v[184:187], a[108:111]
    s_mov_b32 s34, s46
    v_exp_f32 v131, v131
    v_mfma_f32_16x16x32_bf16 a[156:159], a[252:255], v[188:191], a[156:159]
    s_mov_b32 s46, s32
    buffer_load_dwordx4 v216, s[12:15], s30 offen offset:256 nt lds
    v_mfma_f32_16x16x32_bf16 a[204:207], a[252:255], v[192:195], a[204:207]
    s_waitcnt lgkmcnt(8)
    ds_read_b64_tr_b16 a[252:253], v220 offset:2048
    ds_read_b64_tr_b16 a[254:255], v220 offset:8192
    v_mfma_f32_16x16x32_bf16 a[16:19], v[240:243], v[176:179], a[16:19]
    v_exp_f32 v135, v135
    v_mfma_f32_16x16x32_bf16 a[64:67], v[240:243], v[180:183], a[64:67]
    buffer_load_dwordx4 v216, s[12:15], s30 offen offset:3328 nt lds
    v_mfma_f32_16x16x32_bf16 a[112:115], v[240:243], v[184:187], a[112:115]
    s_add_u32 s30, s30, 12288
    v_add_f32 v233, v233, v134
    v_add_f32 v230, v230, v123
    v_mfma_f32_16x16x32_bf16 a[160:163], v[240:243], v[188:191], a[160:163]
    s_add_u32 m0, s32, 0
    v_cvt_pk_bf16_f32 v160, v120, v121
    v_cvt_pk_bf16_f32 v161, v122, v123
    v_mfma_f32_16x16x32_bf16 a[208:211], v[240:243], v[192:195], a[208:211]
    s_waitcnt lgkmcnt(8)
    ds_read_b64_tr_b16 v[240:241], v221 offset:2048
    ds_read_b64_tr_b16 v[242:243], v221 offset:8192
    v_mfma_f32_16x16x32_bf16 a[20:23], v[244:247], v[176:179], a[20:23]
    v_add_f32 v231, v231, v127
    v_cvt_pk_bf16_f32 v164, v124, v125
    v_mfma_f32_16x16x32_bf16 a[68:71], v[244:247], v[180:183], a[68:71]
    v_exp_f32 v140, v140
    v_mfma_f32_16x16x32_bf16 a[116:119], v[244:247], v[184:187], a[116:119]
    v_cvt_pk_bf16_f32 v165, v126, v127
    v_add_f32 v232, v232, v131
    v_mfma_f32_16x16x32_bf16 a[164:167], v[244:247], v[188:191], a[164:167]
    v_cvt_pk_bf16_f32 v168, v128, v129
    v_cvt_pk_bf16_f32 v169, v130, v131
    v_mfma_f32_16x16x32_bf16 a[212:215], v[244:247], v[192:195], a[212:215]
    s_waitcnt lgkmcnt(8)
    ds_read_b64_tr_b16 v[244:245], v222 offset:2048
    ds_read_b64_tr_b16 v[246:247], v222 offset:8192
    v_mfma_f32_16x16x32_bf16 a[24:27], a[240:243], v[176:179], a[24:27]
    s_waitcnt vmcnt(24)
    s_barrier
    v_add_f32 v233, v233, v135
    v_mfma_f32_16x16x32_bf16 a[72:75], a[240:243], v[180:183], a[72:75]
    v_cvt_pk_bf16_f32 v172, v132, v133
    v_cvt_pk_bf16_f32 v173, v134, v135
    v_mfma_f32_16x16x32_bf16 a[120:123], a[240:243], v[184:187], a[120:123]
    v_exp_f32 v144, v144
    v_mfma_f32_16x16x32_bf16 a[168:171], a[240:243], v[188:191], a[168:171]
    v_exp_f32 v148, v148
    v_mfma_f32_16x16x32_bf16 a[216:219], a[240:243], v[192:195], a[216:219]
    s_waitcnt lgkmcnt(8)
    ds_read_b128 a[240:243], v217 offset:0
    v_add_f32 v234, v234, v139
    v_mfma_f32_16x16x32_bf16 a[28:31], a[244:247], v[176:179], a[28:31]
    v_exp_f32 v152, v152
    v_mfma_f32_16x16x32_bf16 a[76:79], a[244:247], v[180:183], a[76:79]
    v_exp_f32 v141, v141
    v_mfma_f32_16x16x32_bf16 a[124:127], a[244:247], v[184:187], a[124:127]
    v_add_f32 v230, v230, v140
    v_add_f32 v231, v231, v144
    v_mfma_f32_16x16x32_bf16 a[172:175], a[244:247], v[188:191], a[172:175]
    v_exp_f32 v145, v145
    v_mfma_f32_16x16x32_bf16 a[220:223], a[244:247], v[192:195], a[220:223]
    s_waitcnt lgkmcnt(7)
    ds_read_b128 a[244:247], v218 offset:0
    v_add_f32 v232, v232, v148
    v_mfma_f32_16x16x32_bf16 a[32:35], a[248:251], v[176:179], a[32:35]
    v_exp_f32 v149, v149
    v_mfma_f32_16x16x32_bf16 a[80:83], a[248:251], v[180:183], a[80:83]
    v_exp_f32 v153, v153
    v_mfma_f32_16x16x32_bf16 a[128:131], a[248:251], v[184:187], a[128:131]
    v_exp_f32 v142, v142
    v_mfma_f32_16x16x32_bf16 a[176:179], a[248:251], v[188:191], a[176:179]
    v_add_f32 v233, v233, v152
    v_add_f32 v230, v230, v141
    v_mfma_f32_16x16x32_bf16 a[224:227], a[248:251], v[192:195], a[224:227]
    s_waitcnt lgkmcnt(6)
    ds_read_b128 a[248:251], v217 offset:1024
    v_add_f32 v234, v234, v156
    v_mfma_f32_16x16x32_bf16 a[36:39], a[252:255], v[176:179], a[36:39]
    v_exp_f32 v146, v146
    v_mfma_f32_16x16x32_bf16 a[84:87], a[252:255], v[180:183], a[84:87]
    v_exp_f32 v150, v150
    v_mfma_f32_16x16x32_bf16 a[132:135], a[252:255], v[184:187], a[132:135]
    v_exp_f32 v154, v154
    v_mfma_f32_16x16x32_bf16 a[180:183], a[252:255], v[188:191], a[180:183]
    v_add_f32 v231, v231, v145
    v_add_f32 v232, v232, v149
    v_mfma_f32_16x16x32_bf16 a[228:231], a[252:255], v[192:195], a[228:231]
    s_waitcnt lgkmcnt(5)
    ds_read_b128 a[252:255], v218 offset:1024
    v_add_f32 v233, v233, v153
    v_mfma_f32_16x16x32_bf16 a[40:43], v[240:243], v[176:179], a[40:43]
    v_exp_f32 v143, v143
    v_mfma_f32_16x16x32_bf16 a[88:91], v[240:243], v[180:183], a[88:91]
    v_add_f32 v230, v230, v142
    v_add_f32 v234, v234, v157
    v_mfma_f32_16x16x32_bf16 a[136:139], v[240:243], v[184:187], a[136:139]
    v_exp_f32 v147, v147
    v_mfma_f32_16x16x32_bf16 a[184:187], v[240:243], v[188:191], a[184:187]
    v_add_f32 v231, v231, v146
    v_add_f32 v232, v232, v150
    v_mfma_f32_16x16x32_bf16 a[232:235], v[240:243], v[192:195], a[232:235]
    s_waitcnt lgkmcnt(4)
    ds_read_b128 v[240:243], v217 offset:2048
    v_add_f32 v233, v233, v154
    v_mfma_f32_16x16x32_bf16 a[44:47], v[244:247], v[176:179], a[44:47]
    v_exp_f32 v151, v151
    v_mfma_f32_16x16x32_bf16 a[92:95], v[244:247], v[180:183], a[92:95]
    v_exp_f32 v155, v155
    v_mfma_f32_16x16x32_bf16 a[140:143], v[244:247], v[184:187], a[140:143]
    v_add_f32 v230, v230, v143
    v_cvt_pk_bf16_f32 v162, v140, v141
    v_mfma_f32_16x16x32_bf16 a[188:191], v[244:247], v[188:191], a[188:191]
    v_cvt_pk_bf16_f32 v163, v142, v143
    v_add_f32 v234, v234, v158
    v_mfma_f32_16x16x32_bf16 a[236:239], v[244:247], v[192:195], a[236:239]
    s_waitcnt lgkmcnt(4)
    ds_read_b128 v[244:247], v218 offset:2048
    v_add_f32 v231, v231, v147
    v_mfma_f32_16x16x32_bf16 v[120:123], a[240:243], v[0:3], v[196:199]
    v_cvt_pk_bf16_f32 v166, v144, v145
    v_cvt_pk_bf16_f32 v167, v146, v147
    v_mfma_f32_16x16x32_bf16 v[124:127], a[240:243], v[24:27], v[200:203]
    v_add_u32 v221, s37, v221
    v_add_f32 v232, v232, v151
    v_mfma_f32_16x16x32_bf16 v[128:131], a[240:243], v[48:51], v[204:207]
    v_cvt_pk_bf16_f32 v170, v148, v149
    v_cvt_pk_bf16_f32 v171, v150, v151
    v_mfma_f32_16x16x32_bf16 v[132:135], a[240:243], v[72:75], v[208:211]
    s_cmp_ge_u32 s30, 196608
    s_cselect_b32 s30, 6144, s30
    v_mfma_f32_16x16x32_bf16 v[136:139], a[240:243], v[96:99], v[212:215]
    s_waitcnt lgkmcnt(4)
    ds_read_b128 a[240:243], v217 offset:6144
    s_mov_b32 s30, s48
    v_mfma_f32_16x16x32_bf16 v[120:123], a[244:247], v[4:7], v[120:123]
    v_add_f32 v233, v233, v155
    v_cvt_pk_bf16_f32 v174, v152, v153
    v_mfma_f32_16x16x32_bf16 v[124:127], a[244:247], v[28:31], v[124:127]
    v_cvt_pk_bf16_f32 v175, v154, v155
    v_add_f32 v234, v234, v159
    v_mfma_f32_16x16x32_bf16 v[128:131], a[244:247], v[52:55], v[128:131]
    v_add_u32 v222, s37, v222
    v_add_u32 v219, s37, v219
    v_mfma_f32_16x16x32_bf16 v[132:135], a[244:247], v[76:79], v[132:135]
    s_lshl_b32 s74, s0, 3
    v_add_u32 v220, s37, v220
    v_mov_b32 v252, 0
    v_mfma_f32_16x16x32_bf16 v[136:139], a[244:247], v[100:103], v[136:139]
    s_waitcnt lgkmcnt(4)
    ds_read_b128 a[244:247], v218 offset:6144
    v_mov_b32 v254, 0
    v_mfma_f32_16x16x32_bf16 v[120:123], a[248:251], v[8:11], v[120:123]
    s_mov_b32 s37, s36
    s_sub_u32 s36, s33, s32
    v_mfma_f32_16x16x32_bf16 v[124:127], a[248:251], v[32:35], v[124:127]
    v_mfma_f32_16x16x32_bf16 v[128:131], a[248:251], v[56:59], v[128:131]
    v_mfma_f32_16x16x32_bf16 v[132:135], a[248:251], v[80:83], v[132:135]
    v_mfma_f32_16x16x32_bf16 v[136:139], a[248:251], v[104:107], v[136:139]
    s_waitcnt lgkmcnt(4)
    ds_read_b128 a[248:251], v217 offset:7168
    v_mfma_f32_16x16x32_bf16 v[120:123], a[252:255], v[12:15], v[120:123]
    v_mfma_f32_16x16x32_bf16 v[124:127], a[252:255], v[36:39], v[124:127]
    v_mfma_f32_16x16x32_bf16 v[128:131], a[252:255], v[60:63], v[128:131]
    v_mfma_f32_16x16x32_bf16 v[132:135], a[252:255], v[84:87], v[132:135]
    v_mfma_f32_16x16x32_bf16 v[136:139], a[252:255], v[108:111], v[136:139]
    s_waitcnt lgkmcnt(4)
    ds_read_b128 a[252:255], v218 offset:7168
    v_mfma_f32_16x16x32_bf16 v[120:123], v[240:243], v[16:19], v[120:123]
    v_mfma_f32_16x16x32_bf16 v[124:127], v[240:243], v[40:43], v[124:127]
    v_mfma_f32_16x16x32_bf16 v[128:131], v[240:243], v[64:67], v[128:131]
    v_mfma_f32_16x16x32_bf16 v[132:135], v[240:243], v[88:91], v[132:135]
    v_mfma_f32_16x16x32_bf16 v[136:139], v[240:243], v[112:115], v[136:139]
    s_waitcnt lgkmcnt(4)
    s_waitcnt vmcnt(18)
    s_barrier
    v_mfma_f32_16x16x32_bf16 v[120:123], v[244:247], v[20:23], v[120:123]
    ds_read_b128 v[240:243], v217 offset:8192
    v_add_u32 v217, s36, v217
    v_mfma_f32_16x16x32_bf16 v[124:127], v[244:247], v[44:47], v[124:127]
    v_mfma_f32_16x16x32_bf16 v[128:131], v[244:247], v[68:71], v[128:131]
    v_mfma_f32_16x16x32_bf16 v[132:135], v[244:247], v[92:95], v[132:135]
    v_exp_f32 v120, v120
    v_mfma_f32_16x16x32_bf16 v[136:139], v[244:247], v[116:119], v[136:139]
    s_waitcnt lgkmcnt(4)
    ds_read_b128 v[244:247], v218 offset:8192
    v_add_f32 v230, v230, v120
    v_mfma_f32_16x16x32_bf16 v[140:143], a[240:243], v[0:3], v[196:199]
    v_exp_f32 v121, v121
    v_mfma_f32_16x16x32_bf16 v[144:147], a[240:243], v[24:27], v[200:203]
    v_exp_f32 v122, v122
    v_mfma_f32_16x16x32_bf16 v[148:151], a[240:243], v[48:51], v[204:207]
    v_exp_f32 v123, v123
    v_mfma_f32_16x16x32_bf16 v[152:155], a[240:243], v[72:75], v[208:211]
    v_exp_f32 v124, v124
    v_mfma_f32_16x16x32_bf16 v[156:159], a[240:243], v[96:99], v[212:215]
    s_waitcnt lgkmcnt(4)
    ds_read_b64_tr_b16 a[240:241], v219 offset:0
    ds_read_b64_tr_b16 a[242:243], v219 offset:6144
    v_mfma_f32_16x16x32_bf16 v[140:143], a[244:247], v[4:7], v[140:143]
    v_exp_f32 v125, v125
    v_mfma_f32_16x16x32_bf16 v[144:147], a[244:247], v[28:31], v[144:147]
    v_exp_f32 v126, v126
    v_mfma_f32_16x16x32_bf16 v[148:151], a[244:247], v[52:55], v[148:151]
    v_exp_f32 v127, v127
    v_mfma_f32_16x16x32_bf16 v[152:155], a[244:247], v[76:79], v[152:155]
    v_exp_f32 v128, v128
    v_mfma_f32_16x16x32_bf16 v[156:159], a[244:247], v[100:103], v[156:159]
    s_waitcnt lgkmcnt(5)
    ds_read_b64_tr_b16 a[244:245], v220 offset:0
    ds_read_b64_tr_b16 a[246:247], v220 offset:6144
    v_mfma_f32_16x16x32_bf16 v[140:143], a[248:251], v[8:11], v[140:143]
    v_exp_f32 v129, v129
    v_mfma_f32_16x16x32_bf16 v[144:147], a[248:251], v[32:35], v[144:147]
    v_exp_f32 v130, v130
    v_mfma_f32_16x16x32_bf16 v[148:151], a[248:251], v[56:59], v[148:151]
    v_exp_f32 v131, v131
    v_mfma_f32_16x16x32_bf16 v[152:155], a[248:251], v[80:83], v[152:155]
    v_exp_f32 v132, v132
    v_mfma_f32_16x16x32_bf16 v[156:159], a[248:251], v[104:107], v[156:159]
    s_waitcnt lgkmcnt(6)
    ds_read_b64_tr_b16 a[248:249], v221 offset:0
    ds_read_b64_tr_b16 a[250:251], v221 offset:6144
    v_mfma_f32_16x16x32_bf16 v[140:143], a[252:255], v[12:15], v[140:143]
    v_exp_f32 v133, v133
    v_mfma_f32_16x16x32_bf16 v[144:147], a[252:255], v[36:39], v[144:147]
    v_exp_f32 v134, v134
    v_mfma_f32_16x16x32_bf16 v[148:151], a[252:255], v[60:63], v[148:151]
    v_exp_f32 v135, v135
    v_mfma_f32_16x16x32_bf16 v[152:155], a[252:255], v[84:87], v[152:155]
    v_exp_f32 v136, v136
    v_mfma_f32_16x16x32_bf16 v[156:159], a[252:255], v[108:111], v[156:159]
    s_waitcnt lgkmcnt(7)
    ds_read_b64_tr_b16 a[252:253], v222 offset:0
    ds_read_b64_tr_b16 a[254:255], v222 offset:6144
    v_mfma_f32_16x16x32_bf16 v[140:143], v[240:243], v[16:19], v[140:143]
    v_exp_f32 v137, v137
    v_mfma_f32_16x16x32_bf16 v[144:147], v[240:243], v[40:43], v[144:147]
    v_exp_f32 v138, v138
    v_mfma_f32_16x16x32_bf16 v[148:151], v[240:243], v[64:67], v[148:151]
    v_exp_f32 v139, v139
    v_mfma_f32_16x16x32_bf16 v[152:155], v[240:243], v[88:91], v[152:155]
    v_cvt_pk_bf16_f32 v176, v120, v121
    v_cvt_pk_bf16_f32 v177, v122, v123
    v_mfma_f32_16x16x32_bf16 v[156:159], v[240:243], v[112:115], v[156:159]
    s_waitcnt lgkmcnt(8)
    ds_read_b64_tr_b16 v[240:241], v219 offset:1024
    ds_read_b64_tr_b16 v[242:243], v219 offset:7168
    v_mfma_f32_16x16x32_bf16 v[140:143], v[244:247], v[20:23], v[140:143]
    v_cvt_pk_bf16_f32 v180, v124, v125
    v_cvt_pk_bf16_f32 v181, v126, v127
    v_mfma_f32_16x16x32_bf16 v[144:147], v[244:247], v[44:47], v[144:147]
    v_cvt_pk_bf16_f32 v184, v128, v129
    v_cvt_pk_bf16_f32 v185, v130, v131
    v_mfma_f32_16x16x32_bf16 v[148:151], v[244:247], v[68:71], v[148:151]
    v_cvt_pk_bf16_f32 v188, v132, v133
    v_cvt_pk_bf16_f32 v189, v134, v135
    v_mfma_f32_16x16x32_bf16 v[152:155], v[244:247], v[92:95], v[152:155]
    v_exp_f32 v140, v140
    v_mfma_f32_16x16x32_bf16 v[156:159], v[244:247], v[116:119], v[156:159]
    s_waitcnt lgkmcnt(8)
    ds_read_b64_tr_b16 v[244:245], v220 offset:1024
    ds_read_b64_tr_b16 v[246:247], v220 offset:7168
    v_mfma_f32_16x16x32_bf16 a[0:3], a[240:243], v[160:163], a[0:3]
    v_exp_f32 v141, v141
    v_mfma_f32_16x16x32_bf16 a[48:51], a[240:243], v[164:167], a[48:51]
    v_exp_f32 v142, v142
    v_mfma_f32_16x16x32_bf16 a[96:99], a[240:243], v[168:171], a[96:99]
    s_barrier
    v_exp_f32 v143, v143
    v_mfma_f32_16x16x32_bf16 a[144:147], a[240:243], v[172:175], a[144:147]
    s_waitcnt lgkmcnt(8)
    buffer_load_dwordx4 v216, s[12:15], s30 offen nt lds
    v_mfma_f32_16x16x32_bf16 a[4:7], a[244:247], v[160:163], a[4:7]
    ds_read_b64_tr_b16 a[240:241], v221 offset:1024
    ds_read_b64_tr_b16 a[242:243], v221 offset:7168
    v_mfma_f32_16x16x32_bf16 a[52:55], a[244:247], v[164:167], a[52:55]
    v_exp_f32 v144, v144
    v_mfma_f32_16x16x32_bf16 a[100:103], a[244:247], v[168:171], a[100:103]
    buffer_load_dwordx4 v216, s[12:15], s30 offen offset:3072 nt lds
    v_mfma_f32_16x16x32_bf16 a[148:151], a[244:247], v[172:175], a[148:151]
    s_waitcnt lgkmcnt(8)
    s_add_u32 m0, s32, 896
    ds_read_b64_tr_b16 a[244:245], v222 offset:1024
    v_mfma_f32_16x16x32_bf16 a[8:11], a[248:251], v[160:163], a[8:11]
    ds_read_b64_tr_b16 a[246:247], v222 offset:7168
    v_cvt_pk_bf16_f32 v178, v140, v141
    v_mfma_f32_16x16x32_bf16 a[56:59], a[248:251], v[164:167], a[56:59]
    buffer_load_dwordx4 v216, s[12:15], s30 offen offset:128 nt lds
    v_mfma_f32_16x16x32_bf16 a[104:107], a[248:251], v[168:171], a[104:107]
    v_exp_f32 v145, v145
    v_mfma_f32_16x16x32_bf16 a[152:155], a[248:251], v[172:175], a[152:155]
    s_waitcnt lgkmcnt(8)
    ds_read_b64_tr_b16 a[248:249], v219 offset:2048
    ds_read_b64_tr_b16 a[250:251], v219 offset:8192
    v_mfma_f32_16x16x32_bf16 a[12:15], a[252:255], v[160:163], a[12:15]
    buffer_load_dwordx4 v216, s[12:15], s30 offen offset:3200 nt lds
    v_mfma_f32_16x16x32_bf16 a[60:63], a[252:255], v[164:167], a[60:63]
    s_add_u32 m0, s32, 1792
    v_add_u32 v219, s37, v219
    v_cvt_pk_bf16_f32 v179, v142, v143
    v_mfma_f32_16x16x32_bf16 a[108:111], a[252:255], v[168:171], a[108:111]
    s_mov_b32 s32, s33
    v_exp_f32 v146, v146
    v_mfma_f32_16x16x32_bf16 a[156:159], a[252:255], v[172:175], a[156:159]
    s_waitcnt lgkmcnt(8)
    buffer_load_dwordx4 v216, s[12:15], s30 offen offset:256 nt lds
    v_mfma_f32_16x16x32_bf16 a[16:19], v[240:243], v[160:163], a[16:19]
    s_mov_b32 s33, s34
    ds_read_b64_tr_b16 a[252:253], v220 offset:2048
    ds_read_b64_tr_b16 a[254:255], v220 offset:8192
    v_mfma_f32_16x16x32_bf16 a[64:67], v[240:243], v[164:167], a[64:67]
    s_mov_b32 s34, s46
    v_add_u32 v220, s37, v220
    v_cvt_pk_bf16_f32 v182, v144, v145
    v_mfma_f32_16x16x32_bf16 a[112:115], v[240:243], v[168:171], a[112:115]
    buffer_load_dwordx4 v216, s[12:15], s30 offen offset:3328 nt lds
    buffer_load_dword v252, v252, s[76:79], s74 offen sc1
    v_mfma_f32_16x16x32_bf16 a[160:163], v[240:243], v[172:175], a[160:163]
    s_waitcnt lgkmcnt(8)
    ds_read_b64_tr_b16 v[240:241], v221 offset:2048
    ds_read_b64_tr_b16 v[242:243], v221 offset:8192
    v_mfma_f32_16x16x32_bf16 a[20:23], v[244:247], v[160:163], a[20:23]
    s_lshr_b32 s74, s71, 1
    s_lshl_b32 s74, s74, 2
    s_xor_b32 s74, s74, 4
    v_mfma_f32_16x16x32_bf16 a[68:71], v[244:247], v[164:167], a[68:71]
    s_add_u32 s30, s30, 12288
    buffer_load_dword v254, v254, s[76:79], s74 offen offset:128 sc1
    v_mfma_f32_16x16x32_bf16 a[116:119], v[244:247], v[168:171], a[116:119]
    v_exp_f32 v147, v147
    v_mfma_f32_16x16x32_bf16 a[164:167], v[244:247], v[172:175], a[164:167]
    s_waitcnt lgkmcnt(8)
    ds_read_b64_tr_b16 v[244:245], v222 offset:2048
    ds_read_b64_tr_b16 v[246:247], v222 offset:8192
    v_mfma_f32_16x16x32_bf16 a[24:27], a[240:243], v[160:163], a[24:27]
    v_exp_f32 v148, v148
    v_mfma_f32_16x16x32_bf16 a[72:75], a[240:243], v[164:167], a[72:75]
    v_exp_f32 v149, v149
    v_mfma_f32_16x16x32_bf16 a[120:123], a[240:243], v[168:171], a[120:123]
    v_exp_f32 v150, v150
    v_mfma_f32_16x16x32_bf16 a[168:171], a[240:243], v[172:175], a[168:171]
    s_waitcnt lgkmcnt(8)
    v_exp_f32 v151, v151
    v_mfma_f32_16x16x32_bf16 a[28:31], a[244:247], v[160:163], a[28:31]
    v_add_u32 v221, s37, v221
    v_cvt_pk_bf16_f32 v183, v146, v147
    v_mfma_f32_16x16x32_bf16 a[76:79], a[244:247], v[164:167], a[76:79]
    v_exp_f32 v152, v152
    v_mfma_f32_16x16x32_bf16 a[124:127], a[244:247], v[168:171], a[124:127]
    v_exp_f32 v153, v153
    v_mfma_f32_16x16x32_bf16 a[172:175], a[244:247], v[172:175], a[172:175]
    s_waitcnt lgkmcnt(6)
    v_exp_f32 v154, v154
    v_mfma_f32_16x16x32_bf16 a[32:35], a[248:251], v[160:163], a[32:35]
    v_exp_f32 v155, v155
    v_mfma_f32_16x16x32_bf16 a[80:83], a[248:251], v[164:167], a[80:83]
    v_exp_f32 v156, v156
    v_mfma_f32_16x16x32_bf16 a[128:131], a[248:251], v[168:171], a[128:131]
    s_waitcnt vmcnt(14)
    s_barrier
    ds_read_b64_tr_b16 a[240:241], v219 offset:0
    v_mfma_f32_16x16x32_bf16 a[176:179], a[248:251], v[172:175], a[176:179]
    s_waitcnt lgkmcnt(5)
    ds_read_b64_tr_b16 a[242:243], v219 offset:6144
    ds_read_b64_tr_b16 a[244:245], v220 offset:0
    v_mfma_f32_16x16x32_bf16 a[36:39], a[252:255], v[160:163], a[36:39]
    v_exp_f32 v157, v157
    v_mfma_f32_16x16x32_bf16 a[84:87], a[252:255], v[164:167], a[84:87]
    ds_read_b64_tr_b16 a[246:247], v220 offset:6144
    ds_read_b64_tr_b16 a[248:249], v221 offset:0
    v_mfma_f32_16x16x32_bf16 a[132:135], a[252:255], v[168:171], a[132:135]
    v_exp_f32 v158, v158
    v_mfma_f32_16x16x32_bf16 a[180:183], a[252:255], v[172:175], a[180:183]
    s_waitcnt lgkmcnt(7)
    v_exp_f32 v159, v159
    v_mfma_f32_16x16x32_bf16 a[40:43], v[240:243], v[160:163], a[40:43]
    ds_read_b64_tr_b16 a[250:251], v221 offset:6144
    v_cvt_pk_bf16_f32 v186, v148, v149
    v_mfma_f32_16x16x32_bf16 a[88:91], v[240:243], v[164:167], a[88:91]
    v_cvt_pk_bf16_f32 v187, v150, v151
    v_cvt_pk_bf16_f32 v190, v152, v153
    v_mfma_f32_16x16x32_bf16 a[136:139], v[240:243], v[168:171], a[136:139]
    v_cvt_pk_bf16_f32 v191, v154, v155
    v_add_u32 v222, s37, v222
    v_mfma_f32_16x16x32_bf16 a[184:187], v[240:243], v[172:175], a[184:187]
    s_waitcnt lgkmcnt(6)
    v_cvt_pk_bf16_f32 v192, v136, v137
    v_cvt_pk_bf16_f32 v193, v138, v139
    v_mfma_f32_16x16x32_bf16 a[44:47], v[244:247], v[160:163], a[44:47]
    v_cvt_pk_bf16_f32 v194, v156, v157
    v_cvt_pk_bf16_f32 v195, v158, v159
    v_mfma_f32_16x16x32_bf16 a[92:95], v[244:247], v[164:167], a[92:95]
    v_add_f32 v231, v231, v124
    v_add_f32 v232, v232, v128
    v_mfma_f32_16x16x32_bf16 a[140:143], v[244:247], v[168:171], a[140:143]
    v_add_f32 v233, v233, v132
    v_add_f32 v230, v230, v121
    v_mfma_f32_16x16x32_bf16 a[188:191], v[244:247], v[172:175], a[188:191]
    s_waitcnt lgkmcnt(4)
    ds_read_b64_tr_b16 a[252:253], v222 offset:0
    ds_read_b64_tr_b16 a[254:255], v222 offset:6144
    v_mfma_f32_16x16x32_bf16 a[0:3], a[240:243], v[176:179], a[0:3]
    v_add_f32 v231, v231, v125
    v_add_f32 v232, v232, v129
    v_mfma_f32_16x16x32_bf16 a[48:51], a[240:243], v[180:183], a[48:51]
    v_add_f32 v233, v233, v133
    v_add_f32 v230, v230, v122
    v_mfma_f32_16x16x32_bf16 a[96:99], a[240:243], v[184:187], a[96:99]
    v_add_f32 v234, v234, v136
    v_add_f32 v231, v231, v126
    v_mfma_f32_16x16x32_bf16 a[144:147], a[240:243], v[188:191], a[144:147]
    v_add_f32 v232, v232, v130
    v_add_f32 v233, v233, v134
    v_mfma_f32_16x16x32_bf16 a[192:195], a[240:243], v[192:195], a[192:195]
    s_waitcnt lgkmcnt(4)
    s_barrier
    ds_read_b64_tr_b16 v[240:241], v219 offset:1024
    v_mfma_f32_16x16x32_bf16 a[4:7], a[244:247], v[176:179], a[4:7]
    ds_read_b64_tr_b16 v[242:243], v219 offset:7168
    v_add_f32 v230, v230, v123
    v_mfma_f32_16x16x32_bf16 a[52:55], a[244:247], v[180:183], a[52:55]
    v_add_f32 v234, v234, v137
    v_add_f32 v231, v231, v127
    v_mfma_f32_16x16x32_bf16 a[100:103], a[244:247], v[184:187], a[100:103]
    ds_write_b128 v249, a[192:195] offset:0
    v_mfma_f32_16x16x32_bf16 a[148:151], a[244:247], v[188:191], a[148:151]
    v_add_f32 v232, v232, v131
    v_add_f32 v233, v233, v135
    v_mfma_f32_16x16x32_bf16 a[196:199], a[244:247], v[192:195], a[196:199]
    s_waitcnt lgkmcnt(5)
    v_add_f32 v230, v230, v140
    v_add_f32 v234, v234, v138
    v_mfma_f32_16x16x32_bf16 a[8:11], a[248:251], v[176:179], a[8:11]
    v_add_f32 v231, v231, v144
    ds_read_b64_tr_b16 v[244:245], v220 offset:1024
    v_mfma_f32_16x16x32_bf16 a[56:59], a[248:251], v[180:183], a[56:59]
    ds_read_b64_tr_b16 v[246:247], v220 offset:7168
    v_add_f32 v232, v232, v148
    v_mfma_f32_16x16x32_bf16 a[104:107], a[248:251], v[184:187], a[104:107]
    ds_write_b128 v249, a[196:199] offset:1024
    v_mfma_f32_16x16x32_bf16 a[152:155], a[248:251], v[188:191], a[152:155]
    v_add_f32 v233, v233, v152
    v_add_f32 v230, v230, v141
    v_mfma_f32_16x16x32_bf16 a[200:203], a[248:251], v[192:195], a[200:203]
    s_waitcnt lgkmcnt(6)
    v_add_f32 v234, v234, v139
    v_add_f32 v231, v231, v145
    v_mfma_f32_16x16x32_bf16 a[12:15], a[252:255], v[176:179], a[12:15]
    v_add_f32 v232, v232, v149
    v_add_f32 v233, v233, v153
    v_mfma_f32_16x16x32_bf16 a[60:63], a[252:255], v[180:183], a[60:63]
    v_add_f32 v230, v230, v142
    ds_read_b64_tr_b16 a[240:241], v221 offset:1024
    v_mfma_f32_16x16x32_bf16 a[108:111], a[252:255], v[184:187], a[108:111]
    ds_write_b128 v249, a[200:203] offset:2048
    v_mfma_f32_16x16x32_bf16 a[156:159], a[252:255], v[188:191], a[156:159]
    ds_read_b64_tr_b16 a[242:243], v221 offset:7168
    v_add_f32 v234, v234, v156
    v_mfma_f32_16x16x32_bf16 a[204:207], a[252:255], v[192:195], a[204:207]
    s_waitcnt lgkmcnt(7)
    v_add_f32 v231, v231, v146
    v_add_f32 v232, v232, v150
    v_mfma_f32_16x16x32_bf16 a[16:19], v[240:243], v[176:179], a[16:19]
    v_add_f32 v233, v233, v154
    v_add_f32 v230, v230, v143
    v_mfma_f32_16x16x32_bf16 a[64:67], v[240:243], v[180:183], a[64:67]
    v_add_f32 v234, v234, v157
    v_add_f32 v231, v231, v147
    v_mfma_f32_16x16x32_bf16 a[112:115], v[240:243], v[184:187], a[112:115]
    ds_write_b128 v249, a[204:207] offset:3072
    v_mfma_f32_16x16x32_bf16 a[160:163], v[240:243], v[188:191], a[160:163]
    v_add_f32 v232, v232, v151
    ds_read_b64_tr_b16 a[244:245], v222 offset:1024
    v_mfma_f32_16x16x32_bf16 a[208:211], v[240:243], v[192:195], a[208:211]
    s_waitcnt lgkmcnt(6)
    ds_read_b64_tr_b16 a[246:247], v222 offset:7168
    v_add_f32 v233, v233, v155
    v_mfma_f32_16x16x32_bf16 a[20:23], v[244:247], v[176:179], a[20:23]
    v_mov_b32 v235, v230
    v_add_f32 v234, v234, v158
    v_mfma_f32_16x16x32_bf16 a[68:71], v[244:247], v[180:183], a[68:71]
    v_mov_b32 v236, v231
    v_mov_b32 v237, v232
    v_mfma_f32_16x16x32_bf16 a[116:119], v[244:247], v[184:187], a[116:119]
    ds_write_b128 v249, a[208:211] offset:4096
    v_mfma_f32_16x16x32_bf16 a[164:167], v[244:247], v[188:191], a[164:167]
    v_mov_b32 v238, v233
    ds_read_b64_tr_b16 a[248:249], v219 offset:2048
    v_mfma_f32_16x16x32_bf16 a[212:215], v[244:247], v[192:195], a[212:215]
    s_waitcnt lgkmcnt(5)
    v_permlane32_swap_b32 v230, v235
    v_mfma_f32_16x16x32_bf16 a[24:27], a[240:243], v[176:179], a[24:27]
    ds_read_b64_tr_b16 a[250:251], v219 offset:8192
    v_add_f32 v234, v234, v159
    v_mfma_f32_16x16x32_bf16 a[72:75], a[240:243], v[180:183], a[72:75]
    v_permlane32_swap_b32 v231, v236
    v_mfma_f32_16x16x32_bf16 a[120:123], a[240:243], v[184:187], a[120:123]
    ds_write_b128 v249, a[212:215] offset:5120
    v_mfma_f32_16x16x32_bf16 a[168:171], a[240:243], v[188:191], a[168:171]
    v_permlane32_swap_b32 v232, v237
    v_mfma_f32_16x16x32_bf16 a[216:219], a[240:243], v[192:195], a[216:219]
    s_waitcnt lgkmcnt(4)
    v_permlane32_swap_b32 v233, v238
    v_mfma_f32_16x16x32_bf16 a[28:31], a[244:247], v[176:179], a[28:31]
    v_add_f32 v230, v230, v235
    v_mov_b32 v239, v234
    v_mfma_f32_16x16x32_bf16 a[76:79], a[244:247], v[180:183], a[76:79]
    ds_read_b64_tr_b16 a[252:253], v220 offset:2048
    ds_read_b64_tr_b16 a[254:255], v220 offset:8192
    v_mfma_f32_16x16x32_bf16 a[124:127], a[244:247], v[184:187], a[124:127]
    v_add_f32 v231, v231, v236
    v_add_f32 v232, v232, v237
    v_mfma_f32_16x16x32_bf16 a[172:175], a[244:247], v[188:191], a[172:175]
    v_mov_b32 v235, v230
    v_add_f32 v233, v233, v238
    v_mfma_f32_16x16x32_bf16 a[220:223], a[244:247], v[192:195], a[220:223]
    s_waitcnt lgkmcnt(3)
    v_permlane32_swap_b32 v234, v239
    v_mfma_f32_16x16x32_bf16 a[32:35], a[248:251], v[176:179], a[32:35]
    ds_read_b64_tr_b16 v[240:241], v221 offset:2048
    ds_read_b64_tr_b16 v[242:243], v221 offset:8192
    v_mfma_f32_16x16x32_bf16 a[80:83], a[248:251], v[180:183], a[80:83]
    v_mov_b32 v236, v231
    v_mov_b32 v237, v232
    v_mfma_f32_16x16x32_bf16 a[128:131], a[248:251], v[184:187], a[128:131]
    v_permlane16_swap_b32 v230, v235
    v_mfma_f32_16x16x32_bf16 a[176:179], a[248:251], v[188:191], a[176:179]
    v_mov_b32 v238, v233
    v_add_f32 v234, v234, v239
    v_mfma_f32_16x16x32_bf16 a[224:227], a[248:251], v[192:195], a[224:227]
    s_waitcnt lgkmcnt(2)
    ds_read_b64_tr_b16 v[244:245], v222 offset:2048
    ds_read_b64_tr_b16 v[246:247], v222 offset:8192
    v_permlane16_swap_b32 v231, v236
    v_mov_b32 v239, v234
    v_mfma_f32_16x16x32_bf16 a[36:39], a[252:255], v[176:179], a[36:39]
    v_permlane16_swap_b32 v232, v237
    v_mfma_f32_16x16x32_bf16 a[84:87], a[252:255], v[180:183], a[84:87]
    v_permlane16_swap_b32 v233, v238
    v_mfma_f32_16x16x32_bf16 a[132:135], a[252:255], v[184:187], a[132:135]
    v_add_f32 v230, v230, v235
    v_add_f32 v231, v231, v236
    v_mfma_f32_16x16x32_bf16 a[180:183], a[252:255], v[188:191], a[180:183]
    v_add_f32 v232, v232, v237
    v_add_f32 v233, v233, v238
    v_mfma_f32_16x16x32_bf16 a[228:231], a[252:255], v[192:195], a[228:231]
    s_waitcnt lgkmcnt(2)
    v_permlane16_swap_b32 v234, v239
    v_mfma_f32_16x16x32_bf16 a[40:43], v[240:243], v[176:179], a[40:43]
    v_add_f32 v235, v230, v231
    v_add_f32 v236, v232, v233
    v_mfma_f32_16x16x32_bf16 a[88:91], v[240:243], v[180:183], a[88:91]
    v_add_f32 v234, v234, v239
    v_add_f32 v235, v235, v236
    v_mfma_f32_16x16x32_bf16 a[136:139], v[240:243], v[184:187], a[136:139]
    ds_write_b32 v249, v234 offset:6144
    v_mfma_f32_16x16x32_bf16 a[184:187], v[240:243], v[188:191], a[184:187]
    v_add_f32 v235, v235, v234
    v_add_u32 v218, s36, v218
    v_mfma_f32_16x16x32_bf16 a[232:235], v[240:243], v[192:195], a[232:235]
    s_waitcnt lgkmcnt(1)
    ds_write_b32 v249, v235 offset:6148
    v_mfma_f32_16x16x32_bf16 a[44:47], v[244:247], v[176:179], a[44:47]
    s_cmp_ge_u32 s30, 196608
    s_cselect_b32 s30, 6144, s30
    v_mfma_f32_16x16x32_bf16 a[92:95], v[244:247], v[180:183], a[92:95]
    v_rcp_f32 v230, v230
    v_mfma_f32_16x16x32_bf16 a[140:143], v[244:247], v[184:187], a[140:143]
    v_rcp_f32 v231, v231
    v_mfma_f32_16x16x32_bf16 a[188:191], v[244:247], v[188:191], a[188:191]
    v_rcp_f32 v232, v232
    v_mfma_f32_16x16x32_bf16 a[236:239], v[244:247], v[192:195], a[236:239]
    s_waitcnt lgkmcnt(0)
    s_barrier
    ds_read_b32 v235, v251 offset:6148
    ds_read_b32 v236, v251 offset:14340
    ds_read_b32 v237, v251 offset:22532
    ds_read_b32 v238, v251 offset:30724
    v_accvgpr_read_b32 v148, a0
    v_accvgpr_read_b32 v149, a1
    v_accvgpr_read_b32 v150, a2
    v_accvgpr_read_b32 v151, a3
    v_accvgpr_read_b32 v152, a4
    v_accvgpr_read_b32 v153, a5
    v_accvgpr_read_b32 v154, a6
    v_accvgpr_read_b32 v155, a7
    v_rcp_f32 v233, v233
    v_mul_f32 v148, v148, v230
    v_mul_f32 v149, v149, v230
    v_mul_f32 v150, v150, v230
    v_mul_f32 v151, v151, v230
    v_mul_f32 v152, v152, v230
    v_mul_f32 v153, v153, v230
    v_mul_f32 v154, v154, v230
    v_mul_f32 v155, v155, v230
    v_accvgpr_read_b32 v160, a48
    v_accvgpr_read_b32 v161, a49
    v_accvgpr_read_b32 v162, a50
    v_accvgpr_read_b32 v163, a51
    v_accvgpr_read_b32 v164, a52
    v_accvgpr_read_b32 v165, a53
    v_accvgpr_read_b32 v166, a54
    v_accvgpr_read_b32 v167, a55
    v_cvt_pk_bf16_f32 v156, v148, v149
    v_cvt_pk_bf16_f32 v157, v150, v151
    v_cvt_pk_bf16_f32 v158, v152, v153
    v_cvt_pk_bf16_f32 v159, v154, v155
    v_mul_f32 v160, v160, v231
    v_mul_f32 v161, v161, v231
    v_mul_f32 v162, v162, v231
    v_mul_f32 v163, v163, v231
    s_waitcnt lgkmcnt(1)
    v_max3_f32 v235, v235, v236, v237
    s_waitcnt lgkmcnt(0)
    v_max_f32 v235, v235, v238
    v_cmp_lt_f32 vcc, s72, v235
    v_mul_f32 v164, v164, v231
    v_mul_f32 v165, v165, v231
    v_mul_f32 v166, v166, v231
    v_mul_f32 v167, v167, v231
    v_accvgpr_read_b32 v196, a96
    v_accvgpr_read_b32 v197, a97
    v_accvgpr_read_b32 v198, a98
    v_accvgpr_read_b32 v199, a99
    v_accvgpr_read_b32 v200, a100
    v_accvgpr_read_b32 v201, a101
    v_accvgpr_read_b32 v202, a102
    v_accvgpr_read_b32 v203, a103
    buffer_store_dwordx4 v[156:159], v248, s[20:23], s38 offen sc1
    v_cvt_pk_bf16_f32 v168, v160, v161
    v_cvt_pk_bf16_f32 v169, v162, v163
    v_cvt_pk_bf16_f32 v170, v164, v165
    v_cvt_pk_bf16_f32 v171, v166, v167
    v_mul_f32 v196, v196, v232
    v_mul_f32 v197, v197, v232
    v_mul_f32 v198, v198, v232
    v_mul_f32 v199, v199, v232
    v_mul_f32 v200, v200, v232
    v_mul_f32 v201, v201, v232
    v_mul_f32 v202, v202, v232
    v_mul_f32 v203, v203, v232
    v_accvgpr_read_b32 v204, a144
    v_accvgpr_read_b32 v205, a145
    v_accvgpr_read_b32 v206, a146
    v_accvgpr_read_b32 v207, a147
    v_accvgpr_read_b32 v208, a148
    v_accvgpr_read_b32 v209, a149
    v_accvgpr_read_b32 v210, a150
    v_accvgpr_read_b32 v211, a151
    buffer_store_dwordx4 v[168:171], v248, s[20:23], s38 offen offset:1024 sc1
    v_cvt_pk_bf16_f32 v172, v196, v197
    v_cvt_pk_bf16_f32 v173, v198, v199
    v_cvt_pk_bf16_f32 v174, v200, v201
    v_cvt_pk_bf16_f32 v175, v202, v203
    v_mul_f32 v204, v204, v233
    v_mul_f32 v205, v205, v233
    v_mul_f32 v206, v206, v233
    v_mul_f32 v207, v207, v233
    v_mul_f32 v208, v208, v233
    v_mul_f32 v209, v209, v233
    v_mul_f32 v210, v210, v233
    v_mul_f32 v211, v211, v233
    buffer_store_dwordx4 v[172:175], v248, s[20:23], s38 offen offset:2048 sc1
    v_cvt_pk_bf16_f32 v212, v204, v205
    v_cvt_pk_bf16_f32 v213, v206, v207
    v_cvt_pk_bf16_f32 v214, v208, v209
    v_cvt_pk_bf16_f32 v215, v210, v211
    buffer_store_dwordx4 v[212:215], v248, s[20:23], s38 offen offset:3072 sc1
    v_accvgpr_read_b32 v148, a8
    v_accvgpr_read_b32 v149, a9
    v_accvgpr_read_b32 v150, a10
    v_accvgpr_read_b32 v151, a11
    v_accvgpr_read_b32 v152, a12
    v_accvgpr_read_b32 v153, a13
    v_accvgpr_read_b32 v154, a14
    v_accvgpr_read_b32 v155, a15
    v_mul_f32 v148, v148, v230
    v_mul_f32 v149, v149, v230
    v_mul_f32 v150, v150, v230
    v_mul_f32 v151, v151, v230
    v_mul_f32 v152, v152, v230
    v_mul_f32 v153, v153, v230
    v_mul_f32 v154, v154, v230
    v_mul_f32 v155, v155, v230
    v_accvgpr_read_b32 v160, a56
    v_accvgpr_read_b32 v161, a57
    v_accvgpr_read_b32 v162, a58
    v_accvgpr_read_b32 v163, a59
    v_accvgpr_read_b32 v164, a60
    v_accvgpr_read_b32 v165, a61
    v_accvgpr_read_b32 v166, a62
    v_accvgpr_read_b32 v167, a63
    ds_read_b32 v239, v250 offset:6144
    s_add_u32 s38, s44, 18432
    v_cvt_pk_bf16_f32 v156, v148, v149
    v_cvt_pk_bf16_f32 v157, v150, v151
    v_cvt_pk_bf16_f32 v158, v152, v153
    v_cvt_pk_bf16_f32 v159, v154, v155
    v_mul_f32 v160, v160, v231
    v_mul_f32 v161, v161, v231
    v_mul_f32 v162, v162, v231
    v_mul_f32 v163, v163, v231
    v_mul_f32 v164, v164, v231
    v_mul_f32 v165, v165, v231
    v_mul_f32 v166, v166, v231
    v_mul_f32 v167, v167, v231
    v_accvgpr_read_b32 v196, a104
    v_accvgpr_read_b32 v197, a105
    v_accvgpr_read_b32 v198, a106
    v_accvgpr_read_b32 v199, a107
    v_accvgpr_read_b32 v200, a108
    v_accvgpr_read_b32 v201, a109
    v_accvgpr_read_b32 v202, a110
    v_accvgpr_read_b32 v203, a111
    buffer_store_dwordx4 v[156:159], v248, s[20:23], s38 offen sc1
    v_cvt_pk_bf16_f32 v168, v160, v161
    v_cvt_pk_bf16_f32 v169, v162, v163
    v_cvt_pk_bf16_f32 v170, v164, v165
    v_cvt_pk_bf16_f32 v171, v166, v167
    v_mul_f32 v196, v196, v232
    v_mul_f32 v197, v197, v232
    v_mul_f32 v198, v198, v232
    v_mul_f32 v199, v199, v232
    v_mul_f32 v200, v200, v232
    v_mul_f32 v201, v201, v232
    v_mul_f32 v202, v202, v232
    v_mul_f32 v203, v203, v232
    v_accvgpr_read_b32 v204, a152
    v_accvgpr_read_b32 v205, a153
    v_accvgpr_read_b32 v206, a154
    v_accvgpr_read_b32 v207, a155
    v_accvgpr_read_b32 v208, a156
    v_accvgpr_read_b32 v209, a157
    v_accvgpr_read_b32 v210, a158
    v_accvgpr_read_b32 v211, a159
    buffer_store_dwordx4 v[168:171], v248, s[20:23], s38 offen offset:1024 sc1
    v_cvt_pk_bf16_f32 v172, v196, v197
    v_cvt_pk_bf16_f32 v173, v198, v199
    v_cvt_pk_bf16_f32 v174, v200, v201
    v_cvt_pk_bf16_f32 v175, v202, v203
    v_mul_f32 v204, v204, v233
    v_mul_f32 v205, v205, v233
    v_mul_f32 v206, v206, v233
    v_mul_f32 v207, v207, v233
    v_mul_f32 v208, v208, v233
    v_mul_f32 v209, v209, v233
    v_mul_f32 v210, v210, v233
    v_mul_f32 v211, v211, v233
    ds_read_b128 v[124:127], v250 offset:0
    ds_read_b128 v[128:131], v250 offset:1024
    buffer_store_dwordx4 v[172:175], v248, s[20:23], s38 offen offset:2048 sc1
    v_cvt_pk_bf16_f32 v212, v204, v205
    v_cvt_pk_bf16_f32 v213, v206, v207
    v_cvt_pk_bf16_f32 v214, v208, v209
    v_cvt_pk_bf16_f32 v215, v210, v211
    buffer_store_dwordx4 v[212:215], v248, s[20:23], s38 offen offset:3072 sc1
    s_cbranch_vccnz K_fix1
    v_accvgpr_read_b32 v96, a16
    v_accvgpr_read_b32 v97, a17
    v_accvgpr_read_b32 v98, a18
    v_accvgpr_read_b32 v99, a19
    v_accvgpr_read_b32 v100, a20
    v_accvgpr_read_b32 v101, a21
    v_accvgpr_read_b32 v102, a22
    v_accvgpr_read_b32 v103, a23
    ds_read_b128 v[132:135], v250 offset:2048
    ds_read_b128 v[136:139], v250 offset:3072
    s_cmp_eq_u32 s75, 0
    s_cbranch_scc1 K_nohook1
    s_add_u32 s8, s8, 6144
    s_addc_u32 s9, s9, 0
    s_sub_u32 s10, s10, 6144
    s_mov_b32 s50, s41
    s_add_u32 m0, s50, 0
    s_nop 0
    buffer_load_dwordx4 v224, s[8:11], s29 offen lds
    s_add_u32 m0, s50, 896
    s_nop 0
    buffer_load_dwordx4 v224, s[8:11], s29 offen offset:128 lds
    s_add_u32 m0, s50, 1792
    s_nop 0
    buffer_load_dwordx4 v224, s[8:11], s29 offen offset:256 lds
    s_add_u32 s29, s29, 393216
    s_add_u32 s50, s50, 12288
    s_cmp_ge_u32 s50, 86016
    s_cselect_b32 s50, s41, s50
    s_add_u32 s38, s28, 81920
    s_add_u32 m0, s40, 0
    s_nop 0
    buffer_load_dwordx4 v223, s[4:7], s38 offen lds
    s_add_u32 s38, s28, 92160
    s_add_u32 m0, s40, 1024
    s_nop 0
    buffer_load_dwordx4 v223, s[4:7], s38 offen lds
    s_add_u32 s38, s28, 102400
    s_add_u32 m0, s40, 2048
    s_nop 0
    buffer_load_dwordx4 v223, s[4:7], s38 offen lds
    s_add_u32 s38, s28, 112640
    s_add_u32 m0, s40, 3072
    s_nop 0
    buffer_load_dwordx4 v223, s[4:7], s38 offen lds
    s_add_u32 s38, s28, 122880
    s_add_u32 m0, s40, 4096
    s_nop 0
    buffer_load_dwordx4 v223, s[4:7], s38 offen lds
    s_add_u32 s38, s28, 133120
    s_add_u32 m0, s40, 5120
    s_nop 0
    buffer_load_dwordx4 v223, s[4:7], s38 offen lds
    s_add_u32 s38, s28, 143360
    s_add_u32 m0, s40, 6144
    s_nop 0
    buffer_load_dwordx4 v223, s[4:7], s38 offen lds
    s_add_u32 s38, s28, 153600
    s_add_u32 m0, s40, 7168
    s_nop 0
    buffer_load_dwordx4 v223, s[4:7], s38 offen lds
    s_add_u32 s38, s28, 163840
    s_add_u32 m0, s40, 8192
    s_nop 0
    buffer_load_dwordx4 v223, s[4:7], s38 offen lds
    s_add_u32 s38, s28, 174080
    s_add_u32 m0, s40, 9216
    s_nop 0
    buffer_load_dwordx4 v223, s[4:7], s38 offen lds
    s_add_u32 s28, s28, 128
    s_cmp_ge_u32 s28, 1280
    s_cselect_b32 s28, 0, s28
    s_add_u32 s16, s16, 3145728
    s_addc_u32 s17, s17, 0
    s_add_u32 s39, s34, s35
    s_add_u32 m0, s39, 0
    s_nop 0
    buffer_load_dwordx4 v216, s[16:19], s31 offen nt lds
    buffer_load_dwordx4 v216, s[16:19], s31 offen offset:3072 nt lds
    s_add_u32 m0, s39, 896
    s_nop 0
    buffer_load_dwordx4 v216, s[16:19], s31 offen offset:128 nt lds
    buffer_load_dwordx4 v216, s[16:19], s31 offen offset:3200 nt lds
    s_add_u32 m0, s39, 1792
    s_nop 0
    buffer_load_dwordx4 v216, s[16:19], s31 offen offset:256 nt lds
    buffer_load_dwordx4 v216, s[16:19], s31 offen offset:3328 nt lds
    s_add_u32 s31, s31, 12288
    s_cmp_ge_u32 s31, 196608
    s_cselect_b32 s31, 6144, s31
K_nohook1:
    v_pk_mul_f32 v[96:97], v[96:97], v[230:231] op_sel:[0,0] op_sel_hi:[1,0]
    v_pk_mul_f32 v[98:99], v[98:99], v[230:231] op_sel:[0,0] op_sel_hi:[1,0]
    v_pk_mul_f32 v[100:101], v[100:101], v[230:231] op_sel:[0,0] op_sel_hi:[1,0]
    v_pk_mul_f32 v[102:103], v[102:103], v[230:231] op_sel:[0,0] op_sel_hi:[1,0]
    v_accvgpr_read_b32 v108, a64
    v_accvgpr_read_b32 v109, a65
    v_accvgpr_read_b32 v110, a66
    v_accvgpr_read_b32 v111, a67
    v_accvgpr_read_b32 v112, a68
    v_accvgpr_read_b32 v113, a69
    v_accvgpr_read_b32 v114, a70
    v_accvgpr_read_b32 v115, a71
    s_add_u32 s38, s44, 36864
    v_cvt_pk_bf16_f32 v104, v96, v97
    v_cvt_pk_bf16_f32 v105, v98, v99
    v_cvt_pk_bf16_f32 v106, v100, v101
    v_cvt_pk_bf16_f32 v107, v102, v103
    v_pk_mul_f32 v[108:109], v[108:109], v[230:231] op_sel:[0,1] op_sel_hi:[1,1]
    v_pk_mul_f32 v[110:111], v[110:111], v[230:231] op_sel:[0,1] op_sel_hi:[1,1]
    v_pk_mul_f32 v[112:113], v[112:113], v[230:231] op_sel:[0,1] op_sel_hi:[1,1]
    v_pk_mul_f32 v[114:115], v[114:115], v[230:231] op_sel:[0,1] op_sel_hi:[1,1]
    v_accvgpr_read_b32 v0, a112
    v_accvgpr_read_b32 v1, a113
    v_accvgpr_read_b32 v2, a114
    v_accvgpr_read_b32 v3, a115
    v_accvgpr_read_b32 v4, a116
    v_accvgpr_read_b32 v5, a117
    v_accvgpr_read_b32 v6, a118
    v_accvgpr_read_b32 v7, a119
    buffer_store_dwordx4 v[104:107], v248, s[20:23], s38 offen sc1
    v_cvt_pk_bf16_f32 v116, v108, v109
    v_cvt_pk_bf16_f32 v117, v110, v111
    v_cvt_pk_bf16_f32 v118, v112, v113
    v_cvt_pk_bf16_f32 v119, v114, v115
    v_pk_mul_f32 v[0:1], v[0:1], v[232:233] op_sel:[0,0] op_sel_hi:[1,0]
    v_pk_mul_f32 v[2:3], v[2:3], v[232:233] op_sel:[0,0] op_sel_hi:[1,0]
    v_pk_mul_f32 v[4:5], v[4:5], v[232:233] op_sel:[0,0] op_sel_hi:[1,0]
    v_pk_mul_f32 v[6:7], v[6:7], v[232:233] op_sel:[0,0] op_sel_hi:[1,0]
    v_accvgpr_read_b32 v12, a160
    v_accvgpr_read_b32 v13, a161
    v_accvgpr_read_b32 v14, a162
    v_accvgpr_read_b32 v15, a163
    v_accvgpr_read_b32 v16, a164
    v_accvgpr_read_b32 v17, a165
    v_accvgpr_read_b32 v18, a166
    v_accvgpr_read_b32 v19, a167
    buffer_store_dwordx4 v[116:119], v248, s[20:23], s38 offen offset:1024 sc1
    v_cvt_pk_bf16_f32 v8, v0, v1
    v_cvt_pk_bf16_f32 v9, v2, v3
    v_cvt_pk_bf16_f32 v10, v4, v5
    v_cvt_pk_bf16_f32 v11, v6, v7
    v_pk_mul_f32 v[12:13], v[12:13], v[232:233] op_sel:[0,1] op_sel_hi:[1,1]
    v_pk_mul_f32 v[14:15], v[14:15], v[232:233] op_sel:[0,1] op_sel_hi:[1,1]
    v_pk_mul_f32 v[16:17], v[16:17], v[232:233] op_sel:[0,1] op_sel_hi:[1,1]
    v_pk_mul_f32 v[18:19], v[18:19], v[232:233] op_sel:[0,1] op_sel_hi:[1,1]
    buffer_store_dwordx4 v[8:11], v248, s[20:23], s38 offen offset:2048 sc1
    v_cvt_pk_bf16_f32 v20, v12, v13
    v_cvt_pk_bf16_f32 v21, v14, v15
    v_cvt_pk_bf16_f32 v22, v16, v17
    v_cvt_pk_bf16_f32 v23, v18, v19
    ds_read_b128 v[140:143], v250 offset:4096
    ds_read_b128 v[144:147], v250 offset:5120
    buffer_store_dwordx4 v[20:23], v248, s[20:23], s38 offen offset:3072 sc1
    v_accvgpr_read_b32 v24, a24
    v_accvgpr_read_b32 v25, a25
    v_accvgpr_read_b32 v26, a26
    v_accvgpr_read_b32 v27, a27
    v_accvgpr_read_b32 v28, a28
    v_accvgpr_read_b32 v29, a29
    v_accvgpr_read_b32 v30, a30
    v_accvgpr_read_b32 v31, a31
    v_pk_mul_f32 v[24:25], v[24:25], v[230:231] op_sel:[0,0] op_sel_hi:[1,0]
    v_pk_mul_f32 v[26:27], v[26:27], v[230:231] op_sel:[0,0] op_sel_hi:[1,0]
    v_pk_mul_f32 v[28:29], v[28:29], v[230:231] op_sel:[0,0] op_sel_hi:[1,0]
    v_pk_mul_f32 v[30:31], v[30:31], v[230:231] op_sel:[0,0] op_sel_hi:[1,0]
    v_accvgpr_read_b32 v36, a72
    v_accvgpr_read_b32 v37, a73
    v_accvgpr_read_b32 v38, a74
    v_accvgpr_read_b32 v39, a75
    v_accvgpr_read_b32 v40, a76
    v_accvgpr_read_b32 v41, a77
    v_accvgpr_read_b32 v42, a78
    v_accvgpr_read_b32 v43, a79
    s_add_u32 s38, s44, 55296
    v_cvt_pk_bf16_f32 v32, v24, v25
    v_cvt_pk_bf16_f32 v33, v26, v27
    v_cvt_pk_bf16_f32 v34, v28, v29
    v_cvt_pk_bf16_f32 v35, v30, v31
    v_pk_mul_f32 v[36:37], v[36:37], v[230:231] op_sel:[0,1] op_sel_hi:[1,1]
    v_pk_mul_f32 v[38:39], v[38:39], v[230:231] op_sel:[0,1] op_sel_hi:[1,1]
    v_pk_mul_f32 v[40:41], v[40:41], v[230:231] op_sel:[0,1] op_sel_hi:[1,1]
    v_pk_mul_f32 v[42:43], v[42:43], v[230:231] op_sel:[0,1] op_sel_hi:[1,1]
    v_accvgpr_read_b32 v48, a120
    v_accvgpr_read_b32 v49, a121
    v_accvgpr_read_b32 v50, a122
    v_accvgpr_read_b32 v51, a123
    v_accvgpr_read_b32 v52, a124
    v_accvgpr_read_b32 v53, a125
    v_accvgpr_read_b32 v54, a126
    v_accvgpr_read_b32 v55, a127
    buffer_store_dwordx4 v[32:35], v248, s[20:23], s38 offen sc1
    v_cvt_pk_bf16_f32 v44, v36, v37
    v_cvt_pk_bf16_f32 v45, v38, v39
    v_cvt_pk_bf16_f32 v46, v40, v41
    v_cvt_pk_bf16_f32 v47, v42, v43
    v_pk_mul_f32 v[48:49], v[48:49], v[232:233] op_sel:[0,0] op_sel_hi:[1,0]
    v_pk_mul_f32 v[50:51], v[50:51], v[232:233] op_sel:[0,0] op_sel_hi:[1,0]
    v_pk_mul_f32 v[52:53], v[52:53], v[232:233] op_sel:[0,0] op_sel_hi:[1,0]
    v_pk_mul_f32 v[54:55], v[54:55], v[232:233] op_sel:[0,0] op_sel_hi:[1,0]
    v_accvgpr_read_b32 v60, a168
    v_accvgpr_read_b32 v61, a169
    v_accvgpr_read_b32 v62, a170
    v_accvgpr_read_b32 v63, a171
    v_accvgpr_read_b32 v64, a172
    v_accvgpr_read_b32 v65, a173
    v_accvgpr_read_b32 v66, a174
    v_accvgpr_read_b32 v67, a175
    buffer_store_dwordx4 v[44:47], v248, s[20:23], s38 offen offset:1024 sc1
    v_cvt_pk_bf16_f32 v56, v48, v49
    v_cvt_pk_bf16_f32 v57, v50, v51
    v_cvt_pk_bf16_f32 v58, v52, v53
    v_cvt_pk_bf16_f32 v59, v54, v55
    v_pk_mul_f32 v[60:61], v[60:61], v[232:233] op_sel:[0,1] op_sel_hi:[1,1]
    v_pk_mul_f32 v[62:63], v[62:63], v[232:233] op_sel:[0,1] op_sel_hi:[1,1]
    v_pk_mul_f32 v[64:65], v[64:65], v[232:233] op_sel:[0,1] op_sel_hi:[1,1]
    v_pk_mul_f32 v[66:67], v[66:67], v[232:233] op_sel:[0,1] op_sel_hi:[1,1]
    buffer_store_dwordx4 v[56:59], v248, s[20:23], s38 offen offset:2048 sc1
    v_cvt_pk_bf16_f32 v68, v60, v61
    v_cvt_pk_bf16_f32 v69, v62, v63
    v_cvt_pk_bf16_f32 v70, v64, v65
    v_cvt_pk_bf16_f32 v71, v66, v67
    buffer_store_dwordx4 v[68:71], v248, s[20:23], s38 offen offset:3072 sc1
    v_accvgpr_read_b32 v72, a32
    v_accvgpr_read_b32 v73, a33
    v_accvgpr_read_b32 v74, a34
    v_accvgpr_read_b32 v75, a35
    v_accvgpr_read_b32 v76, a36
    v_accvgpr_read_b32 v77, a37
    v_accvgpr_read_b32 v78, a38
    v_accvgpr_read_b32 v79, a39
    v_pk_mul_f32 v[72:73], v[72:73], v[230:231] op_sel:[0,0] op_sel_hi:[1,0]
    v_pk_mul_f32 v[74:75], v[74:75], v[230:231] op_sel:[0,0] op_sel_hi:[1,0]
    v_pk_mul_f32 v[76:77], v[76:77], v[230:231] op_sel:[0,0] op_sel_hi:[1,0]
    v_pk_mul_f32 v[78:79], v[78:79], v[230:231] op_sel:[0,0] op_sel_hi:[1,0]
    v_accvgpr_read_b32 v84, a80
    v_accvgpr_read_b32 v85, a81
    v_accvgpr_read_b32 v86, a82
    v_accvgpr_read_b32 v87, a83
    v_accvgpr_read_b32 v88, a84
    v_accvgpr_read_b32 v89, a85
    v_accvgpr_read_b32 v90, a86
    v_accvgpr_read_b32 v91, a87
    s_add_u32 s38, s44, 73728
    v_cvt_pk_bf16_f32 v80, v72, v73
    v_cvt_pk_bf16_f32 v81, v74, v75
    v_cvt_pk_bf16_f32 v82, v76, v77
    v_cvt_pk_bf16_f32 v83, v78, v79
    v_pk_mul_f32 v[84:85], v[84:85], v[230:231] op_sel:[0,1] op_sel_hi:[1,1]
    v_pk_mul_f32 v[86:87], v[86:87], v[230:231] op_sel:[0,1] op_sel_hi:[1,1]
    v_pk_mul_f32 v[88:89], v[88:89], v[230:231] op_sel:[0,1] op_sel_hi:[1,1]
    v_pk_mul_f32 v[90:91], v[90:91], v[230:231] op_sel:[0,1] op_sel_hi:[1,1]
    v_accvgpr_read_b32 v96, a128
    v_accvgpr_read_b32 v97, a129
    v_accvgpr_read_b32 v98, a130
    v_accvgpr_read_b32 v99, a131
    v_accvgpr_read_b32 v100, a132
    v_accvgpr_read_b32 v101, a133
    v_accvgpr_read_b32 v102, a134
    v_accvgpr_read_b32 v103, a135
    buffer_store_dwordx4 v[80:83], v248, s[20:23], s38 offen sc1
    v_cvt_pk_bf16_f32 v92, v84, v85
    v_cvt_pk_bf16_f32 v93, v86, v87
    v_cvt_pk_bf16_f32 v94, v88, v89
    v_cvt_pk_bf16_f32 v95, v90, v91
    v_pk_mul_f32 v[96:97], v[96:97], v[232:233] op_sel:[0,0] op_sel_hi:[1,0]
    v_pk_mul_f32 v[98:99], v[98:99], v[232:233] op_sel:[0,0] op_sel_hi:[1,0]
    v_pk_mul_f32 v[100:101], v[100:101], v[232:233] op_sel:[0,0] op_sel_hi:[1,0]
    v_pk_mul_f32 v[102:103], v[102:103], v[232:233] op_sel:[0,0] op_sel_hi:[1,0]
    v_accvgpr_read_b32 v108, a176
    v_accvgpr_read_b32 v109, a177
    v_accvgpr_read_b32 v110, a178
    v_accvgpr_read_b32 v111, a179
    v_accvgpr_read_b32 v112, a180
    v_accvgpr_read_b32 v113, a181
    v_accvgpr_read_b32 v114, a182
    v_accvgpr_read_b32 v115, a183
    buffer_store_dwordx4 v[92:95], v248, s[20:23], s38 offen offset:1024 sc1
    v_cvt_pk_bf16_f32 v104, v96, v97
    v_cvt_pk_bf16_f32 v105, v98, v99
    v_cvt_pk_bf16_f32 v106, v100, v101
    v_cvt_pk_bf16_f32 v107, v102, v103
    v_pk_mul_f32 v[108:109], v[108:109], v[232:233] op_sel:[0,1] op_sel_hi:[1,1]
    v_pk_mul_f32 v[110:111], v[110:111], v[232:233] op_sel:[0,1] op_sel_hi:[1,1]
    v_pk_mul_f32 v[112:113], v[112:113], v[232:233] op_sel:[0,1] op_sel_hi:[1,1]
    v_pk_mul_f32 v[114:115], v[114:115], v[232:233] op_sel:[0,1] op_sel_hi:[1,1]
    buffer_store_dwordx4 v[104:107], v248, s[20:23], s38 offen offset:2048 sc1
    v_cvt_pk_bf16_f32 v116, v108, v109
    v_cvt_pk_bf16_f32 v117, v110, v111
    v_cvt_pk_bf16_f32 v118, v112, v113
    v_cvt_pk_bf16_f32 v119, v114, v115
    buffer_store_dwordx4 v[116:119], v248, s[20:23], s38 offen offset:3072 sc1
    v_accvgpr_read_b32 v0, a40
    v_accvgpr_read_b32 v1, a41
    v_accvgpr_read_b32 v2, a42
    v_accvgpr_read_b32 v3, a43
    v_accvgpr_read_b32 v4, a44
    v_accvgpr_read_b32 v5, a45
    v_accvgpr_read_b32 v6, a46
    v_accvgpr_read_b32 v7, a47
    v_pk_mul_f32 v[0:1], v[0:1], v[230:231] op_sel:[0,0] op_sel_hi:[1,0]
    v_pk_mul_f32 v[2:3], v[2:3], v[230:231] op_sel:[0,0] op_sel_hi:[1,0]
    v_pk_mul_f32 v[4:5], v[4:5], v[230:231] op_sel:[0,0] op_sel_hi:[1,0]
    v_pk_mul_f32 v[6:7], v[6:7], v[230:231] op_sel:[0,0] op_sel_hi:[1,0]
    v_accvgpr_read_b32 v12, a88
    v_accvgpr_read_b32 v13, a89
    v_accvgpr_read_b32 v14, a90
    v_accvgpr_read_b32 v15, a91
    v_accvgpr_read_b32 v16, a92
    v_accvgpr_read_b32 v17, a93
    v_accvgpr_read_b32 v18, a94
    v_accvgpr_read_b32 v19, a95
    s_add_u32 s38, s44, 92160
    v_cvt_pk_bf16_f32 v8, v0, v1
    v_cvt_pk_bf16_f32 v9, v2, v3
    v_cvt_pk_bf16_f32 v10, v4, v5
    v_cvt_pk_bf16_f32 v11, v6, v7
    v_pk_mul_f32 v[12:13], v[12:13], v[230:231] op_sel:[0,1] op_sel_hi:[1,1]
    v_pk_mul_f32 v[14:15], v[14:15], v[230:231] op_sel:[0,1] op_sel_hi:[1,1]
    v_pk_mul_f32 v[16:17], v[16:17], v[230:231] op_sel:[0,1] op_sel_hi:[1,1]
    v_pk_mul_f32 v[18:19], v[18:19], v[230:231] op_sel:[0,1] op_sel_hi:[1,1]
    v_accvgpr_read_b32 v24, a136
    v_accvgpr_read_b32 v25, a137
    v_accvgpr_read_b32 v26, a138
    v_accvgpr_read_b32 v27, a139
    v_accvgpr_read_b32 v28, a140
    v_accvgpr_read_b32 v29, a141
    v_accvgpr_read_b32 v30, a142
    v_accvgpr_read_b32 v31, a143
    buffer_store_dwordx4 v[8:11], v248, s[20:23], s38 offen sc1
    v_cvt_pk_bf16_f32 v20, v12, v13
    v_cvt_pk_bf16_f32 v21, v14, v15
    v_cvt_pk_bf16_f32 v22, v16, v17
    v_cvt_pk_bf16_f32 v23, v18, v19
    v_pk_mul_f32 v[24:25], v[24:25], v[232:233] op_sel:[0,0] op_sel_hi:[1,0]
    v_pk_mul_f32 v[26:27], v[26:27], v[232:233] op_sel:[0,0] op_sel_hi:[1,0]
    v_pk_mul_f32 v[28:29], v[28:29], v[232:233] op_sel:[0,0] op_sel_hi:[1,0]
    v_pk_mul_f32 v[30:31], v[30:31], v[232:233] op_sel:[0,0] op_sel_hi:[1,0]
    v_accvgpr_read_b32 v36, a184
    v_accvgpr_read_b32 v37, a185
    v_accvgpr_read_b32 v38, a186
    v_accvgpr_read_b32 v39, a187
    v_accvgpr_read_b32 v40, a188
    v_accvgpr_read_b32 v41, a189
    v_accvgpr_read_b32 v42, a190
    v_accvgpr_read_b32 v43, a191
    buffer_store_dwordx4 v[20:23], v248, s[20:23], s38 offen offset:1024 sc1
    v_cvt_pk_bf16_f32 v32, v24, v25
    v_cvt_pk_bf16_f32 v33, v26, v27
    v_cvt_pk_bf16_f32 v34, v28, v29
    v_cvt_pk_bf16_f32 v35, v30, v31
    v_pk_mul_f32 v[36:37], v[36:37], v[232:233] op_sel:[0,1] op_sel_hi:[1,1]
    v_pk_mul_f32 v[38:39], v[38:39], v[232:233] op_sel:[0,1] op_sel_hi:[1,1]
    v_pk_mul_f32 v[40:41], v[40:41], v[232:233] op_sel:[0,1] op_sel_hi:[1,1]
    v_pk_mul_f32 v[42:43], v[42:43], v[232:233] op_sel:[0,1] op_sel_hi:[1,1]
    buffer_store_dwordx4 v[32:35], v248, s[20:23], s38 offen offset:2048 sc1
    v_cvt_pk_bf16_f32 v44, v36, v37
    v_cvt_pk_bf16_f32 v45, v38, v39
    v_cvt_pk_bf16_f32 v46, v40, v41
    v_cvt_pk_bf16_f32 v47, v42, v43
    s_waitcnt lgkmcnt(6)
    v_add_f32 v234, v234, v239
    buffer_store_dwordx4 v[44:47], v248, s[20:23], s38 offen offset:3072 sc1
    v_rcp_f32 v234, v234
    v_accvgpr_read_b32 v48, a216
    v_accvgpr_read_b32 v49, a217
    v_accvgpr_read_b32 v50, a218
    v_accvgpr_read_b32 v51, a219
    v_accvgpr_read_b32 v52, a220
    v_accvgpr_read_b32 v53, a221
    v_accvgpr_read_b32 v54, a222
    v_accvgpr_read_b32 v55, a223
    s_waitcnt lgkmcnt(5)
    v_add_f32 v48, v48, v124
    v_add_f32 v49, v49, v125
    v_add_f32 v50, v50, v126
    v_add_f32 v51, v51, v127
    s_waitcnt lgkmcnt(4)
    v_add_f32 v52, v52, v128
    v_add_f32 v53, v53, v129
    v_add_f32 v54, v54, v130
    v_add_f32 v55, v55, v131
    v_pk_mul_f32 v[48:49], v[48:49], v[234:235] op_sel:[0,0] op_sel_hi:[1,0]
    v_pk_mul_f32 v[50:51], v[50:51], v[234:235] op_sel:[0,0] op_sel_hi:[1,0]
    v_pk_mul_f32 v[52:53], v[52:53], v[234:235] op_sel:[0,0] op_sel_hi:[1,0]
    v_pk_mul_f32 v[54:55], v[54:55], v[234:235] op_sel:[0,0] op_sel_hi:[1,0]
    s_add_u32 s38, s45, 55296
    v_cvt_pk_bf16_f32 v56, v48, v49
    v_cvt_pk_bf16_f32 v57, v50, v51
    v_cvt_pk_bf16_f32 v58, v52, v53
    v_cvt_pk_bf16_f32 v59, v54, v55
    buffer_store_dwordx4 v[56:59], v248, s[20:23], s38 offen sc1
    v_accvgpr_read_b32 v60, a224
    v_accvgpr_read_b32 v61, a225
    v_accvgpr_read_b32 v62, a226
    v_accvgpr_read_b32 v63, a227
    v_accvgpr_read_b32 v64, a228
    v_accvgpr_read_b32 v65, a229
    v_accvgpr_read_b32 v66, a230
    v_accvgpr_read_b32 v67, a231
    s_waitcnt lgkmcnt(3)
    v_add_f32 v60, v60, v132
    v_add_f32 v61, v61, v133
    v_add_f32 v62, v62, v134
    v_add_f32 v63, v63, v135
    s_waitcnt lgkmcnt(2)
    v_add_f32 v64, v64, v136
    v_add_f32 v65, v65, v137
    v_add_f32 v66, v66, v138
    v_add_f32 v67, v67, v139
    v_pk_mul_f32 v[60:61], v[60:61], v[234:235] op_sel:[0,0] op_sel_hi:[1,0]
    v_pk_mul_f32 v[62:63], v[62:63], v[234:235] op_sel:[0,0] op_sel_hi:[1,0]
    v_pk_mul_f32 v[64:65], v[64:65], v[234:235] op_sel:[0,0] op_sel_hi:[1,0]
    v_pk_mul_f32 v[66:67], v[66:67], v[234:235] op_sel:[0,0] op_sel_hi:[1,0]
    s_add_u32 s38, s45, 73728
    v_cvt_pk_bf16_f32 v68, v60, v61
    v_cvt_pk_bf16_f32 v69, v62, v63
    v_cvt_pk_bf16_f32 v70, v64, v65
    v_cvt_pk_bf16_f32 v71, v66, v67
    buffer_store_dwordx4 v[68:71], v248, s[20:23], s38 offen sc1
    v_accvgpr_read_b32 v72, a232
    v_accvgpr_read_b32 v73, a233
    v_accvgpr_read_b32 v74, a234
    v_accvgpr_read_b32 v75, a235
    v_accvgpr_read_b32 v76, a236
    v_accvgpr_read_b32 v77, a237
    v_accvgpr_read_b32 v78, a238
    v_accvgpr_read_b32 v79, a239
    s_waitcnt lgkmcnt(1)
    v_add_f32 v72, v72, v140
    v_add_f32 v73, v73, v141
    v_add_f32 v74, v74, v142
    v_add_f32 v75, v75, v143
    s_waitcnt lgkmcnt(0)
    v_add_f32 v76, v76, v144
    v_add_f32 v77, v77, v145
    v_add_f32 v78, v78, v146
    v_add_f32 v79, v79, v147
    v_pk_mul_f32 v[72:73], v[72:73], v[234:235] op_sel:[0,0] op_sel_hi:[1,0]
    v_pk_mul_f32 v[74:75], v[74:75], v[234:235] op_sel:[0,0] op_sel_hi:[1,0]
    v_pk_mul_f32 v[76:77], v[76:77], v[234:235] op_sel:[0,0] op_sel_hi:[1,0]
    v_pk_mul_f32 v[78:79], v[78:79], v[234:235] op_sel:[0,0] op_sel_hi:[1,0]
    s_add_u32 s38, s45, 92160
    v_cvt_pk_bf16_f32 v80, v72, v73
    v_cvt_pk_bf16_f32 v81, v74, v75
    v_cvt_pk_bf16_f32 v82, v76, v77
    v_cvt_pk_bf16_f32 v83, v78, v79
    buffer_store_dwordx4 v[80:83], v248, s[20:23], s38 offen sc1
    s_cmp_eq_u32 s75, 0
    s_cbranch_scc1 K_o
    s_mov_b32 s68, 1
    s_branch K_q1
K_o:
    s_cmp_lt_u32 s2, 30
    s_cbranch_scc1 K_o2
    s_nop 1
    s_waitcnt vmcnt(0)
    s_barrier
    s_cmp_lg_u32 s24, 0
    s_cbranch_scc1 K_s1b
    v_mov_b32 v252, 1
    v_mov_b32 v254, 4
    s_mov_b64 exec, 1
    buffer_atomic_add v252, v254, s[76:79], s73 offen sc1
    s_mov_b64 exec, -1
K_s1b:
    s_mov_b32 s4, s60
    s_mov_b32 s5, s61
    s_mov_b32 s6, 7864320
    v_lshlrev_b32 v0, 3, v248
    s_bfe_u32 s36, s71, 0x20001
    s_lshl_b32 s36, s36, 1
    s_and_b32 s37, s2, 1
    s_add_u32 s36, s36, s37
    s_lshl_b32 s36, s36, 2
    s_add_u32 s36, s36, s24
    s_lshl_b32 s36, s36, 13
    s_add_u32 s36, s36, 655360
K_idl:
    buffer_load_dword v255, v0, s[4:7], s36 offen
    s_add_u32 s36, s36, 262144
    s_waitcnt vmcnt(2)
    s_cmp_lt_u32 s36, 7864320
    s_cbranch_scc1 K_idl
    s_endpgm
K_o2:
    s_mul_i32 s37, s2, 52
    s_lshr_b32 s37, s37, 8
    s_mul_i32 s37, s37, 5
    s_sub_u32 s40, s2, s37
    s_bfe_u32 s36, s71, 0x10001
    s_and_b32 s41, s24, 2
    s_add_u32 s41, s41, s36
    s_mul_i32 s36, s0, 3538944
    s_mul_i32 s37, s1, 6144
    s_add_u32 s36, s36, s37
    s_add_u32 s4, s66, s36
    s_addc_u32 s5, s67, 0
    s_sub_u32 s6, 3538944, s37
    s_mov_b32 s7, 0x00020000
    s_lshl_b32 s36, s40, 8
    s_add_u32 s8, s60, s36
    s_addc_u32 s9, s61, 0
    s_sub_u32 s10, 7864320, s36
    s_mov_b32 s11, 0x00020000
    s_mov_b32 s12, s62
    s_mov_b32 s13, s63
    s_mov_b32 s14, 5898240
    s_mov_b32 s15, 0x00020000
    s_mul_i32 s28, s41, 18432
    s_mul_i32 s29, s41, 40960
    s_mul_i32 s36, s26, 20480
    s_add_u32 s29, s29, s36
    s_lshl_b32 s38, s25, 15
    s_lshl_b32 s36, s26, 12
    s_add_u32 s30, s38, s36
    s_lshr_b32 s36, s71, 1
    s_lshl_b32 s36, s36, 5
    s_add_u32 s36, s36, s2
    s_lshl_b32 s36, s36, 2
    s_add_u32 s36, s36, s24
    s_mul_i32 s32, s36, 12288
    s_lshl_b32 s35, s36, 7
    s_add_u32 s35, s35, 12582912
    s_xor_b32 s36, s36, 128
    s_mul_i32 s33, s36, 12288
    s_lshl_b32 s34, s36, 7
    s_add_u32 s34, s34, 12582912
    s_and_b32 s36, s0, 7
    s_mul_i32 s36, s36, 288
    s_mul_i32 s37, s1, 96
    s_add_u32 s36, s36, s37
    s_mul_i32 s36, s36, 2560
    s_lshr_b32 s37, s0, 3
    s_mul_i32 s37, s37, 1280
    s_add_u32 s36, s36, s37
    s_lshl_b32 s37, s40, 8
    s_add_u32 s36, s36, s37
    s_lshl_b32 s37, s41, 6
    s_add_u32 s31, s36, s37
    v_lshrrev_b32 v216, 4, v248
    v_mov_b32 v192, v248
    v_add_u32 v193, 4096, v192
    v_lshrrev_b32 v217, 4, v216
    v_and_b32 v218, 15, v216
    v_lshlrev_b32 v219, 1, v217
    v_xor_b32 v219, v218, v219
    v_lshlrev_b32 v219, 4, v219
    v_mul_u32_u24 v220, 1280, v217
    v_add_u32 v194, v220, v219
    v_xor_b32 v219, 128, v219
    v_add_u32 v220, 5120, v220
    v_add_u32 v195, v220, v219
    v_mul_u32_u24 v208, 2560, v218
    v_lshl_add_u32 v208, v217, 4, v208
    v_bfe_u32 v219, v216, 2, 2
    v_and_b32 v220, 3, v216
    v_lshl_add_u32 v221, v217, 2, v219
    v_and_b32 v222, 7, v221
    v_lshlrev_b32 v222, 1, v222
    v_lshrrev_b32 v223, 1, v220
    v_xor_b32 v222, v222, v223
    v_lshlrev_b32 v222, 4, v222
    v_and_b32 v223, 1, v220
    v_lshl_add_u32 v222, v223, 3, v222
    v_xor_b32 v222, s37, v222
    v_lshlrev_b32 v221, 8, v221
    v_add_u32 v221, s38, v221
    v_xor_b32 v223, 128, v222
    v_add_u32 v196, v221, v223
    v_xor_b32 v223, 160, v222
    v_add_u32 v197, v221, v223
    v_xor_b32 v223, 192, v222
    v_add_u32 v198, v221, v223
    v_xor_b32 v223, 224, v222
    v_add_u32 v199, v221, v223
    v_xor_b32 v223, 0, v222
    v_add_u32 v200, v221, v223
    v_xor_b32 v223, 32, v222
    v_add_u32 v201, v221, v223
    v_xor_b32 v223, 64, v222
    v_add_u32 v202, v221, v223
    v_xor_b32 v223, 96, v222
    v_add_u32 v203, v221, v223
    s_mul_i32 s36, s24, 24576
    s_add_u32 s36, s36, 65536
    v_add_u32 v204, s36, v192
    s_xor_b32 s36, s24, 2
    s_mul_i32 s36, s36, 24576
    s_add_u32 s36, s36, 65536
    v_add_u32 v207, s36, v192
    v_mov_b32 v209, 0
    s_lshl_b32 s39, s0, 3
    s_mov_b32 s16, s60
    s_mov_b32 s17, s61
    s_mov_b32 s18, 7864320
    s_mov_b32 s19, 0x00020000
    v_min_u32 v205, 21, v216
    v_lshlrev_b32 v205, 7, v205
    s_lshl_b32 s36, s2, 2
    s_add_u32 s36, s36, s24
    s_mul_i32 s37, s36, 137
    s_lshr_b32 s37, s37, 11
    s_mul_i32 s38, s37, 15
    s_sub_u32 s36, s36, s38
    s_mul_i32 s36, s36, 2816
    s_lshl_b32 s37, s37, 1
    s_and_b32 s38, s41, 1
    s_add_u32 s37, s37, s38
    s_add_u32 s37, s37, 16
    s_mul_i32 s37, s37, 40960
    s_add_u32 s42, s36, s37
    s_waitcnt vmcnt(27)
    v_readfirstlane_b32 s46, v252
    s_nop 0
    s_cmp_lt_u32 s46, 16
    s_cbranch_scc1 O_slow0
O_go:
    v_readfirstlane_b32 s46, v254
    s_nop 0
    s_bitcmp0_b32 s46, s2
    s_cbranch_scc1 O_slow1
O_go1:
    s_barrier
    s_add_u32 m0, s30, 0
    s_nop 0
    buffer_load_dwordx4 v194, s[8:11], s29 offen lds
    s_add_u32 m0, s30, 1024
    s_nop 0
    buffer_load_dwordx4 v195, s[8:11], s29 offen lds
    s_add_u32 m0, s30, 2048
    s_add_u32 s29, s29, 10240
    buffer_load_dwordx4 v194, s[8:11], s29 offen lds
    s_add_u32 m0, s30, 3072
    s_nop 0
    buffer_load_dwordx4 v195, s[8:11], s29 offen lds
    buffer_load_dwordx4 a[0:3], v192, s[4:7], s28 offen sc1
    buffer_load_dwordx4 a[4:7], v192, s[4:7], s28 offen offset:1024 sc1
    buffer_load_dwordx4 a[8:11], v192, s[4:7], s28 offen offset:2048 sc1
    buffer_load_dwordx4 a[12:15], v192, s[4:7], s28 offen offset:3072 sc1
    buffer_load_dwordx4 a[16:19], v193, s[4:7], s28 offen sc1
    buffer_load_dwordx4 a[20:23], v193, s[4:7], s28 offen offset:1024 sc1
    s_add_u32 m0, s30, 8192
    s_add_u32 s29, s29, 153600
    buffer_load_dwordx4 v194, s[8:11], s29 offen lds
    s_add_u32 m0, s30, 9216
    s_add_u32 s28, s28, 73728
    buffer_load_dwordx4 v195, s[8:11], s29 offen lds
    s_add_u32 m0, s30, 10240
    s_add_u32 s29, s29, 10240
    buffer_load_dwordx4 v194, s[8:11], s29 offen lds
    s_add_u32 m0, s30, 11264
    s_waitcnt vmcnt(9)
    buffer_load_dwordx4 v195, s[8:11], s29 offen lds
    buffer_load_dwordx4 a[24:27], v192, s[4:7], s28 offen sc1
    buffer_load_dwordx4 a[28:31], v192, s[4:7], s28 offen offset:1024 sc1
    buffer_load_dwordx4 a[32:35], v192, s[4:7], s28 offen offset:2048 sc1
    buffer_load_dwordx4 a[36:39], v192, s[4:7], s28 offen offset:3072 sc1
    buffer_load_dwordx4 a[40:43], v193, s[4:7], s28 offen sc1
    buffer_load_dwordx4 a[44:47], v193, s[4:7], s28 offen offset:1024 sc1
    s_add_u32 m0, s30, 16384
    s_add_u32 s29, s29, 153600
    buffer_load_dwordx4 v194, s[8:11], s29 offen lds
    s_add_u32 m0, s30, 17408
    s_barrier
    buffer_load_dwordx4 v195, s[8:11], s29 offen lds
    ds_read_b64_tr_b16 a[96:97], v196 offset:0
    ds_read_b64_tr_b16 a[98:99], v196 offset:4096
    s_add_u32 m0, s30, 18432
    s_add_u32 s29, s29, 10240
    buffer_load_dwordx4 v194, s[8:11], s29 offen lds
    s_add_u32 m0, s30, 19456
    s_add_u32 s28, s28, 73728
    buffer_load_dwordx4 v195, s[8:11], s29 offen lds
    buffer_load_dwordx4 a[48:51], v192, s[4:7], s28 offen sc1
    buffer_load_dwordx4 a[52:55], v192, s[4:7], s28 offen offset:1024 sc1
    buffer_load_dwordx4 a[56:59], v192, s[4:7], s28 offen offset:2048 sc1
    buffer_load_dwordx4 a[60:63], v192, s[4:7], s28 offen offset:3072 sc1
    buffer_load_dwordx4 a[64:67], v193, s[4:7], s28 offen sc1
    buffer_load_dwordx4 a[68:71], v193, s[4:7], s28 offen offset:1024 sc1
    ds_read_b64_tr_b16 a[100:101], v197 offset:0
    ds_read_b64_tr_b16 a[102:103], v197 offset:4096
    ds_read_b64_tr_b16 a[104:105], v198 offset:0
    ds_read_b64_tr_b16 a[106:107], v198 offset:4096
    ds_read_b64_tr_b16 a[108:109], v199 offset:0
    ds_read_b64_tr_b16 a[110:111], v199 offset:4096
    ds_read_b64_tr_b16 a[112:113], v200 offset:0
    ds_read_b64_tr_b16 a[114:115], v200 offset:4096
    ds_read_b64_tr_b16 a[116:117], v201 offset:0
    ds_read_b64_tr_b16 a[118:119], v201 offset:4096
    s_add_u32 m0, s30, 24576
    s_add_u32 s29, s29, 153600
    ds_read_b64_tr_b16 a[120:121], v202 offset:0
    ds_read_b64_tr_b16 a[122:123], v202 offset:4096
    ds_read_b64_tr_b16 a[124:125], v203 offset:0
    ds_read_b64_tr_b16 a[126:127], v203 offset:4096
    s_add_u32 s28, s28, 73728
    s_waitcnt lgkmcnt(14)
    s_waitcnt vmcnt(25)
    v_mfma_f32_16x16x32_bf16 v[96:99], a[96:99], a[0:3], 0
    s_waitcnt vmcnt(24)
    v_mfma_f32_16x16x32_bf16 v[100:103], a[96:99], a[4:7], 0
    s_waitcnt vmcnt(23)
    v_mfma_f32_16x16x32_bf16 v[104:107], a[96:99], a[8:11], 0
    s_waitcnt vmcnt(22)
    v_mfma_f32_16x16x32_bf16 v[108:111], a[96:99], a[12:15], 0
    s_waitcnt vmcnt(21)
    v_mfma_f32_16x16x32_bf16 v[112:115], a[96:99], a[16:19], 0
    s_waitcnt vmcnt(20)
    v_mfma_f32_16x16x32_bf16 v[116:119], a[96:99], a[20:23], 0
    s_waitcnt lgkmcnt(12)
    v_mfma_f32_16x16x32_bf16 v[120:123], a[100:103], a[0:3], 0
    v_mfma_f32_16x16x32_bf16 v[124:127], a[100:103], a[4:7], 0
    v_mfma_f32_16x16x32_bf16 v[128:131], a[100:103], a[8:11], 0
    v_mfma_f32_16x16x32_bf16 v[132:135], a[100:103], a[12:15], 0
    v_mfma_f32_16x16x32_bf16 v[136:139], a[100:103], a[16:19], 0
    v_mfma_f32_16x16x32_bf16 v[140:143], a[100:103], a[20:23], 0
    s_waitcnt lgkmcnt(10)
    v_mfma_f32_16x16x32_bf16 v[144:147], a[104:107], a[0:3], 0
    v_mfma_f32_16x16x32_bf16 v[148:151], a[104:107], a[4:7], 0
    v_mfma_f32_16x16x32_bf16 v[152:155], a[104:107], a[8:11], 0
    v_mfma_f32_16x16x32_bf16 v[156:159], a[104:107], a[12:15], 0
    v_mfma_f32_16x16x32_bf16 v[160:163], a[104:107], a[16:19], 0
    v_mfma_f32_16x16x32_bf16 v[164:167], a[104:107], a[20:23], 0
    s_waitcnt lgkmcnt(8)
    v_mfma_f32_16x16x32_bf16 v[168:171], a[108:111], a[0:3], 0
    v_mfma_f32_16x16x32_bf16 v[172:175], a[108:111], a[4:7], 0
    v_mfma_f32_16x16x32_bf16 v[176:179], a[108:111], a[8:11], 0
    s_waitcnt vmcnt(16)
    s_barrier
    ds_read_b64_tr_b16 a[96:97], v196 offset:8192
    v_mfma_f32_16x16x32_bf16 v[180:183], a[108:111], a[12:15], 0
    buffer_load_dwordx4 v194, s[8:11], s29 offen lds
    v_mfma_f32_16x16x32_bf16 v[184:187], a[108:111], a[16:19], 0
    s_add_u32 m0, s30, 25600
    ds_read_b64_tr_b16 a[98:99], v196 offset:12288
    ds_read_b64_tr_b16 a[100:101], v197 offset:8192
    v_mfma_f32_16x16x32_bf16 v[188:191], a[108:111], a[20:23], 0
    s_waitcnt lgkmcnt(9)
    buffer_load_dwordx4 v195, s[8:11], s29 offen lds
    v_mfma_f32_16x16x32_bf16 v[0:3], a[112:115], a[0:3], 0
    s_add_u32 m0, s30, 26624
    s_add_u32 s29, s29, 10240
    ds_read_b64_tr_b16 a[102:103], v197 offset:12288
    v_mfma_f32_16x16x32_bf16 v[4:7], a[112:115], a[4:7], 0
    buffer_load_dwordx4 v194, s[8:11], s29 offen lds
    v_mfma_f32_16x16x32_bf16 v[8:11], a[112:115], a[8:11], 0
    s_add_u32 m0, s30, 27648
    ds_read_b64_tr_b16 a[104:105], v198 offset:8192
    ds_read_b64_tr_b16 a[106:107], v198 offset:12288
    v_mfma_f32_16x16x32_bf16 v[12:15], a[112:115], a[12:15], 0
    buffer_load_dwordx4 v195, s[8:11], s29 offen lds
    v_mfma_f32_16x16x32_bf16 v[16:19], a[112:115], a[16:19], 0
    s_add_u32 s29, s29, 153600
    ds_read_b64_tr_b16 a[108:109], v199 offset:8192
    ds_read_b64_tr_b16 a[110:111], v199 offset:12288
    v_mfma_f32_16x16x32_bf16 v[20:23], a[112:115], a[20:23], 0
    s_waitcnt lgkmcnt(12)
    buffer_load_dwordx4 a[72:75], v192, s[4:7], s28 offen sc1
    v_mfma_f32_16x16x32_bf16 v[24:27], a[116:119], a[0:3], 0
    ds_read_b64_tr_b16 a[112:113], v200 offset:8192
    ds_read_b64_tr_b16 a[114:115], v200 offset:12288
    v_mfma_f32_16x16x32_bf16 v[28:31], a[116:119], a[4:7], 0
    buffer_load_dwordx4 a[76:79], v192, s[4:7], s28 offen offset:1024 sc1
    v_mfma_f32_16x16x32_bf16 v[32:35], a[116:119], a[8:11], 0
    v_mfma_f32_16x16x32_bf16 v[36:39], a[116:119], a[12:15], 0
    buffer_load_dwordx4 a[80:83], v192, s[4:7], s28 offen offset:2048 sc1
    v_mfma_f32_16x16x32_bf16 v[40:43], a[116:119], a[16:19], 0
    v_mfma_f32_16x16x32_bf16 v[44:47], a[116:119], a[20:23], 0
    s_waitcnt lgkmcnt(12)
    buffer_load_dwordx4 a[84:87], v192, s[4:7], s28 offen offset:3072 sc1
    v_mfma_f32_16x16x32_bf16 v[48:51], a[120:123], a[0:3], 0
    ds_read_b64_tr_b16 a[116:117], v201 offset:8192
    ds_read_b64_tr_b16 a[118:119], v201 offset:12288
    v_mfma_f32_16x16x32_bf16 v[52:55], a[120:123], a[4:7], 0
    buffer_load_dwordx4 a[88:91], v193, s[4:7], s28 offen sc1
    v_mfma_f32_16x16x32_bf16 v[56:59], a[120:123], a[8:11], 0
    v_mfma_f32_16x16x32_bf16 v[60:63], a[120:123], a[12:15], 0
    buffer_load_dwordx4 a[92:95], v193, s[4:7], s28 offen offset:1024 sc1
    v_mfma_f32_16x16x32_bf16 v[64:67], a[120:123], a[16:19], 0
    s_add_u32 s28, s28, 73728
    v_mfma_f32_16x16x32_bf16 v[68:71], a[120:123], a[20:23], 0
    s_waitcnt lgkmcnt(12)
    ds_read_b64_tr_b16 a[120:121], v202 offset:8192
    ds_read_b64_tr_b16 a[122:123], v202 offset:12288
    v_mfma_f32_16x16x32_bf16 v[72:75], a[124:127], a[0:3], 0
    v_mfma_f32_16x16x32_bf16 v[76:79], a[124:127], a[4:7], 0
    v_mfma_f32_16x16x32_bf16 v[80:83], a[124:127], a[8:11], 0
    v_mfma_f32_16x16x32_bf16 v[84:87], a[124:127], a[12:15], 0
    v_mfma_f32_16x16x32_bf16 v[88:91], a[124:127], a[16:19], 0
    s_waitcnt vmcnt(20)
    v_mfma_f32_16x16x32_bf16 v[92:95], a[124:127], a[20:23], 0
    s_waitcnt lgkmcnt(12)
    s_add_u32 m0, s30, 0
    ds_read_b64_tr_b16 a[124:125], v203 offset:8192
    v_mfma_f32_16x16x32_bf16 v[96:99], a[96:99], a[24:27], v[96:99]
    ds_read_b64_tr_b16 a[126:127], v203 offset:12288
    v_mfma_f32_16x16x32_bf16 v[100:103], a[96:99], a[28:31], v[100:103]
    v_mfma_f32_16x16x32_bf16 v[104:107], a[96:99], a[32:35], v[104:107]
    v_mfma_f32_16x16x32_bf16 v[108:111], a[96:99], a[36:39], v[108:111]
    v_mfma_f32_16x16x32_bf16 v[112:115], a[96:99], a[40:43], v[112:115]
    s_waitcnt vmcnt(16)
    s_barrier
    v_mfma_f32_16x16x32_bf16 v[116:119], a[96:99], a[44:47], v[116:119]
    s_waitcnt lgkmcnt(12)
    buffer_load_dwordx4 v194, s[8:11], s29 offen lds
    v_mfma_f32_16x16x32_bf16 v[120:123], a[100:103], a[24:27], v[120:123]
    s_add_u32 m0, s30, 1024
    ds_read_b64_tr_b16 a[96:97], v196 offset:16384
    ds_read_b64_tr_b16 a[98:99], v196 offset:20480
    v_mfma_f32_16x16x32_bf16 v[124:127], a[100:103], a[28:31], v[124:127]
    buffer_load_dwordx4 v195, s[8:11], s29 offen lds
    v_mfma_f32_16x16x32_bf16 v[128:131], a[100:103], a[32:35], v[128:131]
    s_add_u32 m0, s30, 2048
    s_add_u32 s29, s29, 10240
    v_mfma_f32_16x16x32_bf16 v[132:135], a[100:103], a[36:39], v[132:135]
    buffer_load_dwordx4 v194, s[8:11], s29 offen lds
    v_mfma_f32_16x16x32_bf16 v[136:139], a[100:103], a[40:43], v[136:139]
    s_add_u32 m0, s30, 3072
    v_mfma_f32_16x16x32_bf16 v[140:143], a[100:103], a[44:47], v[140:143]
    s_waitcnt lgkmcnt(12)
    buffer_load_dwordx4 v195, s[8:11], s29 offen lds
    v_mfma_f32_16x16x32_bf16 v[144:147], a[104:107], a[24:27], v[144:147]
    s_add_u32 s29, s29, 153600
    ds_read_b64_tr_b16 a[100:101], v197 offset:16384
    ds_read_b64_tr_b16 a[102:103], v197 offset:20480
    v_mfma_f32_16x16x32_bf16 v[148:151], a[104:107], a[28:31], v[148:151]
    buffer_load_dwordx4 a[0:3], v192, s[4:7], s28 offen sc1
    v_mfma_f32_16x16x32_bf16 v[152:155], a[104:107], a[32:35], v[152:155]
    v_mfma_f32_16x16x32_bf16 v[156:159], a[104:107], a[36:39], v[156:159]
    v_mfma_f32_16x16x32_bf16 v[160:163], a[104:107], a[40:43], v[160:163]
    v_mfma_f32_16x16x32_bf16 v[164:167], a[104:107], a[44:47], v[164:167]
    s_waitcnt lgkmcnt(12)
    buffer_load_dwordx4 a[4:7], v192, s[4:7], s28 offen offset:1024 sc1
    v_mfma_f32_16x16x32_bf16 v[168:171], a[108:111], a[24:27], v[168:171]
    ds_read_b64_tr_b16 a[104:105], v198 offset:16384
    ds_read_b64_tr_b16 a[106:107], v198 offset:20480
    v_mfma_f32_16x16x32_bf16 v[172:175], a[108:111], a[28:31], v[172:175]
    v_mfma_f32_16x16x32_bf16 v[176:179], a[108:111], a[32:35], v[176:179]
    v_mfma_f32_16x16x32_bf16 v[180:183], a[108:111], a[36:39], v[180:183]
    buffer_load_dwordx4 a[8:11], v192, s[4:7], s28 offen offset:2048 sc1
    v_mfma_f32_16x16x32_bf16 v[184:187], a[108:111], a[40:43], v[184:187]
    v_mfma_f32_16x16x32_bf16 v[188:191], a[108:111], a[44:47], v[188:191]
    s_waitcnt lgkmcnt(12)
    ds_read_b64_tr_b16 a[108:109], v199 offset:16384
    ds_read_b64_tr_b16 a[110:111], v199 offset:20480
    v_mfma_f32_16x16x32_bf16 v[0:3], a[112:115], a[24:27], v[0:3]
    v_mfma_f32_16x16x32_bf16 v[4:7], a[112:115], a[28:31], v[4:7]
    buffer_load_dwordx4 a[12:15], v192, s[4:7], s28 offen offset:3072 sc1
    v_mfma_f32_16x16x32_bf16 v[8:11], a[112:115], a[32:35], v[8:11]
    v_mfma_f32_16x16x32_bf16 v[12:15], a[112:115], a[36:39], v[12:15]
    v_mfma_f32_16x16x32_bf16 v[16:19], a[112:115], a[40:43], v[16:19]
    v_mfma_f32_16x16x32_bf16 v[20:23], a[112:115], a[44:47], v[20:23]
    s_waitcnt lgkmcnt(12)
    buffer_load_dwordx4 a[16:19], v193, s[4:7], s28 offen sc1
    v_mfma_f32_16x16x32_bf16 v[24:27], a[116:119], a[24:27], v[24:27]
    ds_read_b64_tr_b16 a[112:113], v200 offset:16384
    ds_read_b64_tr_b16 a[114:115], v200 offset:20480
    v_mfma_f32_16x16x32_bf16 v[28:31], a[116:119], a[28:31], v[28:31]
    v_mfma_f32_16x16x32_bf16 v[32:35], a[116:119], a[32:35], v[32:35]
    v_mfma_f32_16x16x32_bf16 v[36:39], a[116:119], a[36:39], v[36:39]
    buffer_load_dwordx4 a[20:23], v193, s[4:7], s28 offen offset:1024 sc1
    v_mfma_f32_16x16x32_bf16 v[40:43], a[116:119], a[40:43], v[40:43]
    s_add_u32 s28, s28, 73728
    v_mfma_f32_16x16x32_bf16 v[44:47], a[116:119], a[44:47], v[44:47]
    s_waitcnt lgkmcnt(12)
    ds_read_b64_tr_b16 a[116:117], v201 offset:16384
    ds_read_b64_tr_b16 a[118:119], v201 offset:20480
    v_mfma_f32_16x16x32_bf16 v[48:51], a[120:123], a[24:27], v[48:51]
    v_mfma_f32_16x16x32_bf16 v[52:55], a[120:123], a[28:31], v[52:55]
    v_mfma_f32_16x16x32_bf16 v[56:59], a[120:123], a[32:35], v[56:59]
    v_mfma_f32_16x16x32_bf16 v[60:63], a[120:123], a[36:39], v[60:63]
    v_mfma_f32_16x16x32_bf16 v[64:67], a[120:123], a[40:43], v[64:67]
    v_mfma_f32_16x16x32_bf16 v[68:71], a[120:123], a[44:47], v[68:71]
    s_waitcnt lgkmcnt(12)
    ds_read_b64_tr_b16 a[120:121], v202 offset:16384
    ds_read_b64_tr_b16 a[122:123], v202 offset:20480
    v_mfma_f32_16x16x32_bf16 v[72:75], a[124:127], a[24:27], v[72:75]
    v_mfma_f32_16x16x32_bf16 v[76:79], a[124:127], a[28:31], v[76:79]
    v_mfma_f32_16x16x32_bf16 v[80:83], a[124:127], a[32:35], v[80:83]
    v_mfma_f32_16x16x32_bf16 v[84:87], a[124:127], a[36:39], v[84:87]
    v_mfma_f32_16x16x32_bf16 v[88:91], a[124:127], a[40:43], v[88:91]
    s_waitcnt vmcnt(20)
    v_mfma_f32_16x16x32_bf16 v[92:95], a[124:127], a[44:47], v[92:95]
    s_waitcnt lgkmcnt(12)
    s_add_u32 m0, s30, 8192
    ds_read_b64_tr_b16 a[124:125], v203 offset:16384
    v_mfma_f32_16x16x32_bf16 v[96:99], a[96:99], a[48:51], v[96:99]
    ds_read_b64_tr_b16 a[126:127], v203 offset:20480
    v_mfma_f32_16x16x32_bf16 v[100:103], a[96:99], a[52:55], v[100:103]
    v_mfma_f32_16x16x32_bf16 v[104:107], a[96:99], a[56:59], v[104:107]
    v_mfma_f32_16x16x32_bf16 v[108:111], a[96:99], a[60:63], v[108:111]
    v_mfma_f32_16x16x32_bf16 v[112:115], a[96:99], a[64:67], v[112:115]
    s_waitcnt vmcnt(16)
    s_barrier
    v_mfma_f32_16x16x32_bf16 v[116:119], a[96:99], a[68:71], v[116:119]
    s_waitcnt lgkmcnt(12)
    buffer_load_dwordx4 v194, s[8:11], s29 offen lds
    v_mfma_f32_16x16x32_bf16 v[120:123], a[100:103], a[48:51], v[120:123]
    s_add_u32 m0, s30, 9216
    ds_read_b64_tr_b16 a[96:97], v196 offset:24576
    ds_read_b64_tr_b16 a[98:99], v196 offset:28672
    v_mfma_f32_16x16x32_bf16 v[124:127], a[100:103], a[52:55], v[124:127]
    buffer_load_dwordx4 v195, s[8:11], s29 offen lds
    v_mfma_f32_16x16x32_bf16 v[128:131], a[100:103], a[56:59], v[128:131]
    s_add_u32 m0, s30, 10240
    s_add_u32 s29, s29, 10240
    v_mfma_f32_16x16x32_bf16 v[132:135], a[100:103], a[60:63], v[132:135]
    buffer_load_dwordx4 v194, s[8:11], s29 offen lds
    v_mfma_f32_16x16x32_bf16 v[136:139], a[100:103], a[64:67], v[136:139]
    s_add_u32 m0, s30, 11264
    v_mfma_f32_16x16x32_bf16 v[140:143], a[100:103], a[68:71], v[140:143]
    s_waitcnt lgkmcnt(12)
    buffer_load_dwordx4 v195, s[8:11], s29 offen lds
    v_mfma_f32_16x16x32_bf16 v[144:147], a[104:107], a[48:51], v[144:147]
    s_add_u32 s29, s29, 153600
    ds_read_b64_tr_b16 a[100:101], v197 offset:24576
    ds_read_b64_tr_b16 a[102:103], v197 offset:28672
    v_mfma_f32_16x16x32_bf16 v[148:151], a[104:107], a[52:55], v[148:151]
    buffer_load_dwordx4 a[24:27], v192, s[4:7], s28 offen sc1
    v_mfma_f32_16x16x32_bf16 v[152:155], a[104:107], a[56:59], v[152:155]
    v_mfma_f32_16x16x32_bf16 v[156:159], a[104:107], a[60:63], v[156:159]
    v_mfma_f32_16x16x32_bf16 v[160:163], a[104:107], a[64:67], v[160:163]
    v_mfma_f32_16x16x32_bf16 v[164:167], a[104:107], a[68:71], v[164:167]
    s_waitcnt lgkmcnt(12)
    buffer_load_dwordx4 a[28:31], v192, s[4:7], s28 offen offset:1024 sc1
    v_mfma_f32_16x16x32_bf16 v[168:171], a[108:111], a[48:51], v[168:171]
    ds_read_b64_tr_b16 a[104:105], v198 offset:24576
    ds_read_b64_tr_b16 a[106:107], v198 offset:28672
    v_mfma_f32_16x16x32_bf16 v[172:175], a[108:111], a[52:55], v[172:175]
    v_mfma_f32_16x16x32_bf16 v[176:179], a[108:111], a[56:59], v[176:179]
    v_mfma_f32_16x16x32_bf16 v[180:183], a[108:111], a[60:63], v[180:183]
    buffer_load_dwordx4 a[32:35], v192, s[4:7], s28 offen offset:2048 sc1
    v_mfma_f32_16x16x32_bf16 v[184:187], a[108:111], a[64:67], v[184:187]
    v_mfma_f32_16x16x32_bf16 v[188:191], a[108:111], a[68:71], v[188:191]
    s_waitcnt lgkmcnt(12)
    ds_read_b64_tr_b16 a[108:109], v199 offset:24576
    ds_read_b64_tr_b16 a[110:111], v199 offset:28672
    v_mfma_f32_16x16x32_bf16 v[0:3], a[112:115], a[48:51], v[0:3]
    v_mfma_f32_16x16x32_bf16 v[4:7], a[112:115], a[52:55], v[4:7]
    buffer_load_dwordx4 a[36:39], v192, s[4:7], s28 offen offset:3072 sc1
    v_mfma_f32_16x16x32_bf16 v[8:11], a[112:115], a[56:59], v[8:11]
    v_mfma_f32_16x16x32_bf16 v[12:15], a[112:115], a[60:63], v[12:15]
    v_mfma_f32_16x16x32_bf16 v[16:19], a[112:115], a[64:67], v[16:19]
    v_mfma_f32_16x16x32_bf16 v[20:23], a[112:115], a[68:71], v[20:23]
    s_waitcnt lgkmcnt(12)
    buffer_load_dwordx4 a[40:43], v193, s[4:7], s28 offen sc1
    v_mfma_f32_16x16x32_bf16 v[24:27], a[116:119], a[48:51], v[24:27]
    ds_read_b64_tr_b16 a[112:113], v200 offset:24576
    ds_read_b64_tr_b16 a[114:115], v200 offset:28672
    v_mfma_f32_16x16x32_bf16 v[28:31], a[116:119], a[52:55], v[28:31]
    v_mfma_f32_16x16x32_bf16 v[32:35], a[116:119], a[56:59], v[32:35]
    v_mfma_f32_16x16x32_bf16 v[36:39], a[116:119], a[60:63], v[36:39]
    buffer_load_dwordx4 a[44:47], v193, s[4:7], s28 offen offset:1024 sc1
    v_mfma_f32_16x16x32_bf16 v[40:43], a[116:119], a[64:67], v[40:43]
    s_add_u32 s28, s28, 73728
    v_mfma_f32_16x16x32_bf16 v[44:47], a[116:119], a[68:71], v[44:47]
    s_waitcnt lgkmcnt(12)
    ds_read_b64_tr_b16 a[116:117], v201 offset:24576
    ds_read_b64_tr_b16 a[118:119], v201 offset:28672
    v_mfma_f32_16x16x32_bf16 v[48:51], a[120:123], a[48:51], v[48:51]
    v_mfma_f32_16x16x32_bf16 v[52:55], a[120:123], a[52:55], v[52:55]
    v_mfma_f32_16x16x32_bf16 v[56:59], a[120:123], a[56:59], v[56:59]
    v_mfma_f32_16x16x32_bf16 v[60:63], a[120:123], a[60:63], v[60:63]
    v_mfma_f32_16x16x32_bf16 v[64:67], a[120:123], a[64:67], v[64:67]
    v_mfma_f32_16x16x32_bf16 v[68:71], a[120:123], a[68:71], v[68:71]
    s_waitcnt lgkmcnt(12)
    ds_read_b64_tr_b16 a[120:121], v202 offset:24576
    ds_read_b64_tr_b16 a[122:123], v202 offset:28672
    v_mfma_f32_16x16x32_bf16 v[72:75], a[124:127], a[48:51], v[72:75]
    v_mfma_f32_16x16x32_bf16 v[76:79], a[124:127], a[52:55], v[76:79]
    v_mfma_f32_16x16x32_bf16 v[80:83], a[124:127], a[56:59], v[80:83]
    v_mfma_f32_16x16x32_bf16 v[84:87], a[124:127], a[60:63], v[84:87]
    v_mfma_f32_16x16x32_bf16 v[88:91], a[124:127], a[64:67], v[88:91]
    s_waitcnt vmcnt(20)
    v_mfma_f32_16x16x32_bf16 v[92:95], a[124:127], a[68:71], v[92:95]
    s_waitcnt lgkmcnt(12)
    s_add_u32 m0, s30, 16384
    ds_read_b64_tr_b16 a[124:125], v203 offset:24576
    v_mfma_f32_16x16x32_bf16 v[96:99], a[96:99], a[72:75], v[96:99]
    ds_read_b64_tr_b16 a[126:127], v203 offset:28672
    v_mfma_f32_16x16x32_bf16 v[100:103], a[96:99], a[76:79], v[100:103]
    v_mfma_f32_16x16x32_bf16 v[104:107], a[96:99], a[80:83], v[104:107]
    v_mfma_f32_16x16x32_bf16 v[108:111], a[96:99], a[84:87], v[108:111]
    v_mfma_f32_16x16x32_bf16 v[112:115], a[96:99], a[88:91], v[112:115]
    s_waitcnt vmcnt(16)
    s_barrier
    v_mfma_f32_16x16x32_bf16 v[116:119], a[96:99], a[92:95], v[116:119]
    s_waitcnt lgkmcnt(12)
    buffer_load_dwordx4 v194, s[8:11], s29 offen lds
    v_mfma_f32_16x16x32_bf16 v[120:123], a[100:103], a[72:75], v[120:123]
    s_add_u32 m0, s30, 17408
    ds_read_b64_tr_b16 a[96:97], v196 offset:0
    ds_read_b64_tr_b16 a[98:99], v196 offset:4096
    v_mfma_f32_16x16x32_bf16 v[124:127], a[100:103], a[76:79], v[124:127]
    buffer_load_dwordx4 v195, s[8:11], s29 offen lds
    v_mfma_f32_16x16x32_bf16 v[128:131], a[100:103], a[80:83], v[128:131]
    s_add_u32 m0, s30, 18432
    s_add_u32 s29, s29, 10240
    v_mfma_f32_16x16x32_bf16 v[132:135], a[100:103], a[84:87], v[132:135]
    buffer_load_dwordx4 v194, s[8:11], s29 offen lds
    v_mfma_f32_16x16x32_bf16 v[136:139], a[100:103], a[88:91], v[136:139]
    s_add_u32 m0, s30, 19456
    v_mfma_f32_16x16x32_bf16 v[140:143], a[100:103], a[92:95], v[140:143]
    s_waitcnt lgkmcnt(12)
    buffer_load_dwordx4 v195, s[8:11], s29 offen lds
    v_mfma_f32_16x16x32_bf16 v[144:147], a[104:107], a[72:75], v[144:147]
    s_add_u32 s29, s29, 153600
    ds_read_b64_tr_b16 a[100:101], v197 offset:0
    ds_read_b64_tr_b16 a[102:103], v197 offset:4096
    v_mfma_f32_16x16x32_bf16 v[148:151], a[104:107], a[76:79], v[148:151]
    buffer_load_dwordx4 a[48:51], v192, s[4:7], s28 offen sc1
    v_mfma_f32_16x16x32_bf16 v[152:155], a[104:107], a[80:83], v[152:155]
    v_mfma_f32_16x16x32_bf16 v[156:159], a[104:107], a[84:87], v[156:159]
    v_mfma_f32_16x16x32_bf16 v[160:163], a[104:107], a[88:91], v[160:163]
    v_mfma_f32_16x16x32_bf16 v[164:167], a[104:107], a[92:95], v[164:167]
    s_waitcnt lgkmcnt(12)
    buffer_load_dwordx4 a[52:55], v192, s[4:7], s28 offen offset:1024 sc1
    v_mfma_f32_16x16x32_bf16 v[168:171], a[108:111], a[72:75], v[168:171]
    ds_read_b64_tr_b16 a[104:105], v198 offset:0
    ds_read_b64_tr_b16 a[106:107], v198 offset:4096
    v_mfma_f32_16x16x32_bf16 v[172:175], a[108:111], a[76:79], v[172:175]
    v_mfma_f32_16x16x32_bf16 v[176:179], a[108:111], a[80:83], v[176:179]
    v_mfma_f32_16x16x32_bf16 v[180:183], a[108:111], a[84:87], v[180:183]
    buffer_load_dwordx4 a[56:59], v192, s[4:7], s28 offen offset:2048 sc1
    v_mfma_f32_16x16x32_bf16 v[184:187], a[108:111], a[88:91], v[184:187]
    v_mfma_f32_16x16x32_bf16 v[188:191], a[108:111], a[92:95], v[188:191]
    s_waitcnt lgkmcnt(12)
    ds_read_b64_tr_b16 a[108:109], v199 offset:0
    ds_read_b64_tr_b16 a[110:111], v199 offset:4096
    v_mfma_f32_16x16x32_bf16 v[0:3], a[112:115], a[72:75], v[0:3]
    v_mfma_f32_16x16x32_bf16 v[4:7], a[112:115], a[76:79], v[4:7]
    buffer_load_dwordx4 a[60:63], v192, s[4:7], s28 offen offset:3072 sc1
    v_mfma_f32_16x16x32_bf16 v[8:11], a[112:115], a[80:83], v[8:11]
    v_mfma_f32_16x16x32_bf16 v[12:15], a[112:115], a[84:87], v[12:15]
    v_mfma_f32_16x16x32_bf16 v[16:19], a[112:115], a[88:91], v[16:19]
    v_mfma_f32_16x16x32_bf16 v[20:23], a[112:115], a[92:95], v[20:23]
    s_waitcnt lgkmcnt(12)
    buffer_load_dwordx4 a[64:67], v193, s[4:7], s28 offen sc1
    v_mfma_f32_16x16x32_bf16 v[24:27], a[116:119], a[72:75], v[24:27]
    ds_read_b64_tr_b16 a[112:113], v200 offset:0
    ds_read_b64_tr_b16 a[114:115], v200 offset:4096
    v_mfma_f32_16x16x32_bf16 v[28:31], a[116:119], a[76:79], v[28:31]
    v_mfma_f32_16x16x32_bf16 v[32:35], a[116:119], a[80:83], v[32:35]
    v_mfma_f32_16x16x32_bf16 v[36:39], a[116:119], a[84:87], v[36:39]
    buffer_load_dwordx4 a[68:71], v193, s[4:7], s28 offen offset:1024 sc1
    v_mfma_f32_16x16x32_bf16 v[40:43], a[116:119], a[88:91], v[40:43]
    s_add_u32 s28, s28, 73728
    v_mfma_f32_16x16x32_bf16 v[44:47], a[116:119], a[92:95], v[44:47]
    s_waitcnt lgkmcnt(12)
    ds_read_b64_tr_b16 a[116:117], v201 offset:0
    ds_read_b64_tr_b16 a[118:119], v201 offset:4096
    v_mfma_f32_16x16x32_bf16 v[48:51], a[120:123], a[72:75], v[48:51]
    v_mfma_f32_16x16x32_bf16 v[52:55], a[120:123], a[76:79], v[52:55]
    v_mfma_f32_16x16x32_bf16 v[56:59], a[120:123], a[80:83], v[56:59]
    v_mfma_f32_16x16x32_bf16 v[60:63], a[120:123], a[84:87], v[60:63]
    v_mfma_f32_16x16x32_bf16 v[64:67], a[120:123], a[88:91], v[64:67]
    v_mfma_f32_16x16x32_bf16 v[68:71], a[120:123], a[92:95], v[68:71]
    s_waitcnt lgkmcnt(12)
    ds_read_b64_tr_b16 a[120:121], v202 offset:0
    ds_read_b64_tr_b16 a[122:123], v202 offset:4096
    v_mfma_f32_16x16x32_bf16 v[72:75], a[124:127], a[72:75], v[72:75]
    v_mfma_f32_16x16x32_bf16 v[76:79], a[124:127], a[76:79], v[76:79]
    v_mfma_f32_16x16x32_bf16 v[80:83], a[124:127], a[80:83], v[80:83]
    v_mfma_f32_16x16x32_bf16 v[84:87], a[124:127], a[84:87], v[84:87]
    v_mfma_f32_16x16x32_bf16 v[88:91], a[124:127], a[88:91], v[88:91]
    s_waitcnt vmcnt(20)
    v_mfma_f32_16x16x32_bf16 v[92:95], a[124:127], a[92:95], v[92:95]
    s_waitcnt lgkmcnt(12)
    s_add_u32 m0, s30, 24576
    ds_read_b64_tr_b16 a[124:125], v203 offset:0
    s_cmp_lg_u32 s24, 0
    s_cbranch_scc1 K_s1
    v_mov_b32 v252, 1
    v_mov_b32 v254, 4
    s_mov_b64 exec, 1
    buffer_atomic_add v252, v254, s[76:79], s73 offen sc1
    s_mov_b64 exec, -1
K_s1:
    s_mov_b32 s43, 9
O_loop:
    s_cmp_eq_u32 s43, 5
    s_cbranch_scc1 O_mid
O_cont:
    v_mfma_f32_16x16x32_bf16 v[96:99], a[96:99], a[0:3], v[96:99]
    ds_read_b64_tr_b16 a[126:127], v203 offset:4096
    v_mfma_f32_16x16x32_bf16 v[100:103], a[96:99], a[4:7], v[100:103]
    v_mfma_f32_16x16x32_bf16 v[104:107], a[96:99], a[8:11], v[104:107]
    v_mfma_f32_16x16x32_bf16 v[108:111], a[96:99], a[12:15], v[108:111]
    v_mfma_f32_16x16x32_bf16 v[112:115], a[96:99], a[16:19], v[112:115]
    s_waitcnt vmcnt(16)
    s_barrier
    v_mfma_f32_16x16x32_bf16 v[116:119], a[96:99], a[20:23], v[116:119]
    s_waitcnt lgkmcnt(12)
    buffer_load_dwordx4 v194, s[8:11], s29 offen lds
    v_mfma_f32_16x16x32_bf16 v[120:123], a[100:103], a[0:3], v[120:123]
    s_add_u32 m0, s30, 25600
    ds_read_b64_tr_b16 a[96:97], v196 offset:8192
    ds_read_b64_tr_b16 a[98:99], v196 offset:12288
    v_mfma_f32_16x16x32_bf16 v[124:127], a[100:103], a[4:7], v[124:127]
    buffer_load_dwordx4 v195, s[8:11], s29 offen lds
    v_mfma_f32_16x16x32_bf16 v[128:131], a[100:103], a[8:11], v[128:131]
    s_add_u32 m0, s30, 26624
    s_add_u32 s29, s29, 10240
    v_mfma_f32_16x16x32_bf16 v[132:135], a[100:103], a[12:15], v[132:135]
    buffer_load_dwordx4 v194, s[8:11], s29 offen lds
    v_mfma_f32_16x16x32_bf16 v[136:139], a[100:103], a[16:19], v[136:139]
    s_add_u32 m0, s30, 27648
    v_mfma_f32_16x16x32_bf16 v[140:143], a[100:103], a[20:23], v[140:143]
    s_waitcnt lgkmcnt(12)
    buffer_load_dwordx4 v195, s[8:11], s29 offen lds
    v_mfma_f32_16x16x32_bf16 v[144:147], a[104:107], a[0:3], v[144:147]
    s_add_u32 s29, s29, 153600
    ds_read_b64_tr_b16 a[100:101], v197 offset:8192
    ds_read_b64_tr_b16 a[102:103], v197 offset:12288
    v_mfma_f32_16x16x32_bf16 v[148:151], a[104:107], a[4:7], v[148:151]
    buffer_load_dwordx4 a[72:75], v192, s[4:7], s28 offen sc1
    v_mfma_f32_16x16x32_bf16 v[152:155], a[104:107], a[8:11], v[152:155]
    v_mfma_f32_16x16x32_bf16 v[156:159], a[104:107], a[12:15], v[156:159]
    v_mfma_f32_16x16x32_bf16 v[160:163], a[104:107], a[16:19], v[160:163]
    v_mfma_f32_16x16x32_bf16 v[164:167], a[104:107], a[20:23], v[164:167]
    s_waitcnt lgkmcnt(12)
    buffer_load_dwordx4 a[76:79], v192, s[4:7], s28 offen offset:1024 sc1
    v_mfma_f32_16x16x32_bf16 v[168:171], a[108:111], a[0:3], v[168:171]
    ds_read_b64_tr_b16 a[104:105], v198 offset:8192
    ds_read_b64_tr_b16 a[106:107], v198 offset:12288
    v_mfma_f32_16x16x32_bf16 v[172:175], a[108:111], a[4:7], v[172:175]
    v_mfma_f32_16x16x32_bf16 v[176:179], a[108:111], a[8:11], v[176:179]
    v_mfma_f32_16x16x32_bf16 v[180:183], a[108:111], a[12:15], v[180:183]
    buffer_load_dwordx4 a[80:83], v192, s[4:7], s28 offen offset:2048 sc1
    v_mfma_f32_16x16x32_bf16 v[184:187], a[108:111], a[16:19], v[184:187]
    v_mfma_f32_16x16x32_bf16 v[188:191], a[108:111], a[20:23], v[188:191]
    s_waitcnt lgkmcnt(12)
    ds_read_b64_tr_b16 a[108:109], v199 offset:8192
    ds_read_b64_tr_b16 a[110:111], v199 offset:12288
    v_mfma_f32_16x16x32_bf16 v[0:3], a[112:115], a[0:3], v[0:3]
    v_mfma_f32_16x16x32_bf16 v[4:7], a[112:115], a[4:7], v[4:7]
    buffer_load_dwordx4 a[84:87], v192, s[4:7], s28 offen offset:3072 sc1
    v_mfma_f32_16x16x32_bf16 v[8:11], a[112:115], a[8:11], v[8:11]
    v_mfma_f32_16x16x32_bf16 v[12:15], a[112:115], a[12:15], v[12:15]
    v_mfma_f32_16x16x32_bf16 v[16:19], a[112:115], a[16:19], v[16:19]
    v_mfma_f32_16x16x32_bf16 v[20:23], a[112:115], a[20:23], v[20:23]
    s_waitcnt lgkmcnt(12)
    buffer_load_dwordx4 a[88:91], v193, s[4:7], s28 offen sc1
    v_mfma_f32_16x16x32_bf16 v[24:27], a[116:119], a[0:3], v[24:27]
    ds_read_b64_tr_b16 a[112:113], v200 offset:8192
    ds_read_b64_tr_b16 a[114:115], v200 offset:12288
    v_mfma_f32_16x16x32_bf16 v[28:31], a[116:119], a[4:7], v[28:31]
    v_mfma_f32_16x16x32_bf16 v[32:35], a[116:119], a[8:11], v[32:35]
    v_mfma_f32_16x16x32_bf16 v[36:39], a[116:119], a[12:15], v[36:39]
    buffer_load_dwordx4 a[92:95], v193, s[4:7], s28 offen offset:1024 sc1
    v_mfma_f32_16x16x32_bf16 v[40:43], a[116:119], a[16:19], v[40:43]
    s_add_u32 s28, s28, 73728
    v_mfma_f32_16x16x32_bf16 v[44:47], a[116:119], a[20:23], v[44:47]
    s_waitcnt lgkmcnt(12)
    ds_read_b64_tr_b16 a[116:117], v201 offset:8192
    ds_read_b64_tr_b16 a[118:119], v201 offset:12288
    v_mfma_f32_16x16x32_bf16 v[48:51], a[120:123], a[0:3], v[48:51]
    v_mfma_f32_16x16x32_bf16 v[52:55], a[120:123], a[4:7], v[52:55]
    v_mfma_f32_16x16x32_bf16 v[56:59], a[120:123], a[8:11], v[56:59]
    v_mfma_f32_16x16x32_bf16 v[60:63], a[120:123], a[12:15], v[60:63]
    v_mfma_f32_16x16x32_bf16 v[64:67], a[120:123], a[16:19], v[64:67]
    v_mfma_f32_16x16x32_bf16 v[68:71], a[120:123], a[20:23], v[68:71]
    s_waitcnt lgkmcnt(12)
    ds_read_b64_tr_b16 a[120:121], v202 offset:8192
    ds_read_b64_tr_b16 a[122:123], v202 offset:12288
    v_mfma_f32_16x16x32_bf16 v[72:75], a[124:127], a[0:3], v[72:75]
    v_mfma_f32_16x16x32_bf16 v[76:79], a[124:127], a[4:7], v[76:79]
    v_mfma_f32_16x16x32_bf16 v[80:83], a[124:127], a[8:11], v[80:83]
    v_mfma_f32_16x16x32_bf16 v[84:87], a[124:127], a[12:15], v[84:87]
    v_mfma_f32_16x16x32_bf16 v[88:91], a[124:127], a[16:19], v[88:91]
    s_waitcnt vmcnt(20)
    v_mfma_f32_16x16x32_bf16 v[92:95], a[124:127], a[20:23], v[92:95]
    s_waitcnt lgkmcnt(12)
    s_add_u32 m0, s30, 0
    ds_read_b64_tr_b16 a[124:125], v203 offset:8192
    v_mfma_f32_16x16x32_bf16 v[96:99], a[96:99], a[24:27], v[96:99]
    ds_read_b64_tr_b16 a[126:127], v203 offset:12288
    v_mfma_f32_16x16x32_bf16 v[100:103], a[96:99], a[28:31], v[100:103]
    v_mfma_f32_16x16x32_bf16 v[104:107], a[96:99], a[32:35], v[104:107]
    v_mfma_f32_16x16x32_bf16 v[108:111], a[96:99], a[36:39], v[108:111]
    v_mfma_f32_16x16x32_bf16 v[112:115], a[96:99], a[40:43], v[112:115]
    s_waitcnt vmcnt(16)
    s_barrier
    v_mfma_f32_16x16x32_bf16 v[116:119], a[96:99], a[44:47], v[116:119]
    s_waitcnt lgkmcnt(12)
    buffer_load_dwordx4 v194, s[8:11], s29 offen lds
    v_mfma_f32_16x16x32_bf16 v[120:123], a[100:103], a[24:27], v[120:123]
    s_add_u32 m0, s30, 1024
    ds_read_b64_tr_b16 a[96:97], v196 offset:16384
    ds_read_b64_tr_b16 a[98:99], v196 offset:20480
    v_mfma_f32_16x16x32_bf16 v[124:127], a[100:103], a[28:31], v[124:127]
    buffer_load_dwordx4 v195, s[8:11], s29 offen lds
    v_mfma_f32_16x16x32_bf16 v[128:131], a[100:103], a[32:35], v[128:131]
    s_add_u32 m0, s30, 2048
    s_add_u32 s29, s29, 10240
    v_mfma_f32_16x16x32_bf16 v[132:135], a[100:103], a[36:39], v[132:135]
    buffer_load_dwordx4 v194, s[8:11], s29 offen lds
    v_mfma_f32_16x16x32_bf16 v[136:139], a[100:103], a[40:43], v[136:139]
    s_add_u32 m0, s30, 3072
    v_mfma_f32_16x16x32_bf16 v[140:143], a[100:103], a[44:47], v[140:143]
    s_waitcnt lgkmcnt(12)
    buffer_load_dwordx4 v195, s[8:11], s29 offen lds
    v_mfma_f32_16x16x32_bf16 v[144:147], a[104:107], a[24:27], v[144:147]
    s_add_u32 s29, s29, 153600
    ds_read_b64_tr_b16 a[100:101], v197 offset:16384
    ds_read_b64_tr_b16 a[102:103], v197 offset:20480
    v_mfma_f32_16x16x32_bf16 v[148:151], a[104:107], a[28:31], v[148:151]
    buffer_load_dwordx4 a[0:3], v192, s[4:7], s28 offen sc1
    v_mfma_f32_16x16x32_bf16 v[152:155], a[104:107], a[32:35], v[152:155]
    v_mfma_f32_16x16x32_bf16 v[156:159], a[104:107], a[36:39], v[156:159]
    v_mfma_f32_16x16x32_bf16 v[160:163], a[104:107], a[40:43], v[160:163]
    v_mfma_f32_16x16x32_bf16 v[164:167], a[104:107], a[44:47], v[164:167]
    s_waitcnt lgkmcnt(12)
    buffer_load_dwordx4 a[4:7], v192, s[4:7], s28 offen offset:1024 sc1
    v_mfma_f32_16x16x32_bf16 v[168:171], a[108:111], a[24:27], v[168:171]
    ds_read_b64_tr_b16 a[104:105], v198 offset:16384
    ds_read_b64_tr_b16 a[106:107], v198 offset:20480
    v_mfma_f32_16x16x32_bf16 v[172:175], a[108:111], a[28:31], v[172:175]
    v_mfma_f32_16x16x32_bf16 v[176:179], a[108:111], a[32:35], v[176:179]
    v_mfma_f32_16x16x32_bf16 v[180:183], a[108:111], a[36:39], v[180:183]
    buffer_load_dwordx4 a[8:11], v192, s[4:7], s28 offen offset:2048 sc1
    v_mfma_f32_16x16x32_bf16 v[184:187], a[108:111], a[40:43], v[184:187]
    v_mfma_f32_16x16x32_bf16 v[188:191], a[108:111], a[44:47], v[188:191]
    s_waitcnt lgkmcnt(12)
    ds_read_b64_tr_b16 a[108:109], v199 offset:16384
    ds_read_b64_tr_b16 a[110:111], v199 offset:20480
    v_mfma_f32_16x16x32_bf16 v[0:3], a[112:115], a[24:27], v[0:3]
    v_mfma_f32_16x16x32_bf16 v[4:7], a[112:115], a[28:31], v[4:7]
    buffer_load_dwordx4 a[12:15], v192, s[4:7], s28 offen offset:3072 sc1
    v_mfma_f32_16x16x32_bf16 v[8:11], a[112:115], a[32:35], v[8:11]
    v_mfma_f32_16x16x32_bf16 v[12:15], a[112:115], a[36:39], v[12:15]
    v_mfma_f32_16x16x32_bf16 v[16:19], a[112:115], a[40:43], v[16:19]
    v_mfma_f32_16x16x32_bf16 v[20:23], a[112:115], a[44:47], v[20:23]
    s_waitcnt lgkmcnt(12)
    buffer_load_dwordx4 a[16:19], v193, s[4:7], s28 offen sc1
    v_mfma_f32_16x16x32_bf16 v[24:27], a[116:119], a[24:27], v[24:27]
    ds_read_b64_tr_b16 a[112:113], v200 offset:16384
    ds_read_b64_tr_b16 a[114:115], v200 offset:20480
    v_mfma_f32_16x16x32_bf16 v[28:31], a[116:119], a[28:31], v[28:31]
    v_mfma_f32_16x16x32_bf16 v[32:35], a[116:119], a[32:35], v[32:35]
    v_mfma_f32_16x16x32_bf16 v[36:39], a[116:119], a[36:39], v[36:39]
    buffer_load_dwordx4 a[20:23], v193, s[4:7], s28 offen offset:1024 sc1
    v_mfma_f32_16x16x32_bf16 v[40:43], a[116:119], a[40:43], v[40:43]
    s_add_u32 s28, s28, 73728
    v_mfma_f32_16x16x32_bf16 v[44:47], a[116:119], a[44:47], v[44:47]
    s_waitcnt lgkmcnt(12)
    ds_read_b64_tr_b16 a[116:117], v201 offset:16384
    ds_read_b64_tr_b16 a[118:119], v201 offset:20480
    v_mfma_f32_16x16x32_bf16 v[48:51], a[120:123], a[24:27], v[48:51]
    v_mfma_f32_16x16x32_bf16 v[52:55], a[120:123], a[28:31], v[52:55]
    v_mfma_f32_16x16x32_bf16 v[56:59], a[120:123], a[32:35], v[56:59]
    v_mfma_f32_16x16x32_bf16 v[60:63], a[120:123], a[36:39], v[60:63]
    v_mfma_f32_16x16x32_bf16 v[64:67], a[120:123], a[40:43], v[64:67]
    v_mfma_f32_16x16x32_bf16 v[68:71], a[120:123], a[44:47], v[68:71]
    s_waitcnt lgkmcnt(12)
    ds_read_b64_tr_b16 a[120:121], v202 offset:16384
    ds_read_b64_tr_b16 a[122:123], v202 offset:20480
    v_mfma_f32_16x16x32_bf16 v[72:75], a[124:127], a[24:27], v[72:75]
    v_mfma_f32_16x16x32_bf16 v[76:79], a[124:127], a[28:31], v[76:79]
    v_mfma_f32_16x16x32_bf16 v[80:83], a[124:127], a[32:35], v[80:83]
    v_mfma_f32_16x16x32_bf16 v[84:87], a[124:127], a[36:39], v[84:87]
    v_mfma_f32_16x16x32_bf16 v[88:91], a[124:127], a[40:43], v[88:91]
    s_waitcnt vmcnt(20)
    v_mfma_f32_16x16x32_bf16 v[92:95], a[124:127], a[44:47], v[92:95]
    s_waitcnt lgkmcnt(12)
    s_add_u32 m0, s30, 8192
    ds_read_b64_tr_b16 a[124:125], v203 offset:16384
    v_mfma_f32_16x16x32_bf16 v[96:99], a[96:99], a[48:51], v[96:99]
    ds_read_b64_tr_b16 a[126:127], v203 offset:20480
    v_mfma_f32_16x16x32_bf16 v[100:103], a[96:99], a[52:55], v[100:103]
    v_mfma_f32_16x16x32_bf16 v[104:107], a[96:99], a[56:59], v[104:107]
    v_mfma_f32_16x16x32_bf16 v[108:111], a[96:99], a[60:63], v[108:111]
    v_mfma_f32_16x16x32_bf16 v[112:115], a[96:99], a[64:67], v[112:115]
    s_waitcnt vmcnt(16)
    s_barrier
    v_mfma_f32_16x16x32_bf16 v[116:119], a[96:99], a[68:71], v[116:119]
    s_waitcnt lgkmcnt(12)
    buffer_load_dwordx4 v194, s[8:11], s29 offen lds
    v_mfma_f32_16x16x32_bf16 v[120:123], a[100:103], a[48:51], v[120:123]
    s_add_u32 m0, s30, 9216
    ds_read_b64_tr_b16 a[96:97], v196 offset:24576
    ds_read_b64_tr_b16 a[98:99], v196 offset:28672
    v_mfma_f32_16x16x32_bf16 v[124:127], a[100:103], a[52:55], v[124:127]
    buffer_load_dwordx4 v195, s[8:11], s29 offen lds
    v_mfma_f32_16x16x32_bf16 v[128:131], a[100:103], a[56:59], v[128:131]
    s_add_u32 m0, s30, 10240
    s_add_u32 s29, s29, 10240
    v_mfma_f32_16x16x32_bf16 v[132:135], a[100:103], a[60:63], v[132:135]
    buffer_load_dwordx4 v194, s[8:11], s29 offen lds
    v_mfma_f32_16x16x32_bf16 v[136:139], a[100:103], a[64:67], v[136:139]
    s_add_u32 m0, s30, 11264
    v_mfma_f32_16x16x32_bf16 v[140:143], a[100:103], a[68:71], v[140:143]
    s_waitcnt lgkmcnt(12)
    buffer_load_dwordx4 v195, s[8:11], s29 offen lds
    v_mfma_f32_16x16x32_bf16 v[144:147], a[104:107], a[48:51], v[144:147]
    s_add_u32 s29, s29, 153600
    ds_read_b64_tr_b16 a[100:101], v197 offset:24576
    ds_read_b64_tr_b16 a[102:103], v197 offset:28672
    v_mfma_f32_16x16x32_bf16 v[148:151], a[104:107], a[52:55], v[148:151]
    buffer_load_dwordx4 a[24:27], v192, s[4:7], s28 offen sc1
    v_mfma_f32_16x16x32_bf16 v[152:155], a[104:107], a[56:59], v[152:155]
    v_mfma_f32_16x16x32_bf16 v[156:159], a[104:107], a[60:63], v[156:159]
    v_mfma_f32_16x16x32_bf16 v[160:163], a[104:107], a[64:67], v[160:163]
    v_mfma_f32_16x16x32_bf16 v[164:167], a[104:107], a[68:71], v[164:167]
    s_waitcnt lgkmcnt(12)
    buffer_load_dwordx4 a[28:31], v192, s[4:7], s28 offen offset:1024 sc1
    v_mfma_f32_16x16x32_bf16 v[168:171], a[108:111], a[48:51], v[168:171]
    ds_read_b64_tr_b16 a[104:105], v198 offset:24576
    ds_read_b64_tr_b16 a[106:107], v198 offset:28672
    v_mfma_f32_16x16x32_bf16 v[172:175], a[108:111], a[52:55], v[172:175]
    v_mfma_f32_16x16x32_bf16 v[176:179], a[108:111], a[56:59], v[176:179]
    v_mfma_f32_16x16x32_bf16 v[180:183], a[108:111], a[60:63], v[180:183]
    buffer_load_dwordx4 a[32:35], v192, s[4:7], s28 offen offset:2048 sc1
    v_mfma_f32_16x16x32_bf16 v[184:187], a[108:111], a[64:67], v[184:187]
    v_mfma_f32_16x16x32_bf16 v[188:191], a[108:111], a[68:71], v[188:191]
    s_waitcnt lgkmcnt(12)
    ds_read_b64_tr_b16 a[108:109], v199 offset:24576
    ds_read_b64_tr_b16 a[110:111], v199 offset:28672
    v_mfma_f32_16x16x32_bf16 v[0:3], a[112:115], a[48:51], v[0:3]
    v_mfma_f32_16x16x32_bf16 v[4:7], a[112:115], a[52:55], v[4:7]
    buffer_load_dwordx4 a[36:39], v192, s[4:7], s28 offen offset:3072 sc1
    v_mfma_f32_16x16x32_bf16 v[8:11], a[112:115], a[56:59], v[8:11]
    v_mfma_f32_16x16x32_bf16 v[12:15], a[112:115], a[60:63], v[12:15]
    v_mfma_f32_16x16x32_bf16 v[16:19], a[112:115], a[64:67], v[16:19]
    v_mfma_f32_16x16x32_bf16 v[20:23], a[112:115], a[68:71], v[20:23]
    s_waitcnt lgkmcnt(12)
    buffer_load_dwordx4 a[40:43], v193, s[4:7], s28 offen sc1
    v_mfma_f32_16x16x32_bf16 v[24:27], a[116:119], a[48:51], v[24:27]
    ds_read_b64_tr_b16 a[112:113], v200 offset:24576
    ds_read_b64_tr_b16 a[114:115], v200 offset:28672
    v_mfma_f32_16x16x32_bf16 v[28:31], a[116:119], a[52:55], v[28:31]
    v_mfma_f32_16x16x32_bf16 v[32:35], a[116:119], a[56:59], v[32:35]
    v_mfma_f32_16x16x32_bf16 v[36:39], a[116:119], a[60:63], v[36:39]
    buffer_load_dwordx4 a[44:47], v193, s[4:7], s28 offen offset:1024 sc1
    v_mfma_f32_16x16x32_bf16 v[40:43], a[116:119], a[64:67], v[40:43]
    s_add_u32 s28, s28, 73728
    v_mfma_f32_16x16x32_bf16 v[44:47], a[116:119], a[68:71], v[44:47]
    s_waitcnt lgkmcnt(12)
    ds_read_b64_tr_b16 a[116:117], v201 offset:24576
    ds_read_b64_tr_b16 a[118:119], v201 offset:28672
    v_mfma_f32_16x16x32_bf16 v[48:51], a[120:123], a[48:51], v[48:51]
    v_mfma_f32_16x16x32_bf16 v[52:55], a[120:123], a[52:55], v[52:55]
    v_mfma_f32_16x16x32_bf16 v[56:59], a[120:123], a[56:59], v[56:59]
    v_mfma_f32_16x16x32_bf16 v[60:63], a[120:123], a[60:63], v[60:63]
    v_mfma_f32_16x16x32_bf16 v[64:67], a[120:123], a[64:67], v[64:67]
    v_mfma_f32_16x16x32_bf16 v[68:71], a[120:123], a[68:71], v[68:71]
    s_waitcnt lgkmcnt(12)
    ds_read_b64_tr_b16 a[120:121], v202 offset:24576
    ds_read_b64_tr_b16 a[122:123], v202 offset:28672
    v_mfma_f32_16x16x32_bf16 v[72:75], a[124:127], a[48:51], v[72:75]
    v_mfma_f32_16x16x32_bf16 v[76:79], a[124:127], a[52:55], v[76:79]
    v_mfma_f32_16x16x32_bf16 v[80:83], a[124:127], a[56:59], v[80:83]
    v_mfma_f32_16x16x32_bf16 v[84:87], a[124:127], a[60:63], v[84:87]
    v_mfma_f32_16x16x32_bf16 v[88:91], a[124:127], a[64:67], v[88:91]
    s_waitcnt vmcnt(20)
    v_mfma_f32_16x16x32_bf16 v[92:95], a[124:127], a[68:71], v[92:95]
    s_waitcnt lgkmcnt(12)
    s_add_u32 m0, s30, 16384
    ds_read_b64_tr_b16 a[124:125], v203 offset:24576
    v_mfma_f32_16x16x32_bf16 v[96:99], a[96:99], a[72:75], v[96:99]
    ds_read_b64_tr_b16 a[126:127], v203 offset:28672
    v_mfma_f32_16x16x32_bf16 v[100:103], a[96:99], a[76:79], v[100:103]
    v_mfma_f32_16x16x32_bf16 v[104:107], a[96:99], a[80:83], v[104:107]
    v_mfma_f32_16x16x32_bf16 v[108:111], a[96:99], a[84:87], v[108:111]
    v_mfma_f32_16x16x32_bf16 v[112:115], a[96:99], a[88:91], v[112:115]
    s_waitcnt vmcnt(16)
    s_barrier
    v_mfma_f32_16x16x32_bf16 v[116:119], a[96:99], a[92:95], v[116:119]
    s_waitcnt lgkmcnt(12)
    buffer_load_dwordx4 v194, s[8:11], s29 offen lds
    v_mfma_f32_16x16x32_bf16 v[120:123], a[100:103], a[72:75], v[120:123]
    s_add_u32 m0, s30, 17408
    ds_read_b64_tr_b16 a[96:97], v196 offset:0
    ds_read_b64_tr_b16 a[98:99], v196 offset:4096
    v_mfma_f32_16x16x32_bf16 v[124:127], a[100:103], a[76:79], v[124:127]
    buffer_load_dwordx4 v195, s[8:11], s29 offen lds
    v_mfma_f32_16x16x32_bf16 v[128:131], a[100:103], a[80:83], v[128:131]
    s_add_u32 m0, s30, 18432
    s_add_u32 s29, s29, 10240
    v_mfma_f32_16x16x32_bf16 v[132:135], a[100:103], a[84:87], v[132:135]
    buffer_load_dwordx4 v194, s[8:11], s29 offen lds
    v_mfma_f32_16x16x32_bf16 v[136:139], a[100:103], a[88:91], v[136:139]
    s_add_u32 m0, s30, 19456
    v_mfma_f32_16x16x32_bf16 v[140:143], a[100:103], a[92:95], v[140:143]
    s_waitcnt lgkmcnt(12)
    buffer_load_dwordx4 v195, s[8:11], s29 offen lds
    v_mfma_f32_16x16x32_bf16 v[144:147], a[104:107], a[72:75], v[144:147]
    s_add_u32 s29, s29, 153600
    ds_read_b64_tr_b16 a[100:101], v197 offset:0
    ds_read_b64_tr_b16 a[102:103], v197 offset:4096
    v_mfma_f32_16x16x32_bf16 v[148:151], a[104:107], a[76:79], v[148:151]
    buffer_load_dwordx4 a[48:51], v192, s[4:7], s28 offen sc1
    v_mfma_f32_16x16x32_bf16 v[152:155], a[104:107], a[80:83], v[152:155]
    v_mfma_f32_16x16x32_bf16 v[156:159], a[104:107], a[84:87], v[156:159]
    v_mfma_f32_16x16x32_bf16 v[160:163], a[104:107], a[88:91], v[160:163]
    v_mfma_f32_16x16x32_bf16 v[164:167], a[104:107], a[92:95], v[164:167]
    s_waitcnt lgkmcnt(12)
    buffer_load_dwordx4 a[52:55], v192, s[4:7], s28 offen offset:1024 sc1
    v_mfma_f32_16x16x32_bf16 v[168:171], a[108:111], a[72:75], v[168:171]
    ds_read_b64_tr_b16 a[104:105], v198 offset:0
    ds_read_b64_tr_b16 a[106:107], v198 offset:4096
    v_mfma_f32_16x16x32_bf16 v[172:175], a[108:111], a[76:79], v[172:175]
    v_mfma_f32_16x16x32_bf16 v[176:179], a[108:111], a[80:83], v[176:179]
    v_mfma_f32_16x16x32_bf16 v[180:183], a[108:111], a[84:87], v[180:183]
    buffer_load_dwordx4 a[56:59], v192, s[4:7], s28 offen offset:2048 sc1
    v_mfma_f32_16x16x32_bf16 v[184:187], a[108:111], a[88:91], v[184:187]
    v_mfma_f32_16x16x32_bf16 v[188:191], a[108:111], a[92:95], v[188:191]
    s_waitcnt lgkmcnt(12)
    ds_read_b64_tr_b16 a[108:109], v199 offset:0
    ds_read_b64_tr_b16 a[110:111], v199 offset:4096
    v_mfma_f32_16x16x32_bf16 v[0:3], a[112:115], a[72:75], v[0:3]
    v_mfma_f32_16x16x32_bf16 v[4:7], a[112:115], a[76:79], v[4:7]
    buffer_load_dwordx4 a[60:63], v192, s[4:7], s28 offen offset:3072 sc1
    v_mfma_f32_16x16x32_bf16 v[8:11], a[112:115], a[80:83], v[8:11]
    v_mfma_f32_16x16x32_bf16 v[12:15], a[112:115], a[84:87], v[12:15]
    v_mfma_f32_16x16x32_bf16 v[16:19], a[112:115], a[88:91], v[16:19]
    v_mfma_f32_16x16x32_bf16 v[20:23], a[112:115], a[92:95], v[20:23]
    s_waitcnt lgkmcnt(12)
    buffer_load_dwordx4 a[64:67], v193, s[4:7], s28 offen sc1
    v_mfma_f32_16x16x32_bf16 v[24:27], a[116:119], a[72:75], v[24:27]
    ds_read_b64_tr_b16 a[112:113], v200 offset:0
    ds_read_b64_tr_b16 a[114:115], v200 offset:4096
    v_mfma_f32_16x16x32_bf16 v[28:31], a[116:119], a[76:79], v[28:31]
    v_mfma_f32_16x16x32_bf16 v[32:35], a[116:119], a[80:83], v[32:35]
    v_mfma_f32_16x16x32_bf16 v[36:39], a[116:119], a[84:87], v[36:39]
    buffer_load_dwordx4 a[68:71], v193, s[4:7], s28 offen offset:1024 sc1
    v_mfma_f32_16x16x32_bf16 v[40:43], a[116:119], a[88:91], v[40:43]
    s_add_u32 s28, s28, 73728
    v_mfma_f32_16x16x32_bf16 v[44:47], a[116:119], a[92:95], v[44:47]
    s_waitcnt lgkmcnt(12)
    ds_read_b64_tr_b16 a[116:117], v201 offset:0
    ds_read_b64_tr_b16 a[118:119], v201 offset:4096
    v_mfma_f32_16x16x32_bf16 v[48:51], a[120:123], a[72:75], v[48:51]
    v_mfma_f32_16x16x32_bf16 v[52:55], a[120:123], a[76:79], v[52:55]
    v_mfma_f32_16x16x32_bf16 v[56:59], a[120:123], a[80:83], v[56:59]
    v_mfma_f32_16x16x32_bf16 v[60:63], a[120:123], a[84:87], v[60:63]
    v_mfma_f32_16x16x32_bf16 v[64:67], a[120:123], a[88:91], v[64:67]
    v_mfma_f32_16x16x32_bf16 v[68:71], a[120:123], a[92:95], v[68:71]
    s_waitcnt lgkmcnt(12)
    ds_read_b64_tr_b16 a[120:121], v202 offset:0
    ds_read_b64_tr_b16 a[122:123], v202 offset:4096
    v_mfma_f32_16x16x32_bf16 v[72:75], a[124:127], a[72:75], v[72:75]
    v_mfma_f32_16x16x32_bf16 v[76:79], a[124:127], a[76:79], v[76:79]
    v_mfma_f32_16x16x32_bf16 v[80:83], a[124:127], a[80:83], v[80:83]
    v_mfma_f32_16x16x32_bf16 v[84:87], a[124:127], a[84:87], v[84:87]
    v_mfma_f32_16x16x32_bf16 v[88:91], a[124:127], a[88:91], v[88:91]
    s_waitcnt vmcnt(20)
    v_mfma_f32_16x16x32_bf16 v[92:95], a[124:127], a[92:95], v[92:95]
    s_waitcnt lgkmcnt(12)
    s_add_u32 m0, s30, 24576
    ds_read_b64_tr_b16 a[124:125], v203 offset:0
    s_sub_u32 s43, s43, 1
    s_cbranch_scc0 O_loop
    v_mfma_f32_16x16x32_bf16 v[96:99], a[96:99], a[0:3], v[96:99]
    ds_read_b64_tr_b16 a[126:127], v203 offset:4096
    v_mfma_f32_16x16x32_bf16 v[100:103], a[96:99], a[4:7], v[100:103]
    v_mfma_f32_16x16x32_bf16 v[104:107], a[96:99], a[8:11], v[104:107]
    v_mfma_f32_16x16x32_bf16 v[108:111], a[96:99], a[12:15], v[108:111]
    v_mfma_f32_16x16x32_bf16 v[112:115], a[96:99], a[16:19], v[112:115]
    s_waitcnt vmcnt(16)
    s_barrier
    v_mfma_f32_16x16x32_bf16 v[116:119], a[96:99], a[20:23], v[116:119]
    s_waitcnt lgkmcnt(12)
    buffer_load_dwordx4 v194, s[8:11], s29 offen lds
    v_mfma_f32_16x16x32_bf16 v[120:123], a[100:103], a[0:3], v[120:123]
    s_add_u32 m0, s30, 25600
    ds_read_b64_tr_b16 a[96:97], v196 offset:8192
    ds_read_b64_tr_b16 a[98:99], v196 offset:12288
    v_mfma_f32_16x16x32_bf16 v[124:127], a[100:103], a[4:7], v[124:127]
    buffer_load_dwordx4 v195, s[8:11], s29 offen lds
    v_mfma_f32_16x16x32_bf16 v[128:131], a[100:103], a[8:11], v[128:131]
    s_add_u32 m0, s30, 26624
    s_add_u32 s29, s29, 10240
    v_mfma_f32_16x16x32_bf16 v[132:135], a[100:103], a[12:15], v[132:135]
    buffer_load_dwordx4 v194, s[8:11], s29 offen lds
    v_mfma_f32_16x16x32_bf16 v[136:139], a[100:103], a[16:19], v[136:139]
    s_add_u32 m0, s30, 27648
    v_mfma_f32_16x16x32_bf16 v[140:143], a[100:103], a[20:23], v[140:143]
    s_waitcnt lgkmcnt(12)
    buffer_load_dwordx4 v195, s[8:11], s29 offen lds
    v_mfma_f32_16x16x32_bf16 v[144:147], a[104:107], a[0:3], v[144:147]
    s_add_u32 s29, s29, 153600
    ds_read_b64_tr_b16 a[100:101], v197 offset:8192
    ds_read_b64_tr_b16 a[102:103], v197 offset:12288
    v_mfma_f32_16x16x32_bf16 v[148:151], a[104:107], a[4:7], v[148:151]
    buffer_load_dwordx4 a[72:75], v192, s[4:7], s28 offen sc1
    v_mfma_f32_16x16x32_bf16 v[152:155], a[104:107], a[8:11], v[152:155]
    v_mfma_f32_16x16x32_bf16 v[156:159], a[104:107], a[12:15], v[156:159]
    v_mfma_f32_16x16x32_bf16 v[160:163], a[104:107], a[16:19], v[160:163]
    v_mfma_f32_16x16x32_bf16 v[164:167], a[104:107], a[20:23], v[164:167]
    s_waitcnt lgkmcnt(12)
    buffer_load_dwordx4 a[76:79], v192, s[4:7], s28 offen offset:1024 sc1
    v_mfma_f32_16x16x32_bf16 v[168:171], a[108:111], a[0:3], v[168:171]
    ds_read_b64_tr_b16 a[104:105], v198 offset:8192
    ds_read_b64_tr_b16 a[106:107], v198 offset:12288
    v_mfma_f32_16x16x32_bf16 v[172:175], a[108:111], a[4:7], v[172:175]
    v_mfma_f32_16x16x32_bf16 v[176:179], a[108:111], a[8:11], v[176:179]
    v_mfma_f32_16x16x32_bf16 v[180:183], a[108:111], a[12:15], v[180:183]
    buffer_load_dwordx4 a[80:83], v192, s[4:7], s28 offen offset:2048 sc1
    v_mfma_f32_16x16x32_bf16 v[184:187], a[108:111], a[16:19], v[184:187]
    v_mfma_f32_16x16x32_bf16 v[188:191], a[108:111], a[20:23], v[188:191]
    s_waitcnt lgkmcnt(12)
    ds_read_b64_tr_b16 a[108:109], v199 offset:8192
    ds_read_b64_tr_b16 a[110:111], v199 offset:12288
    v_mfma_f32_16x16x32_bf16 v[0:3], a[112:115], a[0:3], v[0:3]
    v_mfma_f32_16x16x32_bf16 v[4:7], a[112:115], a[4:7], v[4:7]
    buffer_load_dwordx4 a[84:87], v192, s[4:7], s28 offen offset:3072 sc1
    v_mfma_f32_16x16x32_bf16 v[8:11], a[112:115], a[8:11], v[8:11]
    v_mfma_f32_16x16x32_bf16 v[12:15], a[112:115], a[12:15], v[12:15]
    v_mfma_f32_16x16x32_bf16 v[16:19], a[112:115], a[16:19], v[16:19]
    v_mfma_f32_16x16x32_bf16 v[20:23], a[112:115], a[20:23], v[20:23]
    s_waitcnt lgkmcnt(12)
    buffer_load_dwordx4 a[88:91], v193, s[4:7], s28 offen sc1
    v_mfma_f32_16x16x32_bf16 v[24:27], a[116:119], a[0:3], v[24:27]
    ds_read_b64_tr_b16 a[112:113], v200 offset:8192
    ds_read_b64_tr_b16 a[114:115], v200 offset:12288
    v_mfma_f32_16x16x32_bf16 v[28:31], a[116:119], a[4:7], v[28:31]
    v_mfma_f32_16x16x32_bf16 v[32:35], a[116:119], a[8:11], v[32:35]
    v_mfma_f32_16x16x32_bf16 v[36:39], a[116:119], a[12:15], v[36:39]
    buffer_load_dwordx4 a[92:95], v193, s[4:7], s28 offen offset:1024 sc1
    v_mfma_f32_16x16x32_bf16 v[40:43], a[116:119], a[16:19], v[40:43]
    s_add_u32 s28, s28, 73728
    v_mfma_f32_16x16x32_bf16 v[44:47], a[116:119], a[20:23], v[44:47]
    s_waitcnt lgkmcnt(12)
    ds_read_b64_tr_b16 a[116:117], v201 offset:8192
    ds_read_b64_tr_b16 a[118:119], v201 offset:12288
    v_mfma_f32_16x16x32_bf16 v[48:51], a[120:123], a[0:3], v[48:51]
    v_mfma_f32_16x16x32_bf16 v[52:55], a[120:123], a[4:7], v[52:55]
    v_mfma_f32_16x16x32_bf16 v[56:59], a[120:123], a[8:11], v[56:59]
    v_mfma_f32_16x16x32_bf16 v[60:63], a[120:123], a[12:15], v[60:63]
    v_mfma_f32_16x16x32_bf16 v[64:67], a[120:123], a[16:19], v[64:67]
    v_mfma_f32_16x16x32_bf16 v[68:71], a[120:123], a[20:23], v[68:71]
    s_waitcnt lgkmcnt(12)
    ds_read_b64_tr_b16 a[120:121], v202 offset:8192
    ds_read_b64_tr_b16 a[122:123], v202 offset:12288
    v_mfma_f32_16x16x32_bf16 v[72:75], a[124:127], a[0:3], v[72:75]
    v_mfma_f32_16x16x32_bf16 v[76:79], a[124:127], a[4:7], v[76:79]
    v_mfma_f32_16x16x32_bf16 v[80:83], a[124:127], a[8:11], v[80:83]
    v_mfma_f32_16x16x32_bf16 v[84:87], a[124:127], a[12:15], v[84:87]
    v_mfma_f32_16x16x32_bf16 v[88:91], a[124:127], a[16:19], v[88:91]
    s_waitcnt vmcnt(20)
    v_mfma_f32_16x16x32_bf16 v[92:95], a[124:127], a[20:23], v[92:95]
    s_waitcnt lgkmcnt(12)
    ds_read_b64_tr_b16 a[124:125], v203 offset:8192
    ds_read_b64_tr_b16 a[126:127], v203 offset:12288
    v_mfma_f32_16x16x32_bf16 v[96:99], a[96:99], a[24:27], v[96:99]
    v_mfma_f32_16x16x32_bf16 v[100:103], a[96:99], a[28:31], v[100:103]
    v_mfma_f32_16x16x32_bf16 v[104:107], a[96:99], a[32:35], v[104:107]
    v_mfma_f32_16x16x32_bf16 v[108:111], a[96:99], a[36:39], v[108:111]
    v_mfma_f32_16x16x32_bf16 v[112:115], a[96:99], a[40:43], v[112:115]
    s_waitcnt vmcnt(16)
    s_barrier
    v_mfma_f32_16x16x32_bf16 v[116:119], a[96:99], a[44:47], v[116:119]
    s_waitcnt lgkmcnt(12)
    ds_read_b64_tr_b16 a[96:97], v196 offset:16384
    ds_read_b64_tr_b16 a[98:99], v196 offset:20480
    v_mfma_f32_16x16x32_bf16 v[120:123], a[100:103], a[24:27], v[120:123]
    v_mfma_f32_16x16x32_bf16 v[124:127], a[100:103], a[28:31], v[124:127]
    v_mfma_f32_16x16x32_bf16 v[128:131], a[100:103], a[32:35], v[128:131]
    v_mfma_f32_16x16x32_bf16 v[132:135], a[100:103], a[36:39], v[132:135]
    v_mfma_f32_16x16x32_bf16 v[136:139], a[100:103], a[40:43], v[136:139]
    v_mfma_f32_16x16x32_bf16 v[140:143], a[100:103], a[44:47], v[140:143]
    s_waitcnt lgkmcnt(12)
    ds_read_b64_tr_b16 a[100:101], v197 offset:16384
    ds_read_b64_tr_b16 a[102:103], v197 offset:20480
    v_mfma_f32_16x16x32_bf16 v[144:147], a[104:107], a[24:27], v[144:147]
    v_mfma_f32_16x16x32_bf16 v[148:151], a[104:107], a[28:31], v[148:151]
    v_mfma_f32_16x16x32_bf16 v[152:155], a[104:107], a[32:35], v[152:155]
    v_mfma_f32_16x16x32_bf16 v[156:159], a[104:107], a[36:39], v[156:159]
    v_mfma_f32_16x16x32_bf16 v[160:163], a[104:107], a[40:43], v[160:163]
    v_mfma_f32_16x16x32_bf16 v[164:167], a[104:107], a[44:47], v[164:167]
    s_waitcnt lgkmcnt(12)
    ds_read_b64_tr_b16 a[104:105], v198 offset:16384
    ds_read_b64_tr_b16 a[106:107], v198 offset:20480
    v_mfma_f32_16x16x32_bf16 v[168:171], a[108:111], a[24:27], v[168:171]
    v_mfma_f32_16x16x32_bf16 v[172:175], a[108:111], a[28:31], v[172:175]
    v_mfma_f32_16x16x32_bf16 v[176:179], a[108:111], a[32:35], v[176:179]
    v_mfma_f32_16x16x32_bf16 v[180:183], a[108:111], a[36:39], v[180:183]
    v_mfma_f32_16x16x32_bf16 v[184:187], a[108:111], a[40:43], v[184:187]
    v_mfma_f32_16x16x32_bf16 v[188:191], a[108:111], a[44:47], v[188:191]
    s_waitcnt lgkmcnt(12)
    ds_read_b64_tr_b16 a[108:109], v199 offset:16384
    ds_read_b64_tr_b16 a[110:111], v199 offset:20480
    v_mfma_f32_16x16x32_bf16 v[0:3], a[112:115], a[24:27], v[0:3]
    v_mfma_f32_16x16x32_bf16 v[4:7], a[112:115], a[28:31], v[4:7]
    v_mfma_f32_16x16x32_bf16 v[8:11], a[112:115], a[32:35], v[8:11]
    v_mfma_f32_16x16x32_bf16 v[12:15], a[112:115], a[36:39], v[12:15]
    v_mfma_f32_16x16x32_bf16 v[16:19], a[112:115], a[40:43], v[16:19]
    v_mfma_f32_16x16x32_bf16 v[20:23], a[112:115], a[44:47], v[20:23]
    s_waitcnt lgkmcnt(12)
    ds_read_b64_tr_b16 a[112:113], v200 offset:16384
    ds_read_b64_tr_b16 a[114:115], v200 offset:20480
    v_mfma_f32_16x16x32_bf16 v[24:27], a[116:119], a[24:27], v[24:27]
    v_mfma_f32_16x16x32_bf16 v[28:31], a[116:119], a[28:31], v[28:31]
    v_mfma_f32_16x16x32_bf16 v[32:35], a[116:119], a[32:35], v[32:35]
    v_mfma_f32_16x16x32_bf16 v[36:39], a[116:119], a[36:39], v[36:39]
    v_mfma_f32_16x16x32_bf16 v[40:43], a[116:119], a[40:43], v[40:43]
    v_mfma_f32_16x16x32_bf16 v[44:47], a[116:119], a[44:47], v[44:47]
    s_waitcnt lgkmcnt(12)
    ds_read_b64_tr_b16 a[116:117], v201 offset:16384
    ds_read_b64_tr_b16 a[118:119], v201 offset:20480
    v_mfma_f32_16x16x32_bf16 v[48:51], a[120:123], a[24:27], v[48:51]
    v_mfma_f32_16x16x32_bf16 v[52:55], a[120:123], a[28:31], v[52:55]
    v_mfma_f32_16x16x32_bf16 v[56:59], a[120:123], a[32:35], v[56:59]
    v_mfma_f32_16x16x32_bf16 v[60:63], a[120:123], a[36:39], v[60:63]
    v_mfma_f32_16x16x32_bf16 v[64:67], a[120:123], a[40:43], v[64:67]
    v_mfma_f32_16x16x32_bf16 v[68:71], a[120:123], a[44:47], v[68:71]
    s_waitcnt lgkmcnt(12)
    ds_read_b64_tr_b16 a[120:121], v202 offset:16384
    ds_read_b64_tr_b16 a[122:123], v202 offset:20480
    v_mfma_f32_16x16x32_bf16 v[72:75], a[124:127], a[24:27], v[72:75]
    v_mfma_f32_16x16x32_bf16 v[76:79], a[124:127], a[28:31], v[76:79]
    s_add_u32 s16, s66, 62914560
    s_addc_u32 s17, s67, 0
    v_mfma_f32_16x16x32_bf16 v[80:83], a[124:127], a[32:35], v[80:83]
    s_mov_b32 s18, 12713984
    v_mfma_f32_16x16x32_bf16 v[84:87], a[124:127], a[36:39], v[84:87]
    v_mfma_f32_16x16x32_bf16 v[88:91], a[124:127], a[40:43], v[88:91]
    s_waitcnt vmcnt(10)
    v_mfma_f32_16x16x32_bf16 v[92:95], a[124:127], a[44:47], v[92:95]
    s_waitcnt lgkmcnt(12)
    ds_read_b64_tr_b16 a[124:125], v203 offset:16384
    ds_read_b64_tr_b16 a[126:127], v203 offset:20480
    v_mfma_f32_16x16x32_bf16 v[96:99], a[96:99], a[48:51], v[96:99]
    v_mfma_f32_16x16x32_bf16 v[100:103], a[96:99], a[52:55], v[100:103]
    v_mfma_f32_16x16x32_bf16 v[104:107], a[96:99], a[56:59], v[104:107]
    v_mfma_f32_16x16x32_bf16 v[108:111], a[96:99], a[60:63], v[108:111]
    v_mfma_f32_16x16x32_bf16 v[112:115], a[96:99], a[64:67], v[112:115]
    s_waitcnt vmcnt(6)
    s_barrier
    v_mfma_f32_16x16x32_bf16 v[116:119], a[96:99], a[68:71], v[116:119]
    s_waitcnt lgkmcnt(12)
    ds_read_b64_tr_b16 a[96:97], v196 offset:24576
    ds_read_b64_tr_b16 a[98:99], v196 offset:28672
    v_mfma_f32_16x16x32_bf16 v[120:123], a[100:103], a[48:51], v[120:123]
    v_mfma_f32_16x16x32_bf16 v[124:127], a[100:103], a[52:55], v[124:127]
    v_mfma_f32_16x16x32_bf16 v[128:131], a[100:103], a[56:59], v[128:131]
    v_mfma_f32_16x16x32_bf16 v[132:135], a[100:103], a[60:63], v[132:135]
    v_mfma_f32_16x16x32_bf16 v[136:139], a[100:103], a[64:67], v[136:139]
    v_mfma_f32_16x16x32_bf16 v[140:143], a[100:103], a[68:71], v[140:143]
    s_waitcnt lgkmcnt(12)
    ds_read_b64_tr_b16 a[100:101], v197 offset:24576
    ds_read_b64_tr_b16 a[102:103], v197 offset:28672
    v_mfma_f32_16x16x32_bf16 v[144:147], a[104:107], a[48:51], v[144:147]
    v_mfma_f32_16x16x32_bf16 v[148:151], a[104:107], a[52:55], v[148:151]
    v_mfma_f32_16x16x32_bf16 v[152:155], a[104:107], a[56:59], v[152:155]
    v_mfma_f32_16x16x32_bf16 v[156:159], a[104:107], a[60:63], v[156:159]
    v_mfma_f32_16x16x32_bf16 v[160:163], a[104:107], a[64:67], v[160:163]
    v_mfma_f32_16x16x32_bf16 v[164:167], a[104:107], a[68:71], v[164:167]
    s_waitcnt lgkmcnt(12)
    ds_read_b64_tr_b16 a[104:105], v198 offset:24576
    ds_read_b64_tr_b16 a[106:107], v198 offset:28672
    v_mfma_f32_16x16x32_bf16 v[168:171], a[108:111], a[48:51], v[168:171]
    v_mfma_f32_16x16x32_bf16 v[172:175], a[108:111], a[52:55], v[172:175]
    v_mfma_f32_16x16x32_bf16 v[176:179], a[108:111], a[56:59], v[176:179]
    v_mfma_f32_16x16x32_bf16 v[180:183], a[108:111], a[60:63], v[180:183]
    v_mfma_f32_16x16x32_bf16 v[184:187], a[108:111], a[64:67], v[184:187]
    v_mfma_f32_16x16x32_bf16 v[188:191], a[108:111], a[68:71], v[188:191]
    s_waitcnt lgkmcnt(12)
    ds_read_b64_tr_b16 a[108:109], v199 offset:24576
    ds_read_b64_tr_b16 a[110:111], v199 offset:28672
    v_mfma_f32_16x16x32_bf16 v[0:3], a[112:115], a[48:51], v[0:3]
    v_mfma_f32_16x16x32_bf16 v[4:7], a[112:115], a[52:55], v[4:7]
    v_mfma_f32_16x16x32_bf16 v[8:11], a[112:115], a[56:59], v[8:11]
    v_mfma_f32_16x16x32_bf16 v[12:15], a[112:115], a[60:63], v[12:15]
    v_mfma_f32_16x16x32_bf16 v[16:19], a[112:115], a[64:67], v[16:19]
    v_mfma_f32_16x16x32_bf16 v[20:23], a[112:115], a[68:71], v[20:23]
    s_waitcnt lgkmcnt(12)
    ds_read_b64_tr_b16 a[112:113], v200 offset:24576
    ds_read_b64_tr_b16 a[114:115], v200 offset:28672
    v_mfma_f32_16x16x32_bf16 v[24:27], a[116:119], a[48:51], v[24:27]
    v_mfma_f32_16x16x32_bf16 v[28:31], a[116:119], a[52:55], v[28:31]
    v_mfma_f32_16x16x32_bf16 v[32:35], a[116:119], a[56:59], v[32:35]
    v_mfma_f32_16x16x32_bf16 v[36:39], a[116:119], a[60:63], v[36:39]
    v_mfma_f32_16x16x32_bf16 v[40:43], a[116:119], a[64:67], v[40:43]
    v_mfma_f32_16x16x32_bf16 v[44:47], a[116:119], a[68:71], v[44:47]
    s_waitcnt lgkmcnt(12)
    ds_read_b64_tr_b16 a[116:117], v201 offset:24576
    ds_read_b64_tr_b16 a[118:119], v201 offset:28672
    v_mfma_f32_16x16x32_bf16 v[48:51], a[120:123], a[48:51], v[48:51]
    v_mfma_f32_16x16x32_bf16 v[52:55], a[120:123], a[52:55], v[52:55]
    v_mfma_f32_16x16x32_bf16 v[56:59], a[120:123], a[56:59], v[56:59]
    v_mfma_f32_16x16x32_bf16 v[60:63], a[120:123], a[60:63], v[60:63]
    v_mfma_f32_16x16x32_bf16 v[64:67], a[120:123], a[64:67], v[64:67]
    v_mfma_f32_16x16x32_bf16 v[68:71], a[120:123], a[68:71], v[68:71]
    s_waitcnt lgkmcnt(12)
    ds_read_b64_tr_b16 a[120:121], v202 offset:24576
    ds_read_b64_tr_b16 a[122:123], v202 offset:28672
    v_mfma_f32_16x16x32_bf16 v[72:75], a[124:127], a[48:51], v[72:75]
    v_mfma_f32_16x16x32_bf16 v[76:79], a[124:127], a[52:55], v[76:79]
    v_mfma_f32_16x16x32_bf16 v[80:83], a[124:127], a[56:59], v[80:83]
    v_mfma_f32_16x16x32_bf16 v[84:87], a[124:127], a[60:63], v[84:87]
    v_mfma_f32_16x16x32_bf16 v[88:91], a[124:127], a[64:67], v[88:91]
    s_waitcnt vmcnt(0)
    v_mfma_f32_16x16x32_bf16 v[92:95], a[124:127], a[68:71], v[92:95]
    s_waitcnt lgkmcnt(12)
    ds_read_b64_tr_b16 a[124:125], v203 offset:24576
    ds_read_b64_tr_b16 a[126:127], v203 offset:28672
    v_mfma_f32_16x16x32_bf16 v[96:99], a[96:99], a[72:75], v[96:99]
    v_mfma_f32_16x16x32_bf16 v[100:103], a[96:99], a[76:79], v[100:103]
    v_mfma_f32_16x16x32_bf16 v[104:107], a[96:99], a[80:83], v[104:107]
    v_mfma_f32_16x16x32_bf16 v[108:111], a[96:99], a[84:87], v[108:111]
    ds_write_b128 v204, v[96:99] offset:0
    v_mfma_f32_16x16x32_bf16 v[112:115], a[96:99], a[88:91], v[112:115]
    ds_write_b128 v204, v[100:103] offset:1024
    v_mfma_f32_16x16x32_bf16 v[116:119], a[96:99], a[92:95], v[116:119]
    s_waitcnt lgkmcnt(14)
    ds_write_b128 v204, v[104:107] offset:2048
    v_mfma_f32_16x16x32_bf16 v[120:123], a[100:103], a[72:75], v[120:123]
    ds_write_b128 v204, v[108:111] offset:3072
    v_mfma_f32_16x16x32_bf16 v[124:127], a[100:103], a[76:79], v[124:127]
    ds_write_b128 v204, v[112:115] offset:4096
    v_mfma_f32_16x16x32_bf16 v[128:131], a[100:103], a[80:83], v[128:131]
    ds_write_b128 v204, v[116:119] offset:5120
    v_mfma_f32_16x16x32_bf16 v[132:135], a[100:103], a[84:87], v[132:135]
    ds_write_b128 v204, v[120:123] offset:6144
    v_mfma_f32_16x16x32_bf16 v[136:139], a[100:103], a[88:91], v[136:139]
    ds_write_b128 v204, v[124:127] offset:7168
    v_mfma_f32_16x16x32_bf16 v[140:143], a[100:103], a[92:95], v[140:143]
    s_waitcnt lgkmcnt(15)
    ds_write_b128 v204, v[128:131] offset:8192
    v_mfma_f32_16x16x32_bf16 v[144:147], a[104:107], a[72:75], v[144:147]
    ds_write_b128 v204, v[132:135] offset:9216
    v_mfma_f32_16x16x32_bf16 v[148:151], a[104:107], a[76:79], v[148:151]
    ds_write_b128 v204, v[136:139] offset:10240
    v_mfma_f32_16x16x32_bf16 v[152:155], a[104:107], a[80:83], v[152:155]
    ds_write_b128 v204, v[140:143] offset:11264
    v_mfma_f32_16x16x32_bf16 v[156:159], a[104:107], a[84:87], v[156:159]
    ds_write_b128 v204, v[144:147] offset:12288
    v_mfma_f32_16x16x32_bf16 v[160:163], a[104:107], a[88:91], v[160:163]
    ds_write_b128 v204, v[148:151] offset:13312
    v_mfma_f32_16x16x32_bf16 v[164:167], a[104:107], a[92:95], v[164:167]
    ds_write_b128 v204, v[152:155] offset:14336
    v_mfma_f32_16x16x32_bf16 v[168:171], a[108:111], a[72:75], v[168:171]
    ds_write_b128 v204, v[156:159] offset:15360
    v_mfma_f32_16x16x32_bf16 v[172:175], a[108:111], a[76:79], v[172:175]
    ds_write_b128 v204, v[160:163] offset:16384
    v_mfma_f32_16x16x32_bf16 v[176:179], a[108:111], a[80:83], v[176:179]
    ds_write_b128 v204, v[164:167] offset:17408
    v_mfma_f32_16x16x32_bf16 v[180:183], a[108:111], a[84:87], v[180:183]
    ds_write_b128 v204, v[168:171] offset:18432
    v_mfma_f32_16x16x32_bf16 v[184:187], a[108:111], a[88:91], v[184:187]
    ds_write_b128 v204, v[172:175] offset:19456
    v_mfma_f32_16x16x32_bf16 v[188:191], a[108:111], a[92:95], v[188:191]
    s_waitcnt lgkmcnt(15)
    ds_write_b128 v204, v[176:179] offset:20480
    v_mfma_f32_16x16x32_bf16 v[0:3], a[112:115], a[72:75], v[0:3]
    ds_write_b128 v204, v[180:183] offset:21504
    v_mfma_f32_16x16x32_bf16 v[4:7], a[112:115], a[76:79], v[4:7]
    ds_write_b128 v204, v[184:187] offset:22528
    v_mfma_f32_16x16x32_bf16 v[8:11], a[112:115], a[80:83], v[8:11]
    ds_write_b128 v204, v[188:191] offset:23552
    v_mfma_f32_16x16x32_bf16 v[12:15], a[112:115], a[84:87], v[12:15]
    s_waitcnt lgkmcnt(0)
    s_barrier
    ds_read_b128 v[144:147], v207 offset:12288
    v_mfma_f32_16x16x32_bf16 v[16:19], a[112:115], a[88:91], v[16:19]
    ds_read_b128 v[148:151], v207 offset:13312
    ds_read_b128 v[152:155], v207 offset:14336
    v_mfma_f32_16x16x32_bf16 v[20:23], a[112:115], a[92:95], v[20:23]
    ds_read_b128 v[156:159], v207 offset:15360
    ds_read_b128 v[160:163], v207 offset:16384
    v_mfma_f32_16x16x32_bf16 v[24:27], a[116:119], a[72:75], v[24:27]
    ds_read_b128 v[164:167], v207 offset:17408
    ds_read_b128 v[168:171], v207 offset:18432
    v_mfma_f32_16x16x32_bf16 v[28:31], a[116:119], a[76:79], v[28:31]
    ds_read_b128 v[172:175], v207 offset:19456
    ds_read_b128 v[176:179], v207 offset:20480
    v_mfma_f32_16x16x32_bf16 v[32:35], a[116:119], a[80:83], v[32:35]
    ds_read_b128 v[180:183], v207 offset:21504
    ds_read_b128 v[184:187], v207 offset:22528
    v_mfma_f32_16x16x32_bf16 v[36:39], a[116:119], a[84:87], v[36:39]
    ds_read_b128 v[188:191], v207 offset:23552
    ds_read_b128 v[96:99], v207 offset:0
    v_mfma_f32_16x16x32_bf16 v[40:43], a[116:119], a[88:91], v[40:43]
    ds_read_b128 v[100:103], v207 offset:1024
    ds_read_b128 v[104:107], v207 offset:2048
    v_mfma_f32_16x16x32_bf16 v[44:47], a[116:119], a[92:95], v[44:47]
    ds_read_b128 v[108:111], v207 offset:3072
    ds_read_b128 v[112:115], v207 offset:4096
    v_mfma_f32_16x16x32_bf16 v[48:51], a[120:123], a[72:75], v[48:51]
    ds_read_b128 v[116:119], v207 offset:5120
    ds_read_b128 v[120:123], v207 offset:6144
    v_mfma_f32_16x16x32_bf16 v[52:55], a[120:123], a[76:79], v[52:55]
    ds_read_b128 v[124:127], v207 offset:7168
    ds_read_b128 v[128:131], v207 offset:8192
    v_mfma_f32_16x16x32_bf16 v[56:59], a[120:123], a[80:83], v[56:59]
    ds_read_b128 v[132:135], v207 offset:9216
    ds_read_b128 v[136:139], v207 offset:10240
    v_mfma_f32_16x16x32_bf16 v[60:63], a[120:123], a[84:87], v[60:63]
    ds_read_b128 v[140:143], v207 offset:11264
    v_mfma_f32_16x16x32_bf16 v[64:67], a[120:123], a[88:91], v[64:67]
    v_mfma_f32_16x16x32_bf16 v[68:71], a[120:123], a[92:95], v[68:71]
    v_mfma_f32_16x16x32_bf16 v[72:75], a[124:127], a[72:75], v[72:75]
    v_mfma_f32_16x16x32_bf16 v[76:79], a[124:127], a[76:79], v[76:79]
    v_mfma_f32_16x16x32_bf16 v[80:83], a[124:127], a[80:83], v[80:83]
    v_mfma_f32_16x16x32_bf16 v[84:87], a[124:127], a[84:87], v[84:87]
    v_mfma_f32_16x16x32_bf16 v[88:91], a[124:127], a[88:91], v[88:91]
    v_mfma_f32_16x16x32_bf16 v[92:95], a[124:127], a[92:95], v[92:95]
    s_waitcnt lgkmcnt(15)
    v_pk_add_f32 v[48:49], v[48:49], v[144:145]
    v_pk_add_f32 v[50:51], v[50:51], v[146:147]
    buffer_store_dwordx4 v[48:51], v192, s[16:19], s32 offen sc1
    v_pk_add_f32 v[52:53], v[52:53], v[148:149]
    v_pk_add_f32 v[54:55], v[54:55], v[150:151]
    buffer_store_dwordx4 v[52:55], v192, s[16:19], s32 offen offset:1024 sc1
    v_pk_add_f32 v[56:57], v[56:57], v[152:153]
    v_pk_add_f32 v[58:59], v[58:59], v[154:155]
    buffer_store_dwordx4 v[56:59], v192, s[16:19], s32 offen offset:2048 sc1
    v_pk_add_f32 v[60:61], v[60:61], v[156:157]
    v_pk_add_f32 v[62:63], v[62:63], v[158:159]
    buffer_store_dwordx4 v[60:63], v192, s[16:19], s32 offen offset:3072 sc1
    v_pk_add_f32 v[64:65], v[64:65], v[160:161]
    v_pk_add_f32 v[66:67], v[66:67], v[162:163]
    s_add_u32 s32, s32, 4096
    buffer_store_dwordx4 v[64:67], v192, s[16:19], s32 offen sc1
    v_pk_add_f32 v[68:69], v[68:69], v[164:165]
    v_pk_add_f32 v[70:71], v[70:71], v[166:167]
    buffer_store_dwordx4 v[68:71], v192, s[16:19], s32 offen offset:1024 sc1
    v_pk_add_f32 v[72:73], v[72:73], v[168:169]
    v_pk_add_f32 v[74:75], v[74:75], v[170:171]
    buffer_store_dwordx4 v[72:75], v192, s[16:19], s32 offen offset:2048 sc1
    v_pk_add_f32 v[76:77], v[76:77], v[172:173]
    v_pk_add_f32 v[78:79], v[78:79], v[174:175]
    buffer_store_dwordx4 v[76:79], v192, s[16:19], s32 offen offset:3072 sc1
    v_pk_add_f32 v[80:81], v[80:81], v[176:177]
    v_pk_add_f32 v[82:83], v[82:83], v[178:179]
    s_add_u32 s32, s32, 4096
    buffer_store_dwordx4 v[80:83], v192, s[16:19], s32 offen sc1
    s_waitcnt lgkmcnt(14)
    v_pk_add_f32 v[84:85], v[84:85], v[180:181]
    v_pk_add_f32 v[86:87], v[86:87], v[182:183]
    buffer_store_dwordx4 v[84:87], v192, s[16:19], s32 offen offset:1024 sc1
    s_waitcnt lgkmcnt(13)
    v_pk_add_f32 v[88:89], v[88:89], v[184:185]
    v_pk_add_f32 v[90:91], v[90:91], v[186:187]
    buffer_store_dwordx4 v[88:91], v192, s[16:19], s32 offen offset:2048 sc1
    s_waitcnt lgkmcnt(12)
    v_pk_add_f32 v[92:93], v[92:93], v[188:189]
    v_pk_add_f32 v[94:95], v[94:95], v[190:191]
    buffer_store_dwordx4 v[92:95], v192, s[16:19], s32 offen offset:3072 sc1
    s_waitcnt lgkmcnt(11)
    v_pk_add_f32 v[0:1], v[0:1], v[96:97]
    v_pk_add_f32 v[2:3], v[2:3], v[98:99]
    s_waitcnt lgkmcnt(10)
    v_pk_add_f32 v[4:5], v[4:5], v[100:101]
    v_pk_add_f32 v[6:7], v[6:7], v[102:103]
    s_waitcnt lgkmcnt(9)
    v_pk_add_f32 v[8:9], v[8:9], v[104:105]
    v_pk_add_f32 v[10:11], v[10:11], v[106:107]
    s_waitcnt lgkmcnt(8)
    v_pk_add_f32 v[12:13], v[12:13], v[108:109]
    v_pk_add_f32 v[14:15], v[14:15], v[110:111]
    s_waitcnt lgkmcnt(7)
    v_pk_add_f32 v[16:17], v[16:17], v[112:113]
    v_pk_add_f32 v[18:19], v[18:19], v[114:115]
    s_waitcnt lgkmcnt(6)
    v_pk_add_f32 v[20:21], v[20:21], v[116:117]
    v_pk_add_f32 v[22:23], v[22:23], v[118:119]
    s_waitcnt lgkmcnt(5)
    v_pk_add_f32 v[24:25], v[24:25], v[120:121]
    v_pk_add_f32 v[26:27], v[26:27], v[122:123]
    s_waitcnt lgkmcnt(4)
    v_pk_add_f32 v[28:29], v[28:29], v[124:125]
    v_pk_add_f32 v[30:31], v[30:31], v[126:127]
    s_waitcnt lgkmcnt(3)
    v_pk_add_f32 v[32:33], v[32:33], v[128:129]
    v_pk_add_f32 v[34:35], v[34:35], v[130:131]
    s_waitcnt lgkmcnt(2)
    v_pk_add_f32 v[36:37], v[36:37], v[132:133]
    v_pk_add_f32 v[38:39], v[38:39], v[134:135]
    s_waitcnt lgkmcnt(1)
    v_pk_add_f32 v[40:41], v[40:41], v[136:137]
    v_pk_add_f32 v[42:43], v[42:43], v[138:139]
    s_waitcnt lgkmcnt(0)
    v_pk_add_f32 v[44:45], v[44:45], v[140:141]
    v_pk_add_f32 v[46:47], v[46:47], v[142:143]
    v_mov_b32 v210, 1
    s_waitcnt vmcnt(0)
    buffer_store_dword v210, v209, s[16:19], s34 offen sc1
    s_mov_b32 s38, 0
O_xp:
    buffer_load_dword v211, v209, s[16:19], s35 offen sc1
    s_add_u32 s38, s38, 1
    s_waitcnt vmcnt(0)
    v_readfirstlane_b32 s46, v211
    s_cmp_ge_u32 s38, 0x20000
    s_cbranch_scc1 O_x1
    s_cmp_lg_u32 s46, 1
    s_cbranch_scc1 O_xp
O_x1:
    s_add_u32 s32, s32, 4096
    s_add_u32 s38, s33, 0
    buffer_load_dwordx4 v[96:99], v192, s[16:19], s38 offen sc1
    s_add_u32 s38, s33, 6144
    buffer_load_dwordx4 v[120:123], v192, s[16:19], s38 offen sc1
    s_add_u32 s38, s33, 1024
    buffer_load_dwordx4 v[100:103], v192, s[16:19], s38 offen sc1
    s_add_u32 s38, s33, 7168
    buffer_load_dwordx4 v[124:127], v192, s[16:19], s38 offen sc1
    s_add_u32 s38, s33, 2048
    buffer_load_dwordx4 v[104:107], v192, s[16:19], s38 offen sc1
    s_add_u32 s38, s33, 8192
    buffer_load_dwordx4 v[128:131], v192, s[16:19], s38 offen sc1
    s_add_u32 s38, s33, 3072
    buffer_load_dwordx4 v[108:111], v192, s[16:19], s38 offen sc1
    s_add_u32 s38, s33, 9216
    buffer_load_dwordx4 v[132:135], v192, s[16:19], s38 offen sc1
    s_add_u32 s38, s33, 4096
    buffer_load_dwordx4 v[112:115], v192, s[16:19], s38 offen sc1
    s_add_u32 s38, s33, 10240
    buffer_load_dwordx4 v[136:139], v192, s[16:19], s38 offen sc1
    s_add_u32 s38, s33, 5120
    buffer_load_dwordx4 v[116:119], v192, s[16:19], s38 offen sc1
    s_add_u32 s38, s33, 11264
    buffer_load_dwordx4 v[140:143], v192, s[16:19], s38 offen sc1
    s_waitcnt vmcnt(11)
    v_pk_add_f32 v[0:1], v[0:1], v[96:97]
    v_pk_add_f32 v[2:3], v[2:3], v[98:99]
    v_cvt_pk_bf16_f32 v212, v0, v1
    s_waitcnt vmcnt(10)
    v_pk_add_f32 v[24:25], v[24:25], v[120:121]
    v_pk_add_f32 v[26:27], v[26:27], v[122:123]
    v_cvt_pk_bf16_f32 v213, v2, v3
    v_cvt_pk_bf16_f32 v214, v24, v25
    v_cvt_pk_bf16_f32 v215, v26, v27
    s_waitcnt vmcnt(9)
    v_pk_add_f32 v[4:5], v[4:5], v[100:101]
    v_permlane32_swap_b32 v212, v214
    v_permlane32_swap_b32 v213, v215
    v_pk_add_f32 v[6:7], v[6:7], v[102:103]
    s_waitcnt vmcnt(8)
    v_pk_add_f32 v[28:29], v[28:29], v[124:125]
    v_pk_add_f32 v[30:31], v[30:31], v[126:127]
    v_cvt_pk_bf16_f32 v216, v4, v5
    v_cvt_pk_bf16_f32 v217, v6, v7
    v_cvt_pk_bf16_f32 v218, v28, v29
    v_cvt_pk_bf16_f32 v219, v30, v31
    v_permlane16_swap_b32 v212, v214
    v_permlane16_swap_b32 v213, v215
    v_permlane32_swap_b32 v216, v218
    v_permlane32_swap_b32 v217, v219
    buffer_store_dwordx4 v[212:215], v208, s[12:15], s31 offen
    s_waitcnt vmcnt(8)
    v_pk_add_f32 v[8:9], v[8:9], v[104:105]
    v_pk_add_f32 v[10:11], v[10:11], v[106:107]
    s_waitcnt vmcnt(7)
    v_pk_add_f32 v[32:33], v[32:33], v[128:129]
    v_pk_add_f32 v[34:35], v[34:35], v[130:131]
    v_cvt_pk_bf16_f32 v220, v8, v9
    v_cvt_pk_bf16_f32 v221, v10, v11
    v_cvt_pk_bf16_f32 v222, v32, v33
    v_cvt_pk_bf16_f32 v223, v34, v35
    v_permlane16_swap_b32 v216, v218
    v_permlane16_swap_b32 v217, v219
    s_add_u32 s31, s31, 40960
    v_permlane32_swap_b32 v220, v222
    v_permlane32_swap_b32 v221, v223
    buffer_store_dwordx4 v[216:219], v208, s[12:15], s31 offen
    s_waitcnt vmcnt(7)
    v_pk_add_f32 v[12:13], v[12:13], v[108:109]
    v_pk_add_f32 v[14:15], v[14:15], v[110:111]
    s_waitcnt vmcnt(6)
    v_pk_add_f32 v[36:37], v[36:37], v[132:133]
    v_pk_add_f32 v[38:39], v[38:39], v[134:135]
    v_cvt_pk_bf16_f32 v224, v12, v13
    v_cvt_pk_bf16_f32 v225, v14, v15
    v_cvt_pk_bf16_f32 v226, v36, v37
    v_cvt_pk_bf16_f32 v227, v38, v39
    v_permlane16_swap_b32 v220, v222
    v_permlane16_swap_b32 v221, v223
    s_add_u32 s31, s31, 40960
    v_permlane32_swap_b32 v224, v226
    v_permlane32_swap_b32 v225, v227
    buffer_store_dwordx4 v[220:223], v208, s[12:15], s31 offen
    s_waitcnt vmcnt(6)
    v_pk_add_f32 v[16:17], v[16:17], v[112:113]
    v_pk_add_f32 v[18:19], v[18:19], v[114:115]
    s_waitcnt vmcnt(5)
    v_pk_add_f32 v[40:41], v[40:41], v[136:137]
    v_pk_add_f32 v[42:43], v[42:43], v[138:139]
    v_cvt_pk_bf16_f32 v228, v16, v17
    v_cvt_pk_bf16_f32 v229, v18, v19
    v_cvt_pk_bf16_f32 v230, v40, v41
    v_cvt_pk_bf16_f32 v231, v42, v43
    v_permlane16_swap_b32 v224, v226
    v_permlane16_swap_b32 v225, v227
    s_add_u32 s31, s31, 40960
    v_permlane32_swap_b32 v228, v230
    v_permlane32_swap_b32 v229, v231
    buffer_store_dwordx4 v[224:227], v208, s[12:15], s31 offen
    s_waitcnt vmcnt(5)
    v_pk_add_f32 v[20:21], v[20:21], v[116:117]
    v_pk_add_f32 v[22:23], v[22:23], v[118:119]
    s_waitcnt vmcnt(4)
    v_pk_add_f32 v[44:45], v[44:45], v[140:141]
    v_pk_add_f32 v[46:47], v[46:47], v[142:143]
    v_cvt_pk_bf16_f32 v232, v20, v21
    v_cvt_pk_bf16_f32 v233, v22, v23
    v_cvt_pk_bf16_f32 v234, v44, v45
    v_cvt_pk_bf16_f32 v235, v46, v47
    v_permlane16_swap_b32 v228, v230
    v_permlane16_swap_b32 v229, v231
    s_add_u32 s31, s31, 40960
    v_permlane32_swap_b32 v232, v234
    v_permlane32_swap_b32 v233, v235
    buffer_store_dwordx4 v[228:231], v208, s[12:15], s31 offen
    v_permlane16_swap_b32 v232, v234
    v_permlane16_swap_b32 v233, v235
    s_add_u32 s31, s31, 40960
    buffer_store_dwordx4 v[232:235], v208, s[12:15], s31 offen
    s_add_u32 s31, s31, 40960
    s_endpgm
O_mid:
    s_mov_b32 s38, 0
O_poll1:
    buffer_load_dword v210, v209, s[76:79], s39 offen offset:4 sc1
    s_add_u32 s38, s38, 1
    s_waitcnt vmcnt(0)
    v_readfirstlane_b32 s46, v210
    s_cmp_ge_u32 s38, 0x20000
    s_cbranch_scc1 O_poll1_d
    s_cmp_lt_u32 s46, 16
    s_cbranch_scc1 O_poll1
O_poll1_d:
    s_barrier
    s_branch O_cont
O_slow0:
    s_mov_b32 s38, 0
O_poll0:
    buffer_load_dword v210, v209, s[76:79], s39 offen offset:0 sc1
    s_add_u32 s38, s38, 1
    s_waitcnt vmcnt(0)
    v_readfirstlane_b32 s46, v210
    s_cmp_ge_u32 s38, 0x20000
    s_cbranch_scc1 O_poll0_d
    s_cmp_lt_u32 s46, 16
    s_cbranch_scc1 O_poll0
O_poll0_d:
    s_branch O_go
O_slow1:
    s_mov_b32 s38, 0
O_poll2:
    buffer_load_dword v210, v209, s[76:79], s74 offen offset:128 sc1
    s_add_u32 s38, s38, 1
    s_waitcnt vmcnt(0)
    v_readfirstlane_b32 s46, v210
    s_cmp_ge_u32 s38, 0x20000
    s_cbranch_scc1 O_go1
    s_bitcmp0_b32 s46, s2
    s_cbranch_scc1 O_poll2
    s_branch O_go1
K_ra0:
    s_add_u32 m0, s34, 0
    s_add_u32 s38, s44, 0
    buffer_load_dwordx4 v216, s[12:15], s30 offen nt lds
    buffer_load_dwordx4 v216, s[12:15], s30 offen offset:3072 nt lds
    s_add_u32 m0, s34, 896
    s_add_u32 s74, s45, 0
    buffer_load_dwordx4 v216, s[12:15], s30 offen offset:128 nt lds
    buffer_load_dwordx4 v216, s[12:15], s30 offen offset:3200 nt lds
    s_add_u32 m0, s34, 1792
    s_add_u32 s39, s34, s35
    buffer_load_dwordx4 v216, s[12:15], s30 offen offset:256 nt lds
    buffer_load_dwordx4 v216, s[12:15], s30 offen offset:3328 nt lds
    buffer_load_dwordx4 v[0:3], v248, s[20:23], s38 offen sc1
    buffer_load_dwordx4 v[24:27], v248, s[20:23], s38 offen offset:1024 sc1
    buffer_load_dwordx4 v[48:51], v248, s[20:23], s38 offen offset:2048 sc1
    buffer_load_dwordx4 v[72:75], v248, s[20:23], s38 offen offset:3072 sc1
    buffer_load_dwordx4 v[96:99], v248, s[20:23], s74 offen sc1
    s_add_u32 s38, s44, 18432
    buffer_load_dwordx4 v[4:7], v248, s[20:23], s38 offen sc1
    buffer_load_dwordx4 v[28:31], v248, s[20:23], s38 offen offset:1024 sc1
    buffer_load_dwordx4 v[52:55], v248, s[20:23], s38 offen offset:2048 sc1
    buffer_load_dwordx4 v[76:79], v248, s[20:23], s38 offen offset:3072 sc1
    s_add_u32 s74, s45, 18432
    buffer_load_dwordx4 v[100:103], v248, s[20:23], s74 offen sc1
    s_add_u32 s38, s44, 36864
    buffer_load_dwordx4 v[8:11], v248, s[20:23], s38 offen sc1
    buffer_load_dwordx4 v[32:35], v248, s[20:23], s38 offen offset:1024 sc1
    buffer_load_dwordx4 v[56:59], v248, s[20:23], s38 offen offset:2048 sc1
    buffer_load_dwordx4 v[80:83], v248, s[20:23], s38 offen offset:3072 sc1
    s_add_u32 s74, s45, 36864
    buffer_load_dwordx4 v[104:107], v248, s[20:23], s74 offen sc1
    s_add_u32 s38, s44, 55296
    buffer_load_dwordx4 v[12:15], v248, s[20:23], s38 offen sc1
    buffer_load_dwordx4 v[36:39], v248, s[20:23], s38 offen offset:1024 sc1
    buffer_load_dwordx4 v[60:63], v248, s[20:23], s38 offen offset:2048 sc1
    buffer_load_dwordx4 v[84:87], v248, s[20:23], s38 offen offset:3072 sc1
    s_add_u32 s74, s45, 55296
    buffer_load_dwordx4 v[108:111], v248, s[20:23], s74 offen sc1
    s_add_u32 s38, s44, 73728
    buffer_load_dwordx4 v[16:19], v248, s[20:23], s38 offen sc1
    buffer_load_dwordx4 v[40:43], v248, s[20:23], s38 offen offset:1024 sc1
    buffer_load_dwordx4 v[64:67], v248, s[20:23], s38 offen offset:2048 sc1
    buffer_load_dwordx4 v[88:91], v248, s[20:23], s38 offen offset:3072 sc1
    s_add_u32 s74, s45, 73728
    buffer_load_dwordx4 v[112:115], v248, s[20:23], s74 offen sc1
    s_add_u32 s38, s44, 92160
    buffer_load_dwordx4 v[20:23], v248, s[20:23], s38 offen sc1
    buffer_load_dwordx4 v[44:47], v248, s[20:23], s38 offen offset:1024 sc1
    buffer_load_dwordx4 v[68:71], v248, s[20:23], s38 offen offset:2048 sc1
    buffer_load_dwordx4 v[92:95], v248, s[20:23], s38 offen offset:3072 sc1
    s_add_u32 s74, s45, 92160
    buffer_load_dwordx4 v[116:119], v248, s[20:23], s74 offen sc1
    s_add_u32 s30, s30, 12288
    s_add_u32 m0, s32, 0
    s_cmp_ge_u32 s30, 196608
    s_cselect_b32 s30, 0, s30
    buffer_load_dwordx4 v216, s[12:15], s30 offen nt lds
    buffer_load_dwordx4 v216, s[12:15], s30 offen offset:3072 nt lds
    s_add_u32 m0, s32, 896
    s_waitcnt vmcnt(32)
    buffer_load_dwordx4 v216, s[12:15], s30 offen offset:128 nt lds
    buffer_load_dwordx4 v216, s[12:15], s30 offen offset:3200 nt lds
    s_add_u32 m0, s32, 1792
    s_barrier
    buffer_load_dwordx4 v216, s[12:15], s30 offen offset:256 nt lds
    buffer_load_dwordx4 v216, s[12:15], s30 offen offset:3328 nt lds
    s_add_u32 m0, s39, 0
    s_add_u32 s30, s30, 12288
    s_cmp_ge_u32 s30, 196608
    s_cselect_b32 s30, 0, s30
    v_mov_b32 v230, 0
    v_mov_b32 v231, 0
    v_mov_b32 v232, 0
    v_mov_b32 v233, 0
    ds_read_b128 a[240:243], v217 offset:0
    ds_read_b128 a[244:247], v218 offset:0
    ds_read_b128 a[248:251], v217 offset:1024
    ds_read_b128 v[240:243], v217 offset:2048
    ds_read_b128 a[252:255], v218 offset:1024
    ds_read_b128 v[244:247], v218 offset:2048
    s_sub_u32 s36, s32, s34
    v_mov_b32 v234, 0
    s_mov_b32 s46, s32
    v_accvgpr_write_b32 a192, 0
    v_accvgpr_write_b32 a193, 0
    v_accvgpr_write_b32 a194, 0
    v_accvgpr_write_b32 a195, 0
    v_accvgpr_write_b32 a196, 0
    v_accvgpr_write_b32 a197, 0
    v_accvgpr_write_b32 a198, 0
    v_accvgpr_write_b32 a199, 0
    v_accvgpr_write_b32 a200, 0
    v_accvgpr_write_b32 a201, 0
    v_accvgpr_write_b32 a202, 0
    v_accvgpr_write_b32 a203, 0
    v_accvgpr_write_b32 a204, 0
    v_accvgpr_write_b32 a205, 0
    v_accvgpr_write_b32 a206, 0
    v_accvgpr_write_b32 a207, 0
    v_accvgpr_write_b32 a208, 0
    v_accvgpr_write_b32 a209, 0
    v_accvgpr_write_b32 a210, 0
    v_accvgpr_write_b32 a211, 0
    v_accvgpr_write_b32 a212, 0
    v_accvgpr_write_b32 a213, 0
    v_accvgpr_write_b32 a214, 0
    v_accvgpr_write_b32 a215, 0
    v_accvgpr_write_b32 a216, 0
    v_accvgpr_write_b32 a217, 0
    v_accvgpr_write_b32 a218, 0
    v_accvgpr_write_b32 a219, 0
    s_mov_b32 s37, s36
    v_accvgpr_write_b32 a220, 0
    v_accvgpr_write_b32 a221, 0
    v_accvgpr_write_b32 a222, 0
    v_accvgpr_write_b32 a223, 0
    v_accvgpr_write_b32 a224, 0
    v_accvgpr_write_b32 a225, 0
    v_accvgpr_write_b32 a226, 0
    v_accvgpr_write_b32 a227, 0
    v_accvgpr_write_b32 a228, 0
    v_accvgpr_write_b32 a229, 0
    v_accvgpr_write_b32 a230, 0
    v_accvgpr_write_b32 a231, 0
    v_accvgpr_write_b32 a232, 0
    v_accvgpr_write_b32 a233, 0
    s_waitcnt lgkmcnt(5)
    s_waitcnt vmcnt(35)
    v_mfma_f32_16x16x32_bf16 v[120:123], a[240:243], v[0:3], 0
    buffer_load_dwordx4 v216, s[16:19], s31 offen nt lds
    s_waitcnt vmcnt(35)
    v_mfma_f32_16x16x32_bf16 v[124:127], a[240:243], v[24:27], 0
    v_accvgpr_write_b32 a234, 0
    v_accvgpr_write_b32 a235, 0
    s_waitcnt vmcnt(34)
    v_mfma_f32_16x16x32_bf16 v[128:131], a[240:243], v[48:51], 0
    v_accvgpr_write_b32 a236, 0
    v_accvgpr_write_b32 a237, 0
    s_waitcnt vmcnt(33)
    v_mfma_f32_16x16x32_bf16 v[132:135], a[240:243], v[72:75], 0
    buffer_load_dwordx4 v216, s[16:19], s31 offen offset:3072 nt lds
    s_waitcnt vmcnt(33)
    v_mfma_f32_16x16x32_bf16 v[136:139], a[240:243], v[96:99], 0
    s_waitcnt lgkmcnt(4)
    s_add_u32 m0, s39, 896
    ds_read_b128 a[240:243], v217 offset:6144
    s_waitcnt vmcnt(32)
    v_mfma_f32_16x16x32_bf16 v[120:123], a[244:247], v[4:7], v[120:123]
    v_accvgpr_write_b32 a238, 0
    v_accvgpr_write_b32 a239, 0
    s_waitcnt vmcnt(31)
    v_mfma_f32_16x16x32_bf16 v[124:127], a[244:247], v[28:31], v[124:127]
    buffer_load_dwordx4 v216, s[16:19], s31 offen offset:128 nt lds
    s_waitcnt vmcnt(31)
    v_mfma_f32_16x16x32_bf16 v[128:131], a[244:247], v[52:55], v[128:131]
    s_waitcnt vmcnt(30)
    v_mfma_f32_16x16x32_bf16 v[132:135], a[244:247], v[76:79], v[132:135]
    s_waitcnt vmcnt(29)
    v_mfma_f32_16x16x32_bf16 v[136:139], a[244:247], v[100:103], v[136:139]
    s_waitcnt lgkmcnt(4)
    buffer_load_dwordx4 v216, s[16:19], s31 offen offset:3200 nt lds
    s_waitcnt vmcnt(29)
    v_mfma_f32_16x16x32_bf16 v[120:123], a[248:251], v[8:11], v[120:123]
    s_add_u32 m0, s39, 1792
    s_add_u32 s39, s32, s35
    ds_read_b128 a[244:247], v218 offset:6144
    s_waitcnt vmcnt(28)
    v_mfma_f32_16x16x32_bf16 v[124:127], a[248:251], v[32:35], v[124:127]
    s_waitcnt vmcnt(27)
    v_mfma_f32_16x16x32_bf16 v[128:131], a[248:251], v[56:59], v[128:131]
    buffer_load_dwordx4 v216, s[16:19], s31 offen offset:256 nt lds
    s_waitcnt vmcnt(27)
    v_mfma_f32_16x16x32_bf16 v[132:135], a[248:251], v[80:83], v[132:135]
    s_waitcnt vmcnt(26)
    v_mfma_f32_16x16x32_bf16 v[136:139], a[248:251], v[104:107], v[136:139]
    s_waitcnt lgkmcnt(3)
    ds_read_b128 a[248:251], v217 offset:7168
    s_waitcnt vmcnt(25)
    v_mfma_f32_16x16x32_bf16 v[120:123], a[252:255], v[12:15], v[120:123]
    buffer_load_dwordx4 v216, s[16:19], s31 offen offset:3328 nt lds
    s_waitcnt vmcnt(25)
    v_mfma_f32_16x16x32_bf16 v[124:127], a[252:255], v[36:39], v[124:127]
    s_add_u32 m0, s33, 0
    s_add_u32 s31, s31, 12288
    s_waitcnt vmcnt(24)
    v_mfma_f32_16x16x32_bf16 v[128:131], a[252:255], v[60:63], v[128:131]
    s_cmp_ge_u32 s31, 196608
    s_cselect_b32 s31, 0, s31
    s_waitcnt vmcnt(23)
    v_mfma_f32_16x16x32_bf16 v[132:135], a[252:255], v[84:87], v[132:135]
    buffer_load_dwordx4 v216, s[12:15], s30 offen nt lds
    s_waitcnt vmcnt(23)
    v_mfma_f32_16x16x32_bf16 v[136:139], a[252:255], v[108:111], v[136:139]
    ds_read_b128 a[252:255], v218 offset:7168
    s_waitcnt vmcnt(22)
    v_mfma_f32_16x16x32_bf16 v[120:123], v[240:243], v[16:19], v[120:123]
    s_waitcnt vmcnt(21)
    v_mfma_f32_16x16x32_bf16 v[124:127], v[240:243], v[40:43], v[124:127]
    buffer_load_dwordx4 v216, s[12:15], s30 offen offset:3072 nt lds
    s_waitcnt vmcnt(21)
    v_mfma_f32_16x16x32_bf16 v[128:131], v[240:243], v[64:67], v[128:131]
    s_add_u32 m0, s33, 896
    s_waitcnt vmcnt(20)
    v_mfma_f32_16x16x32_bf16 v[132:135], v[240:243], v[88:91], v[132:135]
    s_waitcnt vmcnt(19)
    v_mfma_f32_16x16x32_bf16 v[136:139], v[240:243], v[112:115], v[136:139]
    s_waitcnt lgkmcnt(4)
    buffer_load_dwordx4 v216, s[12:15], s30 offen offset:128 nt lds
    s_waitcnt vmcnt(19)
    v_mfma_f32_16x16x32_bf16 v[120:123], v[244:247], v[20:23], v[120:123]
    ds_read_b128 v[240:243], v217 offset:8192
    v_add_u32 v217, s36, v217
    s_waitcnt vmcnt(18)
    v_mfma_f32_16x16x32_bf16 v[124:127], v[244:247], v[44:47], v[124:127]
    s_waitcnt vmcnt(17)
    v_mfma_f32_16x16x32_bf16 v[128:131], v[244:247], v[68:71], v[128:131]
    buffer_load_dwordx4 v216, s[12:15], s30 offen offset:3200 nt lds
    s_waitcnt vmcnt(17)
    v_mfma_f32_16x16x32_bf16 v[132:135], v[244:247], v[92:95], v[132:135]
    s_add_u32 m0, s33, 1792
    v_max3_f32 v196, v120, v121, v122
    v_max3_f32 v196, v196, v123, v235
    s_waitcnt vmcnt(16)
    v_mfma_f32_16x16x32_bf16 v[136:139], v[244:247], v[116:119], v[136:139]
    s_waitcnt lgkmcnt(4)
    v_max3_f32 v200, v124, v125, v126
    v_max3_f32 v200, v200, v127, v236
    v_mfma_f32_16x16x32_bf16 v[140:143], a[240:243], v[0:3], 0
    s_waitcnt vmcnt(10)
    s_barrier
    v_max3_f32 v204, v128, v129, v130
    v_mfma_f32_16x16x32_bf16 v[144:147], a[240:243], v[24:27], 0
    buffer_load_dwordx4 v216, s[12:15], s30 offen offset:256 nt lds
    v_mfma_f32_16x16x32_bf16 v[148:151], a[240:243], v[48:51], 0
    v_mov_b32 v197, v196
    v_max3_f32 v208, v132, v133, v134
    v_mfma_f32_16x16x32_bf16 v[152:155], a[240:243], v[72:75], 0
    buffer_load_dwordx4 v216, s[12:15], s30 offen offset:3328 nt lds
    v_mfma_f32_16x16x32_bf16 v[156:159], a[240:243], v[96:99], 0
    s_waitcnt lgkmcnt(3)
    s_add_u32 m0, s39, 0
    v_max3_f32 v204, v204, v131, v237
    v_mfma_f32_16x16x32_bf16 v[140:143], a[244:247], v[4:7], v[140:143]
    s_add_u32 s30, s30, 12288
    v_mov_b32 v201, v200
    v_max3_f32 v208, v208, v135, v238
    v_mfma_f32_16x16x32_bf16 v[144:147], a[244:247], v[28:31], v[144:147]
    buffer_load_dwordx4 v216, s[16:19], s31 offen nt lds
    v_mfma_f32_16x16x32_bf16 v[148:151], a[244:247], v[52:55], v[148:151]
    v_permlane32_swap_b32 v196, v197
    v_mfma_f32_16x16x32_bf16 v[152:155], a[244:247], v[76:79], v[152:155]
    v_mov_b32 v205, v204
    v_max_f32 v196, v196, v197
    v_mfma_f32_16x16x32_bf16 v[156:159], a[244:247], v[100:103], v[156:159]
    s_waitcnt lgkmcnt(2)
    buffer_load_dwordx4 v216, s[16:19], s31 offen offset:3072 nt lds
    v_mfma_f32_16x16x32_bf16 v[140:143], a[248:251], v[8:11], v[140:143]
    s_add_u32 m0, s39, 896
    v_permlane32_swap_b32 v200, v201
    v_mfma_f32_16x16x32_bf16 v[144:147], a[248:251], v[32:35], v[144:147]
    v_mov_b32 v209, v208
    v_max_f32 v200, v200, v201
    v_mfma_f32_16x16x32_bf16 v[148:151], a[248:251], v[56:59], v[148:151]
    buffer_load_dwordx4 v216, s[16:19], s31 offen offset:128 nt lds
    v_mfma_f32_16x16x32_bf16 v[152:155], a[248:251], v[80:83], v[152:155]
    v_permlane32_swap_b32 v204, v205
    v_mfma_f32_16x16x32_bf16 v[156:159], a[248:251], v[104:107], v[156:159]
    s_waitcnt lgkmcnt(1)
    v_mov_b32 v197, v196
    v_max_f32 v204, v204, v205
    v_mfma_f32_16x16x32_bf16 v[140:143], a[252:255], v[12:15], v[140:143]
    buffer_load_dwordx4 v216, s[16:19], s31 offen offset:3200 nt lds
    v_mfma_f32_16x16x32_bf16 v[144:147], a[252:255], v[36:39], v[144:147]
    s_add_u32 m0, s39, 1792
    v_permlane32_swap_b32 v208, v209
    v_mfma_f32_16x16x32_bf16 v[148:151], a[252:255], v[60:63], v[148:151]
    s_add_u32 s39, s33, s35
    v_mov_b32 v201, v200
    v_max_f32 v208, v208, v209
    v_mfma_f32_16x16x32_bf16 v[152:155], a[252:255], v[84:87], v[152:155]
    buffer_load_dwordx4 v216, s[16:19], s31 offen offset:256 nt lds
    v_mfma_f32_16x16x32_bf16 v[156:159], a[252:255], v[108:111], v[156:159]
    s_waitcnt lgkmcnt(0)
    v_permlane16_swap_b32 v196, v197
    v_mfma_f32_16x16x32_bf16 v[140:143], v[240:243], v[16:19], v[140:143]
    s_cmp_ge_u32 s30, 196608
    s_cselect_b32 s30, 0, s30
    v_mfma_f32_16x16x32_bf16 v[144:147], v[240:243], v[40:43], v[144:147]
    buffer_load_dwordx4 v216, s[16:19], s31 offen offset:3328 nt lds
    v_mfma_f32_16x16x32_bf16 v[148:151], v[240:243], v[64:67], v[148:151]
    s_add_u32 m0, s34, 0
    v_mov_b32 v205, v204
    v_mov_b32 v209, v208
    v_mfma_f32_16x16x32_bf16 v[152:155], v[240:243], v[88:91], v[152:155]
    s_add_u32 s31, s31, 12288
    v_permlane16_swap_b32 v200, v201
    v_mfma_f32_16x16x32_bf16 v[156:159], v[240:243], v[112:115], v[156:159]
    v_max_f32 v196, v196, v197
    v_permlane16_swap_b32 v204, v205
    v_permlane16_swap_b32 v208, v209
    v_max_f32 v200, v200, v201
    v_max3_f32 v212, v136, v137, v138
    v_sub_f32 v197, 0, v196
    v_sub_f32 v201, 0, v200
    v_max_f32 v204, v204, v205
    v_max_f32 v208, v208, v209
    v_max3_f32 v212, v212, v139, v239
    v_add_f32 v120, v120, v197
    v_add_f32 v124, v124, v201
    v_sub_f32 v205, 0, v204
    v_sub_f32 v209, 0, v208
    v_mov_b32 v213, v212
    v_exp_f32 v120, v120
    v_add_f32 v121, v121, v197
    v_exp_f32 v124, v124
    v_add_f32 v125, v125, v201
    v_add_f32 v128, v128, v205
    v_add_f32 v132, v132, v209
    v_permlane32_swap_b32 v212, v213
    v_exp_f32 v121, v121
    v_add_f32 v122, v122, v197
    v_add_f32 v230, v230, v120
    v_exp_f32 v125, v125
    v_add_f32 v126, v126, v201
    v_add_f32 v231, v231, v124
    v_exp_f32 v128, v128
    v_add_f32 v129, v129, v205
    v_exp_f32 v132, v132
    v_add_f32 v133, v133, v209
    v_max_f32 v212, v212, v213
    v_add_f32 v123, v123, v197
    v_exp_f32 v122, v122
    v_add_f32 v230, v230, v121
    v_add_f32 v127, v127, v201
    v_exp_f32 v126, v126
    v_add_f32 v231, v231, v125
    v_add_f32 v130, v130, v205
    v_exp_f32 v129, v129
    v_add_f32 v232, v232, v128
    v_add_f32 v134, v134, v209
    v_exp_f32 v133, v133
    v_add_f32 v233, v233, v132
    v_mov_b32 v213, v212
    s_cmp_ge_u32 s31, 196608
    s_cselect_b32 s31, 0, s31
    v_exp_f32 v123, v123
    v_add_f32 v230, v230, v122
    v_exp_f32 v127, v127
    v_add_f32 v231, v231, v126
    v_exp_f32 v130, v130
    v_add_f32 v131, v131, v205
    v_add_f32 v232, v232, v129
    v_exp_f32 v134, v134
    v_add_f32 v135, v135, v209
    v_add_f32 v233, v233, v133
    v_permlane16_swap_b32 v212, v213
    v_add_f32 v230, v230, v123
    v_add_f32 v231, v231, v127
    v_exp_f32 v131, v131
    v_add_f32 v232, v232, v130
    v_exp_f32 v135, v135
    v_add_f32 v233, v233, v134
    v_max_f32 v212, v212, v213
    v_add_f32 v232, v232, v131
    v_add_f32 v233, v233, v135
    v_sub_f32 v213, 0, v212
    ds_read_b128 v[244:247], v218 offset:8192
    v_add_f32 v136, v136, v213
    v_add_u32 v218, s36, v218
    v_add_f32 v137, v137, v213
    v_exp_f32 v136, v136
    v_sub_f32 v198, 0, v196
    v_sub_f32 v199, 0, v196
    v_sub_f32 v202, 0, v200
    v_sub_f32 v203, 0, v200
    v_sub_f32 v206, 0, v204
    v_sub_f32 v207, 0, v204
    v_sub_f32 v210, 0, v208
    v_sub_f32 v211, 0, v208
    ds_read_b128 a[240:243], v217 offset:0
    ds_read_b128 a[244:247], v218 offset:0
    ds_read_b128 a[248:251], v217 offset:1024
    v_exp_f32 v137, v137
    v_add_f32 v138, v138, v213
    v_add_f32 v234, v234, v136
    v_sub_f32 v196, 0, v196
    v_cvt_pk_bf16_f32 v160, v120, v121
    v_cvt_pk_bf16_f32 v161, v122, v123
    v_sub_f32 v200, 0, v200
    v_cvt_pk_bf16_f32 v164, v124, v125
    v_cvt_pk_bf16_f32 v165, v126, v127
    ds_read_b128 a[252:255], v218 offset:1024
    v_sub_f32 v204, 0, v204
    v_cvt_pk_bf16_f32 v168, v128, v129
    v_cvt_pk_bf16_f32 v169, v130, v131
    v_sub_f32 v208, 0, v208
    v_cvt_pk_bf16_f32 v172, v132, v133
    v_cvt_pk_bf16_f32 v173, v134, v135
    ds_read_b128 v[240:243], v217 offset:2048
    v_add_f32 v139, v139, v213
    s_waitcnt lgkmcnt(5)
    v_mfma_f32_16x16x32_bf16 v[140:143], v[244:247], v[20:23], v[140:143]
    v_exp_f32 v138, v138
    v_mfma_f32_16x16x32_bf16 v[144:147], v[244:247], v[44:47], v[144:147]
    s_sub_u32 s36, s33, s32
    v_add_f32 v234, v234, v137
    v_add_f32 v234, v234, v138
    v_mfma_f32_16x16x32_bf16 v[148:151], v[244:247], v[68:71], v[148:151]
    s_mov_b32 s32, s33
    v_exp_f32 v139, v139
    v_mfma_f32_16x16x32_bf16 v[152:155], v[244:247], v[92:95], v[152:155]
    s_mov_b32 s33, s34
    v_add_f32 v140, v140, v197
    v_add_f32 v141, v141, v197
    v_mfma_f32_16x16x32_bf16 v[156:159], v[244:247], v[116:119], v[156:159]
    s_waitcnt lgkmcnt(4)
    s_barrier
    v_add_f32 v144, v144, v201
    v_mfma_f32_16x16x32_bf16 v[120:123], a[240:243], v[0:3], v[196:199]
    buffer_load_dwordx4 v216, s[12:15], s30 offen nt lds
    v_mfma_f32_16x16x32_bf16 v[124:127], a[240:243], v[24:27], v[200:203]
    buffer_load_dwordx4 v216, s[12:15], s30 offen offset:3072 nt lds
    v_mfma_f32_16x16x32_bf16 v[128:131], a[240:243], v[48:51], v[204:207]
    s_add_u32 m0, s34, 896
    v_exp_f32 v140, v140
    v_mfma_f32_16x16x32_bf16 v[132:135], a[240:243], v[72:75], v[208:211]
    s_waitcnt lgkmcnt(3)
    buffer_load_dwordx4 v216, s[12:15], s30 offen offset:128 nt lds
    v_mfma_f32_16x16x32_bf16 v[120:123], a[244:247], v[4:7], v[120:123]
    buffer_load_dwordx4 v216, s[12:15], s30 offen offset:3200 nt lds
    v_mfma_f32_16x16x32_bf16 v[124:127], a[244:247], v[28:31], v[124:127]
    s_add_u32 m0, s34, 1792
    v_exp_f32 v144, v144
    v_mfma_f32_16x16x32_bf16 v[128:131], a[244:247], v[52:55], v[128:131]
    s_mov_b32 s34, s46
    buffer_load_dwordx4 v216, s[12:15], s30 offen offset:256 nt lds
    v_mfma_f32_16x16x32_bf16 v[132:135], a[244:247], v[76:79], v[132:135]
    s_waitcnt lgkmcnt(2)
    buffer_load_dwordx4 v216, s[12:15], s30 offen offset:3328 nt lds
    v_mfma_f32_16x16x32_bf16 v[120:123], a[248:251], v[8:11], v[120:123]
    s_add_u32 m0, s39, 0
    v_add_f32 v145, v145, v201
    v_add_f32 v148, v148, v205
    v_mfma_f32_16x16x32_bf16 v[124:127], a[248:251], v[32:35], v[124:127]
    s_add_u32 s30, s30, 12288
    v_add_f32 v152, v152, v209
    v_add_f32 v142, v142, v197
    v_mfma_f32_16x16x32_bf16 v[128:131], a[248:251], v[56:59], v[128:131]
    v_exp_f32 v141, v141
    v_mfma_f32_16x16x32_bf16 v[132:135], a[248:251], v[80:83], v[132:135]
    s_waitcnt lgkmcnt(1)
    v_add_f32 v230, v230, v140
    v_add_f32 v146, v146, v201
    v_mfma_f32_16x16x32_bf16 v[120:123], a[252:255], v[12:15], v[120:123]
    v_exp_f32 v145, v145
    v_mfma_f32_16x16x32_bf16 v[124:127], a[252:255], v[36:39], v[124:127]
    v_add_f32 v231, v231, v144
    v_add_f32 v149, v149, v205
    v_mfma_f32_16x16x32_bf16 v[128:131], a[252:255], v[60:63], v[128:131]
    v_exp_f32 v148, v148
    v_mfma_f32_16x16x32_bf16 v[132:135], a[252:255], v[84:87], v[132:135]
    s_waitcnt lgkmcnt(0)
    v_add_f32 v153, v153, v209
    v_add_f32 v143, v143, v197
    v_mfma_f32_16x16x32_bf16 v[120:123], v[240:243], v[16:19], v[120:123]
    v_exp_f32 v152, v152
    v_mfma_f32_16x16x32_bf16 v[124:127], v[240:243], v[40:43], v[124:127]
    v_exp_f32 v142, v142
    v_mfma_f32_16x16x32_bf16 v[128:131], v[240:243], v[64:67], v[128:131]
    v_add_f32 v230, v230, v141
    v_add_f32 v147, v147, v201
    v_mfma_f32_16x16x32_bf16 v[132:135], v[240:243], v[88:91], v[132:135]
    v_exp_f32 v146, v146
    v_add_f32 v231, v231, v145
    v_add_f32 v150, v150, v205
    v_exp_f32 v149, v149
    v_add_f32 v232, v232, v148
    v_exp_f32 v153, v153
    v_add_f32 v154, v154, v209
    v_add_f32 v233, v233, v152
    v_exp_f32 v143, v143
    v_add_f32 v230, v230, v142
    v_exp_f32 v147, v147
    v_add_f32 v231, v231, v146
    v_exp_f32 v150, v150
    v_add_f32 v151, v151, v205
    v_add_f32 v232, v232, v149
    v_add_f32 v155, v155, v209
    v_exp_f32 v154, v154
    v_add_f32 v233, v233, v153
    v_add_f32 v230, v230, v143
    v_add_f32 v231, v231, v147
    v_exp_f32 v151, v151
    v_add_f32 v232, v232, v150
    v_exp_f32 v155, v155
    v_add_f32 v233, v233, v154
    s_cmp_ge_u32 s30, 196608
    s_cselect_b32 s30, 0, s30
    v_add_f32 v232, v232, v151
    ds_read_b128 v[244:247], v218 offset:2048
    v_add_f32 v233, v233, v155
    ds_read_b128 a[240:243], v217 offset:6144
    v_add_f32 v156, v156, v213
    ds_read_b128 a[244:247], v218 offset:6144
    v_add_f32 v157, v157, v213
    v_add_f32 v158, v158, v213
    v_add_f32 v159, v159, v213
    ds_read_b128 a[248:251], v217 offset:7168
    v_cvt_pk_bf16_f32 v162, v140, v141
    v_cvt_pk_bf16_f32 v163, v142, v143
    v_cvt_pk_bf16_f32 v166, v144, v145
    v_cvt_pk_bf16_f32 v167, v146, v147
    v_cvt_pk_bf16_f32 v170, v148, v149
    v_cvt_pk_bf16_f32 v171, v150, v151
    ds_read_b128 a[252:255], v218 offset:7168
    v_cvt_pk_bf16_f32 v174, v152, v153
    v_cvt_pk_bf16_f32 v175, v154, v155
    ds_read_b128 v[240:243], v217 offset:8192
    v_exp_f32 v156, v156
    v_exp_f32 v157, v157
    v_exp_f32 v158, v158
    v_exp_f32 v159, v159
    v_add_f32 v234, v234, v139
    v_cvt_pk_bf16_f32 v192, v136, v137
    v_cvt_pk_bf16_f32 v193, v138, v139
    v_cvt_pk_bf16_f32 v194, v156, v157
    v_cvt_pk_bf16_f32 v195, v158, v159
    v_add_f32 v234, v234, v156
    v_add_f32 v234, v234, v157
    v_add_u32 v217, s36, v217
    v_sub_f32 v214, 0, v212
    s_waitcnt lgkmcnt(5)
    v_mfma_f32_16x16x32_bf16 v[120:123], v[244:247], v[20:23], v[120:123]
    v_sub_f32 v215, 0, v212
    v_add_f32 v234, v234, v158
    v_mfma_f32_16x16x32_bf16 v[124:127], v[244:247], v[44:47], v[124:127]
    v_sub_f32 v212, 0, v212
    v_add_f32 v234, v234, v159
    v_mfma_f32_16x16x32_bf16 v[128:131], v[244:247], v[68:71], v[128:131]
    v_mfma_f32_16x16x32_bf16 v[132:135], v[244:247], v[92:95], v[132:135]
    s_waitcnt lgkmcnt(4)
    v_exp_f32 v120, v120
    v_mfma_f32_16x16x32_bf16 v[140:143], a[240:243], v[0:3], v[196:199]
    s_waitcnt vmcnt(18)
    s_barrier
    v_add_f32 v230, v230, v120
    v_mfma_f32_16x16x32_bf16 v[144:147], a[240:243], v[24:27], v[200:203]
    buffer_load_dwordx4 v216, s[16:19], s31 offen nt lds
    v_mfma_f32_16x16x32_bf16 v[148:151], a[240:243], v[48:51], v[204:207]
    v_exp_f32 v124, v124
    v_mfma_f32_16x16x32_bf16 v[152:155], a[240:243], v[72:75], v[208:211]
    s_waitcnt lgkmcnt(3)
    buffer_load_dwordx4 v216, s[16:19], s31 offen offset:3072 nt lds
    v_mfma_f32_16x16x32_bf16 v[140:143], a[244:247], v[4:7], v[140:143]
    s_add_u32 m0, s39, 896
    v_exp_f32 v121, v121
    v_mfma_f32_16x16x32_bf16 v[144:147], a[244:247], v[28:31], v[144:147]
    buffer_load_dwordx4 v216, s[16:19], s31 offen offset:128 nt lds
    v_mfma_f32_16x16x32_bf16 v[148:151], a[244:247], v[52:55], v[148:151]
    v_exp_f32 v125, v125
    v_mfma_f32_16x16x32_bf16 v[152:155], a[244:247], v[76:79], v[152:155]
    s_waitcnt lgkmcnt(2)
    buffer_load_dwordx4 v216, s[16:19], s31 offen offset:3200 nt lds
    v_mfma_f32_16x16x32_bf16 v[140:143], a[248:251], v[8:11], v[140:143]
    s_add_u32 m0, s39, 1792
    v_add_f32 v231, v231, v124
    v_add_f32 v230, v230, v121
    v_mfma_f32_16x16x32_bf16 v[144:147], a[248:251], v[32:35], v[144:147]
    s_add_u32 s39, s33, s35
    buffer_load_dwordx4 v216, s[16:19], s31 offen offset:256 nt lds
    v_mfma_f32_16x16x32_bf16 v[148:151], a[248:251], v[56:59], v[148:151]
    v_exp_f32 v128, v128
    v_mfma_f32_16x16x32_bf16 v[152:155], a[248:251], v[80:83], v[152:155]
    s_waitcnt lgkmcnt(1)
    buffer_load_dwordx4 v216, s[16:19], s31 offen offset:3328 nt lds
    v_mfma_f32_16x16x32_bf16 v[140:143], a[252:255], v[12:15], v[140:143]
    s_add_u32 m0, s46, 0
    v_exp_f32 v132, v132
    v_mfma_f32_16x16x32_bf16 v[144:147], a[252:255], v[36:39], v[144:147]
    s_add_u32 s31, s31, 12288
    v_exp_f32 v122, v122
    v_mfma_f32_16x16x32_bf16 v[148:151], a[252:255], v[60:63], v[148:151]
    v_exp_f32 v126, v126
    v_mfma_f32_16x16x32_bf16 v[152:155], a[252:255], v[84:87], v[152:155]
    s_waitcnt lgkmcnt(0)
    v_add_f32 v231, v231, v125
    v_add_f32 v232, v232, v128
    v_mfma_f32_16x16x32_bf16 v[140:143], v[240:243], v[16:19], v[140:143]
    s_cmp_eq_u32 s43, 0
    s_cselect_b32 s14, 0, s14
    v_mfma_f32_16x16x32_bf16 v[144:147], v[240:243], v[40:43], v[144:147]
    v_exp_f32 v129, v129
    v_mfma_f32_16x16x32_bf16 v[148:151], v[240:243], v[64:67], v[148:151]
    v_exp_f32 v133, v133
    v_mfma_f32_16x16x32_bf16 v[152:155], v[240:243], v[88:91], v[152:155]
    v_add_f32 v233, v233, v132
    v_exp_f32 v123, v123
    v_add_f32 v230, v230, v122
    v_exp_f32 v127, v127
    ds_read_b128 v[244:247], v218 offset:8192
    v_add_f32 v231, v231, v126
    ds_read_b64_tr_b16 a[240:241], v219 offset:0
    ds_read_b64_tr_b16 a[242:243], v219 offset:6144
    v_exp_f32 v130, v130
    v_add_f32 v232, v232, v129
    ds_read_b64_tr_b16 a[244:245], v220 offset:0
    v_exp_f32 v134, v134
    ds_read_b64_tr_b16 a[246:247], v220 offset:6144
    v_add_f32 v233, v233, v133
    ds_read_b64_tr_b16 a[248:249], v221 offset:0
    ds_read_b64_tr_b16 a[250:251], v221 offset:6144
    v_add_f32 v230, v230, v123
    ds_read_b64_tr_b16 a[252:253], v222 offset:0
    ds_read_b64_tr_b16 a[254:255], v222 offset:6144
    v_add_f32 v231, v231, v127
    ds_read_b64_tr_b16 v[240:241], v219 offset:1024
    v_exp_f32 v131, v131
    ds_read_b64_tr_b16 v[242:243], v219 offset:7168
    v_add_f32 v232, v232, v130
    v_exp_f32 v135, v135
    v_add_f32 v233, v233, v134
    v_add_f32 v232, v232, v131
    v_add_f32 v233, v233, v135
    v_add_u32 v218, s36, v218
    s_cmp_ge_u32 s31, 196608
    s_cselect_b32 s31, 0, s31
    v_cvt_pk_bf16_f32 v176, v120, v121
    v_cvt_pk_bf16_f32 v177, v122, v123
    v_cvt_pk_bf16_f32 v180, v124, v125
    v_cvt_pk_bf16_f32 v181, v126, v127
    v_cvt_pk_bf16_f32 v184, v128, v129
    s_waitcnt lgkmcnt(10)
    v_mfma_f32_16x16x32_bf16 v[140:143], v[244:247], v[20:23], v[140:143]
    v_cvt_pk_bf16_f32 v185, v130, v131
    v_cvt_pk_bf16_f32 v188, v132, v133
    v_mfma_f32_16x16x32_bf16 v[144:147], v[244:247], v[44:47], v[144:147]
    v_cvt_pk_bf16_f32 v189, v134, v135
    v_mfma_f32_16x16x32_bf16 v[148:151], v[244:247], v[68:71], v[148:151]
    v_mfma_f32_16x16x32_bf16 v[152:155], v[244:247], v[92:95], v[152:155]
    s_waitcnt lgkmcnt(8)
    v_exp_f32 v140, v140
    v_mfma_f32_16x16x32_bf16 a[0:3], a[240:243], v[160:163], 0
    v_exp_f32 v144, v144
    v_mfma_f32_16x16x32_bf16 a[48:51], a[240:243], v[164:167], 0
    ds_read_b64_tr_b16 v[244:245], v220 offset:1024
    ds_read_b64_tr_b16 v[246:247], v220 offset:7168
    v_mfma_f32_16x16x32_bf16 a[96:99], a[240:243], v[168:171], 0
    v_exp_f32 v141, v141
    v_mfma_f32_16x16x32_bf16 a[144:147], a[240:243], v[172:175], 0
    v_add_f32 v230, v230, v140
    v_add_f32 v231, v231, v144
    v_mfma_f32_16x16x32_bf16 a[192:195], a[240:243], v[192:195], a[192:195]
    s_waitcnt lgkmcnt(8)
    ds_read_b64_tr_b16 a[240:241], v221 offset:1024
    ds_read_b64_tr_b16 a[242:243], v221 offset:7168
    v_mfma_f32_16x16x32_bf16 a[4:7], a[244:247], v[160:163], 0
    v_exp_f32 v145, v145
    v_mfma_f32_16x16x32_bf16 a[52:55], a[244:247], v[164:167], 0
    v_exp_f32 v148, v148
    v_mfma_f32_16x16x32_bf16 a[100:103], a[244:247], v[168:171], 0
    v_exp_f32 v152, v152
    v_mfma_f32_16x16x32_bf16 a[148:151], a[244:247], v[172:175], 0
    v_exp_f32 v142, v142
    v_mfma_f32_16x16x32_bf16 a[196:199], a[244:247], v[192:195], a[196:199]
    s_waitcnt lgkmcnt(8)
    ds_read_b64_tr_b16 a[244:245], v222 offset:1024
    ds_read_b64_tr_b16 a[246:247], v222 offset:7168
    v_mfma_f32_16x16x32_bf16 a[8:11], a[248:251], v[160:163], 0
    v_add_f32 v230, v230, v141
    v_add_f32 v231, v231, v145
    v_mfma_f32_16x16x32_bf16 a[56:59], a[248:251], v[164:167], 0
    v_exp_f32 v146, v146
    v_mfma_f32_16x16x32_bf16 a[104:107], a[248:251], v[168:171], 0
    v_exp_f32 v149, v149
    v_mfma_f32_16x16x32_bf16 a[152:155], a[248:251], v[172:175], 0
    v_exp_f32 v153, v153
    v_mfma_f32_16x16x32_bf16 a[200:203], a[248:251], v[192:195], a[200:203]
    s_waitcnt lgkmcnt(8)
    ds_read_b64_tr_b16 a[248:249], v219 offset:2048
    ds_read_b64_tr_b16 a[250:251], v219 offset:8192
    v_mfma_f32_16x16x32_bf16 a[12:15], a[252:255], v[160:163], 0
    v_add_f32 v232, v232, v148
    v_add_f32 v233, v233, v152
    v_mfma_f32_16x16x32_bf16 a[60:63], a[252:255], v[164:167], 0
    v_exp_f32 v143, v143
    v_mfma_f32_16x16x32_bf16 a[108:111], a[252:255], v[168:171], 0
    v_add_f32 v230, v230, v142
    v_add_f32 v231, v231, v146
    v_mfma_f32_16x16x32_bf16 a[156:159], a[252:255], v[172:175], 0
    v_exp_f32 v147, v147
    v_mfma_f32_16x16x32_bf16 a[204:207], a[252:255], v[192:195], a[204:207]
    s_waitcnt lgkmcnt(8)
    ds_read_b64_tr_b16 a[252:253], v220 offset:2048
    ds_read_b64_tr_b16 a[254:255], v220 offset:8192
    v_mfma_f32_16x16x32_bf16 a[16:19], v[240:243], v[160:163], 0
    v_exp_f32 v150, v150
    v_mfma_f32_16x16x32_bf16 a[64:67], v[240:243], v[164:167], 0
    v_exp_f32 v154, v154
    v_mfma_f32_16x16x32_bf16 a[112:115], v[240:243], v[168:171], 0
    v_add_f32 v232, v232, v149
    v_add_f32 v233, v233, v153
    v_mfma_f32_16x16x32_bf16 a[160:163], v[240:243], v[172:175], 0
    v_add_f32 v230, v230, v143
    v_cvt_pk_bf16_f32 v178, v140, v141
    v_mfma_f32_16x16x32_bf16 a[208:211], v[240:243], v[192:195], a[208:211]
    s_waitcnt lgkmcnt(8)
    ds_read_b64_tr_b16 v[240:241], v221 offset:2048
    ds_read_b64_tr_b16 v[242:243], v221 offset:8192
    v_mfma_f32_16x16x32_bf16 a[20:23], v[244:247], v[160:163], 0
    v_cvt_pk_bf16_f32 v179, v142, v143
    v_add_f32 v231, v231, v147
    v_mfma_f32_16x16x32_bf16 a[68:71], v[244:247], v[164:167], 0
    v_cvt_pk_bf16_f32 v182, v144, v145
    v_cvt_pk_bf16_f32 v183, v146, v147
    v_mfma_f32_16x16x32_bf16 a[116:119], v[244:247], v[168:171], 0
    v_exp_f32 v151, v151
    v_mfma_f32_16x16x32_bf16 a[164:167], v[244:247], v[172:175], 0
    v_exp_f32 v155, v155
    v_mfma_f32_16x16x32_bf16 a[212:215], v[244:247], v[192:195], a[212:215]
    s_waitcnt lgkmcnt(8)
    ds_read_b64_tr_b16 v[244:245], v222 offset:2048
    ds_read_b64_tr_b16 v[246:247], v222 offset:8192
    v_mfma_f32_16x16x32_bf16 a[24:27], a[240:243], v[160:163], 0
    s_waitcnt vmcnt(18)
    s_barrier
    v_add_f32 v232, v232, v150
    v_mfma_f32_16x16x32_bf16 a[72:75], a[240:243], v[164:167], 0
    buffer_load_dwordx4 v216, s[12:15], s30 offen nt lds
    v_mfma_f32_16x16x32_bf16 a[120:123], a[240:243], v[168:171], 0
    v_add_f32 v233, v233, v154
    v_mfma_f32_16x16x32_bf16 a[168:171], a[240:243], v[172:175], 0
    buffer_load_dwordx4 v216, s[12:15], s30 offen offset:3072 nt lds
    v_mfma_f32_16x16x32_bf16 a[216:219], a[240:243], v[192:195], a[216:219]
    s_waitcnt lgkmcnt(8)
    s_add_u32 m0, s46, 896
    ds_read_b128 a[240:243], v217 offset:0
    v_mfma_f32_16x16x32_bf16 a[28:31], a[244:247], v[160:163], 0
    buffer_load_dwordx4 v216, s[12:15], s30 offen offset:128 nt lds
    v_mfma_f32_16x16x32_bf16 a[76:79], a[244:247], v[164:167], 0
    v_mfma_f32_16x16x32_bf16 a[124:127], a[244:247], v[168:171], 0
    buffer_load_dwordx4 v216, s[12:15], s30 offen offset:3200 nt lds
    v_mfma_f32_16x16x32_bf16 a[172:175], a[244:247], v[172:175], 0
    s_add_u32 m0, s46, 1792
    s_mov_b32 s46, s32
    v_mfma_f32_16x16x32_bf16 a[220:223], a[244:247], v[192:195], a[220:223]
    s_waitcnt lgkmcnt(7)
    buffer_load_dwordx4 v216, s[12:15], s30 offen offset:256 nt lds
    v_mfma_f32_16x16x32_bf16 a[32:35], a[248:251], v[160:163], 0
    ds_read_b128 a[244:247], v218 offset:0
    v_mfma_f32_16x16x32_bf16 a[80:83], a[248:251], v[164:167], 0
    buffer_load_dwordx4 v216, s[12:15], s30 offen offset:3328 nt lds
    v_mfma_f32_16x16x32_bf16 a[128:131], a[248:251], v[168:171], 0
    s_add_u32 s30, s30, 12288
    s_add_u32 m0, s39, 0
    v_mfma_f32_16x16x32_bf16 a[176:179], a[248:251], v[172:175], 0
    v_mfma_f32_16x16x32_bf16 a[224:227], a[248:251], v[192:195], a[224:227]
    s_waitcnt lgkmcnt(6)
    ds_read_b128 a[248:251], v217 offset:1024
    v_mfma_f32_16x16x32_bf16 a[36:39], a[252:255], v[160:163], 0
    v_mfma_f32_16x16x32_bf16 a[84:87], a[252:255], v[164:167], 0
    v_mfma_f32_16x16x32_bf16 a[132:135], a[252:255], v[168:171], 0
    v_mfma_f32_16x16x32_bf16 a[180:183], a[252:255], v[172:175], 0
    v_mfma_f32_16x16x32_bf16 a[228:231], a[252:255], v[192:195], a[228:231]
    s_waitcnt lgkmcnt(5)
    ds_read_b128 a[252:255], v218 offset:1024
    v_mfma_f32_16x16x32_bf16 a[40:43], v[240:243], v[160:163], 0
    v_mfma_f32_16x16x32_bf16 a[88:91], v[240:243], v[164:167], 0
    v_mfma_f32_16x16x32_bf16 a[136:139], v[240:243], v[168:171], 0
    v_mfma_f32_16x16x32_bf16 a[184:187], v[240:243], v[172:175], 0
    v_mfma_f32_16x16x32_bf16 a[232:235], v[240:243], v[192:195], a[232:235]
    s_waitcnt lgkmcnt(4)
    ds_read_b128 v[240:243], v217 offset:2048
    v_mfma_f32_16x16x32_bf16 a[44:47], v[244:247], v[160:163], 0
    v_mfma_f32_16x16x32_bf16 a[92:95], v[244:247], v[164:167], 0
    v_mfma_f32_16x16x32_bf16 a[140:143], v[244:247], v[168:171], 0
    v_mfma_f32_16x16x32_bf16 a[188:191], v[244:247], v[172:175], 0
    v_mfma_f32_16x16x32_bf16 a[236:239], v[244:247], v[192:195], a[236:239]
    s_waitcnt lgkmcnt(4)
    ds_read_b128 v[244:247], v218 offset:2048
    s_branch K_aj0
K_fix0:
    s_waitcnt vmcnt(0) lgkmcnt(0)
    s_barrier
    s_lshl_b32 s37, s68, 4
    s_add_u32 s37, s37, s69
    s_and_b32 s36, s100, 7
    s_lshl_b32 s36, s36, 1
    s_add_u32 s36, s36, s25
    s_lshl_b32 s36, s36, 5
    s_add_u32 s36, s36, s37
    s_mul_i32 s36, s36, 196608
    s_add_u32 s12, s54, s36
    s_addc_u32 s13, s55, 0
    s_mov_b32 s15, 0x00020000
    s_add_u32 s16, s56, s36
    s_addc_u32 s17, s57, 0
    s_mov_b32 s19, 0x00020000
    s_mov_b32 s14, 196608
    s_mov_b32 s18, s14
    s_mul_i32 s45, s25, 9216
    s_lshl_b32 s36, s26, 12
    s_add_u32 s44, s45, s36
    s_add_u32 s45, s45, 8192
    s_xor_b32 s75, s68, 1
    s_mul_i32 s30, s26, 6144
    s_mov_b32 s31, s30
    s_cmp_eq_u32 s25, 0
    s_cselect_b32 s38, 0, 151552
    s_mov_b32 s35, -12288
    s_cselect_b32 s35, 12288, s35
    s_lshl_b32 s37, s35, 1
    s_add_u32 s34, s38, s30
    s_add_u32 s32, s34, s37
    s_add_u32 s33, s32, s37
    s_lshl_b32 s47, s24, 13
    s_xor_b32 s48, s47, 0x2000
    s_mul_i32 s36, s25, 6144
    s_add_u32 s36, s36, 73728
    v_mbcnt_lo_u32_b32 v120, -1, 0
    v_mbcnt_hi_u32_b32 v120, -1, v120
    v_lshlrev_b32 v248, 4, v120
    v_add_u32 v229, s36, v248
    v_add_u32 v251, 49152, v248
    v_add_u32 v249, s47, v251
    v_add_u32 v250, s48, v251
    v_lshrrev_b32 v121, 3, v120
    v_and_b32 v122, 7, v120
    v_and_b32 v123, 6, v121
    v_xor_b32 v123, v122, v123
    v_lshlrev_b32 v123, 4, v123
    v_mul_u32_u24 v216, 384, v121
    v_add_u32 v216, v216, v123
    v_and_b32 v121, 15, v120
    v_lshrrev_b32 v122, 4, v120
    v_and_b32 v123, 7, v121
    v_and_b32 v124, 6, v121
    v_xor_b32 v124, v122, v124
    v_lshl_add_u32 v124, v123, 3, v124
    v_lshlrev_b32 v124, 4, v124
    v_xor_b32 v125, 64, v124
    v_lshrrev_b32 v126, 3, v121
    v_mul_u32_u24 v127, 3072, v126
    v_add_u32 v127, s38, v127
    v_add_u32 v217, v127, v124
    v_add_u32 v218, v127, v125
    v_lshlrev_b32 v127, 10, v126
    v_add_u32 v128, s40, v127
    v_add_u32 v225, v128, v124
    v_add_u32 v226, v128, v125
    v_bfe_u32 v123, v120, 2, 2
    v_and_b32 v124, 3, v120
    v_and_b32 v125, 1, v122
    v_lshl_add_u32 v126, v125, 2, v123
    v_and_b32 v127, 6, v126
    v_lshrrev_b32 v128, 1, v124
    v_xor_b32 v127, v127, v128
    v_lshl_add_u32 v127, v126, 3, v127
    v_lshlrev_b32 v127, 4, v127
    v_and_b32 v128, 1, v124
    v_lshl_add_u32 v127, v128, 3, v127
    v_lshrrev_b32 v128, 1, v122
    v_mul_u32_u24 v128, 3072, v128
    s_add_u32 s36, s38, s35
    v_add_u32 v128, s36, v128
    v_xor_b32 v129, 0, v127
    v_add_u32 v219, v128, v129
    v_xor_b32 v129, 32, v127
    v_add_u32 v220, v128, v129
    v_xor_b32 v129, 64, v127
    v_add_u32 v221, v128, v129
    v_xor_b32 v129, 96, v127
    v_add_u32 v222, v128, v129
    v_lshlrev_b32 v127, 2, v125
    v_xor_b32 v127, v127, v124
    v_lshl_add_u32 v127, v123, 3, v127
    v_lshlrev_b32 v127, 4, v127
    v_mul_u32_u24 v128, 3072, v122
    v_add_u32 v128, 36864, v128
    v_add_u32 v227, v128, v127
    v_xor_b32 v127, 64, v127
    v_add_u32 v228, v128, v127
    s_mov_b32 s51, 0
    s_mov_b32 s46, -36864
    s_mov_b32 s42, 0x3dd53b95
    s_mul_i32 s36, s100, 0
    s_mul_i32 s37, s69, 0
    s_add_u32 s36, s36, s37
    s_mul_i32 s37, s25, 0
    s_add_u32 s36, s36, s37
    s_and_b32 s37, s36, 15
    s_mul_i32 s37, s37, 12288
    s_add_u32 s48, s30, s37
    s_mov_b32 s30, s48
    s_mov_b32 s31, s48
    s_add_u32 s38, s44, 0
    buffer_store_dwordx4 v[0:3], v248, s[20:23], s38 offen sc1
    buffer_store_dwordx4 v[24:27], v248, s[20:23], s38 offen offset:1024 sc1
    buffer_store_dwordx4 v[48:51], v248, s[20:23], s38 offen offset:2048 sc1
    buffer_store_dwordx4 v[72:75], v248, s[20:23], s38 offen offset:3072 sc1
    s_add_u32 s38, s44, 18432
    buffer_store_dwordx4 v[4:7], v248, s[20:23], s38 offen sc1
    buffer_store_dwordx4 v[28:31], v248, s[20:23], s38 offen offset:1024 sc1
    buffer_store_dwordx4 v[52:55], v248, s[20:23], s38 offen offset:2048 sc1
    buffer_store_dwordx4 v[76:79], v248, s[20:23], s38 offen offset:3072 sc1
    s_add_u32 s38, s44, 36864
    buffer_store_dwordx4 v[8:11], v248, s[20:23], s38 offen sc1
    buffer_store_dwordx4 v[32:35], v248, s[20:23], s38 offen offset:1024 sc1
    buffer_store_dwordx4 v[56:59], v248, s[20:23], s38 offen offset:2048 sc1
    buffer_store_dwordx4 v[80:83], v248, s[20:23], s38 offen offset:3072 sc1
    s_add_u32 s38, s44, 55296
    buffer_store_dwordx4 v[12:15], v248, s[20:23], s38 offen sc1
    buffer_store_dwordx4 v[36:39], v248, s[20:23], s38 offen offset:1024 sc1
    buffer_store_dwordx4 v[60:63], v248, s[20:23], s38 offen offset:2048 sc1
    buffer_store_dwordx4 v[84:87], v248, s[20:23], s38 offen offset:3072 sc1
    s_add_u32 s38, s44, 73728
    buffer_store_dwordx4 v[16:19], v248, s[20:23], s38 offen sc1
    buffer_store_dwordx4 v[40:43], v248, s[20:23], s38 offen offset:1024 sc1
    buffer_store_dwordx4 v[64:67], v248, s[20:23], s38 offen offset:2048 sc1
    buffer_store_dwordx4 v[88:91], v248, s[20:23], s38 offen offset:3072 sc1
    s_add_u32 s38, s44, 92160
    buffer_store_dwordx4 v[20:23], v248, s[20:23], s38 offen sc1
    buffer_store_dwordx4 v[44:47], v248, s[20:23], s38 offen offset:1024 sc1
    buffer_store_dwordx4 v[68:71], v248, s[20:23], s38 offen offset:2048 sc1
    buffer_store_dwordx4 v[92:95], v248, s[20:23], s38 offen offset:3072 sc1
    s_add_u32 s38, s45, 0
    buffer_store_dwordx4 v[96:99], v248, s[20:23], s38 offen sc1
    s_add_u32 s38, s45, 18432
    buffer_store_dwordx4 v[100:103], v248, s[20:23], s38 offen sc1
    s_add_u32 s38, s45, 36864
    buffer_store_dwordx4 v[104:107], v248, s[20:23], s38 offen sc1
    v_and_b32 v121, 15, v120
    v_lshrrev_b32 v122, 4, v120
    v_mul_u32_u24 v121, 384, v121
    v_lshl_add_u32 v121, v122, 4, v121
    v_mov_b32 v235, 0xff7fffff
    v_mov_b32 v236, 0xff7fffff
    v_mov_b32 v237, 0xff7fffff
    v_mov_b32 v238, 0xff7fffff
    v_mov_b32 v239, 0xff7fffff
    s_mov_b32 s38, 0
K_fixl0:
    buffer_load_dwordx4 v[160:163], v121, s[12:15], s38 offen offset:0
    buffer_load_dwordx4 v[164:167], v121, s[12:15], s38 offen offset:64
    buffer_load_dwordx4 v[168:171], v121, s[12:15], s38 offen offset:128
    buffer_load_dwordx4 v[172:175], v121, s[12:15], s38 offen offset:192
    buffer_load_dwordx4 v[176:179], v121, s[12:15], s38 offen offset:256
    buffer_load_dwordx4 v[180:183], v121, s[12:15], s38 offen offset:320
    s_waitcnt vmcnt(0)
    v_mfma_f32_16x16x32_bf16 v[124:127], v[160:163], v[0:3], 0
    v_mfma_f32_16x16x32_bf16 v[128:131], v[160:163], v[24:27], 0
    v_mfma_f32_16x16x32_bf16 v[132:135], v[160:163], v[48:51], 0
    v_mfma_f32_16x16x32_bf16 v[136:139], v[160:163], v[72:75], 0
    v_mfma_f32_16x16x32_bf16 v[140:143], v[160:163], v[96:99], 0
    v_mfma_f32_16x16x32_bf16 v[124:127], v[164:167], v[4:7], v[124:127]
    v_mfma_f32_16x16x32_bf16 v[128:131], v[164:167], v[28:31], v[128:131]
    v_mfma_f32_16x16x32_bf16 v[132:135], v[164:167], v[52:55], v[132:135]
    v_mfma_f32_16x16x32_bf16 v[136:139], v[164:167], v[76:79], v[136:139]
    v_mfma_f32_16x16x32_bf16 v[140:143], v[164:167], v[100:103], v[140:143]
    v_mfma_f32_16x16x32_bf16 v[124:127], v[168:171], v[8:11], v[124:127]
    v_mfma_f32_16x16x32_bf16 v[128:131], v[168:171], v[32:35], v[128:131]
    v_mfma_f32_16x16x32_bf16 v[132:135], v[168:171], v[56:59], v[132:135]
    v_mfma_f32_16x16x32_bf16 v[136:139], v[168:171], v[80:83], v[136:139]
    v_mfma_f32_16x16x32_bf16 v[140:143], v[168:171], v[104:107], v[140:143]
    v_mfma_f32_16x16x32_bf16 v[124:127], v[172:175], v[12:15], v[124:127]
    v_mfma_f32_16x16x32_bf16 v[128:131], v[172:175], v[36:39], v[128:131]
    v_mfma_f32_16x16x32_bf16 v[132:135], v[172:175], v[60:63], v[132:135]
    v_mfma_f32_16x16x32_bf16 v[136:139], v[172:175], v[84:87], v[136:139]
    v_mfma_f32_16x16x32_bf16 v[140:143], v[172:175], v[108:111], v[140:143]
    v_mfma_f32_16x16x32_bf16 v[124:127], v[176:179], v[16:19], v[124:127]
    v_mfma_f32_16x16x32_bf16 v[128:131], v[176:179], v[40:43], v[128:131]
    v_mfma_f32_16x16x32_bf16 v[132:135], v[176:179], v[64:67], v[132:135]
    v_mfma_f32_16x16x32_bf16 v[136:139], v[176:179], v[88:91], v[136:139]
    v_mfma_f32_16x16x32_bf16 v[140:143], v[176:179], v[112:115], v[140:143]
    v_mfma_f32_16x16x32_bf16 v[124:127], v[180:183], v[20:23], v[124:127]
    v_mfma_f32_16x16x32_bf16 v[128:131], v[180:183], v[44:47], v[128:131]
    v_mfma_f32_16x16x32_bf16 v[132:135], v[180:183], v[68:71], v[132:135]
    v_mfma_f32_16x16x32_bf16 v[136:139], v[180:183], v[92:95], v[136:139]
    v_mfma_f32_16x16x32_bf16 v[140:143], v[180:183], v[116:119], v[140:143]
    s_nop 15
    v_max3_f32 v235, v235, v124, v125
    v_max3_f32 v235, v235, v126, v127
    v_max3_f32 v236, v236, v128, v129
    v_max3_f32 v236, v236, v130, v131
    v_max3_f32 v237, v237, v132, v133
    v_max3_f32 v237, v237, v134, v135
    v_max3_f32 v238, v238, v136, v137
    v_max3_f32 v238, v238, v138, v139
    v_max3_f32 v239, v239, v140, v141
    v_max3_f32 v239, v239, v142, v143
    s_add_u32 s38, s38, 6144
    s_cmp_lt_u32 s38, 196608
    s_cbranch_scc1 K_fixl0
    s_mov_b32 s72, 0x7f800000
    s_waitcnt vmcnt(0)
    s_barrier
    s_branch K_ra0
K_ra1:
    s_add_u32 m0, s34, 0
    s_add_u32 s38, s44, 0
    buffer_load_dwordx4 v216, s[12:15], s30 offen nt lds
    buffer_load_dwordx4 v216, s[12:15], s30 offen offset:3072 nt lds
    s_add_u32 m0, s34, 896
    s_add_u32 s74, s45, 0
    buffer_load_dwordx4 v216, s[12:15], s30 offen offset:128 nt lds
    buffer_load_dwordx4 v216, s[12:15], s30 offen offset:3200 nt lds
    s_add_u32 m0, s34, 1792
    s_add_u32 s39, s34, s35
    buffer_load_dwordx4 v216, s[12:15], s30 offen offset:256 nt lds
    buffer_load_dwordx4 v216, s[12:15], s30 offen offset:3328 nt lds
    buffer_load_dwordx4 v[0:3], v248, s[20:23], s38 offen sc1
    buffer_load_dwordx4 v[24:27], v248, s[20:23], s38 offen offset:1024 sc1
    buffer_load_dwordx4 v[48:51], v248, s[20:23], s38 offen offset:2048 sc1
    buffer_load_dwordx4 v[72:75], v248, s[20:23], s38 offen offset:3072 sc1
    buffer_load_dwordx4 v[96:99], v248, s[20:23], s74 offen sc1
    s_add_u32 s38, s44, 18432
    buffer_load_dwordx4 v[4:7], v248, s[20:23], s38 offen sc1
    buffer_load_dwordx4 v[28:31], v248, s[20:23], s38 offen offset:1024 sc1
    buffer_load_dwordx4 v[52:55], v248, s[20:23], s38 offen offset:2048 sc1
    buffer_load_dwordx4 v[76:79], v248, s[20:23], s38 offen offset:3072 sc1
    s_add_u32 s74, s45, 18432
    buffer_load_dwordx4 v[100:103], v248, s[20:23], s74 offen sc1
    s_add_u32 s38, s44, 36864
    buffer_load_dwordx4 v[8:11], v248, s[20:23], s38 offen sc1
    buffer_load_dwordx4 v[32:35], v248, s[20:23], s38 offen offset:1024 sc1
    buffer_load_dwordx4 v[56:59], v248, s[20:23], s38 offen offset:2048 sc1
    buffer_load_dwordx4 v[80:83], v248, s[20:23], s38 offen offset:3072 sc1
    s_add_u32 s74, s45, 36864
    buffer_load_dwordx4 v[104:107], v248, s[20:23], s74 offen sc1
    s_add_u32 s38, s44, 55296
    buffer_load_dwordx4 v[12:15], v248, s[20:23], s38 offen sc1
    buffer_load_dwordx4 v[36:39], v248, s[20:23], s38 offen offset:1024 sc1
    buffer_load_dwordx4 v[60:63], v248, s[20:23], s38 offen offset:2048 sc1
    buffer_load_dwordx4 v[84:87], v248, s[20:23], s38 offen offset:3072 sc1
    s_add_u32 s74, s45, 55296
    buffer_load_dwordx4 v[108:111], v248, s[20:23], s74 offen sc1
    s_add_u32 s38, s44, 73728
    buffer_load_dwordx4 v[16:19], v248, s[20:23], s38 offen sc1
    buffer_load_dwordx4 v[40:43], v248, s[20:23], s38 offen offset:1024 sc1
    buffer_load_dwordx4 v[64:67], v248, s[20:23], s38 offen offset:2048 sc1
    buffer_load_dwordx4 v[88:91], v248, s[20:23], s38 offen offset:3072 sc1
    s_add_u32 s74, s45, 73728
    buffer_load_dwordx4 v[112:115], v248, s[20:23], s74 offen sc1
    s_add_u32 s38, s44, 92160
    buffer_load_dwordx4 v[20:23], v248, s[20:23], s38 offen sc1
    buffer_load_dwordx4 v[44:47], v248, s[20:23], s38 offen offset:1024 sc1
    buffer_load_dwordx4 v[68:71], v248, s[20:23], s38 offen offset:2048 sc1
    buffer_load_dwordx4 v[92:95], v248, s[20:23], s38 offen offset:3072 sc1
    s_add_u32 s74, s45, 92160
    buffer_load_dwordx4 v[116:119], v248, s[20:23], s74 offen sc1
    s_add_u32 s30, s30, 12288
    s_add_u32 m0, s32, 0
    s_cmp_ge_u32 s30, 196608
    s_cselect_b32 s30, 6144, s30
    buffer_load_dwordx4 v216, s[12:15], s30 offen nt lds
    buffer_load_dwordx4 v216, s[12:15], s30 offen offset:3072 nt lds
    s_add_u32 m0, s32, 896
    s_waitcnt vmcnt(32)
    buffer_load_dwordx4 v216, s[12:15], s30 offen offset:128 nt lds
    buffer_load_dwordx4 v216, s[12:15], s30 offen offset:3200 nt lds
    s_add_u32 m0, s32, 1792
    s_barrier
    buffer_load_dwordx4 v216, s[12:15], s30 offen offset:256 nt lds
    buffer_load_dwordx4 v216, s[12:15], s30 offen offset:3328 nt lds
    s_add_u32 m0, s39, 0
    s_add_u32 s30, s30, 12288
    s_cmp_ge_u32 s30, 196608
    s_cselect_b32 s30, 6144, s30
    v_mov_b32 v230, 0
    v_mov_b32 v231, 0
    v_mov_b32 v232, 0
    ds_read_b128 a[240:243], v217 offset:0
    v_mov_b32 v233, 0
    ds_read_b128 a[244:247], v218 offset:0
    ds_read_b128 a[248:251], v217 offset:1024
    ds_read_b128 v[240:243], v217 offset:2048
    ds_read_b128 a[252:255], v218 offset:1024
    ds_read_b128 v[244:247], v218 offset:2048
    s_sub_u32 s36, s32, s34
    s_mov_b32 s46, s32
    s_mov_b32 s37, s36
    v_mov_b32 v234, 0
    v_accvgpr_write_b32 a192, 0
    v_accvgpr_write_b32 a193, 0
    v_accvgpr_write_b32 a194, 0
    v_accvgpr_write_b32 a195, 0
    v_accvgpr_write_b32 a196, 0
    v_accvgpr_write_b32 a197, 0
    v_accvgpr_write_b32 a198, 0
    v_accvgpr_write_b32 a199, 0
    v_accvgpr_write_b32 a200, 0
    v_accvgpr_write_b32 a201, 0
    v_accvgpr_write_b32 a202, 0
    v_accvgpr_write_b32 a203, 0
    v_accvgpr_write_b32 a204, 0
    v_accvgpr_write_b32 a205, 0
    v_accvgpr_write_b32 a206, 0
    v_accvgpr_write_b32 a207, 0
    v_accvgpr_write_b32 a208, 0
    v_accvgpr_write_b32 a209, 0
    v_accvgpr_write_b32 a210, 0
    v_accvgpr_write_b32 a211, 0
    v_accvgpr_write_b32 a212, 0
    v_accvgpr_write_b32 a213, 0
    v_accvgpr_write_b32 a214, 0
    v_accvgpr_write_b32 a215, 0
    v_accvgpr_write_b32 a216, 0
    v_accvgpr_write_b32 a217, 0
    v_accvgpr_write_b32 a218, 0
    v_accvgpr_write_b32 a219, 0
    v_accvgpr_write_b32 a220, 0
    v_accvgpr_write_b32 a221, 0
    v_accvgpr_write_b32 a222, 0
    v_accvgpr_write_b32 a223, 0
    v_accvgpr_write_b32 a224, 0
    v_accvgpr_write_b32 a225, 0
    v_accvgpr_write_b32 a226, 0
    v_accvgpr_write_b32 a227, 0
    v_accvgpr_write_b32 a228, 0
    v_accvgpr_write_b32 a229, 0
    v_accvgpr_write_b32 a230, 0
    v_accvgpr_write_b32 a231, 0
    v_accvgpr_write_b32 a232, 0
    v_accvgpr_write_b32 a233, 0
    s_waitcnt lgkmcnt(5)
    s_waitcnt vmcnt(35)
    v_mfma_f32_16x16x32_bf16 v[120:123], a[240:243], v[0:3], 0
    buffer_load_dwordx4 v216, s[16:19], s31 offen nt lds
    s_waitcnt vmcnt(35)
    v_mfma_f32_16x16x32_bf16 v[124:127], a[240:243], v[24:27], 0
    v_accvgpr_write_b32 a234, 0
    v_accvgpr_write_b32 a235, 0
    s_waitcnt vmcnt(34)
    v_mfma_f32_16x16x32_bf16 v[128:131], a[240:243], v[48:51], 0
    v_accvgpr_write_b32 a236, 0
    v_accvgpr_write_b32 a237, 0
    s_waitcnt vmcnt(33)
    v_mfma_f32_16x16x32_bf16 v[132:135], a[240:243], v[72:75], 0
    buffer_load_dwordx4 v216, s[16:19], s31 offen offset:3072 nt lds
    s_waitcnt vmcnt(33)
    v_mfma_f32_16x16x32_bf16 v[136:139], a[240:243], v[96:99], 0
    s_waitcnt lgkmcnt(4)
    s_add_u32 m0, s39, 896
    ds_read_b128 a[240:243], v217 offset:6144
    s_waitcnt vmcnt(32)
    v_mfma_f32_16x16x32_bf16 v[120:123], a[244:247], v[4:7], v[120:123]
    v_accvgpr_write_b32 a238, 0
    v_accvgpr_write_b32 a239, 0
    s_waitcnt vmcnt(31)
    v_mfma_f32_16x16x32_bf16 v[124:127], a[244:247], v[28:31], v[124:127]
    buffer_load_dwordx4 v216, s[16:19], s31 offen offset:128 nt lds
    s_waitcnt vmcnt(31)
    v_mfma_f32_16x16x32_bf16 v[128:131], a[244:247], v[52:55], v[128:131]
    s_waitcnt vmcnt(30)
    v_mfma_f32_16x16x32_bf16 v[132:135], a[244:247], v[76:79], v[132:135]
    s_waitcnt vmcnt(29)
    v_mfma_f32_16x16x32_bf16 v[136:139], a[244:247], v[100:103], v[136:139]
    s_waitcnt lgkmcnt(4)
    buffer_load_dwordx4 v216, s[16:19], s31 offen offset:3200 nt lds
    s_waitcnt vmcnt(29)
    v_mfma_f32_16x16x32_bf16 v[120:123], a[248:251], v[8:11], v[120:123]
    s_add_u32 m0, s39, 1792
    s_add_u32 s39, s32, s35
    ds_read_b128 a[244:247], v218 offset:6144
    s_waitcnt vmcnt(28)
    v_mfma_f32_16x16x32_bf16 v[124:127], a[248:251], v[32:35], v[124:127]
    s_waitcnt vmcnt(27)
    v_mfma_f32_16x16x32_bf16 v[128:131], a[248:251], v[56:59], v[128:131]
    buffer_load_dwordx4 v216, s[16:19], s31 offen offset:256 nt lds
    s_waitcnt vmcnt(27)
    v_mfma_f32_16x16x32_bf16 v[132:135], a[248:251], v[80:83], v[132:135]
    s_waitcnt vmcnt(26)
    v_mfma_f32_16x16x32_bf16 v[136:139], a[248:251], v[104:107], v[136:139]
    s_waitcnt lgkmcnt(3)
    ds_read_b128 a[248:251], v217 offset:7168
    s_waitcnt vmcnt(25)
    v_mfma_f32_16x16x32_bf16 v[120:123], a[252:255], v[12:15], v[120:123]
    buffer_load_dwordx4 v216, s[16:19], s31 offen offset:3328 nt lds
    s_waitcnt vmcnt(25)
    v_mfma_f32_16x16x32_bf16 v[124:127], a[252:255], v[36:39], v[124:127]
    s_add_u32 m0, s33, 0
    s_add_u32 s31, s31, 12288
    s_waitcnt vmcnt(24)
    v_mfma_f32_16x16x32_bf16 v[128:131], a[252:255], v[60:63], v[128:131]
    s_cmp_ge_u32 s31, 196608
    s_cselect_b32 s31, 6144, s31
    s_waitcnt vmcnt(23)
    v_mfma_f32_16x16x32_bf16 v[132:135], a[252:255], v[84:87], v[132:135]
    buffer_load_dwordx4 v216, s[12:15], s30 offen nt lds
    s_waitcnt vmcnt(23)
    v_mfma_f32_16x16x32_bf16 v[136:139], a[252:255], v[108:111], v[136:139]
    ds_read_b128 a[252:255], v218 offset:7168
    s_waitcnt vmcnt(22)
    v_mfma_f32_16x16x32_bf16 v[120:123], v[240:243], v[16:19], v[120:123]
    s_waitcnt vmcnt(21)
    v_mfma_f32_16x16x32_bf16 v[124:127], v[240:243], v[40:43], v[124:127]
    buffer_load_dwordx4 v216, s[12:15], s30 offen offset:3072 nt lds
    s_waitcnt vmcnt(21)
    v_mfma_f32_16x16x32_bf16 v[128:131], v[240:243], v[64:67], v[128:131]
    s_add_u32 m0, s33, 896
    s_waitcnt vmcnt(20)
    v_mfma_f32_16x16x32_bf16 v[132:135], v[240:243], v[88:91], v[132:135]
    s_waitcnt vmcnt(19)
    v_mfma_f32_16x16x32_bf16 v[136:139], v[240:243], v[112:115], v[136:139]
    s_waitcnt lgkmcnt(4)
    buffer_load_dwordx4 v216, s[12:15], s30 offen offset:128 nt lds
    s_waitcnt vmcnt(19)
    v_mfma_f32_16x16x32_bf16 v[120:123], v[244:247], v[20:23], v[120:123]
    ds_read_b128 v[240:243], v217 offset:8192
    v_add_u32 v217, s36, v217
    s_waitcnt vmcnt(18)
    v_mfma_f32_16x16x32_bf16 v[124:127], v[244:247], v[44:47], v[124:127]
    s_waitcnt vmcnt(17)
    v_mfma_f32_16x16x32_bf16 v[128:131], v[244:247], v[68:71], v[128:131]
    buffer_load_dwordx4 v216, s[12:15], s30 offen offset:3200 nt lds
    s_waitcnt vmcnt(17)
    v_mfma_f32_16x16x32_bf16 v[132:135], v[244:247], v[92:95], v[132:135]
    s_add_u32 m0, s33, 1792
    v_max3_f32 v196, v120, v121, v122
    v_max3_f32 v196, v196, v123, v235
    s_waitcnt vmcnt(16)
    v_mfma_f32_16x16x32_bf16 v[136:139], v[244:247], v[116:119], v[136:139]
    s_waitcnt lgkmcnt(4)
    v_max3_f32 v200, v124, v125, v126
    v_max3_f32 v200, v200, v127, v236
    v_mfma_f32_16x16x32_bf16 v[140:143], a[240:243], v[0:3], 0
    s_waitcnt vmcnt(10)
    s_barrier
    v_mov_b32 v197, v196
    v_mfma_f32_16x16x32_bf16 v[144:147], a[240:243], v[24:27], 0
    buffer_load_dwordx4 v216, s[12:15], s30 offen offset:256 nt lds
    v_mfma_f32_16x16x32_bf16 v[148:151], a[240:243], v[48:51], 0
    v_mov_b32 v201, v200
    v_max3_f32 v204, v128, v129, v130
    v_mfma_f32_16x16x32_bf16 v[152:155], a[240:243], v[72:75], 0
    buffer_load_dwordx4 v216, s[12:15], s30 offen offset:3328 nt lds
    v_mfma_f32_16x16x32_bf16 v[156:159], a[240:243], v[96:99], 0
    s_waitcnt lgkmcnt(3)
    s_add_u32 m0, s39, 0
    v_max3_f32 v208, v132, v133, v134
    v_mfma_f32_16x16x32_bf16 v[140:143], a[244:247], v[4:7], v[140:143]
    s_add_u32 s30, s30, 12288
    v_permlane32_swap_b32 v196, v197
    v_mfma_f32_16x16x32_bf16 v[144:147], a[244:247], v[28:31], v[144:147]
    buffer_load_dwordx4 v216, s[16:19], s31 offen nt lds
    v_mfma_f32_16x16x32_bf16 v[148:151], a[244:247], v[52:55], v[148:151]
    v_permlane32_swap_b32 v200, v201
    v_mfma_f32_16x16x32_bf16 v[152:155], a[244:247], v[76:79], v[152:155]
    v_max3_f32 v204, v204, v131, v237
    v_max3_f32 v208, v208, v135, v238
    v_mfma_f32_16x16x32_bf16 v[156:159], a[244:247], v[100:103], v[156:159]
    s_waitcnt lgkmcnt(2)
    buffer_load_dwordx4 v216, s[16:19], s31 offen offset:3072 nt lds
    v_mfma_f32_16x16x32_bf16 v[140:143], a[248:251], v[8:11], v[140:143]
    s_add_u32 m0, s39, 896
    v_max_f32 v196, v196, v197
    v_max_f32 v200, v200, v201
    v_mfma_f32_16x16x32_bf16 v[144:147], a[248:251], v[32:35], v[144:147]
    v_mov_b32 v205, v204
    v_mov_b32 v209, v208
    v_mfma_f32_16x16x32_bf16 v[148:151], a[248:251], v[56:59], v[148:151]
    buffer_load_dwordx4 v216, s[16:19], s31 offen offset:128 nt lds
    v_mfma_f32_16x16x32_bf16 v[152:155], a[248:251], v[80:83], v[152:155]
    v_mov_b32 v197, v196
    v_mov_b32 v201, v200
    v_mfma_f32_16x16x32_bf16 v[156:159], a[248:251], v[104:107], v[156:159]
    s_waitcnt lgkmcnt(1)
    v_permlane32_swap_b32 v204, v205
    v_mfma_f32_16x16x32_bf16 v[140:143], a[252:255], v[12:15], v[140:143]
    buffer_load_dwordx4 v216, s[16:19], s31 offen offset:3200 nt lds
    v_mfma_f32_16x16x32_bf16 v[144:147], a[252:255], v[36:39], v[144:147]
    s_add_u32 m0, s39, 1792
    v_permlane32_swap_b32 v208, v209
    v_mfma_f32_16x16x32_bf16 v[148:151], a[252:255], v[60:63], v[148:151]
    s_add_u32 s39, s33, s35
    v_permlane16_swap_b32 v196, v197
    v_mfma_f32_16x16x32_bf16 v[152:155], a[252:255], v[84:87], v[152:155]
    buffer_load_dwordx4 v216, s[16:19], s31 offen offset:256 nt lds
    v_mfma_f32_16x16x32_bf16 v[156:159], a[252:255], v[108:111], v[156:159]
    s_waitcnt lgkmcnt(0)
    s_cmp_ge_u32 s30, 196608
    s_cselect_b32 s30, 6144, s30
    v_mfma_f32_16x16x32_bf16 v[140:143], v[240:243], v[16:19], v[140:143]
    v_permlane16_swap_b32 v200, v201
    v_mfma_f32_16x16x32_bf16 v[144:147], v[240:243], v[40:43], v[144:147]
    buffer_load_dwordx4 v216, s[16:19], s31 offen offset:3328 nt lds
    v_mfma_f32_16x16x32_bf16 v[148:151], v[240:243], v[64:67], v[148:151]
    s_add_u32 m0, s34, 0
    v_max_f32 v204, v204, v205
    v_max_f32 v208, v208, v209
    v_mfma_f32_16x16x32_bf16 v[152:155], v[240:243], v[88:91], v[152:155]
    s_add_u32 s31, s31, 12288
    v_mov_b32 v205, v204
    v_max_f32 v196, v196, v197
    v_mfma_f32_16x16x32_bf16 v[156:159], v[240:243], v[112:115], v[156:159]
    v_max_f32 v200, v200, v201
    v_mov_b32 v209, v208
    v_permlane16_swap_b32 v204, v205
    v_sub_f32 v197, 0, v196
    v_sub_f32 v201, 0, v200
    v_permlane16_swap_b32 v208, v209
    v_max_f32 v204, v204, v205
    v_add_f32 v120, v120, v197
    v_add_f32 v124, v124, v201
    v_max3_f32 v212, v136, v137, v138
    v_sub_f32 v205, 0, v204
    v_max_f32 v208, v208, v209
    v_exp_f32 v120, v120
    v_add_f32 v121, v121, v197
    v_exp_f32 v124, v124
    v_add_f32 v125, v125, v201
    v_max3_f32 v212, v212, v139, v239
    v_add_f32 v128, v128, v205
    v_sub_f32 v209, 0, v208
    v_add_f32 v122, v122, v197
    v_exp_f32 v121, v121
    v_add_f32 v230, v230, v120
    v_add_f32 v126, v126, v201
    v_exp_f32 v125, v125
    v_mov_b32 v213, v212
    v_add_f32 v231, v231, v124
    v_exp_f32 v128, v128
    v_add_f32 v129, v129, v205
    v_add_f32 v132, v132, v209
    v_add_f32 v123, v123, v197
    v_exp_f32 v122, v122
    v_add_f32 v230, v230, v121
    v_add_f32 v127, v127, v201
    v_exp_f32 v126, v126
    v_permlane32_swap_b32 v212, v213
    v_add_f32 v231, v231, v125
    v_add_f32 v130, v130, v205
    v_exp_f32 v129, v129
    v_add_f32 v232, v232, v128
    v_exp_f32 v132, v132
    v_add_f32 v133, v133, v209
    v_exp_f32 v123, v123
    s_cmp_ge_u32 s31, 196608
    s_cselect_b32 s31, 6144, s31
    v_add_f32 v230, v230, v122
    v_exp_f32 v127, v127
    v_add_f32 v231, v231, v126
    v_max_f32 v212, v212, v213
    v_add_f32 v131, v131, v205
    v_exp_f32 v130, v130
    v_add_f32 v232, v232, v129
    v_exp_f32 v133, v133
    v_add_f32 v134, v134, v209
    v_add_f32 v233, v233, v132
    v_add_f32 v230, v230, v123
    v_add_f32 v231, v231, v127
    v_mov_b32 v213, v212
    v_exp_f32 v131, v131
    v_add_f32 v232, v232, v130
    v_add_f32 v135, v135, v209
    v_exp_f32 v134, v134
    v_add_f32 v233, v233, v133
    v_permlane16_swap_b32 v212, v213
    ds_read_b128 v[244:247], v218 offset:8192
    v_add_f32 v232, v232, v131
    v_exp_f32 v135, v135
    v_add_f32 v233, v233, v134
    v_max_f32 v212, v212, v213
    v_add_u32 v218, s36, v218
    v_sub_f32 v198, 0, v196
    v_sub_f32 v199, 0, v196
    v_sub_f32 v202, 0, v200
    v_sub_f32 v203, 0, v200
    v_add_f32 v233, v233, v135
    v_sub_f32 v206, 0, v204
    v_sub_f32 v207, 0, v204
    v_sub_f32 v210, 0, v208
    v_sub_f32 v211, 0, v208
    ds_read_b128 a[240:243], v217 offset:0
    v_sub_f32 v213, 0, v212
    v_sub_f32 v214, 0, v212
    v_sub_f32 v215, 0, v212
    ds_read_b128 a[244:247], v218 offset:0
    v_sub_f32 v196, 0, v196
    v_cvt_pk_bf16_f32 v160, v120, v121
    v_cvt_pk_bf16_f32 v161, v122, v123
    ds_read_b128 a[248:251], v217 offset:1024
    v_sub_f32 v200, 0, v200
    v_cvt_pk_bf16_f32 v164, v124, v125
    v_cvt_pk_bf16_f32 v165, v126, v127
    v_sub_f32 v204, 0, v204
    v_cvt_pk_bf16_f32 v168, v128, v129
    v_cvt_pk_bf16_f32 v169, v130, v131
    v_sub_f32 v208, 0, v208
    v_cvt_pk_bf16_f32 v172, v132, v133
    v_cvt_pk_bf16_f32 v173, v134, v135
    v_sub_f32 v212, 0, v212
    v_add_f32 v136, v136, v213
    s_waitcnt lgkmcnt(3)
    v_mfma_f32_16x16x32_bf16 v[140:143], v[244:247], v[20:23], v[140:143]
    v_add_f32 v137, v137, v213
    v_add_f32 v138, v138, v213
    v_mfma_f32_16x16x32_bf16 v[144:147], v[244:247], v[44:47], v[144:147]
    s_sub_u32 s36, s33, s32
    v_add_f32 v139, v139, v213
    ds_read_b128 a[252:255], v218 offset:1024
    v_mfma_f32_16x16x32_bf16 v[148:151], v[244:247], v[68:71], v[148:151]
    s_mov_b32 s32, s33
    ds_read_b128 v[240:243], v217 offset:2048
    s_mov_b32 s33, s34
    v_mfma_f32_16x16x32_bf16 v[152:155], v[244:247], v[92:95], v[152:155]
    v_add_f32 v140, v140, v197
    v_add_f32 v141, v141, v197
    v_mfma_f32_16x16x32_bf16 v[156:159], v[244:247], v[116:119], v[156:159]
    s_waitcnt lgkmcnt(4)
    s_barrier
    v_add_f32 v144, v144, v201
    v_mfma_f32_16x16x32_bf16 v[120:123], a[240:243], v[0:3], v[196:199]
    buffer_load_dwordx4 v216, s[12:15], s30 offen nt lds
    v_mfma_f32_16x16x32_bf16 v[124:127], a[240:243], v[24:27], v[200:203]
    buffer_load_dwordx4 v216, s[12:15], s30 offen offset:3072 nt lds
    v_mfma_f32_16x16x32_bf16 v[128:131], a[240:243], v[48:51], v[204:207]
    s_add_u32 m0, s34, 896
    v_exp_f32 v140, v140
    v_mfma_f32_16x16x32_bf16 v[132:135], a[240:243], v[72:75], v[208:211]
    buffer_load_dwordx4 v216, s[12:15], s30 offen offset:128 nt lds
    v_mfma_f32_16x16x32_bf16 v[136:139], a[240:243], v[96:99], v[212:215]
    s_waitcnt lgkmcnt(3)
    buffer_load_dwordx4 v216, s[12:15], s30 offen offset:3200 nt lds
    v_mfma_f32_16x16x32_bf16 v[120:123], a[244:247], v[4:7], v[120:123]
    s_add_u32 m0, s34, 1792
    v_exp_f32 v144, v144
    v_mfma_f32_16x16x32_bf16 v[124:127], a[244:247], v[28:31], v[124:127]
    s_mov_b32 s34, s46
    buffer_load_dwordx4 v216, s[12:15], s30 offen offset:256 nt lds
    v_mfma_f32_16x16x32_bf16 v[128:131], a[244:247], v[52:55], v[128:131]
    buffer_load_dwordx4 v216, s[12:15], s30 offen offset:3328 nt lds
    v_mfma_f32_16x16x32_bf16 v[132:135], a[244:247], v[76:79], v[132:135]
    s_add_u32 m0, s39, 0
    v_add_f32 v145, v145, v201
    v_add_f32 v148, v148, v205
    v_mfma_f32_16x16x32_bf16 v[136:139], a[244:247], v[100:103], v[136:139]
    s_waitcnt lgkmcnt(2)
    v_add_f32 v142, v142, v197
    v_add_f32 v146, v146, v201
    v_mfma_f32_16x16x32_bf16 v[120:123], a[248:251], v[8:11], v[120:123]
    s_add_u32 s30, s30, 12288
    v_exp_f32 v141, v141
    v_mfma_f32_16x16x32_bf16 v[124:127], a[248:251], v[32:35], v[124:127]
    v_add_f32 v230, v230, v140
    v_add_f32 v231, v231, v144
    v_mfma_f32_16x16x32_bf16 v[128:131], a[248:251], v[56:59], v[128:131]
    v_exp_f32 v145, v145
    v_mfma_f32_16x16x32_bf16 v[132:135], a[248:251], v[80:83], v[132:135]
    v_exp_f32 v148, v148
    v_mfma_f32_16x16x32_bf16 v[136:139], a[248:251], v[104:107], v[136:139]
    s_waitcnt lgkmcnt(1)
    v_add_f32 v149, v149, v205
    v_add_f32 v152, v152, v209
    v_mfma_f32_16x16x32_bf16 v[120:123], a[252:255], v[12:15], v[120:123]
    v_add_f32 v143, v143, v197
    v_add_f32 v147, v147, v201
    v_mfma_f32_16x16x32_bf16 v[124:127], a[252:255], v[36:39], v[124:127]
    v_exp_f32 v142, v142
    v_mfma_f32_16x16x32_bf16 v[128:131], a[252:255], v[60:63], v[128:131]
    v_exp_f32 v146, v146
    v_mfma_f32_16x16x32_bf16 v[132:135], a[252:255], v[84:87], v[132:135]
    v_add_f32 v230, v230, v141
    v_add_f32 v231, v231, v145
    v_mfma_f32_16x16x32_bf16 v[136:139], a[252:255], v[108:111], v[136:139]
    s_waitcnt lgkmcnt(0)
    v_add_f32 v150, v150, v205
    v_add_f32 v232, v232, v148
    v_mfma_f32_16x16x32_bf16 v[120:123], v[240:243], v[16:19], v[120:123]
    v_exp_f32 v149, v149
    v_mfma_f32_16x16x32_bf16 v[124:127], v[240:243], v[40:43], v[124:127]
    v_exp_f32 v152, v152
    v_mfma_f32_16x16x32_bf16 v[128:131], v[240:243], v[64:67], v[128:131]
    v_add_f32 v153, v153, v209
    v_add_f32 v230, v230, v142
    v_mfma_f32_16x16x32_bf16 v[132:135], v[240:243], v[88:91], v[132:135]
    v_exp_f32 v143, v143
    v_mfma_f32_16x16x32_bf16 v[136:139], v[240:243], v[112:115], v[136:139]
    s_waitcnt vmcnt(18)
    s_barrier
    v_exp_f32 v147, v147
    v_add_f32 v231, v231, v146
    v_exp_f32 v150, v150
    v_add_f32 v151, v151, v205
    v_add_f32 v232, v232, v149
    v_add_f32 v154, v154, v209
    v_exp_f32 v153, v153
    v_add_f32 v233, v233, v152
    v_add_f32 v230, v230, v143
    v_add_f32 v231, v231, v147
    v_exp_f32 v151, v151
    v_add_f32 v232, v232, v150
    v_add_f32 v155, v155, v209
    v_exp_f32 v154, v154
    v_add_f32 v233, v233, v153
    s_cmp_ge_u32 s30, 196608
    s_cselect_b32 s30, 6144, s30
    v_add_f32 v232, v232, v151
    ds_read_b128 v[244:247], v218 offset:2048
    v_exp_f32 v155, v155
    v_add_f32 v233, v233, v154
    ds_read_b128 a[240:243], v217 offset:6144
    ds_read_b128 a[244:247], v218 offset:6144
    ds_read_b128 a[248:251], v217 offset:7168
    v_cvt_pk_bf16_f32 v162, v140, v141
    v_cvt_pk_bf16_f32 v163, v142, v143
    v_cvt_pk_bf16_f32 v166, v144, v145
    v_cvt_pk_bf16_f32 v167, v146, v147
    v_add_f32 v233, v233, v155
    v_cvt_pk_bf16_f32 v170, v148, v149
    v_cvt_pk_bf16_f32 v171, v150, v151
    ds_read_b128 a[252:255], v218 offset:7168
    v_cvt_pk_bf16_f32 v174, v152, v153
    v_cvt_pk_bf16_f32 v175, v154, v155
    ds_read_b128 v[240:243], v217 offset:8192
    v_add_f32 v156, v156, v213
    v_add_f32 v157, v157, v213
    v_add_f32 v158, v158, v213
    v_add_f32 v159, v159, v213
    v_add_u32 v217, s36, v217
    s_waitcnt lgkmcnt(5)
    v_mfma_f32_16x16x32_bf16 v[120:123], v[244:247], v[20:23], v[120:123]
    buffer_load_dwordx4 v216, s[16:19], s31 offen nt lds
    v_mfma_f32_16x16x32_bf16 v[124:127], v[244:247], v[44:47], v[124:127]
    v_mfma_f32_16x16x32_bf16 v[128:131], v[244:247], v[68:71], v[128:131]
    buffer_load_dwordx4 v216, s[16:19], s31 offen offset:3072 nt lds
    v_mfma_f32_16x16x32_bf16 v[132:135], v[244:247], v[92:95], v[132:135]
    s_add_u32 m0, s39, 896
    v_exp_f32 v120, v120
    v_mfma_f32_16x16x32_bf16 v[136:139], v[244:247], v[116:119], v[136:139]
    s_waitcnt lgkmcnt(4)
    buffer_load_dwordx4 v216, s[16:19], s31 offen offset:128 nt lds
    v_mfma_f32_16x16x32_bf16 v[140:143], a[240:243], v[0:3], v[196:199]
    v_exp_f32 v124, v124
    v_mfma_f32_16x16x32_bf16 v[144:147], a[240:243], v[24:27], v[200:203]
    buffer_load_dwordx4 v216, s[16:19], s31 offen offset:3200 nt lds
    v_mfma_f32_16x16x32_bf16 v[148:151], a[240:243], v[48:51], v[204:207]
    s_add_u32 m0, s39, 1792
    v_exp_f32 v121, v121
    v_mfma_f32_16x16x32_bf16 v[152:155], a[240:243], v[72:75], v[208:211]
    s_add_u32 s39, s33, s35
    buffer_load_dwordx4 v216, s[16:19], s31 offen offset:256 nt lds
    v_mfma_f32_16x16x32_bf16 v[156:159], a[240:243], v[96:99], v[212:215]
    s_waitcnt lgkmcnt(3)
    v_exp_f32 v125, v125
    v_mfma_f32_16x16x32_bf16 v[140:143], a[244:247], v[4:7], v[140:143]
    buffer_load_dwordx4 v216, s[16:19], s31 offen offset:3328 nt lds
    v_mfma_f32_16x16x32_bf16 v[144:147], a[244:247], v[28:31], v[144:147]
    s_add_u32 m0, s46, 0
    v_add_f32 v230, v230, v120
    v_add_f32 v231, v231, v124
    v_mfma_f32_16x16x32_bf16 v[148:151], a[244:247], v[52:55], v[148:151]
    s_add_u32 s31, s31, 12288
    v_exp_f32 v128, v128
    v_mfma_f32_16x16x32_bf16 v[152:155], a[244:247], v[76:79], v[152:155]
    v_exp_f32 v122, v122
    v_mfma_f32_16x16x32_bf16 v[156:159], a[244:247], v[100:103], v[156:159]
    s_waitcnt lgkmcnt(2)
    v_exp_f32 v126, v126
    v_mfma_f32_16x16x32_bf16 v[140:143], a[248:251], v[8:11], v[140:143]
    s_cmp_eq_u32 s43, 0
    s_cselect_b32 s14, 0, s14
    v_mfma_f32_16x16x32_bf16 v[144:147], a[248:251], v[32:35], v[144:147]
    v_add_f32 v230, v230, v121
    v_add_f32 v231, v231, v125
    v_mfma_f32_16x16x32_bf16 v[148:151], a[248:251], v[56:59], v[148:151]
    v_exp_f32 v129, v129
    v_mfma_f32_16x16x32_bf16 v[152:155], a[248:251], v[80:83], v[152:155]
    v_add_f32 v232, v232, v128
    ds_read_b128 v[244:247], v218 offset:8192
    v_mfma_f32_16x16x32_bf16 v[156:159], a[248:251], v[104:107], v[156:159]
    s_waitcnt lgkmcnt(2)
    v_exp_f32 v132, v132
    v_mfma_f32_16x16x32_bf16 v[140:143], a[252:255], v[12:15], v[140:143]
    v_exp_f32 v123, v123
    v_mfma_f32_16x16x32_bf16 v[144:147], a[252:255], v[36:39], v[144:147]
    v_add_f32 v230, v230, v122
    ds_read_b64_tr_b16 a[240:241], v219 offset:0
    v_mfma_f32_16x16x32_bf16 v[148:151], a[252:255], v[60:63], v[148:151]
    v_exp_f32 v127, v127
    v_mfma_f32_16x16x32_bf16 v[152:155], a[252:255], v[84:87], v[152:155]
    v_exp_f32 v130, v130
    v_mfma_f32_16x16x32_bf16 v[156:159], a[252:255], v[108:111], v[156:159]
    s_waitcnt lgkmcnt(2)
    v_add_f32 v231, v231, v126
    v_add_f32 v232, v232, v129
    v_mfma_f32_16x16x32_bf16 v[140:143], v[240:243], v[16:19], v[140:143]
    ds_read_b64_tr_b16 a[242:243], v219 offset:6144
    v_add_f32 v233, v233, v132
    v_mfma_f32_16x16x32_bf16 v[144:147], v[240:243], v[40:43], v[144:147]
    v_exp_f32 v133, v133
    v_mfma_f32_16x16x32_bf16 v[148:151], v[240:243], v[64:67], v[148:151]
    ds_read_b64_tr_b16 a[244:245], v220 offset:0
    ds_read_b64_tr_b16 a[246:247], v220 offset:6144
    v_mfma_f32_16x16x32_bf16 v[152:155], v[240:243], v[88:91], v[152:155]
    ds_read_b64_tr_b16 a[248:249], v221 offset:0
    ds_read_b64_tr_b16 a[250:251], v221 offset:6144
    v_mfma_f32_16x16x32_bf16 v[156:159], v[240:243], v[112:115], v[156:159]
    s_waitcnt lgkmcnt(6)
    v_add_f32 v230, v230, v123
    v_add_f32 v231, v231, v127
    v_mfma_f32_16x16x32_bf16 v[140:143], v[244:247], v[20:23], v[140:143]
    v_exp_f32 v131, v131
    v_mfma_f32_16x16x32_bf16 v[144:147], v[244:247], v[44:47], v[144:147]
    v_add_f32 v232, v232, v130
    v_add_f32 v233, v233, v133
    v_mfma_f32_16x16x32_bf16 v[148:151], v[244:247], v[68:71], v[148:151]
    v_exp_f32 v134, v134
    v_mfma_f32_16x16x32_bf16 v[152:155], v[244:247], v[92:95], v[152:155]
    v_exp_f32 v140, v140
    v_mfma_f32_16x16x32_bf16 v[156:159], v[244:247], v[116:119], v[156:159]
    s_waitcnt lgkmcnt(4)
    v_exp_f32 v144, v144
    v_mfma_f32_16x16x32_bf16 a[0:3], a[240:243], v[160:163], 0
    ds_read_b64_tr_b16 a[252:253], v222 offset:0
    ds_read_b64_tr_b16 a[254:255], v222 offset:6144
    v_mfma_f32_16x16x32_bf16 a[48:51], a[240:243], v[164:167], 0
    ds_read_b64_tr_b16 v[240:241], v219 offset:1024
    ds_read_b64_tr_b16 v[242:243], v219 offset:7168
    v_mfma_f32_16x16x32_bf16 a[96:99], a[240:243], v[168:171], 0
    ds_read_b64_tr_b16 v[244:245], v220 offset:1024
    ds_read_b64_tr_b16 v[246:247], v220 offset:7168
    v_mfma_f32_16x16x32_bf16 a[144:147], a[240:243], v[172:175], 0
    s_waitcnt lgkmcnt(8)
    v_exp_f32 v141, v141
    v_mfma_f32_16x16x32_bf16 a[4:7], a[244:247], v[160:163], 0
    ds_read_b64_tr_b16 a[240:241], v221 offset:1024
    ds_read_b64_tr_b16 a[242:243], v221 offset:7168
    v_mfma_f32_16x16x32_bf16 a[52:55], a[244:247], v[164:167], 0
    v_exp_f32 v145, v145
    v_mfma_f32_16x16x32_bf16 a[100:103], a[244:247], v[168:171], 0
    v_add_f32 v230, v230, v140
    v_add_f32 v231, v231, v144
    v_mfma_f32_16x16x32_bf16 a[148:151], a[244:247], v[172:175], 0
    s_waitcnt lgkmcnt(8)
    v_exp_f32 v148, v148
    v_mfma_f32_16x16x32_bf16 a[8:11], a[248:251], v[160:163], 0
    v_add_f32 v232, v232, v131
    v_add_f32 v233, v233, v134
    v_mfma_f32_16x16x32_bf16 a[56:59], a[248:251], v[164:167], 0
    v_exp_f32 v135, v135
    v_mfma_f32_16x16x32_bf16 a[104:107], a[248:251], v[168:171], 0
    ds_read_b64_tr_b16 a[244:245], v222 offset:1024
    ds_read_b64_tr_b16 a[246:247], v222 offset:7168
    v_mfma_f32_16x16x32_bf16 a[152:155], a[248:251], v[172:175], 0
    s_waitcnt lgkmcnt(8)
    ds_read_b64_tr_b16 a[248:249], v219 offset:2048
    ds_read_b64_tr_b16 a[250:251], v219 offset:8192
    v_mfma_f32_16x16x32_bf16 a[12:15], a[252:255], v[160:163], 0
    v_exp_f32 v142, v142
    v_mfma_f32_16x16x32_bf16 a[60:63], a[252:255], v[164:167], 0
    v_exp_f32 v146, v146
    v_mfma_f32_16x16x32_bf16 a[108:111], a[252:255], v[168:171], 0
    v_add_f32 v230, v230, v141
    v_add_f32 v231, v231, v145
    v_mfma_f32_16x16x32_bf16 a[156:159], a[252:255], v[172:175], 0
    s_waitcnt lgkmcnt(8)
    v_exp_f32 v149, v149
    v_mfma_f32_16x16x32_bf16 a[16:19], v[240:243], v[160:163], 0
    v_add_u32 v218, s36, v218
    v_add_f32 v232, v232, v148
    v_mfma_f32_16x16x32_bf16 a[64:67], v[240:243], v[164:167], 0
    v_exp_f32 v152, v152
    v_mfma_f32_16x16x32_bf16 a[112:115], v[240:243], v[168:171], 0
    s_waitcnt vmcnt(18)
    s_barrier
    v_add_f32 v233, v233, v135
    v_mfma_f32_16x16x32_bf16 a[160:163], v[240:243], v[172:175], 0
    s_waitcnt lgkmcnt(6)
    buffer_load_dwordx4 v216, s[12:15], s30 offen nt lds
    v_mfma_f32_16x16x32_bf16 a[20:23], v[244:247], v[160:163], 0
    ds_read_b64_tr_b16 a[252:253], v220 offset:2048
    ds_read_b64_tr_b16 a[254:255], v220 offset:8192
    v_mfma_f32_16x16x32_bf16 a[68:71], v[244:247], v[164:167], 0
    buffer_load_dwordx4 v216, s[12:15], s30 offen offset:3072 nt lds
    v_mfma_f32_16x16x32_bf16 a[116:119], v[244:247], v[168:171], 0
    s_add_u32 m0, s46, 896
    ds_read_b64_tr_b16 v[240:241], v221 offset:2048
    ds_read_b64_tr_b16 v[242:243], v221 offset:8192
    v_mfma_f32_16x16x32_bf16 a[164:167], v[244:247], v[172:175], 0
    s_waitcnt lgkmcnt(8)
    buffer_load_dwordx4 v216, s[12:15], s30 offen offset:128 nt lds
    v_mfma_f32_16x16x32_bf16 a[24:27], a[240:243], v[160:163], 0
    ds_read_b64_tr_b16 v[244:245], v222 offset:2048
    ds_read_b64_tr_b16 v[246:247], v222 offset:8192
    v_mfma_f32_16x16x32_bf16 a[72:75], a[240:243], v[164:167], 0
    s_cmp_ge_u32 s31, 196608
    s_cselect_b32 s31, 6144, s31
    v_mfma_f32_16x16x32_bf16 a[120:123], a[240:243], v[168:171], 0
    buffer_load_dwordx4 v216, s[12:15], s30 offen offset:3200 nt lds
    v_mfma_f32_16x16x32_bf16 a[168:171], a[240:243], v[172:175], 0
    s_waitcnt lgkmcnt(8)
    s_add_u32 m0, s46, 1792
    ds_read_b128 a[240:243], v217 offset:0
    v_mfma_f32_16x16x32_bf16 a[28:31], a[244:247], v[160:163], 0
    s_mov_b32 s46, s32
    buffer_load_dwordx4 v216, s[12:15], s30 offen offset:256 nt lds
    v_mfma_f32_16x16x32_bf16 a[76:79], a[244:247], v[164:167], 0
    buffer_load_dwordx4 v216, s[12:15], s30 offen offset:3328 nt lds
    v_mfma_f32_16x16x32_bf16 a[124:127], a[244:247], v[168:171], 0
    s_add_u32 s30, s30, 12288
    v_exp_f32 v143, v143
    v_mfma_f32_16x16x32_bf16 a[172:175], a[244:247], v[172:175], 0
    s_waitcnt lgkmcnt(7)
    v_exp_f32 v147, v147
    v_mfma_f32_16x16x32_bf16 a[32:35], a[248:251], v[160:163], 0
    s_add_u32 m0, s39, 0
    v_add_f32 v230, v230, v142
    v_add_f32 v231, v231, v146
    v_mfma_f32_16x16x32_bf16 a[80:83], a[248:251], v[164:167], 0
    v_exp_f32 v150, v150
    v_mfma_f32_16x16x32_bf16 a[128:131], a[248:251], v[168:171], 0
    ds_read_b128 a[244:247], v218 offset:0
    v_add_f32 v232, v232, v149
    v_mfma_f32_16x16x32_bf16 a[176:179], a[248:251], v[172:175], 0
    s_waitcnt lgkmcnt(6)
    v_exp_f32 v153, v153
    v_mfma_f32_16x16x32_bf16 a[36:39], a[252:255], v[160:163], 0
    v_add_f32 v233, v233, v152
    ds_read_b128 a[248:251], v217 offset:1024
    v_mfma_f32_16x16x32_bf16 a[84:87], a[252:255], v[164:167], 0
    v_cvt_pk_bf16_f32 v176, v120, v121
    v_cvt_pk_bf16_f32 v177, v122, v123
    v_mfma_f32_16x16x32_bf16 a[132:135], a[252:255], v[168:171], 0
    v_cvt_pk_bf16_f32 v180, v124, v125
    v_cvt_pk_bf16_f32 v181, v126, v127
    v_mfma_f32_16x16x32_bf16 a[180:183], a[252:255], v[172:175], 0
    s_waitcnt lgkmcnt(5)
    v_cvt_pk_bf16_f32 v184, v128, v129
    v_cvt_pk_bf16_f32 v185, v130, v131
    v_mfma_f32_16x16x32_bf16 a[40:43], v[240:243], v[160:163], 0
    v_cvt_pk_bf16_f32 v188, v132, v133
    v_cvt_pk_bf16_f32 v189, v134, v135
    v_mfma_f32_16x16x32_bf16 a[88:91], v[240:243], v[164:167], 0
    v_add_f32 v230, v230, v143
    v_cvt_pk_bf16_f32 v178, v140, v141
    v_mfma_f32_16x16x32_bf16 a[136:139], v[240:243], v[168:171], 0
    v_cvt_pk_bf16_f32 v179, v142, v143
    v_add_f32 v231, v231, v147
    v_mfma_f32_16x16x32_bf16 a[184:187], v[240:243], v[172:175], 0
    s_waitcnt lgkmcnt(3)
    v_cvt_pk_bf16_f32 v182, v144, v145
    v_cvt_pk_bf16_f32 v183, v146, v147
    v_mfma_f32_16x16x32_bf16 a[44:47], v[244:247], v[160:163], 0
    v_exp_f32 v151, v151
    v_mfma_f32_16x16x32_bf16 a[92:95], v[244:247], v[164:167], 0
    v_add_f32 v232, v232, v150
    v_add_f32 v233, v233, v153
    v_mfma_f32_16x16x32_bf16 a[140:143], v[244:247], v[168:171], 0
    v_exp_f32 v154, v154
    v_mfma_f32_16x16x32_bf16 a[188:191], v[244:247], v[172:175], 0
    s_waitcnt lgkmcnt(2)
    ds_read_b128 a[252:255], v218 offset:1024
    ds_read_b128 v[240:243], v217 offset:2048
    ds_read_b128 v[244:247], v218 offset:2048
    s_branch K_aj1
K_fix1:
    s_waitcnt vmcnt(0) lgkmcnt(0)
    s_barrier
    s_lshl_b32 s37, s68, 4
    s_add_u32 s37, s37, s69
    s_and_b32 s36, s100, 7
    s_lshl_b32 s36, s36, 1
    s_add_u32 s36, s36, s25
    s_lshl_b32 s36, s36, 5
    s_add_u32 s36, s36, s37
    s_mul_i32 s36, s36, 196608
    s_add_u32 s12, s54, s36
    s_addc_u32 s13, s55, 0
    s_mov_b32 s15, 0x00020000
    s_add_u32 s16, s56, s36
    s_addc_u32 s17, s57, 0
    s_mov_b32 s19, 0x00020000
    s_mov_b32 s14, 196608
    s_mov_b32 s18, s14
    s_mul_i32 s45, s25, 9216
    s_lshl_b32 s36, s26, 12
    s_add_u32 s44, s45, s36
    s_add_u32 s45, s45, 8192
    s_xor_b32 s75, s68, 1
    s_mul_i32 s30, s26, 6144
    s_mov_b32 s31, s30
    s_cmp_eq_u32 s25, 0
    s_cselect_b32 s38, 0, 151552
    s_mov_b32 s35, -12288
    s_cselect_b32 s35, 12288, s35
    s_lshl_b32 s37, s35, 1
    s_add_u32 s34, s38, s30
    s_add_u32 s32, s34, s37
    s_add_u32 s33, s32, s37
    s_lshl_b32 s47, s24, 13
    s_xor_b32 s48, s47, 0x2000
    s_mul_i32 s36, s25, 6144
    s_add_u32 s36, s36, 73728
    v_mbcnt_lo_u32_b32 v120, -1, 0
    v_mbcnt_hi_u32_b32 v120, -1, v120
    v_lshlrev_b32 v248, 4, v120
    v_add_u32 v229, s36, v248
    v_add_u32 v251, 49152, v248
    v_add_u32 v249, s47, v251
    v_add_u32 v250, s48, v251
    v_lshrrev_b32 v121, 3, v120
    v_and_b32 v122, 7, v120
    v_and_b32 v123, 6, v121
    v_xor_b32 v123, v122, v123
    v_lshlrev_b32 v123, 4, v123
    v_mul_u32_u24 v216, 384, v121
    v_add_u32 v216, v216, v123
    v_and_b32 v121, 15, v120
    v_lshrrev_b32 v122, 4, v120
    v_and_b32 v123, 7, v121
    v_and_b32 v124, 6, v121
    v_xor_b32 v124, v122, v124
    v_lshl_add_u32 v124, v123, 3, v124
    v_lshlrev_b32 v124, 4, v124
    v_xor_b32 v125, 64, v124
    v_lshrrev_b32 v126, 3, v121
    v_mul_u32_u24 v127, 3072, v126
    v_add_u32 v127, s38, v127
    v_add_u32 v217, v127, v124
    v_add_u32 v218, v127, v125
    v_lshlrev_b32 v127, 10, v126
    v_add_u32 v128, s40, v127
    v_add_u32 v225, v128, v124
    v_add_u32 v226, v128, v125
    v_bfe_u32 v123, v120, 2, 2
    v_and_b32 v124, 3, v120
    v_and_b32 v125, 1, v122
    v_lshl_add_u32 v126, v125, 2, v123
    v_and_b32 v127, 6, v126
    v_lshrrev_b32 v128, 1, v124
    v_xor_b32 v127, v127, v128
    v_lshl_add_u32 v127, v126, 3, v127
    v_lshlrev_b32 v127, 4, v127
    v_and_b32 v128, 1, v124
    v_lshl_add_u32 v127, v128, 3, v127
    v_lshrrev_b32 v128, 1, v122
    v_mul_u32_u24 v128, 3072, v128
    s_add_u32 s36, s38, s35
    v_add_u32 v128, s36, v128
    v_xor_b32 v129, 0, v127
    v_add_u32 v219, v128, v129
    v_xor_b32 v129, 32, v127
    v_add_u32 v220, v128, v129
    v_xor_b32 v129, 64, v127
    v_add_u32 v221, v128, v129
    v_xor_b32 v129, 96, v127
    v_add_u32 v222, v128, v129
    v_lshlrev_b32 v127, 2, v125
    v_xor_b32 v127, v127, v124
    v_lshl_add_u32 v127, v123, 3, v127
    v_lshlrev_b32 v127, 4, v127
    v_mul_u32_u24 v128, 3072, v122
    v_add_u32 v128, 36864, v128
    v_add_u32 v227, v128, v127
    v_xor_b32 v127, 64, v127
    v_add_u32 v228, v128, v127
    s_mov_b32 s51, 0
    s_mov_b32 s46, -36864
    s_mov_b32 s42, 0x3dd53b95
    s_mul_i32 s36, s100, 0
    s_mul_i32 s37, s69, 0
    s_add_u32 s36, s36, s37
    s_mul_i32 s37, s25, 0
    s_add_u32 s36, s36, s37
    s_and_b32 s37, s36, 15
    s_mul_i32 s37, s37, 12288
    s_add_u32 s48, s30, s37
    s_mov_b32 s30, s48
    s_mov_b32 s31, s48
    s_add_u32 s38, s44, 0
    buffer_store_dwordx4 v[0:3], v248, s[20:23], s38 offen sc1
    buffer_store_dwordx4 v[24:27], v248, s[20:23], s38 offen offset:1024 sc1
    buffer_store_dwordx4 v[48:51], v248, s[20:23], s38 offen offset:2048 sc1
    buffer_store_dwordx4 v[72:75], v248, s[20:23], s38 offen offset:3072 sc1
    s_add_u32 s38, s44, 18432
    buffer_store_dwordx4 v[4:7], v248, s[20:23], s38 offen sc1
    buffer_store_dwordx4 v[28:31], v248, s[20:23], s38 offen offset:1024 sc1
    buffer_store_dwordx4 v[52:55], v248, s[20:23], s38 offen offset:2048 sc1
    buffer_store_dwordx4 v[76:79], v248, s[20:23], s38 offen offset:3072 sc1
    s_add_u32 s38, s44, 36864
    buffer_store_dwordx4 v[8:11], v248, s[20:23], s38 offen sc1
    buffer_store_dwordx4 v[32:35], v248, s[20:23], s38 offen offset:1024 sc1
    buffer_store_dwordx4 v[56:59], v248, s[20:23], s38 offen offset:2048 sc1
    buffer_store_dwordx4 v[80:83], v248, s[20:23], s38 offen offset:3072 sc1
    s_add_u32 s38, s44, 55296
    buffer_store_dwordx4 v[12:15], v248, s[20:23], s38 offen sc1
    buffer_store_dwordx4 v[36:39], v248, s[20:23], s38 offen offset:1024 sc1
    buffer_store_dwordx4 v[60:63], v248, s[20:23], s38 offen offset:2048 sc1
    buffer_store_dwordx4 v[84:87], v248, s[20:23], s38 offen offset:3072 sc1
    s_add_u32 s38, s44, 73728
    buffer_store_dwordx4 v[16:19], v248, s[20:23], s38 offen sc1
    buffer_store_dwordx4 v[40:43], v248, s[20:23], s38 offen offset:1024 sc1
    buffer_store_dwordx4 v[64:67], v248, s[20:23], s38 offen offset:2048 sc1
    buffer_store_dwordx4 v[88:91], v248, s[20:23], s38 offen offset:3072 sc1
    s_add_u32 s38, s44, 92160
    buffer_store_dwordx4 v[20:23], v248, s[20:23], s38 offen sc1
    buffer_store_dwordx4 v[44:47], v248, s[20:23], s38 offen offset:1024 sc1
    buffer_store_dwordx4 v[68:71], v248, s[20:23], s38 offen offset:2048 sc1
    buffer_store_dwordx4 v[92:95], v248, s[20:23], s38 offen offset:3072 sc1
    s_add_u32 s38, s45, 55296
    buffer_store_dwordx4 v[108:111], v248, s[20:23], s38 offen sc1
    s_add_u32 s38, s45, 73728
    buffer_store_dwordx4 v[112:115], v248, s[20:23], s38 offen sc1
    s_add_u32 s38, s45, 92160
    buffer_store_dwordx4 v[116:119], v248, s[20:23], s38 offen sc1
    v_and_b32 v121, 15, v120
    v_lshrrev_b32 v122, 4, v120
    v_mul_u32_u24 v121, 384, v121
    v_lshl_add_u32 v121, v122, 4, v121
    v_mov_b32 v235, 0xff7fffff
    v_mov_b32 v236, 0xff7fffff
    v_mov_b32 v237, 0xff7fffff
    v_mov_b32 v238, 0xff7fffff
    v_mov_b32 v239, 0xff7fffff
    s_mov_b32 s38, 0
K_fixl1:
    buffer_load_dwordx4 v[160:163], v121, s[12:15], s38 offen offset:0
    buffer_load_dwordx4 v[164:167], v121, s[12:15], s38 offen offset:64
    buffer_load_dwordx4 v[168:171], v121, s[12:15], s38 offen offset:128
    buffer_load_dwordx4 v[172:175], v121, s[12:15], s38 offen offset:192
    buffer_load_dwordx4 v[176:179], v121, s[12:15], s38 offen offset:256
    buffer_load_dwordx4 v[180:183], v121, s[12:15], s38 offen offset:320
    s_waitcnt vmcnt(0)
    v_mfma_f32_16x16x32_bf16 v[124:127], v[160:163], v[0:3], 0
    v_mfma_f32_16x16x32_bf16 v[128:131], v[160:163], v[24:27], 0
    v_mfma_f32_16x16x32_bf16 v[132:135], v[160:163], v[48:51], 0
    v_mfma_f32_16x16x32_bf16 v[136:139], v[160:163], v[72:75], 0
    v_mfma_f32_16x16x32_bf16 v[140:143], v[160:163], v[96:99], 0
    v_mfma_f32_16x16x32_bf16 v[124:127], v[164:167], v[4:7], v[124:127]
    v_mfma_f32_16x16x32_bf16 v[128:131], v[164:167], v[28:31], v[128:131]
    v_mfma_f32_16x16x32_bf16 v[132:135], v[164:167], v[52:55], v[132:135]
    v_mfma_f32_16x16x32_bf16 v[136:139], v[164:167], v[76:79], v[136:139]
    v_mfma_f32_16x16x32_bf16 v[140:143], v[164:167], v[100:103], v[140:143]
    v_mfma_f32_16x16x32_bf16 v[124:127], v[168:171], v[8:11], v[124:127]
    v_mfma_f32_16x16x32_bf16 v[128:131], v[168:171], v[32:35], v[128:131]
    v_mfma_f32_16x16x32_bf16 v[132:135], v[168:171], v[56:59], v[132:135]
    v_mfma_f32_16x16x32_bf16 v[136:139], v[168:171], v[80:83], v[136:139]
    v_mfma_f32_16x16x32_bf16 v[140:143], v[168:171], v[104:107], v[140:143]
    v_mfma_f32_16x16x32_bf16 v[124:127], v[172:175], v[12:15], v[124:127]
    v_mfma_f32_16x16x32_bf16 v[128:131], v[172:175], v[36:39], v[128:131]
    v_mfma_f32_16x16x32_bf16 v[132:135], v[172:175], v[60:63], v[132:135]
    v_mfma_f32_16x16x32_bf16 v[136:139], v[172:175], v[84:87], v[136:139]
    v_mfma_f32_16x16x32_bf16 v[140:143], v[172:175], v[108:111], v[140:143]
    v_mfma_f32_16x16x32_bf16 v[124:127], v[176:179], v[16:19], v[124:127]
    v_mfma_f32_16x16x32_bf16 v[128:131], v[176:179], v[40:43], v[128:131]
    v_mfma_f32_16x16x32_bf16 v[132:135], v[176:179], v[64:67], v[132:135]
    v_mfma_f32_16x16x32_bf16 v[136:139], v[176:179], v[88:91], v[136:139]
    v_mfma_f32_16x16x32_bf16 v[140:143], v[176:179], v[112:115], v[140:143]
    v_mfma_f32_16x16x32_bf16 v[124:127], v[180:183], v[20:23], v[124:127]
    v_mfma_f32_16x16x32_bf16 v[128:131], v[180:183], v[44:47], v[128:131]
    v_mfma_f32_16x16x32_bf16 v[132:135], v[180:183], v[68:71], v[132:135]
    v_mfma_f32_16x16x32_bf16 v[136:139], v[180:183], v[92:95], v[136:139]
    v_mfma_f32_16x16x32_bf16 v[140:143], v[180:183], v[116:119], v[140:143]
    s_nop 15
    v_max3_f32 v235, v235, v124, v125
    v_max3_f32 v235, v235, v126, v127
    v_max3_f32 v236, v236, v128, v129
    v_max3_f32 v236, v236, v130, v131
    v_max3_f32 v237, v237, v132, v133
    v_max3_f32 v237, v237, v134, v135
    v_max3_f32 v238, v238, v136, v137
    v_max3_f32 v238, v238, v138, v139
    v_max3_f32 v239, v239, v140, v141
    v_max3_f32 v239, v239, v142, v143
    s_add_u32 s38, s38, 6144
    s_cmp_lt_u32 s38, 196608
    s_cbranch_scc1 K_fixl1
    s_mov_b32 s72, 0x7f800000
    s_waitcnt vmcnt(0)
    s_barrier
    s_branch K_ra1
K_end:
    s_endpgm
.section .rodata,"a"
.p2align 6
.amdhsa_kernel concat_heads__mha_block_cached__gqa_block_cached__near_ridge_kernel
  .amdhsa_next_free_vgpr 512
  .amdhsa_next_free_sgpr 102
  .amdhsa_accum_offset 256
  .amdhsa_group_segment_fixed_size 0
  .amdhsa_kernarg_size 104
  .amdhsa_user_sgpr_count 2
  .amdhsa_user_sgpr_kernarg_segment_ptr 1
  .amdhsa_system_sgpr_workgroup_id_x 1
.end_amdhsa_kernel
```
